```python
import torch

def _softmax(x, axis=-1):
    return torch.softmax(x, dim=axis)
def _gelu(x):
    return torch.nn.functional.gelu(x, approximate="tanh")
def _silu(x):
    return torch.nn.functional.silu(x)
def _sigmoid(x):
    return torch.sigmoid(x)
def _layernorm(x, axis=-1, eps=1e-5):
    m = x.mean(dim=axis, keepdim=True)
    v = x.var(dim=axis, keepdim=True, unbiased=False)
    return (x - m) / torch.sqrt(v + eps)
def _scatter_add(tgt, idx, src, axis=0):
    return tgt.clone().index_add_(axis, idx, src)
def _segment_sum(src, seg, n):
    out = torch.zeros((n,) + src.shape[1:], dtype=src.dtype)
    return out.index_add_(0, seg, src)
def _pad(x, pw):
    flat = tuple(v for pair in reversed(pw) for v in pair)
    return torch.nn.functional.pad(x, flat)

kernel_name = 'standalone__mha_softmax__near_ridge'

def setup_inputs():

    _w = (lambda a: (lambda t: t.to(torch.bfloat16) if t.is_floating_point() else t)(torch.as_tensor(a)))
    B, H, Sq, Sk, D = 8, 16, 1312, 512, 256
    return {
        "q": _w((lambda *s: torch.randn(*s, dtype=torch.bfloat16) * 0.8)(B, H, Sq, D)),
        "k": _w((lambda *s: torch.randn(*s, dtype=torch.bfloat16) * 0.8)(B, H, Sk, D)),
        "v": _w((lambda *s: torch.randn(*s, dtype=torch.bfloat16) * 0.05)(B, H, Sk, D)),
    }

def reference(q, k, v):
    scale = q.shape[-1] ** -0.5
    scores = torch.einsum("bhqd,bhkd->bhqk", q, k) * scale
    p = _softmax(scores, axis=-1)
    return torch.einsum("bhqk,bhkd->bhqd", p, v)
```

```asm
; @launch grid=(256,1,1) block=(256,1,1) lds=163840
.amdgcn_target "amdgcn-amd-amdhsa--gfx950"
.text
.globl standalone__mha_softmax__near_ridge_kernel
.p2align 12
.p2align 8
.type standalone__mha_softmax__near_ridge_kernel,@function
standalone__mha_softmax__near_ridge_kernel:
    s_cmp_ge_u32 s2, 256
    s_cbranch_scc1 L_end0
    s_load_dwordx2 s[44:45], s[0:1], 0
    s_load_dwordx2 s[12:13], s[0:1], 8
    s_load_dwordx2 s[16:17], s[0:1], 16
    s_load_dwordx2 s[46:47], s[0:1], 24
    s_branch L_go
L_end0:
    s_endpgm
L_go:
    v_lshrrev_b32 v21, 6, v0
    v_and_b32 v0, 63, v0
    v_readfirstlane_b32 s38, v21
    s_mov_b32 s37, 0
    s_and_b32 s42, s2, 7
    s_lshr_b32 s52, s2, 3
    s_lshl_b32 s42, s42, 4
    s_lshr_b32 s72, s52, 2
    s_add_u32 s72, s72, 0
    s_and_b32 s41, s52, 3
    s_add_u32 s72, s72, s42
    s_mul_i32 s73, s72, 671744
    s_lshl_b32 s72, s72, 18
    s_and_b32 s40, s52, 3
    s_lshl_b32 s40, s40, 14
    s_or_b32 s72, s72, s40
    s_lshl_b32 s40, s41, 17
    s_cmp_eq_u32 s41, 5
    s_cselect_b32 s40, 598016, s40
    s_add_u32 s73, s73, s40
    s_mov_b32 s74, 131072
    s_cmp_ge_u32 s41, 4
    s_cselect_b32 s74, 73728, s74
    s_cselect_b32 s75, 3, 4
    s_lshl_b32 s33, s41, 1
    v_lshrrev_b32 v48, 5, v0
    s_lshl_b32 s40, s38, 1
    v_add_u32 v49, s40, v48
    v_lshlrev_b32 v49, 1, v49
    v_and_b32 v50, 31, v0
    v_xor_b32 v51, v50, v49
    v_lshlrev_b32 v51, 4, v51
    v_lshlrev_b32 v49, 9, v48
    v_add_u32 v7, v49, v51
    s_lshl_b32 s30, s38, 12
    v_add_u32 v7, s30, v7
    s_lshl_b32 s31, s38, 13
    v_add_u32 v49, s31, v49
    s_sub_u32 s34, 0, s31
    s_cmp_eq_u32 s75, 3
    s_cselect_b32 s34, s34, 0
    v_lshlrev_b32 v51, 1, v48
    v_xor_b32 v51, v50, v51
    v_lshlrev_b32 v51, 4, v51
    v_add_u32 v9, v49, v51
    s_mul_i32 s54, s38, 24576
    s_add_u32 s54, s54, 65536
    s_mov_b32 s29, s72
    v_xor_b32 v42, 64, v9
    v_xor_b32 v43, 128, v9
    v_xor_b32 v44, 192, v9
    s_getpc_b64 s[60:61]
L_pc:
    s_lshl_b32 s40, s52, 2
    s_add_u32 s40, s40, s38
    s_lshl_b32 s40, s40, 10
    s_min_u32 s40, s40, L_end-L_pc-1024
    s_add_u32 s60, s60, s40
    s_addc_u32 s61, s61, 0
    s_and_b32 s60, s60, -16
    v_lshlrev_b32 v206, 4, v0
    v_mov_b32 v207, s61
    v_add_co_u32 v206, vcc, s60, v206
    s_nop 1
    v_addc_co_u32 v207, vcc, 0, v207, vcc
    global_load_dwordx4 v[208:211], v[206:207], off
    s_waitcnt lgkmcnt(0)
    s_mov_b32 s14, 33554432
    s_mov_b32 s15, 0x20000
    s_mov_b32 s18, 33554432
    s_mov_b32 s19, 0x20000
    s_add_u32 s64, s44, s73
    s_addc_u32 s65, s45, 0
    s_mov_b32 s66, s74
    s_mov_b32 s67, 0x20000
    s_load_dword s26, s[64:65], 0
    s_load_dword s27, s[16:17], s72
    s_add_u32 m0, s30, 0
    s_xor_b32 s48, s29, 0
    buffer_load_dwordx4 v7, s[12:15], s48 offen offset:0 lds
    buffer_load_dwordx4 v7, s[12:15], s48 offen offset:1024 lds
    buffer_load_dwordx4 v7, s[12:15], s48 offen offset:2048 lds
    buffer_load_dwordx4 v7, s[12:15], s48 offen offset:3072 lds
    s_add_u32 m0, s54, 0
    s_mov_b32 s49, 0
    buffer_load_dwordx4 v9, s[64:67], s49 offen offset:0 nt lds
    buffer_load_dwordx4 v42, s[64:67], s49 offen offset:1024 nt lds
    buffer_load_dwordx4 v43, s[64:67], s49 offen offset:2048 nt lds
    buffer_load_dwordx4 v44, s[64:67], s49 offen offset:3072 nt lds
    s_add_u32 m0, s54, 4096
    s_mov_b32 s49, 4096
    buffer_load_dwordx4 v9, s[64:67], s49 offen offset:0 nt lds
    buffer_load_dwordx4 v42, s[64:67], s49 offen offset:1024 nt lds
    buffer_load_dwordx4 v43, s[64:67], s49 offen offset:2048 nt lds
    buffer_load_dwordx4 v44, s[64:67], s49 offen offset:3072 nt lds
    s_add_u32 m0, s30, 16384
    s_xor_b32 s48, s29, 16384
    buffer_load_dwordx4 v7, s[12:15], s48 offen offset:0 lds
    buffer_load_dwordx4 v7, s[12:15], s48 offen offset:1024 lds
    buffer_load_dwordx4 v7, s[12:15], s48 offen offset:2048 lds
    buffer_load_dwordx4 v7, s[12:15], s48 offen offset:3072 lds
    s_add_u32 m0, s54, 8192
    s_mov_b32 s49, 32768
    buffer_load_dwordx4 v9, s[64:67], s49 offen offset:0 nt lds
    buffer_load_dwordx4 v42, s[64:67], s49 offen offset:1024 nt lds
    buffer_load_dwordx4 v43, s[64:67], s49 offen offset:2048 nt lds
    buffer_load_dwordx4 v44, s[64:67], s49 offen offset:3072 nt lds
    s_add_u32 m0, s54, 12288
    s_mov_b32 s49, 36864
    buffer_load_dwordx4 v9, s[64:67], s49 offen offset:0 nt lds
    buffer_load_dwordx4 v42, s[64:67], s49 offen offset:1024 nt lds
    buffer_load_dwordx4 v43, s[64:67], s49 offen offset:2048 nt lds
    buffer_load_dwordx4 v44, s[64:67], s49 offen offset:3072 nt lds
    s_lshr_b32 s76, s52, 2
    s_add_u32 s76, s76, 8
    s_and_b32 s41, s52, 3
    s_add_u32 s76, s76, s42
    s_mul_i32 s77, s76, 671744
    s_lshl_b32 s76, s76, 18
    s_and_b32 s40, s52, 3
    s_lshl_b32 s40, s40, 14
    s_or_b32 s76, s76, s40
    s_lshl_b32 s40, s41, 17
    s_cmp_eq_u32 s41, 5
    s_cselect_b32 s40, 598016, s40
    s_add_u32 s77, s77, s40
    s_mov_b32 s78, 131072
    s_cmp_ge_u32 s41, 4
    s_cselect_b32 s78, 73728, s78
    s_cselect_b32 s79, 3, 4
    s_lshr_b32 s80, s52, 1
    s_and_b32 s41, s52, 1
    s_add_u32 s41, s41, 4
    s_add_u32 s80, s80, s42
    s_mul_i32 s81, s80, 671744
    s_lshl_b32 s80, s80, 18
    s_and_b32 s40, s52, 3
    s_lshl_b32 s40, s40, 14
    s_or_b32 s80, s80, s40
    s_lshl_b32 s40, s41, 17
    s_cmp_eq_u32 s41, 5
    s_cselect_b32 s40, 598016, s40
    s_add_u32 s81, s81, s40
    s_mov_b32 s82, 131072
    s_cmp_ge_u32 s41, 4
    s_cselect_b32 s82, 73728, s82
    s_cselect_b32 s83, 3, 4
    s_mov_b32 s84, 1073741824
    s_mov_b32 s85, 0
    s_mov_b32 s86, 0
    s_mov_b32 s87, 0
    s_mov_b32 s24, 0x3db8aa3b
    s_mov_b32 s25, 0x5f800000
    s_mov_b32 s53, 1073741824
    s_mov_b32 s20, s46
    s_mov_b32 s21, s47
    s_mov_b32 s22, 0
    s_mov_b32 s23, 0x20000
    s_mov_b32 s50, 0
    s_mov_b32 s11, 0
    s_mov_b32 s10, 0
    v_and_b32 v48, 15, v0
    v_and_b32 v49, 6, v48
    v_lshlrev_b32 v49, 11, v49
    v_and_b32_e64 v50, 8, v48
    v_lshl_add_u32 v49, v50, 7, v49
    v_and_b32_e64 v50, 1, v48
    v_lshl_add_u32 v49, v50, 9, v49
    v_and_b32 v50, 7, v0
    v_lshlrev_b32 v50, 1, v50
    v_lshrrev_b32 v51, 4, v0
    v_xor_b32 v51, v51, v50
    v_lshlrev_b32 v50, 4, v51
    v_add_u32 v1, v50, v49
    v_xor_b32_e64 v2, 64, v1
    v_xor_b32 v3, 128, v1
    v_xor_b32 v4, 192, v1
    v_lshl_add_u32 v49, v48, 9, s54
    v_add_u32_e64 v10, v49, v50
    v_bfe_u32 v50, v0, 3, 1
    v_xor_b32 v51, v51, v50
    v_lshlrev_b32 v51, 3, v51
    v_lshl_add_u32 v49, v48, 7, s54
    v_add_u32 v11, v49, v51
    v_lshrrev_b32 v48, 3, v0
    v_and_b32 v49, 7, v0
    v_xor_b32 v49, v49, v48
    v_lshlrev_b32 v49, 4, v49
    s_lshl_b32 s41, s38, 5
    v_xor_b32_e64 v49, s41, v49
    v_lshl_add_u32 v48, v48, 9, s31
    v_add_u32 v12, v48, v49
    v_lshrrev_b32 v48, 2, v0
    v_and_b32 v49, 3, v0
    v_lshlrev_b32 v50, 3, v49
    v_lshl_add_u32 v50, v48, 7, v50
    v_and_b32_e64 v51, 6, v48
    v_lshl_add_u32 v50, v51, 4, v50
    v_xor_b32 v5, s41, v50
    v_xor_b32 v6, 32, v5
    v_xor_b32_e64 v21, 64, v5
    v_xor_b32 v45, 96, v5
    v_lshrrev_b32 v48, 3, v0
    v_and_b32 v51, 6, v48
    v_and_b32 v49, 7, v0
    v_xor_b32 v49, v49, v51
    v_lshlrev_b32_e64 v49, 4, v49
    v_lshl_add_u32 v49, v51, 11, v49
    v_and_b32_e64 v48, 1, v48
    v_lshl_add_u32 v49, v48, 9, v49
    s_lshl_b32 s40, s38, 14
    s_xor_b32 s40, s40, s72
    s_and_b32 s40, s40, 0xc000
    v_add_u32_e64 v8, s40, v49
    v_lshl_add_u32 v0, v0, 4, s54
    v_and_b32 v48, 48, v0
    v_cmp_eq_u32 vcc, 0, v48
    v_mov_b32 v49, 0x3f803f80
    s_nop 1
    v_cndmask_b32 v22, 0, v49, vcc
    v_cndmask_b32 v23, 0, v49, vcc
    v_cndmask_b32 v24, 0, v49, vcc
    v_cndmask_b32 v25, 0, v49, vcc
L_start_4:
    s_nop 0
    s_add_u32 m0, s30, 32768
    s_xor_b32 s48, s29, 32768
    buffer_load_dwordx4 v7, s[12:15], s48 offen offset:0 lds
    buffer_load_dwordx4 v7, s[12:15], s48 offen offset:1024 lds
    buffer_load_dwordx4 v7, s[12:15], s48 offen offset:2048 lds
    buffer_load_dwordx4 v7, s[12:15], s48 offen offset:3072 lds
    s_waitcnt vmcnt(16)
    ds_read_b128 a[0:3], v10 offset:0
    ds_read_b128 a[16:19], v10 offset:256
    v_xor_b32 v46, 64, v10
    ds_read_b128 a[4:7], v46 offset:0
    ds_read_b128 a[20:23], v46 offset:256
    v_xor_b32 v46, 128, v10
    ds_read_b128 a[8:11], v46 offset:0
    ds_read_b128 a[24:27], v46 offset:256
    v_xor_b32 v46, 192, v10
    ds_read_b128 a[12:15], v46 offset:0
    ds_read_b128 a[28:31], v46 offset:256
    s_waitcnt vmcnt(12)
    s_barrier
    ds_read_b128 a[128:131], v1 offset:0
    ds_read_b128 a[132:135], v2 offset:0
    ds_read_b128 a[136:139], v3 offset:0
    ds_read_b128 a[140:143], v4 offset:0
    ds_read_b128 a[144:147], v1 offset:256
    ds_read_b128 a[148:151], v2 offset:256
    ds_read_b128 a[152:155], v3 offset:256
    ds_read_b128 a[156:159], v4 offset:256
    ds_read_b128 a[160:163], v1 offset:2048
    ds_read_b128 a[164:167], v2 offset:2048
    ds_read_b128 a[168:171], v3 offset:2048
    ds_read_b128 a[172:175], v4 offset:2048
    ds_read_b128 a[176:179], v1 offset:2304
    ds_read_b128 a[180:183], v2 offset:2304
    ds_read_b128 a[184:187], v3 offset:2304
    ds_read_b128 a[188:191], v4 offset:2304
    ds_read_b128 a[192:195], v1 offset:16384
    ds_read_b128 a[196:199], v2 offset:16384
    ds_read_b128 a[200:203], v3 offset:16384
    ds_read_b128 a[204:207], v4 offset:16384
    ds_read_b128 a[208:211], v1 offset:16640
    ds_read_b128 a[212:215], v2 offset:16640
    ds_read_b128 a[216:219], v3 offset:16640
    ds_read_b128 a[220:223], v4 offset:16640
    ds_read_b128 a[224:227], v1 offset:18432
    ds_read_b128 a[228:231], v2 offset:18432
    ds_read_b128 a[232:235], v3 offset:18432
    ds_read_b128 a[236:239], v4 offset:18432
    ds_read_b128 a[240:243], v1 offset:18688
    ds_read_b128 a[244:247], v2 offset:18688
    ds_read_b128 a[248:251], v3 offset:18688
    ds_read_b128 a[252:255], v4 offset:18688
    s_waitcnt lgkmcnt(0)
    v_mfma_f32_16x16x32_bf16 v[48:51], a[128:131], a[0:3], 0
    v_mfma_f32_16x16x32_bf16 v[48:51], a[132:135], a[4:7], v[48:51]
    s_add_u32 m0, s54, 16384
    s_add_u32 s49, s34, 65536
    buffer_load_dwordx4 v9, s[64:67], s49 offen offset:0 nt lds
    v_mfma_f32_16x16x32_bf16 v[48:51], a[136:139], a[8:11], v[48:51]
    v_mfma_f32_16x16x32_bf16 v[48:51], a[140:143], a[12:15], v[48:51]
    v_mfma_f32_16x16x32_bf16 v[48:51], a[144:147], a[16:19], v[48:51]
    v_mfma_f32_16x16x32_bf16 v[48:51], a[148:151], a[20:23], v[48:51]
    v_mfma_f32_16x16x32_bf16 v[48:51], a[152:155], a[24:27], v[48:51]
    v_mfma_f32_16x16x32_bf16 v[48:51], a[156:159], a[28:31], v[48:51]
    v_mfma_f32_16x16x32_bf16 v[52:55], a[160:163], a[0:3], 0
    buffer_load_dwordx4 v42, s[64:67], s49 offen offset:1024 nt lds
    v_mfma_f32_16x16x32_bf16 v[52:55], a[164:167], a[4:7], v[52:55]
    v_mfma_f32_16x16x32_bf16 v[52:55], a[168:171], a[8:11], v[52:55]
    v_mfma_f32_16x16x32_bf16 v[52:55], a[172:175], a[12:15], v[52:55]
    v_mfma_f32_16x16x32_bf16 v[52:55], a[176:179], a[16:19], v[52:55]
    v_mfma_f32_16x16x32_bf16 v[52:55], a[180:183], a[20:23], v[52:55]
    v_mfma_f32_16x16x32_bf16 v[52:55], a[184:187], a[24:27], v[52:55]
    v_max3_f32 v13, v48, v49, v50
    v_mfma_f32_16x16x32_bf16 v[52:55], a[188:191], a[28:31], v[52:55]
    buffer_load_dwordx4 v43, s[64:67], s49 offen offset:2048 nt lds
    v_mfma_f32_16x16x32_bf16 v[80:83], a[192:195], a[0:3], 0
    v_max_f32 v13, v13, v51
    v_mfma_f32_16x16x32_bf16 v[80:83], a[196:199], a[4:7], v[80:83]
    v_mov_b32 v26, v13
    v_mfma_f32_16x16x32_bf16 v[80:83], a[200:203], a[8:11], v[80:83]
    v_mfma_f32_16x16x32_bf16 v[80:83], a[204:207], a[12:15], v[80:83]
    v_permlane32_swap_b32 v13, v26
    v_mfma_f32_16x16x32_bf16 v[80:83], a[208:211], a[16:19], v[80:83]
    v_max_f32 v13, v13, v26
    v_mfma_f32_16x16x32_bf16 v[80:83], a[212:215], a[20:23], v[80:83]
    v_mov_b32 v26, v13
    v_mfma_f32_16x16x32_bf16 v[80:83], a[216:219], a[24:27], v[80:83]
    buffer_load_dwordx4 v44, s[64:67], s49 offen offset:3072 nt lds
    v_mfma_f32_16x16x32_bf16 v[80:83], a[220:223], a[28:31], v[80:83]
    v_permlane16_swap_b32 v13, v26
    v_mfma_f32_16x16x32_bf16 v[84:87], a[224:227], a[0:3], 0
    v_max_f32 v13, v13, v26
    v_mfma_f32_16x16x32_bf16 v[84:87], a[228:231], a[4:7], v[84:87]
    v_mul_f32 v13, s24, v13
    v_mfma_f32_16x16x32_bf16 v[84:87], a[232:235], a[8:11], v[84:87]
    v_fma_f32 v48, v48, s24, -v13
    v_fma_f32 v49, v49, s24, -v13
    v_mfma_f32_16x16x32_bf16 v[84:87], a[236:239], a[12:15], v[84:87]
    v_fma_f32 v50, v50, s24, -v13
    v_fma_f32 v51, v51, s24, -v13
    v_mfma_f32_16x16x32_bf16 v[84:87], a[240:243], a[16:19], v[84:87]
    v_exp_f32 v48, v48
    v_mfma_f32_16x16x32_bf16 v[84:87], a[244:247], a[20:23], v[84:87]
    s_add_u32 m0, s54, 20480
    s_add_u32 s49, s34, 69632
    buffer_load_dwordx4 v9, s[64:67], s49 offen offset:0 nt lds
    v_mfma_f32_16x16x32_bf16 v[84:87], a[248:251], a[24:27], v[84:87]
    v_exp_f32 v49, v49
    v_mfma_f32_16x16x32_bf16 v[84:87], a[252:255], a[28:31], v[84:87]
    v_exp_f32 v50, v50
    s_waitcnt vmcnt(5)
    s_barrier
    ds_read_b128 v[176:179], v1 offset:32768
    ds_read_b128 v[180:183], v2 offset:32768
    ds_read_b128 v[184:187], v3 offset:32768
    ds_read_b128 v[188:191], v4 offset:32768
    ds_read_b128 v[192:195], v1 offset:33024
    ds_read_b128 v[196:199], v2 offset:33024
    ds_read_b128 v[200:203], v3 offset:33024
    ds_read_b128 v[204:207], v4 offset:33024
    ds_read_b128 v[208:211], v1 offset:34816
    ds_read_b128 v[212:215], v2 offset:34816
    ds_read_b128 v[216:219], v3 offset:34816
    ds_read_b128 v[220:223], v4 offset:34816
    ds_read_b128 v[224:227], v1 offset:35072
    ds_read_b128 v[228:231], v2 offset:35072
    ds_read_b128 v[232:235], v3 offset:35072
    ds_read_b128 v[236:239], v4 offset:35072
    v_exp_f32_e64 v51, v51
    v_cvt_pk_bf16_f32 v112, v48, v49
    v_cvt_pk_bf16_f32 v113, v50, v51
    v_fma_f32 v52, v52, s24, -v13
    v_fma_f32 v53, v53, s24, -v13
    v_fma_f32 v54, v54, s24, -v13
    v_fma_f32 v55, v55, s24, -v13
    v_exp_f32 v52, v52
    v_exp_f32 v53, v53
    v_exp_f32 v54, v54
    v_exp_f32 v55, v55
    v_cvt_pk_bf16_f32 v114, v52, v53
    v_cvt_pk_bf16_f32 v115, v54, v55
    v_fma_f32 v80, v80, s24, -v13
    v_fma_f32 v81, v81, s24, -v13
    v_fma_f32 v82, v82, s24, -v13
    v_fma_f32 v83, v83, s24, -v13
    v_exp_f32 v80, v80
    s_waitcnt lgkmcnt(0)
    v_mfma_f32_16x16x32_bf16 v[48:51], v[176:179], a[0:3], 0
    v_exp_f32 v81, v81
    v_mfma_f32_16x16x32_bf16 v[48:51], v[180:183], a[4:7], v[48:51]
    v_exp_f32 v82, v82
    v_mfma_f32_16x16x32_bf16 v[48:51], v[184:187], a[8:11], v[48:51]
    v_exp_f32 v83, v83
    v_mfma_f32_16x16x32_bf16 v[48:51], v[188:191], a[12:15], v[48:51]
    v_cvt_pk_bf16_f32 v128, v80, v81
    v_cvt_pk_bf16_f32 v129, v82, v83
    v_mfma_f32_16x16x32_bf16 v[48:51], v[192:195], a[16:19], v[48:51]
    buffer_load_dwordx4 v42, s[64:67], s49 offen offset:1024 nt lds
    v_mfma_f32_16x16x32_bf16 v[48:51], v[196:199], a[20:23], v[48:51]
    v_fma_f32 v84, v84, s24, -v13
    v_fma_f32 v85, v85, s24, -v13
    v_mfma_f32_16x16x32_bf16 v[48:51], v[200:203], a[24:27], v[48:51]
    v_fma_f32 v86, v86, s24, -v13
    v_fma_f32 v87, v87, s24, -v13
    v_mfma_f32_16x16x32_bf16 v[48:51], v[204:207], a[28:31], v[48:51]
    v_exp_f32 v84, v84
    v_mfma_f32_16x16x32_bf16 v[52:55], v[208:211], a[0:3], 0
    v_exp_f32 v85, v85
    v_mfma_f32_16x16x32_bf16 v[52:55], v[212:215], a[4:7], v[52:55]
    v_exp_f32 v86, v86
    v_mfma_f32_16x16x32_bf16 v[52:55], v[216:219], a[8:11], v[52:55]
    v_exp_f32 v87, v87
    v_mfma_f32_16x16x32_bf16 v[52:55], v[220:223], a[12:15], v[52:55]
    buffer_load_dwordx4 v43, s[64:67], s49 offen offset:2048 nt lds
    v_mfma_f32_16x16x32_bf16 v[52:55], v[224:227], a[16:19], v[52:55]
    v_mfma_f32_16x16x32_bf16 v[52:55], v[228:231], a[20:23], v[52:55]
    v_mfma_f32_16x16x32_bf16 v[52:55], v[232:235], a[24:27], v[52:55]
    v_mfma_f32_16x16x32_bf16 v[52:55], v[236:239], a[28:31], v[52:55]
    s_mov_b32 s36, 1
    s_mov_b64 exec, 0
    s_cmp_eq_u32 s38, 0
    s_cbranch_scc1 L_t3_0
    s_cmp_eq_u32 s38, 1
    s_cbranch_scc1 L_t3_1
    s_cmp_eq_u32 s38, 2
    s_cbranch_scc1 L_t3_2
    s_branch L_t3_3
L_tr1_3:
    ds_read_b128 a[32:35], v10 offset:8192
    ds_read_b128 a[48:51], v10 offset:8448
    v_xor_b32_e64 v46, 64, v10
    ds_read_b128 a[36:39], v46 offset:8192
    ds_read_b128 a[52:55], v46 offset:8448
    v_xor_b32 v46, 128, v10
    ds_read_b128 a[40:43], v46 offset:8192
    ds_read_b128 a[56:59], v46 offset:8448
    v_xor_b32 v46, 192, v10
    ds_read_b128 a[44:47], v46 offset:8192
    ds_read_b128 a[60:63], v46 offset:8448
    s_waitcnt lgkmcnt(0)
    v_mfma_f32_16x16x32_bf16 v[56:59], a[128:131], a[32:35], 0
    v_mfma_f32_16x16x32_bf16 v[56:59], a[132:135], a[36:39], v[56:59]
    buffer_load_dwordx4 v44, s[64:67], s49 offen offset:3072 nt lds
    v_mfma_f32_16x16x32_bf16 v[56:59], a[136:139], a[40:43], v[56:59]
    v_mfma_f32_16x16x32_bf16 v[56:59], a[140:143], a[44:47], v[56:59]
    v_mfma_f32_16x16x32_bf16 v[56:59], a[144:147], a[48:51], v[56:59]
    v_mfma_f32_16x16x32_bf16 v[56:59], a[148:151], a[52:55], v[56:59]
    v_mfma_f32_16x16x32_bf16 v[56:59], a[152:155], a[56:59], v[56:59]
    v_mfma_f32_16x16x32_bf16 v[56:59], a[156:159], a[60:63], v[56:59]
    v_mfma_f32_16x16x32_bf16 v[60:63], a[160:163], a[32:35], 0
    s_add_u32 m0, s54, 0
    s_mov_b32 s49, 98304
    buffer_load_dwordx4 v9, s[64:67], s49 offen offset:0 nt lds
    v_mfma_f32_16x16x32_bf16 v[60:63], a[164:167], a[36:39], v[60:63]
    v_mfma_f32_16x16x32_bf16 v[60:63], a[168:171], a[40:43], v[60:63]
    v_mfma_f32_16x16x32_bf16 v[60:63], a[172:175], a[44:47], v[60:63]
    v_mfma_f32_16x16x32_bf16 v[60:63], a[176:179], a[48:51], v[60:63]
    v_max3_f32 v14, v56, v57, v58
    v_mfma_f32_16x16x32_bf16 v[60:63], a[180:183], a[52:55], v[60:63]
    v_max_f32 v14, v14, v59
    v_mfma_f32_16x16x32_bf16 v[60:63], a[184:187], a[56:59], v[60:63]
    v_mov_b32 v30, v14
    v_mfma_f32_16x16x32_bf16 v[60:63], a[188:191], a[60:63], v[60:63]
    buffer_load_dwordx4 v42, s[64:67], s49 offen offset:1024 nt lds
    v_mfma_f32_16x16x32_bf16 v[88:91], a[192:195], a[32:35], 0
    v_permlane32_swap_b32 v14, v30
    v_mfma_f32_16x16x32_bf16 v[88:91], a[196:199], a[36:39], v[88:91]
    v_max_f32 v14, v14, v30
    v_mfma_f32_16x16x32_bf16 v[88:91], a[200:203], a[40:43], v[88:91]
    v_mov_b32 v30, v14
    v_mfma_f32_16x16x32_bf16 v[88:91], a[204:207], a[44:47], v[88:91]
    v_mfma_f32_16x16x32_bf16 v[88:91], a[208:211], a[48:51], v[88:91]
    v_permlane16_swap_b32 v14, v30
    v_mfma_f32_16x16x32_bf16 v[88:91], a[212:215], a[52:55], v[88:91]
    v_max_f32 v14, v14, v30
    v_mfma_f32_16x16x32_bf16 v[88:91], a[216:219], a[56:59], v[88:91]
    buffer_load_dwordx4 v43, s[64:67], s49 offen offset:2048 nt lds
    v_mfma_f32_16x16x32_bf16 v[88:91], a[220:223], a[60:63], v[88:91]
    v_mul_f32 v14, s24, v14
    v_mfma_f32_16x16x32_bf16 v[92:95], a[224:227], a[32:35], 0
    v_fma_f32 v56, v56, s24, -v14
    v_fma_f32 v57, v57, s24, -v14
    v_mfma_f32_16x16x32_bf16 v[92:95], a[228:231], a[36:39], v[92:95]
    v_fma_f32 v58, v58, s24, -v14
    v_fma_f32 v59, v59, s24, -v14
    v_mfma_f32_16x16x32_bf16 v[92:95], a[232:235], a[40:43], v[92:95]
    v_exp_f32 v56, v56
    v_mfma_f32_16x16x32_bf16 v[92:95], a[236:239], a[44:47], v[92:95]
    v_exp_f32 v57, v57
    v_mfma_f32_16x16x32_bf16 v[92:95], a[240:243], a[48:51], v[92:95]
    v_exp_f32 v58, v58
    v_mfma_f32_16x16x32_bf16 v[92:95], a[244:247], a[52:55], v[92:95]
    buffer_load_dwordx4 v44, s[64:67], s49 offen offset:3072 nt lds
    v_mfma_f32_16x16x32_bf16 v[92:95], a[248:251], a[56:59], v[92:95]
    v_exp_f32 v59, v59
    v_mfma_f32_16x16x32_bf16 v[92:95], a[252:255], a[60:63], v[92:95]
    v_cvt_pk_bf16_f32 v116, v56, v57
    v_cvt_pk_bf16_f32 v117, v58, v59
    v_mfma_f32_16x16x32_bf16 v[56:59], v[176:179], a[32:35], 0
    v_fma_f32 v60, v60, s24, -v14
    v_fma_f32 v61, v61, s24, -v14
    v_mfma_f32_16x16x32_bf16 v[56:59], v[180:183], a[36:39], v[56:59]
    v_fma_f32 v62, v62, s24, -v14
    v_fma_f32 v63, v63, s24, -v14
    v_mfma_f32_16x16x32_bf16 v[56:59], v[184:187], a[40:43], v[56:59]
    v_exp_f32 v60, v60
    v_mfma_f32_16x16x32_bf16 v[56:59], v[188:191], a[44:47], v[56:59]
    v_exp_f32 v61, v61
    v_mfma_f32_16x16x32_bf16 v[56:59], v[192:195], a[48:51], v[56:59]
    s_add_u32 m0, s54, 4096
    s_mov_b32 s49, 102400
    buffer_load_dwordx4 v9, s[64:67], s49 offen offset:0 nt lds
    v_mfma_f32_16x16x32_bf16 v[56:59], v[196:199], a[52:55], v[56:59]
    v_exp_f32 v62, v62
    v_mfma_f32_16x16x32_bf16 v[56:59], v[200:203], a[56:59], v[56:59]
    v_exp_f32 v63, v63
    v_mfma_f32_16x16x32_bf16 v[56:59], v[204:207], a[60:63], v[56:59]
    v_cvt_pk_bf16_f32 v118, v60, v61
    v_cvt_pk_bf16_f32 v119, v62, v63
    v_mfma_f32_16x16x32_bf16 v[60:63], v[208:211], a[32:35], 0
    v_fma_f32 v88, v88, s24, -v14
    v_fma_f32 v89, v89, s24, -v14
    v_mfma_f32_16x16x32_bf16 v[60:63], v[212:215], a[36:39], v[60:63]
    v_fma_f32 v90, v90, s24, -v14
    v_fma_f32 v91, v91, s24, -v14
    v_mfma_f32_16x16x32_bf16 v[60:63], v[216:219], a[40:43], v[60:63]
    v_exp_f32 v88, v88
    v_mfma_f32_16x16x32_bf16 v[60:63], v[220:223], a[44:47], v[60:63]
    buffer_load_dwordx4 v42, s[64:67], s49 offen offset:1024 nt lds
    v_mfma_f32_16x16x32_bf16 v[60:63], v[224:227], a[48:51], v[60:63]
    v_exp_f32 v89, v89
    v_mfma_f32_16x16x32_bf16 v[60:63], v[228:231], a[52:55], v[60:63]
    v_exp_f32 v90, v90
    v_mfma_f32_16x16x32_bf16 v[60:63], v[232:235], a[56:59], v[60:63]
    v_exp_f32 v91, v91
    v_mfma_f32_16x16x32_bf16 v[60:63], v[236:239], a[60:63], v[60:63]
    v_cvt_pk_bf16_f32 v132, v88, v89
    v_cvt_pk_bf16_f32 v133, v90, v91
    buffer_load_dwordx4 v43, s[64:67], s49 offen offset:2048 nt lds
    buffer_load_dwordx4 v44, s[64:67], s49 offen offset:3072 nt lds
    s_mov_b32 s29, s72
    s_mov_b32 s28, s76
    s_add_u32 s64, s44, s77
    s_addc_u32 s65, s45, 0
    s_mov_b32 s66, s78
    s_sub_u32 s34, 0, s31
    s_cmp_eq_u32 s79, 3
    s_cselect_b32 s34, s34, 0
    s_mov_b32 s36, 2
    s_mov_b64 exec, 0
    s_cmp_eq_u32 s38, 0
    s_cbranch_scc1 L_t4_0
    s_cmp_eq_u32 s38, 1
    s_cbranch_scc1 L_t4_1
    s_cmp_eq_u32 s38, 2
    s_cbranch_scc1 L_t4_2
    s_branch L_t4_3
L_tr2_4:
    s_waitcnt vmcnt(8)
    ds_read_b128 a[64:67], v10 offset:16384
    ds_read_b128 a[80:83], v10 offset:16640
    v_xor_b32_e64 v46, 64, v10
    ds_read_b128 a[68:71], v46 offset:16384
    ds_read_b128 a[84:87], v46 offset:16640
    v_xor_b32 v46, 128, v10
    ds_read_b128 a[72:75], v46 offset:16384
    ds_read_b128 a[88:91], v46 offset:16640
    v_xor_b32 v46, 192, v10
    ds_read_b128 a[76:79], v46 offset:16384
    ds_read_b128 a[92:95], v46 offset:16640
    s_waitcnt lgkmcnt(0)
    v_mfma_f32_16x16x32_bf16 v[64:67], a[128:131], a[64:67], 0
    v_mfma_f32_16x16x32_bf16 v[64:67], a[132:135], a[68:71], v[64:67]
    s_add_u32 m0, s30, 49152
    s_xor_b32 s48, s29, 49152
    buffer_load_dwordx4 v7, s[12:15], s48 offen offset:0 lds
    v_mfma_f32_16x16x32_bf16 v[64:67], a[136:139], a[72:75], v[64:67]
    v_mfma_f32_16x16x32_bf16 v[64:67], a[140:143], a[76:79], v[64:67]
    v_mfma_f32_16x16x32_bf16 v[64:67], a[144:147], a[80:83], v[64:67]
    v_mfma_f32_16x16x32_bf16 v[64:67], a[148:151], a[84:87], v[64:67]
    buffer_load_dwordx4 v7, s[12:15], s48 offen offset:1024 lds
    v_mfma_f32_16x16x32_bf16 v[64:67], a[152:155], a[88:91], v[64:67]
    v_mfma_f32_16x16x32_bf16 v[64:67], a[156:159], a[92:95], v[64:67]
    v_mfma_f32_16x16x32_bf16 v[68:71], a[160:163], a[64:67], 0
    v_mfma_f32_16x16x32_bf16 v[68:71], a[164:167], a[68:71], v[68:71]
    buffer_load_dwordx4 v7, s[12:15], s48 offen offset:2048 lds
    v_mfma_f32_16x16x32_bf16 v[68:71], a[168:171], a[72:75], v[68:71]
    v_mfma_f32_16x16x32_bf16 v[68:71], a[172:175], a[76:79], v[68:71]
    v_mfma_f32_16x16x32_bf16 v[68:71], a[176:179], a[80:83], v[68:71]
    v_mfma_f32_16x16x32_bf16 v[68:71], a[180:183], a[84:87], v[68:71]
    buffer_load_dwordx4 v7, s[12:15], s48 offen offset:3072 lds
    v_mfma_f32_16x16x32_bf16 v[68:71], a[184:187], a[88:91], v[68:71]
    v_max3_f32 v15, v64, v65, v66
    v_mfma_f32_16x16x32_bf16 v[68:71], a[188:191], a[92:95], v[68:71]
    v_max_f32 v15, v15, v67
    v_mfma_f32_16x16x32_bf16 v[96:99], a[192:195], a[64:67], 0
    v_mov_b32 v34, v15
    v_mfma_f32_16x16x32_bf16 v[96:99], a[196:199], a[68:71], v[96:99]
    s_add_u32 m0, s30, 0
    s_xor_b32 s48, s29, 65536
    buffer_load_dwordx4 v7, s[12:15], s48 offen offset:0 lds
    v_mfma_f32_16x16x32_bf16 v[96:99], a[200:203], a[72:75], v[96:99]
    v_permlane32_swap_b32 v15, v34
    v_mfma_f32_16x16x32_bf16 v[96:99], a[204:207], a[76:79], v[96:99]
    v_max_f32 v15, v15, v34
    v_mfma_f32_16x16x32_bf16 v[96:99], a[208:211], a[80:83], v[96:99]
    v_mov_b32 v34, v15
    v_mfma_f32_16x16x32_bf16 v[96:99], a[212:215], a[84:87], v[96:99]
    buffer_load_dwordx4 v7, s[12:15], s48 offen offset:1024 lds
    v_mfma_f32_16x16x32_bf16 v[96:99], a[216:219], a[88:91], v[96:99]
    v_permlane16_swap_b32 v15, v34
    v_mfma_f32_16x16x32_bf16 v[96:99], a[220:223], a[92:95], v[96:99]
    v_max_f32 v15, v15, v34
    v_mfma_f32_16x16x32_bf16 v[100:103], a[224:227], a[64:67], 0
    v_mul_f32 v15, s24, v15
    v_mfma_f32_16x16x32_bf16 v[100:103], a[228:231], a[68:71], v[100:103]
    buffer_load_dwordx4 v7, s[12:15], s48 offen offset:2048 lds
    v_mfma_f32_16x16x32_bf16 v[100:103], a[232:235], a[72:75], v[100:103]
    v_fma_f32 v64, v64, s24, -v15
    v_fma_f32 v65, v65, s24, -v15
    v_mfma_f32_16x16x32_bf16 v[100:103], a[236:239], a[76:79], v[100:103]
    v_fma_f32 v66, v66, s24, -v15
    v_fma_f32 v67, v67, s24, -v15
    v_mfma_f32_16x16x32_bf16 v[100:103], a[240:243], a[80:83], v[100:103]
    v_exp_f32 v64, v64
    v_mfma_f32_16x16x32_bf16 v[100:103], a[244:247], a[84:87], v[100:103]
    buffer_load_dwordx4 v7, s[12:15], s48 offen offset:3072 lds
    v_mfma_f32_16x16x32_bf16 v[100:103], a[248:251], a[88:91], v[100:103]
    v_exp_f32 v65, v65
    v_mfma_f32_16x16x32_bf16 v[100:103], a[252:255], a[92:95], v[100:103]
    v_exp_f32 v66, v66
    v_exp_f32 v67, v67
    v_cvt_pk_bf16_f32 v120, v64, v65
    v_cvt_pk_bf16_f32 v121, v66, v67
    v_mfma_f32_16x16x32_bf16 v[64:67], v[176:179], a[64:67], 0
    v_fma_f32 v68, v68, s24, -v15
    v_fma_f32 v69, v69, s24, -v15
    v_mfma_f32_16x16x32_bf16 v[64:67], v[180:183], a[68:71], v[64:67]
    s_add_u32 m0, s30, 16384
    s_xor_b32 s48, s29, 81920
    buffer_load_dwordx4 v7, s[12:15], s48 offen offset:0 lds
    v_mfma_f32_16x16x32_bf16 v[64:67], v[184:187], a[72:75], v[64:67]
    v_fma_f32 v70, v70, s24, -v15
    v_fma_f32 v71, v71, s24, -v15
    v_mfma_f32_16x16x32_bf16 v[64:67], v[188:191], a[76:79], v[64:67]
    v_exp_f32 v68, v68
    v_mfma_f32_16x16x32_bf16 v[64:67], v[192:195], a[80:83], v[64:67]
    v_exp_f32 v69, v69
    v_mfma_f32_16x16x32_bf16 v[64:67], v[196:199], a[84:87], v[64:67]
    buffer_load_dwordx4 v7, s[12:15], s48 offen offset:1024 lds
    v_mfma_f32_16x16x32_bf16 v[64:67], v[200:203], a[88:91], v[64:67]
    v_exp_f32 v70, v70
    v_mfma_f32_16x16x32_bf16 v[64:67], v[204:207], a[92:95], v[64:67]
    v_exp_f32 v71, v71
    v_cvt_pk_bf16_f32 v122, v68, v69
    v_cvt_pk_bf16_f32 v123, v70, v71
    v_mfma_f32_16x16x32_bf16 v[68:71], v[208:211], a[64:67], 0
    v_fma_f32 v96, v96, s24, -v15
    v_fma_f32 v97, v97, s24, -v15
    v_mfma_f32_16x16x32_bf16 v[68:71], v[212:215], a[68:71], v[68:71]
    buffer_load_dwordx4 v7, s[12:15], s48 offen offset:2048 lds
    v_mfma_f32_16x16x32_bf16 v[68:71], v[216:219], a[72:75], v[68:71]
    v_fma_f32 v98, v98, s24, -v15
    v_fma_f32 v99, v99, s24, -v15
    v_mfma_f32_16x16x32_bf16 v[68:71], v[220:223], a[76:79], v[68:71]
    v_exp_f32 v96, v96
    v_mfma_f32_16x16x32_bf16 v[68:71], v[224:227], a[80:83], v[68:71]
    v_exp_f32 v97, v97
    v_mfma_f32_16x16x32_bf16 v[68:71], v[228:231], a[84:87], v[68:71]
    buffer_load_dwordx4 v7, s[12:15], s48 offen offset:3072 lds
    v_mfma_f32_16x16x32_bf16 v[68:71], v[232:235], a[88:91], v[68:71]
    v_exp_f32 v98, v98
    v_mfma_f32_16x16x32_bf16 v[68:71], v[236:239], a[92:95], v[68:71]
    v_exp_f32 v99, v99
    s_waitcnt vmcnt(12)
    ds_read_b128 a[96:99], v10 offset:0
    ds_read_b128 a[112:115], v10 offset:256
    v_xor_b32 v46, 64, v10
    ds_read_b128 a[100:103], v46 offset:0
    ds_read_b128 a[116:119], v46 offset:256
    v_xor_b32 v46, 128, v10
    ds_read_b128 a[104:107], v46 offset:0
    ds_read_b128 a[120:123], v46 offset:256
    v_xor_b32 v46, 192, v10
    ds_read_b128 a[108:111], v46 offset:0
    ds_read_b128 a[124:127], v46 offset:256
    v_cvt_pk_bf16_f32 v136, v96, v97
    v_cvt_pk_bf16_f32 v137, v98, v99
    s_waitcnt lgkmcnt(0)
    v_mfma_f32_16x16x32_bf16 v[72:75], a[128:131], a[96:99], 0
    v_mfma_f32_16x16x32_bf16 v[72:75], a[132:135], a[100:103], v[72:75]
    v_mfma_f32_16x16x32_bf16 v[72:75], a[136:139], a[104:107], v[72:75]
    v_mfma_f32_16x16x32_bf16 v[72:75], a[140:143], a[108:111], v[72:75]
    v_mfma_f32_16x16x32_bf16 v[72:75], a[144:147], a[112:115], v[72:75]
    v_mfma_f32_16x16x32_bf16 v[72:75], a[148:151], a[116:119], v[72:75]
    v_mfma_f32_16x16x32_bf16 v[72:75], a[152:155], a[120:123], v[72:75]
    v_mfma_f32_16x16x32_bf16 v[72:75], a[156:159], a[124:127], v[72:75]
    v_mfma_f32_16x16x32_bf16 v[76:79], a[160:163], a[96:99], 0
    v_mfma_f32_16x16x32_bf16 v[76:79], a[164:167], a[100:103], v[76:79]
    v_mfma_f32_16x16x32_bf16 v[76:79], a[168:171], a[104:107], v[76:79]
    v_mfma_f32_16x16x32_bf16 v[76:79], a[172:175], a[108:111], v[76:79]
    v_mfma_f32_16x16x32_bf16 v[76:79], a[176:179], a[112:115], v[76:79]
    v_mfma_f32_16x16x32_bf16 v[76:79], a[180:183], a[116:119], v[76:79]
    v_mfma_f32_16x16x32_bf16 v[76:79], a[184:187], a[120:123], v[76:79]
    v_mfma_f32_16x16x32_bf16 v[76:79], a[188:191], a[124:127], v[76:79]
    v_max3_f32 v16, v72, v73, v74
    v_mfma_f32_16x16x32_bf16 v[104:107], a[192:195], a[96:99], 0
    v_max_f32 v16, v16, v75
    v_mfma_f32_16x16x32_bf16 v[104:107], a[196:199], a[100:103], v[104:107]
    v_mov_b32 v38, v16
    v_mfma_f32_16x16x32_bf16 v[104:107], a[200:203], a[104:107], v[104:107]
    v_mfma_f32_16x16x32_bf16 v[104:107], a[204:207], a[108:111], v[104:107]
    v_permlane32_swap_b32 v16, v38
    v_mfma_f32_16x16x32_bf16 v[104:107], a[208:211], a[112:115], v[104:107]
    v_max_f32 v16, v16, v38
    v_mfma_f32_16x16x32_bf16 v[104:107], a[212:215], a[116:119], v[104:107]
    v_mov_b32 v38, v16
    v_mfma_f32_16x16x32_bf16 v[104:107], a[216:219], a[120:123], v[104:107]
    v_mfma_f32_16x16x32_bf16 v[104:107], a[220:223], a[124:127], v[104:107]
    v_permlane16_swap_b32 v16, v38
    v_mfma_f32_16x16x32_bf16 v[108:111], a[224:227], a[96:99], 0
    v_max_f32 v16, v16, v38
    v_mfma_f32_16x16x32_bf16 v[108:111], a[228:231], a[100:103], v[108:111]
    v_mul_f32 v16, s24, v16
    v_mfma_f32_16x16x32_bf16 v[108:111], a[232:235], a[104:107], v[108:111]
    v_fma_f32 v72, v72, s24, -v16
    v_fma_f32 v73, v73, s24, -v16
    v_mfma_f32_16x16x32_bf16 v[108:111], a[236:239], a[108:111], v[108:111]
    v_fma_f32 v74, v74, s24, -v16
    v_fma_f32 v75, v75, s24, -v16
    v_mfma_f32_16x16x32_bf16 v[108:111], a[240:243], a[112:115], v[108:111]
    v_exp_f32 v72, v72
    v_mfma_f32_16x16x32_bf16 v[108:111], a[244:247], a[116:119], v[108:111]
    v_exp_f32 v73, v73
    v_mfma_f32_16x16x32_bf16 v[108:111], a[248:251], a[120:123], v[108:111]
    v_exp_f32 v74, v74
    v_mfma_f32_16x16x32_bf16 v[108:111], a[252:255], a[124:127], v[108:111]
    v_exp_f32 v75, v75
    v_cvt_pk_bf16_f32 v124, v72, v73
    v_cvt_pk_bf16_f32 v125, v74, v75
    v_mfma_f32_16x16x32_bf16 v[72:75], v[176:179], a[96:99], 0
    v_fma_f32 v76, v76, s24, -v16
    v_fma_f32 v77, v77, s24, -v16
    v_mfma_f32_16x16x32_bf16 v[72:75], v[180:183], a[100:103], v[72:75]
    v_fma_f32 v78, v78, s24, -v16
    v_fma_f32 v79, v79, s24, -v16
    v_mfma_f32_16x16x32_bf16 v[72:75], v[184:187], a[104:107], v[72:75]
    v_exp_f32 v76, v76
    v_mfma_f32_16x16x32_bf16 v[72:75], v[188:191], a[108:111], v[72:75]
    v_exp_f32 v77, v77
    v_mfma_f32_16x16x32_bf16 v[72:75], v[192:195], a[112:115], v[72:75]
    v_exp_f32 v78, v78
    v_mfma_f32_16x16x32_bf16 v[72:75], v[196:199], a[116:119], v[72:75]
    v_exp_f32 v79, v79
    v_mfma_f32_16x16x32_bf16 v[72:75], v[200:203], a[120:123], v[72:75]
    v_cvt_pk_bf16_f32 v126, v76, v77
    v_cvt_pk_bf16_f32 v127, v78, v79
    v_mfma_f32_16x16x32_bf16 v[72:75], v[204:207], a[124:127], v[72:75]
    v_fma_f32 v104, v104, s24, -v16
    v_fma_f32 v105, v105, s24, -v16
    v_mfma_f32_16x16x32_bf16 v[76:79], v[208:211], a[96:99], 0
    v_fma_f32 v106, v106, s24, -v16
    v_fma_f32 v107, v107, s24, -v16
    v_mfma_f32_16x16x32_bf16 v[76:79], v[212:215], a[100:103], v[76:79]
    v_exp_f32 v104, v104
    v_mfma_f32_16x16x32_bf16 v[76:79], v[216:219], a[104:107], v[76:79]
    v_exp_f32 v105, v105
    v_mfma_f32_16x16x32_bf16 v[76:79], v[220:223], a[108:111], v[76:79]
    v_exp_f32 v106, v106
    v_mfma_f32_16x16x32_bf16 v[76:79], v[224:227], a[112:115], v[76:79]
    v_exp_f32 v107, v107
    v_mfma_f32_16x16x32_bf16 v[76:79], v[228:231], a[116:119], v[76:79]
    v_cvt_pk_bf16_f32 v140, v104, v105
    v_cvt_pk_bf16_f32 v141, v106, v107
    v_mfma_f32_16x16x32_bf16 v[76:79], v[232:235], a[120:123], v[76:79]
    v_mfma_f32_16x16x32_bf16 v[76:79], v[236:239], a[124:127], v[76:79]
    s_waitcnt vmcnt(8)
    s_barrier
    ds_read_b128 a[128:131], v1 offset:49152
    ds_read_b128 a[132:135], v2 offset:49152
    ds_read_b128 a[136:139], v3 offset:49152
    s_waitcnt lgkmcnt(0)
    s_nop 7
    s_branch L_body_4
L_tback4:
    s_mov_b64 exec, -1
    s_cmp_lg_u32 s36, 0
    s_cbranch_scc1 L_tr2_4
.p2align 3
L_tile_4:
    v_mfma_f32_16x16x32_bf16 v[48:51], a[128:131], a[0:3], 0
    s_add_u32 s50, s11, 0
    ds_read_b128 a[140:143], v4 offset:0
    v_xor_b32 v42, 64, v11
    v_mfma_f32_16x16x32_bf16 v[48:51], a[132:135], a[4:7], v[48:51]
    s_waitcnt vmcnt(7)
    v_xor_b32 v43, 96, v11
    v_mul_f32 v80, v80, v17
    v_mfma_f32_16x16x32_bf16 v[56:59], a[128:131], a[32:35], 0
    s_barrier
    v_mul_f32 v81, v81, v17
    v_mul_f32 v82, v82, v17
    v_mfma_f32_16x16x32_bf16 v[56:59], a[132:135], a[36:39], v[56:59]
    s_add_u32 m0, s30, 49152
    v_mul_f32 v83, v83, v17
    v_cvt_pk_bf16_f32 v80, v80, v81
    v_mfma_f32_16x16x32_bf16 v[64:67], a[128:131], a[64:67], 0
    s_xor_b32 s48, s29, 49152
    v_cvt_pk_bf16_f32 v81, v82, v83
    v_mul_f32 v88, v88, v18
    v_mfma_f32_16x16x32_bf16 v[64:67], a[132:135], a[68:71], v[64:67]
L_t4_0:
    s_cbranch_execz L_t4_4
    ds_write_b64 v42, v[80:81] offset:8192
    v_mfma_f32_16x16x32_bf16 v[72:75], a[128:131], a[96:99], 0
    ds_read_b128 a[128:131], v1 offset:256
    v_mul_f32 v89, v89, v18
    v_mfma_f32_16x16x32_bf16 v[72:75], a[132:135], a[100:103], v[72:75]
    s_waitcnt lgkmcnt(2)
    ds_read_b128 a[132:135], v2 offset:256
    v_mul_f32 v90, v90, v18
    v_mfma_f32_16x16x32_bf16 v[48:51], a[136:139], a[8:11], v[48:51]
    buffer_load_dwordx4 v7, s[12:15], s48 offen offset:0 lds
    v_mfma_f32_16x16x32_bf16 v[48:51], a[140:143], a[12:15], v[48:51]
    v_mul_f32 v91, v91, v18
    v_cvt_pk_bf16_f32 v88, v88, v89
    v_mfma_f32_16x16x32_bf16 v[56:59], a[136:139], a[40:43], v[56:59]
    v_cvt_pk_bf16_f32 v89, v90, v91
    v_mul_f32 v96, v96, v19
    v_mfma_f32_16x16x32_bf16 v[56:59], a[140:143], a[44:47], v[56:59]
    ds_write_b64 v42, v[88:89] offset:10240
    v_mfma_f32_16x16x32_bf16 v[64:67], a[136:139], a[72:75], v[64:67]
    buffer_load_dwordx4 v7, s[12:15], s48 offen offset:1024 lds
    v_mfma_f32_16x16x32_bf16 v[64:67], a[140:143], a[76:79], v[64:67]
    v_mul_f32 v97, v97, v19
    v_mul_f32 v98, v98, v19
    v_mfma_f32_16x16x32_bf16 v[72:75], a[136:139], a[104:107], v[72:75]
    ds_read_b128 a[136:139], v3 offset:256
    v_mul_f32 v99, v99, v19
    v_mfma_f32_16x16x32_bf16 v[72:75], a[140:143], a[108:111], v[72:75]
    s_waitcnt lgkmcnt(2)
    ds_read_b128 a[140:143], v4 offset:256
    v_cvt_pk_bf16_f32 v96, v96, v97
    v_mfma_f32_16x16x32_bf16 v[48:51], a[128:131], a[16:19], v[48:51]
    buffer_load_dwordx4 v7, s[12:15], s48 offen offset:2048 lds
    v_mfma_f32_16x16x32_bf16 v[48:51], a[132:135], a[20:23], v[48:51]
    v_cvt_pk_bf16_f32 v97, v98, v99
    v_mul_f32 v104, v104, v20
    v_mfma_f32_16x16x32_bf16 v[56:59], a[128:131], a[48:51], v[56:59]
    ds_write_b64 v42, v[96:97] offset:12288
    v_mfma_f32_16x16x32_bf16 v[56:59], a[132:135], a[52:55], v[56:59]
    v_mul_f32 v105, v105, v20
    v_mul_f32 v106, v106, v20
    v_mfma_f32_16x16x32_bf16 v[64:67], a[128:131], a[80:83], v[64:67]
    buffer_load_dwordx4 v7, s[12:15], s48 offen offset:3072 lds
    v_mfma_f32_16x16x32_bf16 v[64:67], a[132:135], a[84:87], v[64:67]
    v_mul_f32 v107, v107, v20
    v_cvt_pk_bf16_f32 v104, v104, v105
    v_mfma_f32_16x16x32_bf16 v[72:75], a[128:131], a[112:115], v[72:75]
    ds_read_b128 a[128:131], v1 offset:2048
    v_cvt_pk_bf16_f32 v105, v106, v107
    v_mfma_f32_16x16x32_bf16 v[72:75], a[132:135], a[116:119], v[72:75]
    s_waitcnt lgkmcnt(2)
    ds_read_b128 a[132:135], v2 offset:2048
    v_mul_f32 v84, v84, v17
    v_mfma_f32_16x16x32_bf16 v[48:51], a[136:139], a[24:27], v[48:51]
    ds_write_b64 v42, v[104:105] offset:14336
    v_mfma_f32_16x16x32_bf16 v[48:51], a[140:143], a[28:31], v[48:51]
    v_mul_f32 v85, v85, v17
    v_mul_f32 v86, v86, v17
    v_mfma_f32_16x16x32_bf16 v[56:59], a[136:139], a[56:59], v[56:59]
    v_mul_f32 v87, v87, v17
    v_cvt_pk_bf16_f32 v84, v84, v85
    v_mfma_f32_16x16x32_bf16 v[56:59], a[140:143], a[60:63], v[56:59]
    v_cvt_pk_bf16_f32 v85, v86, v87
    v_mul_f32 v92, v92, v18
    v_mfma_f32_16x16x32_bf16 v[64:67], a[136:139], a[88:91], v[64:67]
    ds_write_b64 v43, v[84:85] offset:8192
    v_mfma_f32_16x16x32_bf16 v[64:67], a[140:143], a[92:95], v[64:67]
    v_mul_f32 v93, v93, v18
    v_mul_f32 v94, v94, v18
    v_mfma_f32_16x16x32_bf16 v[72:75], a[136:139], a[120:123], v[72:75]
    ds_read_b128 a[136:139], v3 offset:2048
    v_mul_f32 v95, v95, v18
    v_mfma_f32_16x16x32_bf16 v[72:75], a[140:143], a[124:127], v[72:75]
    s_waitcnt lgkmcnt(3)
    ds_read_b128 a[140:143], v4 offset:2048
    v_cvt_pk_bf16_f32 v92, v92, v93
    v_mfma_f32_16x16x32_bf16 v[52:55], a[128:131], a[0:3], 0
    v_cvt_pk_bf16_f32 v93, v94, v95
    v_mul_f32 v100, v100, v19
    v_mfma_f32_16x16x32_bf16 v[52:55], a[132:135], a[4:7], v[52:55]
    ds_write_b64 v43, v[92:93] offset:10240
    v_mfma_f32_16x16x32_bf16 v[60:63], a[128:131], a[32:35], 0
    v_mul_f32 v101, v101, v19
    v_mul_f32 v102, v102, v19
    v_mfma_f32_16x16x32_bf16 v[60:63], a[132:135], a[36:39], v[60:63]
    v_mul_f32 v103, v103, v19
    v_cvt_pk_bf16_f32 v100, v100, v101
    v_mfma_f32_16x16x32_bf16 v[68:71], a[128:131], a[64:67], 0
    v_cvt_pk_bf16_f32 v101, v102, v103
    v_mul_f32 v108, v108, v20
    v_mfma_f32_16x16x32_bf16 v[68:71], a[132:135], a[68:71], v[68:71]
    ds_write_b64 v43, v[100:101] offset:12288
    v_mfma_f32_16x16x32_bf16 v[76:79], a[128:131], a[96:99], 0
    ds_read_b128 a[128:131], v1 offset:2304
    v_mul_f32 v109, v109, v20
    v_mfma_f32_16x16x32_bf16 v[76:79], a[132:135], a[100:103], v[76:79]
    s_waitcnt lgkmcnt(3)
    ds_read_b128 a[132:135], v2 offset:2304
    v_mul_f32 v110, v110, v20
    v_mfma_f32_16x16x32_bf16 v[52:55], a[136:139], a[8:11], v[52:55]
    v_mul_f32 v111, v111, v20
    v_cvt_pk_bf16_f32 v108, v108, v109
    v_mfma_f32_16x16x32_bf16 v[52:55], a[140:143], a[12:15], v[52:55]
    v_cvt_pk_bf16_f32 v109, v110, v111
    v_max3_f32 v13, v48, v49, v50
    v_mfma_f32_16x16x32_bf16 v[60:63], a[136:139], a[40:43], v[60:63]
    ds_write_b64 v43, v[108:109] offset:14336
    v_mfma_f32_16x16x32_bf16 v[60:63], a[140:143], a[44:47], v[60:63]
    ds_read_b128 v[224:227], v0 offset:8192
    v_max3_f32 v14, v56, v57, v58
    v_mfma_f32_16x16x32_bf16 v[68:71], a[136:139], a[72:75], v[68:71]
    ds_read_b64 v[228:229], v0 offset:9224
    v_max3_f32 v15, v64, v65, v66
    v_mfma_f32_16x16x32_bf16 v[68:71], a[140:143], a[76:79], v[68:71]
    ds_read_b64 v[230:231], v0 offset:9216
    v_max3_f32 v16, v72, v73, v74
    v_mfma_f32_16x16x32_bf16 v[76:79], a[136:139], a[104:107], v[76:79]
    ds_read_b128 a[136:139], v3 offset:2304
    v_max_f32 v13, v13, v51
    v_mfma_f32_16x16x32_bf16 v[76:79], a[140:143], a[108:111], v[76:79]
    s_waitcnt lgkmcnt(5)
    ds_read_b128 a[140:143], v4 offset:2304
    v_max_f32 v14, v14, v59
    v_mfma_f32_16x16x32_bf16 v[52:55], a[128:131], a[16:19], v[52:55]
    ds_read_b128 v[232:235], v0 offset:10240
    v_max_f32 v15, v15, v67
    v_mfma_f32_16x16x32_bf16 v[52:55], a[132:135], a[20:23], v[52:55]
    ds_read_b64 v[236:237], v0 offset:11272
    v_max_f32 v16, v16, v75
    v_mfma_f32_16x16x32_bf16 v[60:63], a[128:131], a[48:51], v[60:63]
    ds_read_b64 v[238:239], v0 offset:11264
    v_mov_b32 v26, v13
    v_mfma_f32_16x16x32_bf16 v[60:63], a[132:135], a[52:55], v[60:63]
    v_mov_b32 v30, v14
    v_mov_b32 v34, v15
    v_mfma_f32_16x16x32_bf16 v[68:71], a[128:131], a[80:83], v[68:71]
    v_permlane32_swap_b32 v13, v26
    v_mfma_f32_16x16x32_bf16 v[68:71], a[132:135], a[84:87], v[68:71]
    v_permlane32_swap_b32 v14, v30
    v_mfma_f32_16x16x32_bf16 v[76:79], a[128:131], a[112:115], v[76:79]
    ds_read_b128 a[128:131], v1 offset:16384
    v_mov_b32 v38, v16
    v_mfma_f32_16x16x32_bf16 v[76:79], a[132:135], a[116:119], v[76:79]
    s_waitcnt lgkmcnt(4)
    ds_read_b128 a[132:135], v2 offset:16384
    v_max_f32 v13, v13, v26
    v_mfma_f32_16x16x32_bf16 v[52:55], a[136:139], a[24:27], v[52:55]
    buffer_store_dwordx4 v[224:227], v12, s[20:23], s50 offen nt
    v_mfma_f32_16x16x32_bf16 v[52:55], a[140:143], a[28:31], v[52:55]
    s_add_u32 s50, s11, 4096
    ds_read_b128 v[224:227], v0 offset:12288
    v_max_f32 v14, v14, v30
    v_mfma_f32_16x16x32_bf16 v[60:63], a[136:139], a[56:59], v[60:63]
    v_permlane32_swap_b32 v15, v34
    v_mfma_f32_16x16x32_bf16 v[60:63], a[140:143], a[60:63], v[60:63]
    v_permlane32_swap_b32 v16, v38
    v_mfma_f32_16x16x32_bf16 v[68:71], a[136:139], a[88:91], v[68:71]
    v_max_f32 v15, v15, v34
    v_max_f32 v16, v16, v38
    v_mfma_f32_16x16x32_bf16 v[68:71], a[140:143], a[92:95], v[68:71]
    v_mov_b32 v26, v13
    v_mov_b32 v30, v14
    v_mfma_f32_16x16x32_bf16 v[76:79], a[136:139], a[120:123], v[76:79]
    ds_read_b128 a[136:139], v3 offset:16384
    v_mov_b32 v34, v15
    v_mfma_f32_16x16x32_bf16 v[76:79], a[140:143], a[124:127], v[76:79]
    s_waitcnt lgkmcnt(2)
    v_permlane16_swap_b32 v13, v26
    v_mfma_f32_16x16x32_bf16 v[80:83], a[128:131], a[0:3], 0
    s_waitcnt vmcnt(6)
    ds_read_b128 a[140:143], v4 offset:16384
    v_mov_b32 v38, v16
    v_mfma_f32_16x16x32_bf16 v[80:83], a[132:135], a[4:7], v[80:83]
    s_barrier
    v_permlane16_swap_b32 v14, v30
    v_mfma_f32_16x16x32_bf16 v[88:91], a[128:131], a[32:35], 0
    s_add_u32 m0, s30, 0
    v_permlane16_swap_b32 v15, v34
    v_mfma_f32_16x16x32_bf16 v[88:91], a[132:135], a[36:39], v[88:91]
    s_xor_b32 s48, s29, 65536
    v_permlane16_swap_b32 v16, v38
    v_mfma_f32_16x16x32_bf16 v[96:99], a[128:131], a[64:67], 0
    buffer_load_dwordx4 v7, s[12:15], s48 offen offset:0 lds
    v_mfma_f32_16x16x32_bf16 v[96:99], a[132:135], a[68:71], v[96:99]
    v_max_f32 v13, v13, v26
    v_max_f32 v14, v14, v30
    v_mfma_f32_16x16x32_bf16 v[104:107], a[128:131], a[96:99], 0
    ds_read_b128 a[128:131], v1 offset:16640
    v_max_f32 v15, v15, v34
    v_mfma_f32_16x16x32_bf16 v[104:107], a[132:135], a[100:103], v[104:107]
    s_waitcnt lgkmcnt(1)
    ds_read_b128 a[132:135], v2 offset:16640
    v_max_f32 v16, v16, v38
    v_mfma_f32_16x16x32_bf16 v[80:83], a[136:139], a[8:11], v[80:83]
    buffer_load_dwordx4 v7, s[12:15], s48 offen offset:1024 lds
    v_mfma_f32_16x16x32_bf16 v[80:83], a[140:143], a[12:15], v[80:83]
    v_mul_f32 v13, s24, v13
    v_mul_f32 v14, s24, v14
    v_mfma_f32_16x16x32_bf16 v[88:91], a[136:139], a[40:43], v[88:91]
    v_mul_f32 v15, s24, v15
    v_mul_f32 v16, s24, v16
    v_mfma_f32_16x16x32_bf16 v[88:91], a[140:143], a[44:47], v[88:91]
    v_fma_f32 v48, v48, s24, -v13
    v_fma_f32 v49, v49, s24, -v13
    v_mfma_f32_16x16x32_bf16 v[96:99], a[136:139], a[72:75], v[96:99]
    buffer_load_dwordx4 v7, s[12:15], s48 offen offset:2048 lds
    v_mfma_f32_16x16x32_bf16 v[96:99], a[140:143], a[76:79], v[96:99]
    v_exp_f32 v48, v48
    v_mfma_f32_16x16x32_bf16 v[104:107], a[136:139], a[104:107], v[104:107]
    ds_read_b128 a[136:139], v3 offset:16640
    v_fma_f32 v50, v50, s24, -v13
    v_mfma_f32_16x16x32_bf16 v[104:107], a[140:143], a[108:111], v[104:107]
    s_waitcnt lgkmcnt(1)
    ds_read_b128 a[140:143], v4 offset:16640
    v_fma_f32 v51, v51, s24, -v13
    v_mfma_f32_16x16x32_bf16 v[80:83], a[128:131], a[16:19], v[80:83]
    buffer_load_dwordx4 v7, s[12:15], s48 offen offset:3072 lds
    v_mfma_f32_16x16x32_bf16 v[80:83], a[132:135], a[20:23], v[80:83]
    v_exp_f32 v49, v49
    v_mfma_f32_16x16x32_bf16 v[88:91], a[128:131], a[48:51], v[88:91]
    v_exp_f32 v50, v50
    v_mfma_f32_16x16x32_bf16 v[88:91], a[132:135], a[52:55], v[88:91]
    v_exp_f32 v51, v51
    v_mfma_f32_16x16x32_bf16 v[96:99], a[128:131], a[80:83], v[96:99]
    buffer_store_dwordx4 v[228:231], v12, s[20:23], s50 offen nt
    v_mfma_f32_16x16x32_bf16 v[96:99], a[132:135], a[84:87], v[96:99]
    s_add_u32 s50, s11, 32768
    ds_read_b64 v[228:229], v0 offset:13320
    v_cvt_pk_bf16_f32 v112, v48, v49
    v_mfma_f32_16x16x32_bf16 v[104:107], a[128:131], a[112:115], v[104:107]
    ds_read_b128 a[128:131], v1 offset:18432
    v_cvt_pk_bf16_f32 v113, v50, v51
    v_mfma_f32_16x16x32_bf16 v[104:107], a[132:135], a[116:119], v[104:107]
    s_waitcnt lgkmcnt(2)
    ds_read_b128 a[132:135], v2 offset:18432
    v_fma_f32 v56, v56, s24, -v14
    v_mfma_f32_16x16x32_bf16 v[80:83], a[136:139], a[24:27], v[80:83]
    ds_read_b64 v[230:231], v0 offset:13312
    v_fma_f32 v57, v57, s24, -v14
    v_mfma_f32_16x16x32_bf16 v[80:83], a[140:143], a[28:31], v[80:83]
    v_exp_f32 v56, v56
    v_mfma_f32_16x16x32_bf16 v[88:91], a[136:139], a[56:59], v[88:91]
    v_exp_f32 v57, v57
    v_mfma_f32_16x16x32_bf16 v[88:91], a[140:143], a[60:63], v[88:91]
    v_fma_f32 v58, v58, s24, -v14
    v_fma_f32 v59, v59, s24, -v14
    v_mfma_f32_16x16x32_bf16 v[96:99], a[136:139], a[88:91], v[96:99]
    v_exp_f32 v58, v58
    v_mfma_f32_16x16x32_bf16 v[96:99], a[140:143], a[92:95], v[96:99]
    v_exp_f32 v59, v59
    v_mfma_f32_16x16x32_bf16 v[104:107], a[136:139], a[120:123], v[104:107]
    ds_read_b128 a[136:139], v3 offset:18432
    v_cvt_pk_bf16_f32 v116, v56, v57
    v_mfma_f32_16x16x32_bf16 v[104:107], a[140:143], a[124:127], v[104:107]
    s_waitcnt lgkmcnt(2)
    ds_read_b128 a[140:143], v4 offset:18432
    v_cvt_pk_bf16_f32 v117, v58, v59
    v_mfma_f32_16x16x32_bf16 v[84:87], a[128:131], a[0:3], 0
    v_fma_f32 v64, v64, s24, -v15
    v_fma_f32 v65, v65, s24, -v15
    v_mfma_f32_16x16x32_bf16 v[84:87], a[132:135], a[4:7], v[84:87]
    v_exp_f32 v64, v64
    v_mfma_f32_16x16x32_bf16 v[92:95], a[128:131], a[32:35], 0
    v_exp_f32 v65, v65
    v_mfma_f32_16x16x32_bf16 v[92:95], a[132:135], a[36:39], v[92:95]
    v_fma_f32 v66, v66, s24, -v15
    v_fma_f32 v67, v67, s24, -v15
    v_mfma_f32_16x16x32_bf16 v[100:103], a[128:131], a[64:67], 0
    v_exp_f32 v66, v66
    v_mfma_f32_16x16x32_bf16 v[100:103], a[132:135], a[68:71], v[100:103]
    v_exp_f32 v67, v67
    v_mfma_f32_16x16x32_bf16 v[108:111], a[128:131], a[96:99], 0
    ds_read_b128 a[128:131], v1 offset:18688
    v_cvt_pk_bf16_f32 v120, v64, v65
    v_mfma_f32_16x16x32_bf16 v[108:111], a[132:135], a[100:103], v[108:111]
    s_waitcnt lgkmcnt(1)
    ds_read_b128 a[132:135], v2 offset:18688
    v_cvt_pk_bf16_f32 v121, v66, v67
    v_mfma_f32_16x16x32_bf16 v[84:87], a[136:139], a[8:11], v[84:87]
    v_fma_f32 v72, v72, s24, -v16
    v_fma_f32 v73, v73, s24, -v16
    v_mfma_f32_16x16x32_bf16 v[84:87], a[140:143], a[12:15], v[84:87]
    v_exp_f32 v72, v72
    v_mfma_f32_16x16x32_bf16 v[92:95], a[136:139], a[40:43], v[92:95]
    v_exp_f32 v73, v73
    v_mfma_f32_16x16x32_bf16 v[92:95], a[140:143], a[44:47], v[92:95]
    v_fma_f32 v74, v74, s24, -v16
    v_fma_f32 v75, v75, s24, -v16
    v_mfma_f32_16x16x32_bf16 v[100:103], a[136:139], a[72:75], v[100:103]
    v_exp_f32 v74, v74
    v_mfma_f32_16x16x32_bf16 v[100:103], a[140:143], a[76:79], v[100:103]
    v_exp_f32 v75, v75
    v_mfma_f32_16x16x32_bf16 v[108:111], a[136:139], a[104:107], v[108:111]
    ds_read_b128 a[136:139], v3 offset:18688
    v_cvt_pk_bf16_f32 v124, v72, v73
    v_mfma_f32_16x16x32_bf16 v[108:111], a[140:143], a[108:111], v[108:111]
    s_waitcnt lgkmcnt(1)
    ds_read_b128 a[140:143], v4 offset:18688
    v_cvt_pk_bf16_f32 v125, v74, v75
    v_mfma_f32_16x16x32_bf16 v[84:87], a[128:131], a[16:19], v[84:87]
    buffer_store_dwordx4 v[232:235], v12, s[20:23], s50 offen nt
    v_mfma_f32_16x16x32_bf16 v[84:87], a[132:135], a[20:23], v[84:87]
    s_add_u32 s50, s11, 36864
    ds_read_b128 v[232:235], v0 offset:14336
    v_fma_f32 v52, v52, s24, -v13
    v_mfma_f32_16x16x32_bf16 v[92:95], a[128:131], a[48:51], v[92:95]
    v_exp_f32 v52, v52
    v_mfma_f32_16x16x32_bf16 v[92:95], a[132:135], a[52:55], v[92:95]
    v_fma_f32 v53, v53, s24, -v13
    v_fma_f32 v54, v54, s24, -v13
    v_mfma_f32_16x16x32_bf16 v[100:103], a[128:131], a[80:83], v[100:103]
    v_exp_f32 v53, v53
    v_mfma_f32_16x16x32_bf16 v[100:103], a[132:135], a[84:87], v[100:103]
    v_exp_f32 v54, v54
    v_mfma_f32_16x16x32_bf16 v[108:111], a[128:131], a[112:115], v[108:111]
    ds_read_b128 a[128:131], v1 offset:32768
    v_fma_f32 v55, v55, s24, -v13
    v_mfma_f32_16x16x32_bf16 v[108:111], a[132:135], a[116:119], v[108:111]
    s_waitcnt lgkmcnt(2)
    ds_read_b128 a[132:135], v2 offset:32768
    v_cvt_pk_bf16_f32 v114, v52, v53
    v_mfma_f32_16x16x32_bf16 v[84:87], a[136:139], a[24:27], v[84:87]
    v_exp_f32 v55, v55
    v_mfma_f32_16x16x32_bf16 v[84:87], a[140:143], a[28:31], v[84:87]
    v_cvt_pk_bf16_f32 v115, v54, v55
    v_fma_f32 v60, v60, s24, -v14
    v_mfma_f32_16x16x32_bf16 v[92:95], a[136:139], a[56:59], v[92:95]
    v_exp_f32 v60, v60
    v_mfma_f32_16x16x32_bf16 v[92:95], a[140:143], a[60:63], v[92:95]
    v_fma_f32 v61, v61, s24, -v14
    v_fma_f32 v62, v62, s24, -v14
    v_mfma_f32_16x16x32_bf16 v[100:103], a[136:139], a[88:91], v[100:103]
    v_exp_f32 v61, v61
    v_mfma_f32_16x16x32_bf16 v[100:103], a[140:143], a[92:95], v[100:103]
    v_exp_f32 v62, v62
    v_mfma_f32_16x16x32_bf16 v[108:111], a[136:139], a[120:123], v[108:111]
    ds_read_b128 a[136:139], v3 offset:32768
    v_fma_f32 v63, v63, s24, -v14
    v_mfma_f32_16x16x32_bf16 v[108:111], a[140:143], a[124:127], v[108:111]
    s_waitcnt lgkmcnt(1)
    v_exp_f32 v63, v63
    v_mfma_f32_16x16x32_bf16 v[48:51], a[128:131], a[0:3], 0
    s_waitcnt vmcnt(7)
    ds_read_b128 a[140:143], v4 offset:32768
    v_cvt_pk_bf16_f32 v118, v60, v61
    v_mfma_f32_16x16x32_bf16 v[48:51], a[132:135], a[4:7], v[48:51]
    s_barrier
    v_cvt_pk_bf16_f32 v119, v62, v63
    v_fma_f32 v68, v68, s24, -v15
    v_mfma_f32_16x16x32_bf16 v[56:59], a[128:131], a[32:35], 0
    s_add_u32 m0, s30, 16384
    v_exp_f32 v68, v68
    v_mfma_f32_16x16x32_bf16 v[56:59], a[132:135], a[36:39], v[56:59]
    s_xor_b32 s48, s29, 81920
    v_fma_f32 v69, v69, s24, -v15
    v_fma_f32 v70, v70, s24, -v15
    v_mfma_f32_16x16x32_bf16 v[64:67], a[128:131], a[64:67], 0
    buffer_load_dwordx4 v7, s[12:15], s48 offen offset:0 lds
    v_mfma_f32_16x16x32_bf16 v[64:67], a[132:135], a[68:71], v[64:67]
    v_exp_f32 v69, v69
    v_mfma_f32_16x16x32_bf16 v[72:75], a[128:131], a[96:99], 0
    ds_read_b128 a[128:131], v1 offset:33024
    v_fma_f32 v71, v71, s24, -v15
    v_mfma_f32_16x16x32_bf16 v[72:75], a[132:135], a[100:103], v[72:75]
    s_waitcnt lgkmcnt(1)
    ds_read_b128 a[132:135], v2 offset:33024
    v_cvt_pk_bf16_f32 v122, v68, v69
    v_mfma_f32_16x16x32_bf16 v[48:51], a[136:139], a[8:11], v[48:51]
    buffer_load_dwordx4 v7, s[12:15], s48 offen offset:1024 lds
    v_mfma_f32_16x16x32_bf16 v[48:51], a[140:143], a[12:15], v[48:51]
    v_exp_f32 v70, v70
    v_mfma_f32_16x16x32_bf16 v[56:59], a[136:139], a[40:43], v[56:59]
    v_exp_f32 v71, v71
    v_mfma_f32_16x16x32_bf16 v[56:59], a[140:143], a[44:47], v[56:59]
    v_cvt_pk_bf16_f32 v123, v70, v71
    v_fma_f32 v76, v76, s24, -v16
    v_mfma_f32_16x16x32_bf16 v[64:67], a[136:139], a[72:75], v[64:67]
    buffer_store_dwordx4 v[236:239], v12, s[20:23], s50 offen nt
    v_mfma_f32_16x16x32_bf16 v[64:67], a[140:143], a[76:79], v[64:67]
    s_add_u32 s50, s11, 65536
    ds_read_b64 v[236:237], v0 offset:15368
    v_fma_f32 v77, v77, s24, -v16
    v_mfma_f32_16x16x32_bf16 v[72:75], a[136:139], a[104:107], v[72:75]
    ds_read_b128 a[136:139], v3 offset:33024
    v_fma_f32 v78, v78, s24, -v16
    v_mfma_f32_16x16x32_bf16 v[72:75], a[140:143], a[108:111], v[72:75]
    s_waitcnt lgkmcnt(2)
    ds_read_b128 a[140:143], v4 offset:33024
    v_fma_f32 v79, v79, s24, -v16
    v_mfma_f32_16x16x32_bf16 v[48:51], a[128:131], a[16:19], v[48:51]
    buffer_load_dwordx4 v7, s[12:15], s48 offen offset:2048 lds
    v_mfma_f32_16x16x32_bf16 v[48:51], a[132:135], a[20:23], v[48:51]
    ds_read_b64 v[238:239], v0 offset:15360
    v_fma_f32 v80, v80, s24, -v13
    v_mfma_f32_16x16x32_bf16 v[56:59], a[128:131], a[48:51], v[56:59]
    v_exp_f32 v76, v76
    v_mfma_f32_16x16x32_bf16 v[56:59], a[132:135], a[52:55], v[56:59]
    v_exp_f32 v77, v77
    v_mfma_f32_16x16x32_bf16 v[64:67], a[128:131], a[80:83], v[64:67]
    buffer_load_dwordx4 v7, s[12:15], s48 offen offset:3072 lds
    v_mfma_f32_16x16x32_bf16 v[64:67], a[132:135], a[84:87], v[64:67]
    v_exp_f32 v78, v78
    v_mfma_f32_16x16x32_bf16 v[72:75], a[128:131], a[112:115], v[72:75]
    ds_read_b128 a[128:131], v1 offset:34816
    v_cvt_pk_bf16_f32 v126, v76, v77
    v_mfma_f32_16x16x32_bf16 v[72:75], a[132:135], a[116:119], v[72:75]
    s_waitcnt lgkmcnt(2)
    ds_read_b128 a[132:135], v2 offset:34816
    v_fma_f32 v81, v81, s24, -v13
    v_mfma_f32_16x16x32_bf16 v[48:51], a[136:139], a[24:27], v[48:51]
    v_exp_f32 v79, v79
    v_mfma_f32_16x16x32_bf16 v[48:51], a[140:143], a[28:31], v[48:51]
    v_exp_f32 v80, v80
    v_mfma_f32_16x16x32_bf16 v[56:59], a[136:139], a[56:59], v[56:59]
    v_exp_f32 v81, v81
    v_mfma_f32_16x16x32_bf16 v[56:59], a[140:143], a[60:63], v[56:59]
    v_cvt_pk_bf16_f32 v127, v78, v79
    v_fma_f32 v82, v82, s24, -v13
    v_mfma_f32_16x16x32_bf16 v[64:67], a[136:139], a[88:91], v[64:67]
    v_exp_f32 v82, v82
    v_mfma_f32_16x16x32_bf16 v[64:67], a[140:143], a[92:95], v[64:67]
    v_fma_f32 v83, v83, s24, -v13
    v_cvt_pk_bf16_f32 v128, v80, v81
    v_mfma_f32_16x16x32_bf16 v[72:75], a[136:139], a[120:123], v[72:75]
    ds_read_b128 a[136:139], v3 offset:34816
    v_fma_f32 v88, v88, s24, -v14
    v_mfma_f32_16x16x32_bf16 v[72:75], a[140:143], a[124:127], v[72:75]
    s_waitcnt lgkmcnt(1)
    ds_read_b128 a[140:143], v4 offset:34816
    v_fma_f32 v89, v89, s24, -v14
    v_mfma_f32_16x16x32_bf16 v[52:55], a[128:131], a[0:3], 0
L_t4_1:
    s_cbranch_execz L_t4_5
    v_exp_f32 v83, v83
    v_mfma_f32_16x16x32_bf16 v[52:55], a[132:135], a[4:7], v[52:55]
    v_exp_f32 v88, v88
    v_mfma_f32_16x16x32_bf16 v[60:63], a[128:131], a[32:35], 0
    v_exp_f32 v89, v89
    v_mfma_f32_16x16x32_bf16 v[60:63], a[132:135], a[36:39], v[60:63]
    v_cvt_pk_bf16_f32 v129, v82, v83
    v_fma_f32 v90, v90, s24, -v14
    v_mfma_f32_16x16x32_bf16 v[68:71], a[128:131], a[64:67], 0
    v_exp_f32 v90, v90
    v_mfma_f32_16x16x32_bf16 v[68:71], a[132:135], a[68:71], v[68:71]
    v_fma_f32 v91, v91, s24, -v14
    v_cvt_pk_bf16_f32 v132, v88, v89
    v_mfma_f32_16x16x32_bf16 v[76:79], a[128:131], a[96:99], 0
    ds_read_b128 a[128:131], v1 offset:35072
    v_fma_f32 v96, v96, s24, -v15
    v_mfma_f32_16x16x32_bf16 v[76:79], a[132:135], a[100:103], v[76:79]
    s_waitcnt lgkmcnt(1)
    ds_read_b128 a[132:135], v2 offset:35072
    v_fma_f32 v97, v97, s24, -v15
    v_mfma_f32_16x16x32_bf16 v[52:55], a[136:139], a[8:11], v[52:55]
    buffer_store_dwordx4 v[224:227], v12, s[20:23], s50 offen nt
    v_mfma_f32_16x16x32_bf16 v[52:55], a[140:143], a[12:15], v[52:55]
    s_add_u32 s50, s11, 69632
    v_exp_f32 v91, v91
    v_mfma_f32_16x16x32_bf16 v[60:63], a[136:139], a[40:43], v[60:63]
    v_exp_f32 v96, v96
    v_mfma_f32_16x16x32_bf16 v[60:63], a[140:143], a[44:47], v[60:63]
    v_exp_f32 v97, v97
    v_mfma_f32_16x16x32_bf16 v[68:71], a[136:139], a[72:75], v[68:71]
    v_cvt_pk_bf16_f32 v133, v90, v91
    v_fma_f32 v98, v98, s24, -v15
    v_mfma_f32_16x16x32_bf16 v[68:71], a[140:143], a[76:79], v[68:71]
    v_exp_f32 v98, v98
    v_mfma_f32_16x16x32_bf16 v[76:79], a[136:139], a[104:107], v[76:79]
    ds_read_b128 a[136:139], v3 offset:35072
    v_fma_f32 v99, v99, s24, -v15
    v_mfma_f32_16x16x32_bf16 v[76:79], a[140:143], a[108:111], v[76:79]
    s_waitcnt lgkmcnt(1)
    ds_read_b128 a[140:143], v4 offset:35072
    v_cvt_pk_bf16_f32 v136, v96, v97
    v_mfma_f32_16x16x32_bf16 v[52:55], a[128:131], a[16:19], v[52:55]
    v_exp_f32 v99, v99
    v_mfma_f32_16x16x32_bf16 v[52:55], a[132:135], a[20:23], v[52:55]
    v_cvt_pk_bf16_f32 v137, v98, v99
    v_fma_f32 v104, v104, s24, -v16
    v_mfma_f32_16x16x32_bf16 v[60:63], a[128:131], a[48:51], v[60:63]
    v_exp_f32 v104, v104
    v_mfma_f32_16x16x32_bf16 v[60:63], a[132:135], a[52:55], v[60:63]
    v_fma_f32 v105, v105, s24, -v16
    v_fma_f32 v106, v106, s24, -v16
    v_mfma_f32_16x16x32_bf16 v[68:71], a[128:131], a[80:83], v[68:71]
    v_exp_f32 v105, v105
    v_mfma_f32_16x16x32_bf16 v[68:71], a[132:135], a[84:87], v[68:71]
    v_exp_f32 v106, v106
    v_mfma_f32_16x16x32_bf16 v[76:79], a[128:131], a[112:115], v[76:79]
    ds_read_b128 a[128:131], v1 offset:49152
    v_fma_f32 v107, v107, s24, -v16
    v_mfma_f32_16x16x32_bf16 v[76:79], a[132:135], a[116:119], v[76:79]
    s_waitcnt lgkmcnt(1)
    ds_read_b128 a[132:135], v2 offset:49152
    v_cvt_pk_bf16_f32 v140, v104, v105
    v_mfma_f32_16x16x32_bf16 v[52:55], a[136:139], a[24:27], v[52:55]
    v_exp_f32 v107, v107
    v_mfma_f32_16x16x32_bf16 v[52:55], a[140:143], a[28:31], v[52:55]
    v_cvt_pk_bf16_f32 v141, v106, v107
    v_fma_f32 v84, v84, s24, -v13
    v_mfma_f32_16x16x32_bf16 v[60:63], a[136:139], a[56:59], v[60:63]
    v_exp_f32 v84, v84
    v_mfma_f32_16x16x32_bf16 v[60:63], a[140:143], a[60:63], v[60:63]
    v_fma_f32 v85, v85, s24, -v13
    v_fma_f32 v86, v86, s24, -v13
    v_mfma_f32_16x16x32_bf16 v[68:71], a[136:139], a[88:91], v[68:71]
    v_exp_f32 v85, v85
    v_mfma_f32_16x16x32_bf16 v[68:71], a[140:143], a[92:95], v[68:71]
    v_exp_f32 v86, v86
    v_mfma_f32_16x16x32_bf16 v[76:79], a[136:139], a[120:123], v[76:79]
    ds_read_b128 a[136:139], v3 offset:49152
    v_fma_f32 v87, v87, s24, -v13
    v_mfma_f32_16x16x32_bf16 v[76:79], a[140:143], a[124:127], v[76:79]
    s_waitcnt lgkmcnt(1)
    v_exp_f32 v87, v87
L_body_4:
    v_mfma_f32_16x16x32_bf16 v[80:83], a[128:131], a[0:3], 0
    s_waitcnt vmcnt(4)
    ds_read_b128 a[140:143], v4 offset:49152
    v_xor_b32 v46, 64, v9
    v_mfma_f32_16x16x32_bf16 v[80:83], a[132:135], a[4:7], v[80:83]
    s_barrier
    v_cvt_pk_bf16_f32 v130, v84, v85
    v_cvt_pk_bf16_f32 v131, v86, v87
    v_mfma_f32_16x16x32_bf16 v[88:91], a[128:131], a[32:35], 0
    s_add_u32 m0, s30, 32768
    v_fma_f32 v92, v92, s24, -v14
    v_fma_f32 v93, v93, s24, -v14
    v_mfma_f32_16x16x32_bf16 v[88:91], a[132:135], a[36:39], v[88:91]
    s_xor_b32 s48, s29, 98304
    v_exp_f32 v92, v92
    v_mfma_f32_16x16x32_bf16 v[96:99], a[128:131], a[64:67], 0
    buffer_store_dwordx4 v[228:231], v12, s[20:23], s50 offen nt
    v_mfma_f32_16x16x32_bf16 v[96:99], a[132:135], a[68:71], v[96:99]
    s_add_u32 s50, s11, 98304
    v_exp_f32 v93, v93
    v_mfma_f32_16x16x32_bf16 v[104:107], a[128:131], a[96:99], 0
    s_add_u32 s49, s34, 65536
    ds_read_b128 a[128:131], v1 offset:49408
    v_fma_f32 v94, v94, s24, -v14
    v_mfma_f32_16x16x32_bf16 v[104:107], a[132:135], a[100:103], v[104:107]
    s_waitcnt lgkmcnt(1)
    ds_read_b128 a[132:135], v2 offset:49408
    v_fma_f32 v95, v95, s24, -v14
    v_mfma_f32_16x16x32_bf16 v[80:83], a[136:139], a[8:11], v[80:83]
    buffer_load_dwordx4 v7, s[12:15], s48 offen offset:0 lds
    v_mfma_f32_16x16x32_bf16 v[80:83], a[140:143], a[12:15], v[80:83]
    v_exp_f32 v94, v94
    v_mfma_f32_16x16x32_bf16 v[88:91], a[136:139], a[40:43], v[88:91]
    v_exp_f32 v95, v95
    v_mfma_f32_16x16x32_bf16 v[88:91], a[140:143], a[44:47], v[88:91]
    v_cvt_pk_bf16_f32 v134, v92, v93
    v_cvt_pk_bf16_f32 v135, v94, v95
    v_mfma_f32_16x16x32_bf16 v[96:99], a[136:139], a[72:75], v[96:99]
    buffer_load_dwordx4 v7, s[12:15], s48 offen offset:1024 lds
    v_mfma_f32_16x16x32_bf16 v[96:99], a[140:143], a[76:79], v[96:99]
    v_fma_f32 v100, v100, s24, -v15
    v_fma_f32 v101, v101, s24, -v15
    v_mfma_f32_16x16x32_bf16 v[104:107], a[136:139], a[104:107], v[104:107]
    ds_read_b128 a[136:139], v3 offset:49408
    v_fma_f32 v102, v102, s24, -v15
    v_mfma_f32_16x16x32_bf16 v[104:107], a[140:143], a[108:111], v[104:107]
    s_waitcnt lgkmcnt(1)
    ds_read_b128 a[140:143], v4 offset:49408
    v_fma_f32 v103, v103, s24, -v15
    v_mfma_f32_16x16x32_bf16 v[80:83], a[128:131], a[16:19], v[80:83]
    buffer_load_dwordx4 v7, s[12:15], s48 offen offset:2048 lds
    v_mfma_f32_16x16x32_bf16 v[80:83], a[132:135], a[20:23], v[80:83]
    v_exp_f32 v100, v100
    v_mfma_f32_16x16x32_bf16 v[88:91], a[128:131], a[48:51], v[88:91]
    v_exp_f32 v101, v101
    v_mfma_f32_16x16x32_bf16 v[88:91], a[132:135], a[52:55], v[88:91]
    v_exp_f32 v102, v102
    v_mfma_f32_16x16x32_bf16 v[96:99], a[128:131], a[80:83], v[96:99]
    buffer_load_dwordx4 v7, s[12:15], s48 offen offset:3072 lds
    v_mfma_f32_16x16x32_bf16 v[96:99], a[132:135], a[84:87], v[96:99]
    s_add_u32 m0, s54, 16384
    v_exp_f32 v103, v103
    v_mfma_f32_16x16x32_bf16 v[104:107], a[128:131], a[112:115], v[104:107]
    ds_read_b128 a[128:131], v1 offset:51200
    v_cvt_pk_bf16_f32 v138, v100, v101
    v_mfma_f32_16x16x32_bf16 v[104:107], a[132:135], a[116:119], v[104:107]
    s_waitcnt lgkmcnt(1)
    ds_read_b128 a[132:135], v2 offset:51200
    v_cvt_pk_bf16_f32 v139, v102, v103
    v_mfma_f32_16x16x32_bf16 v[80:83], a[136:139], a[24:27], v[80:83]
    buffer_load_dwordx4 v9, s[64:67], s49 offen offset:0 nt lds
    v_mfma_f32_16x16x32_bf16 v[80:83], a[140:143], a[28:31], v[80:83]
    v_fma_f32 v108, v108, s24, -v16
    v_fma_f32 v109, v109, s24, -v16
    v_mfma_f32_16x16x32_bf16 v[88:91], a[136:139], a[56:59], v[88:91]
    v_exp_f32 v108, v108
    v_mfma_f32_16x16x32_bf16 v[88:91], a[140:143], a[60:63], v[88:91]
    v_exp_f32 v109, v109
    v_mfma_f32_16x16x32_bf16 v[96:99], a[136:139], a[88:91], v[96:99]
    buffer_load_dwordx4 v46, s[64:67], s49 offen offset:1024 nt lds
    v_mfma_f32_16x16x32_bf16 v[96:99], a[140:143], a[92:95], v[96:99]
    v_fma_f32 v110, v110, s24, -v16
    v_fma_f32 v111, v111, s24, -v16
    v_mfma_f32_16x16x32_bf16 v[104:107], a[136:139], a[120:123], v[104:107]
    ds_read_b128 a[136:139], v3 offset:51200
    v_cvt_pk_bf16_f32 v142, v108, v109
    v_mfma_f32_16x16x32_bf16 v[104:107], a[140:143], a[124:127], v[104:107]
    s_waitcnt lgkmcnt(1)
    ds_read_b128 a[140:143], v4 offset:51200
    v_fma_f32 v48, v48, s24, -v13
    v_mfma_f32_16x16x32_bf16 v[84:87], a[128:131], a[0:3], 0
    buffer_store_dwordx4 v[232:235], v12, s[20:23], s50 offen nt
    v_mfma_f32_16x16x32_bf16 v[84:87], a[132:135], a[4:7], v[84:87]
    s_add_u32 s50, s11, 102400
    v_exp_f32 v110, v110
    v_mfma_f32_16x16x32_bf16 v[92:95], a[128:131], a[32:35], 0
    v_exp_f32 v111, v111
    v_mfma_f32_16x16x32_bf16 v[92:95], a[132:135], a[36:39], v[92:95]
    v_exp_f32 v48, v48
    v_mfma_f32_16x16x32_bf16 v[100:103], a[128:131], a[64:67], 0
    v_cvt_pk_bf16_f32 v143, v110, v111
    v_fma_f32 v49, v49, s24, -v13
    v_mfma_f32_16x16x32_bf16 v[100:103], a[132:135], a[68:71], v[100:103]
    v_exp_f32 v49, v49
    v_mfma_f32_16x16x32_bf16 v[108:111], a[128:131], a[96:99], 0
    ds_read_b128 a[128:131], v1 offset:51456
    v_fma_f32 v50, v50, s24, -v13
    v_mfma_f32_16x16x32_bf16 v[108:111], a[132:135], a[100:103], v[108:111]
    s_waitcnt lgkmcnt(1)
    ds_read_b128 a[132:135], v2 offset:51456
    v_fma_f32 v51, v51, s24, -v13
    v_mfma_f32_16x16x32_bf16 v[84:87], a[136:139], a[8:11], v[84:87]
    v_exp_f32 v50, v50
    v_mfma_f32_16x16x32_bf16 v[84:87], a[140:143], a[12:15], v[84:87]
    v_exp_f32 v51, v51
    v_mfma_f32_16x16x32_bf16 v[92:95], a[136:139], a[40:43], v[92:95]
    v_cvt_pk_bf16_f32 v144, v48, v49
    v_cvt_pk_bf16_f32 v145, v50, v51
    v_mfma_f32_16x16x32_bf16 v[92:95], a[140:143], a[44:47], v[92:95]
    v_fma_f32 v56, v56, s24, -v14
    v_fma_f32 v57, v57, s24, -v14
    v_mfma_f32_16x16x32_bf16 v[100:103], a[136:139], a[72:75], v[100:103]
    v_exp_f32 v56, v56
    v_mfma_f32_16x16x32_bf16 v[100:103], a[140:143], a[76:79], v[100:103]
    v_exp_f32 v57, v57
    v_mfma_f32_16x16x32_bf16 v[108:111], a[136:139], a[104:107], v[108:111]
    ds_read_b128 a[136:139], v3 offset:51456
    v_fma_f32 v58, v58, s24, -v14
    v_mfma_f32_16x16x32_bf16 v[108:111], a[140:143], a[108:111], v[108:111]
    ds_read_b128 a[140:143], v4 offset:51456
    v_fma_f32 v59, v59, s24, -v14
    v_mfma_f32_16x16x32_bf16 v[26:29], v[22:25], v[112:115], 0
    v_exp_f32 v58, v58
    v_mfma_f32_16x16x32_bf16 v[26:29], v[22:25], v[128:131], v[26:29]
    v_exp_f32 v59, v59
    v_mfma_f32_16x16x32_bf16 v[30:33], v[22:25], v[116:119], 0
    v_cvt_pk_bf16_f32 v148, v56, v57
    v_cvt_pk_bf16_f32 v149, v58, v59
    v_mfma_f32_16x16x32_bf16 v[30:33], v[22:25], v[132:135], v[30:33]
    v_fma_f32 v64, v64, s24, -v15
    v_fma_f32 v65, v65, s24, -v15
    v_mfma_f32_16x16x32_bf16 v[34:37], v[22:25], v[120:123], 0
    v_exp_f32 v64, v64
    v_mfma_f32_16x16x32_bf16 v[34:37], v[22:25], v[136:139], v[34:37]
    v_exp_f32 v65, v65
    v_mfma_f32_16x16x32_bf16 v[38:41], v[22:25], v[124:127], 0
    v_fma_f32 v66, v66, s24, -v15
    v_fma_f32 v67, v67, s24, -v15
    v_mfma_f32_16x16x32_bf16 v[38:41], v[22:25], v[140:143], v[38:41]
    s_waitcnt lgkmcnt(2)
    v_exp_f32 v66, v66
    v_mfma_f32_16x16x32_bf16 v[84:87], a[128:131], a[16:19], v[84:87]
    v_exp_f32 v67, v67
    v_mfma_f32_16x16x32_bf16 v[84:87], a[132:135], a[20:23], v[84:87]
    v_cvt_pk_bf16_f32 v152, v64, v65
    v_cvt_pk_bf16_f32 v153, v66, v67
    v_mfma_f32_16x16x32_bf16 v[92:95], a[128:131], a[48:51], v[92:95]
    v_fma_f32 v72, v72, s24, -v16
    v_fma_f32 v73, v73, s24, -v16
    v_mfma_f32_16x16x32_bf16 v[92:95], a[132:135], a[52:55], v[92:95]
    v_exp_f32 v72, v72
    v_mfma_f32_16x16x32_bf16 v[100:103], a[128:131], a[80:83], v[100:103]
    buffer_store_dwordx4 v[236:239], v12, s[20:23], s50 offen nt
    v_mfma_f32_16x16x32_bf16 v[100:103], a[132:135], a[84:87], v[100:103]
    v_exp_f32 v73, v73
    v_mfma_f32_16x16x32_bf16 v[108:111], a[128:131], a[112:115], v[108:111]
    ds_read_b128 a[128:131], v1 offset:0
    v_fma_f32 v74, v74, s24, -v16
    v_mfma_f32_16x16x32_bf16 v[108:111], a[132:135], a[116:119], v[108:111]
    s_waitcnt lgkmcnt(1)
    ds_read_b128 a[132:135], v2 offset:0
    v_fma_f32 v75, v75, s24, -v16
    v_mfma_f32_16x16x32_bf16 v[84:87], a[136:139], a[24:27], v[84:87]
    v_exp_f32 v74, v74
    v_mfma_f32_16x16x32_bf16 v[84:87], a[140:143], a[28:31], v[84:87]
    v_exp_f32 v75, v75
    v_mfma_f32_16x16x32_bf16 v[92:95], a[136:139], a[56:59], v[92:95]
    v_cvt_pk_bf16_f32 v156, v72, v73
    v_cvt_pk_bf16_f32 v157, v74, v75
    v_mfma_f32_16x16x32_bf16 v[92:95], a[140:143], a[60:63], v[92:95]
    v_fma_f32 v52, v52, s24, -v13
    v_fma_f32 v53, v53, s24, -v13
    v_mfma_f32_16x16x32_bf16 v[100:103], a[136:139], a[88:91], v[100:103]
    v_exp_f32 v52, v52
    v_mfma_f32_16x16x32_bf16 v[100:103], a[140:143], a[92:95], v[100:103]
    v_exp_f32 v53, v53
    v_mfma_f32_16x16x32_bf16 v[108:111], a[136:139], a[120:123], v[108:111]
    ds_read_b128 a[136:139], v3 offset:0
    v_fma_f32 v54, v54, s24, -v13
    v_mfma_f32_16x16x32_bf16 v[108:111], a[140:143], a[124:127], v[108:111]
    s_waitcnt lgkmcnt(1)
    v_exp_f32 v54, v54
    v_mfma_f32_16x16x32_bf16 v[48:51], a[128:131], a[0:3], 0
    s_waitcnt vmcnt(9)
    ds_read_b128 a[140:143], v4 offset:0
    v_xor_b32 v44, 128, v9
    v_mfma_f32_16x16x32_bf16 v[48:51], a[132:135], a[4:7], v[48:51]
    s_barrier
    v_xor_b32 v46, 192, v9
    v_fma_f32 v55, v55, s24, -v13
    v_mfma_f32_16x16x32_bf16 v[56:59], a[128:131], a[32:35], 0
    s_add_u32 m0, s30, 49152
    v_exp_f32 v55, v55
    v_mfma_f32_16x16x32_bf16 v[56:59], a[132:135], a[36:39], v[56:59]
    s_xor_b32 s48, s29, 114688
    v_cvt_pk_bf16_f32 v146, v52, v53
    v_cvt_pk_bf16_f32 v147, v54, v55
    v_mfma_f32_16x16x32_bf16 v[64:67], a[128:131], a[64:67], 0
    buffer_load_dwordx4 v7, s[12:15], s48 offen offset:0 lds
    v_mfma_f32_16x16x32_bf16 v[64:67], a[132:135], a[68:71], v[64:67]
    s_add_u32 s49, s34, 65536
    v_fma_f32 v60, v60, s24, -v14
    v_fma_f32 v61, v61, s24, -v14
    v_mfma_f32_16x16x32_bf16 v[72:75], a[128:131], a[96:99], 0
    ds_read_b128 a[128:131], v1 offset:256
    v_fma_f32 v62, v62, s24, -v14
    v_mfma_f32_16x16x32_bf16 v[72:75], a[132:135], a[100:103], v[72:75]
    s_waitcnt lgkmcnt(1)
    ds_read_b128 a[132:135], v2 offset:256
    v_fma_f32 v63, v63, s24, -v14
    v_mfma_f32_16x16x32_bf16 v[48:51], a[136:139], a[8:11], v[48:51]
    buffer_load_dwordx4 v7, s[12:15], s48 offen offset:1024 lds
    v_mfma_f32_16x16x32_bf16 v[48:51], a[140:143], a[12:15], v[48:51]
    v_exp_f32 v60, v60
    v_mfma_f32_16x16x32_bf16 v[56:59], a[136:139], a[40:43], v[56:59]
    v_exp_f32 v61, v61
    v_mfma_f32_16x16x32_bf16 v[56:59], a[140:143], a[44:47], v[56:59]
    v_exp_f32 v62, v62
    v_mfma_f32_16x16x32_bf16 v[64:67], a[136:139], a[72:75], v[64:67]
    buffer_load_dwordx4 v7, s[12:15], s48 offen offset:2048 lds
    v_mfma_f32_16x16x32_bf16 v[64:67], a[140:143], a[76:79], v[64:67]
    v_exp_f32 v63, v63
    v_mfma_f32_16x16x32_bf16 v[72:75], a[136:139], a[104:107], v[72:75]
    ds_read_b128 a[136:139], v3 offset:256
    v_cvt_pk_bf16_f32 v150, v60, v61
    v_mfma_f32_16x16x32_bf16 v[72:75], a[140:143], a[108:111], v[72:75]
    s_waitcnt lgkmcnt(1)
    ds_read_b128 a[140:143], v4 offset:256
    v_cvt_pk_bf16_f32 v151, v62, v63
    v_mfma_f32_16x16x32_bf16 v[48:51], a[128:131], a[16:19], v[48:51]
    buffer_load_dwordx4 v7, s[12:15], s48 offen offset:3072 lds
    v_mfma_f32_16x16x32_bf16 v[48:51], a[132:135], a[20:23], v[48:51]
    s_add_u32 m0, s54, 16384
    v_fma_f32 v68, v68, s24, -v15
    v_fma_f32 v69, v69, s24, -v15
    v_mfma_f32_16x16x32_bf16 v[56:59], a[128:131], a[48:51], v[56:59]
    v_exp_f32 v68, v68
    v_mfma_f32_16x16x32_bf16 v[56:59], a[132:135], a[52:55], v[56:59]
    v_exp_f32 v69, v69
    v_mfma_f32_16x16x32_bf16 v[64:67], a[128:131], a[80:83], v[64:67]
    buffer_load_dwordx4 v44, s[64:67], s49 offen offset:2048 nt lds
    v_mfma_f32_16x16x32_bf16 v[64:67], a[132:135], a[84:87], v[64:67]
    v_fma_f32 v70, v70, s24, -v15
    v_fma_f32 v71, v71, s24, -v15
    v_mfma_f32_16x16x32_bf16 v[72:75], a[128:131], a[112:115], v[72:75]
    ds_read_b128 a[128:131], v1 offset:2048
    v_cvt_pk_bf16_f32 v154, v68, v69
    v_mfma_f32_16x16x32_bf16 v[72:75], a[132:135], a[116:119], v[72:75]
    s_waitcnt lgkmcnt(1)
    ds_read_b128 a[132:135], v2 offset:2048
    v_fma_f32 v76, v76, s24, -v16
    v_mfma_f32_16x16x32_bf16 v[48:51], a[136:139], a[24:27], v[48:51]
    buffer_load_dwordx4 v46, s[64:67], s49 offen offset:3072 nt lds
    v_mfma_f32_16x16x32_bf16 v[48:51], a[140:143], a[28:31], v[48:51]
    v_exp_f32 v70, v70
    v_mfma_f32_16x16x32_bf16 v[56:59], a[136:139], a[56:59], v[56:59]
    v_exp_f32 v71, v71
    v_mfma_f32_16x16x32_bf16 v[56:59], a[140:143], a[60:63], v[56:59]
    v_exp_f32 v76, v76
    v_mfma_f32_16x16x32_bf16 v[64:67], a[136:139], a[88:91], v[64:67]
    v_cvt_pk_bf16_f32 v155, v70, v71
    v_fma_f32 v77, v77, s24, -v16
    v_mfma_f32_16x16x32_bf16 v[64:67], a[140:143], a[92:95], v[64:67]
    v_exp_f32 v77, v77
    v_mfma_f32_16x16x32_bf16 v[72:75], a[136:139], a[120:123], v[72:75]
    ds_read_b128 a[136:139], v3 offset:2048
    v_fma_f32 v78, v78, s24, -v16
    v_mfma_f32_16x16x32_bf16 v[72:75], a[140:143], a[124:127], v[72:75]
    s_waitcnt lgkmcnt(1)
    ds_read_b128 a[140:143], v4 offset:2048
    v_fma_f32 v79, v79, s24, -v16
    v_mfma_f32_16x16x32_bf16 v[52:55], a[128:131], a[0:3], 0
    v_exp_f32 v78, v78
    v_mfma_f32_16x16x32_bf16 v[52:55], a[132:135], a[4:7], v[52:55]
    v_exp_f32 v79, v79
    v_mfma_f32_16x16x32_bf16 v[60:63], a[128:131], a[32:35], 0
    v_cvt_pk_bf16_f32 v158, v76, v77
    v_cvt_pk_bf16_f32 v159, v78, v79
    v_mfma_f32_16x16x32_bf16 v[60:63], a[132:135], a[36:39], v[60:63]
    v_fma_f32 v80, v80, s24, -v13
    v_fma_f32 v81, v81, s24, -v13
    v_mfma_f32_16x16x32_bf16 v[68:71], a[128:131], a[64:67], 0
    v_exp_f32 v80, v80
    v_mfma_f32_16x16x32_bf16 v[68:71], a[132:135], a[68:71], v[68:71]
    v_exp_f32 v81, v81
    v_mfma_f32_16x16x32_bf16 v[76:79], a[128:131], a[96:99], 0
    ds_read_b128 a[128:131], v1 offset:2304
    v_fma_f32 v82, v82, s24, -v13
    v_mfma_f32_16x16x32_bf16 v[76:79], a[132:135], a[100:103], v[76:79]
    s_waitcnt lgkmcnt(1)
    ds_read_b128 a[132:135], v2 offset:2304
    v_fma_f32 v83, v83, s24, -v13
    v_mfma_f32_16x16x32_bf16 v[52:55], a[136:139], a[8:11], v[52:55]
    v_exp_f32 v82, v82
    v_mfma_f32_16x16x32_bf16 v[52:55], a[140:143], a[12:15], v[52:55]
    v_exp_f32 v83, v83
    v_mfma_f32_16x16x32_bf16 v[60:63], a[136:139], a[40:43], v[60:63]
    v_cvt_pk_bf16_f32 v80, v80, v81
    v_cvt_pk_bf16_f32 v82, v82, v83
    v_mfma_f32_16x16x32_bf16 v[60:63], a[140:143], a[44:47], v[60:63]
    v_accvgpr_write_b32 a144, v80
    v_accvgpr_write_b32 a145, v82
    v_mfma_f32_16x16x32_bf16 v[68:71], a[136:139], a[72:75], v[68:71]
    v_fma_f32 v88, v88, s24, -v14
    v_fma_f32 v89, v89, s24, -v14
    v_mfma_f32_16x16x32_bf16 v[68:71], a[140:143], a[76:79], v[68:71]
    v_exp_f32 v88, v88
    v_mfma_f32_16x16x32_bf16 v[76:79], a[136:139], a[104:107], v[76:79]
    ds_read_b128 a[136:139], v3 offset:2304
    v_fma_f32 v90, v90, s24, -v14
    v_mfma_f32_16x16x32_bf16 v[76:79], a[140:143], a[108:111], v[76:79]
    s_waitcnt lgkmcnt(1)
    ds_read_b128 a[140:143], v4 offset:2304
    v_fma_f32 v91, v91, s24, -v14
    v_mfma_f32_16x16x32_bf16 v[52:55], a[128:131], a[16:19], v[52:55]
    v_exp_f32 v89, v89
    v_mfma_f32_16x16x32_bf16 v[52:55], a[132:135], a[20:23], v[52:55]
    v_exp_f32 v90, v90
    v_mfma_f32_16x16x32_bf16 v[60:63], a[128:131], a[48:51], v[60:63]
    v_exp_f32 v91, v91
    v_mfma_f32_16x16x32_bf16 v[60:63], a[132:135], a[52:55], v[60:63]
    v_cvt_pk_bf16_f32 v88, v88, v89
    v_cvt_pk_bf16_f32 v90, v90, v91
    v_mfma_f32_16x16x32_bf16 v[68:71], a[128:131], a[80:83], v[68:71]
    v_accvgpr_write_b32 a148, v88
    v_accvgpr_write_b32 a149, v90
    v_mfma_f32_16x16x32_bf16 v[68:71], a[132:135], a[84:87], v[68:71]
    v_fma_f32 v96, v96, s24, -v15
    v_fma_f32 v97, v97, s24, -v15
    v_mfma_f32_16x16x32_bf16 v[76:79], a[128:131], a[112:115], v[76:79]
    ds_read_b128 a[128:131], v1 offset:16384
    v_fma_f32 v98, v98, s24, -v15
    v_mfma_f32_16x16x32_bf16 v[76:79], a[132:135], a[116:119], v[76:79]
    s_waitcnt lgkmcnt(1)
    ds_read_b128 a[132:135], v2 offset:16384
    v_fma_f32 v99, v99, s24, -v15
    v_mfma_f32_16x16x32_bf16 v[52:55], a[136:139], a[24:27], v[52:55]
    v_exp_f32 v96, v96
    v_mfma_f32_16x16x32_bf16 v[52:55], a[140:143], a[28:31], v[52:55]
    v_exp_f32 v97, v97
    v_mfma_f32_16x16x32_bf16 v[60:63], a[136:139], a[56:59], v[60:63]
    v_exp_f32 v98, v98
    v_mfma_f32_16x16x32_bf16 v[60:63], a[140:143], a[60:63], v[60:63]
    v_exp_f32 v99, v99
    v_mfma_f32_16x16x32_bf16 v[68:71], a[136:139], a[88:91], v[68:71]
    v_cvt_pk_bf16_f32 v96, v96, v97
    v_cvt_pk_bf16_f32 v98, v98, v99
    v_mfma_f32_16x16x32_bf16 v[68:71], a[140:143], a[92:95], v[68:71]
    v_accvgpr_write_b32 a152, v96
    v_accvgpr_write_b32 a153, v98
    v_mfma_f32_16x16x32_bf16 v[76:79], a[136:139], a[120:123], v[76:79]
    ds_read_b128 a[136:139], v3 offset:16384
    v_fma_f32 v104, v104, s24, -v16
    v_mfma_f32_16x16x32_bf16 v[76:79], a[140:143], a[124:127], v[76:79]
    s_waitcnt lgkmcnt(1)
    v_exp_f32 v104, v104
    v_mfma_f32_16x16x32_bf16 v[80:83], a[128:131], a[0:3], 0
    s_add_u32 s20, s46, s73
    s_addc_u32 s21, s47, 0
    ds_read_b128 a[140:143], v4 offset:16384
    v_xor_b32 v46, 64, v9
    v_mfma_f32_16x16x32_bf16 v[80:83], a[132:135], a[4:7], v[80:83]
    s_mov_b32 s22, s74
    v_xor_b32 v44, 128, v9
    v_fma_f32 v105, v105, s24, -v16
    v_mfma_f32_16x16x32_bf16 v[88:91], a[128:131], a[32:35], 0
    s_lshl_b32 s41, s52, 7
    v_exp_f32 v105, v105
    v_mfma_f32_16x16x32_bf16 v[88:91], a[132:135], a[36:39], v[88:91]
    s_and_b32 s8, s41, 384
    v_fma_f32 v106, v106, s24, -v16
    v_fma_f32 v107, v107, s24, -v16
    v_mfma_f32_16x16x32_bf16 v[96:99], a[128:131], a[64:67], 0
    s_xor_b32 s9, s8, 128
    v_exp_f32 v106, v106
    v_mfma_f32_16x16x32_bf16 v[96:99], a[132:135], a[68:71], v[96:99]
    s_xor_b32 s10, s8, 256
    v_exp_f32_e64 v107, v107
    v_cvt_pk_bf16_f32 v104, v104, v105
    v_cvt_pk_bf16_f32 v106, v106, v107
    v_accvgpr_write_b32 a156, v104
    v_accvgpr_write_b32 a157, v106
    v_mfma_f32_16x16x32_bf16 v[104:107], a[128:131], a[96:99], 0
    s_xor_b32 s11, s8, 384
    ds_read_b128 a[128:131], v1 offset:16640
    v_fma_f32 v84, v84, s24, -v13
    v_mfma_f32_16x16x32_bf16 v[104:107], a[132:135], a[100:103], v[104:107]
    s_waitcnt lgkmcnt(1)
    ds_read_b128 a[132:135], v2 offset:16640
    v_fma_f32 v85, v85, s24, -v13
    v_mfma_f32_16x16x32_bf16 v[80:83], a[136:139], a[8:11], v[80:83]
    s_andn2_b32 s41, s29, 0xc000
    v_exp_f32 v84, v84
    v_mfma_f32_16x16x32_bf16 v[80:83], a[140:143], a[12:15], v[80:83]
    s_add_u32 s4, s41, s8
    v_exp_f32 v85, v85
    v_mfma_f32_16x16x32_bf16 v[88:91], a[136:139], a[40:43], v[88:91]
    s_add_u32 s5, s41, s9
    v_fma_f32 v86, v86, s24, -v13
    v_fma_f32 v87, v87, s24, -v13
    v_mfma_f32_16x16x32_bf16 v[88:91], a[140:143], a[44:47], v[88:91]
    s_add_u32 s6, s41, s10
    v_exp_f32 v86, v86
    v_mfma_f32_16x16x32_bf16 v[96:99], a[136:139], a[72:75], v[96:99]
    s_add_u32 s7, s41, s11
    v_exp_f32 v87, v87
    v_mfma_f32_16x16x32_bf16 v[96:99], a[140:143], a[76:79], v[96:99]
    s_waitcnt vmcnt(10)
    v_cvt_pk_bf16_f32 v84, v84, v85
    v_cvt_pk_bf16_f32 v86, v86, v87
    v_mfma_f32_16x16x32_bf16 v[104:107], a[136:139], a[104:107], v[104:107]
    s_barrier
    ds_read_b128 a[136:139], v3 offset:16640
    v_accvgpr_write_b32 a146, v84
    v_mfma_f32_16x16x32_bf16 v[104:107], a[140:143], a[108:111], v[104:107]
    s_waitcnt lgkmcnt(1)
    ds_read_b128 a[140:143], v4 offset:16640
    v_accvgpr_write_b32 a147, v86
    v_mfma_f32_16x16x32_bf16 v[80:83], a[128:131], a[16:19], v[80:83]
    s_add_u32 m0, s30, 0
    v_fma_f32 v92, v92, s24, -v14
    v_fma_f32 v93, v93, s24, -v14
    v_mfma_f32_16x16x32_bf16 v[80:83], a[132:135], a[20:23], v[80:83]
    s_xor_b32 s48, s29, 131072
    v_exp_f32 v92, v92
    v_mfma_f32_16x16x32_bf16 v[88:91], a[128:131], a[48:51], v[88:91]
    buffer_load_dwordx4 v7, s[12:15], s48 offen offset:0 lds
    v_mfma_f32_16x16x32_bf16 v[88:91], a[132:135], a[52:55], v[88:91]
    s_add_u32 s49, s34, 69632
    v_exp_f32 v93, v93
    v_mfma_f32_16x16x32_bf16 v[96:99], a[128:131], a[80:83], v[96:99]
    v_fma_f32 v94, v94, s24, -v14
    v_fma_f32 v95, v95, s24, -v14
    v_mfma_f32_16x16x32_bf16 v[96:99], a[132:135], a[84:87], v[96:99]
    v_exp_f32 v94, v94
    v_mfma_f32_16x16x32_bf16 v[104:107], a[128:131], a[112:115], v[104:107]
    ds_read_b128 a[128:131], v1 offset:18432
    v_cvt_pk_bf16_f32 v92, v92, v93
    v_mfma_f32_16x16x32_bf16 v[104:107], a[132:135], a[116:119], v[104:107]
    s_waitcnt lgkmcnt(1)
    ds_read_b128 a[132:135], v2 offset:18432
    v_accvgpr_write_b32 a150, v92
    v_mfma_f32_16x16x32_bf16 v[80:83], a[136:139], a[24:27], v[80:83]
    buffer_load_dwordx4 v7, s[12:15], s48 offen offset:1024 lds
    v_mfma_f32_16x16x32_bf16 v[80:83], a[140:143], a[28:31], v[80:83]
    v_exp_f32 v95, v95
    v_mfma_f32_16x16x32_bf16 v[88:91], a[136:139], a[56:59], v[88:91]
    v_cvt_pk_bf16_f32 v94, v94, v95
    v_fma_f32 v100, v100, s24, -v15
    v_mfma_f32_16x16x32_bf16 v[88:91], a[140:143], a[60:63], v[88:91]
    v_exp_f32 v100, v100
    v_mfma_f32_16x16x32_bf16 v[96:99], a[136:139], a[88:91], v[96:99]
    buffer_load_dwordx4 v7, s[12:15], s48 offen offset:2048 lds
    v_mfma_f32_16x16x32_bf16 v[96:99], a[140:143], a[92:95], v[96:99]
    v_accvgpr_write_b32 a151, v94
    v_fma_f32 v101, v101, s24, -v15
    v_mfma_f32_16x16x32_bf16 v[104:107], a[136:139], a[120:123], v[104:107]
    ds_read_b128 a[136:139], v3 offset:18432
    v_fma_f32 v102, v102, s24, -v15
    v_mfma_f32_16x16x32_bf16 v[104:107], a[140:143], a[124:127], v[104:107]
    s_waitcnt lgkmcnt(1)
    ds_read_b128 a[140:143], v4 offset:18432
    v_fma_f32 v103, v103, s24, -v15
    v_mfma_f32_16x16x32_bf16 v[84:87], a[128:131], a[0:3], 0
    buffer_load_dwordx4 v7, s[12:15], s48 offen offset:3072 lds
    v_mfma_f32_16x16x32_bf16 v[84:87], a[132:135], a[4:7], v[84:87]
    s_add_u32 m0, s54, 20480
    v_exp_f32 v101, v101
    v_mfma_f32_16x16x32_bf16 v[92:95], a[128:131], a[32:35], 0
    v_exp_f32 v102, v102
    v_mfma_f32_16x16x32_bf16 v[92:95], a[132:135], a[36:39], v[92:95]
    v_exp_f32_e64 v103, v103
    v_cvt_pk_bf16_f32 v100, v100, v101
    v_cvt_pk_bf16_f32 v102, v102, v103
    v_accvgpr_write_b32 a154, v100
    v_accvgpr_write_b32 a155, v102
    v_mfma_f32_16x16x32_bf16 v[100:103], a[128:131], a[64:67], 0
    buffer_load_dwordx4 v9, s[64:67], s49 offen offset:0 nt lds
    v_mfma_f32_16x16x32_bf16 v[100:103], a[132:135], a[68:71], v[100:103]
    v_fma_f32 v108, v108, s24, -v16
    v_fma_f32 v109, v109, s24, -v16
    v_fma_f32 v110, v110, s24, -v16
    v_fma_f32 v111, v111, s24, -v16
    v_exp_f32 v108, v108
    v_exp_f32 v109, v109
    v_exp_f32 v110, v110
    v_exp_f32 v111, v111
L_t4_2:
    s_cbranch_execz L_t4_6
    v_cvt_pk_bf16_f32 v108, v108, v109
    v_cvt_pk_bf16_f32 v110, v110, v111
    v_accvgpr_write_b32 a158, v108
    v_accvgpr_write_b32 a159, v110
    v_mfma_f32_16x16x32_bf16 v[108:111], a[128:131], a[96:99], 0
    ds_read_b128 a[128:131], v1 offset:18688
    v_fma_f32 v48, v48, s24, -v13
    v_mfma_f32_16x16x32_bf16 v[108:111], a[132:135], a[100:103], v[108:111]
    s_waitcnt lgkmcnt(1)
    ds_read_b128 a[132:135], v2 offset:18688
    v_fma_f32 v49, v49, s24, -v13
    v_mfma_f32_16x16x32_bf16 v[84:87], a[136:139], a[8:11], v[84:87]
    buffer_load_dwordx4 v46, s[64:67], s49 offen offset:1024 nt lds
    v_mfma_f32_16x16x32_bf16 v[84:87], a[140:143], a[12:15], v[84:87]
    v_exp_f32 v48, v48
    v_mfma_f32_16x16x32_bf16 v[92:95], a[136:139], a[40:43], v[92:95]
    v_exp_f32 v49, v49
    v_mfma_f32_16x16x32_bf16 v[92:95], a[140:143], a[44:47], v[92:95]
    v_fma_f32 v50, v50, s24, -v13
    v_fma_f32 v51, v51, s24, -v13
    v_mfma_f32_16x16x32_bf16 v[100:103], a[136:139], a[72:75], v[100:103]
    buffer_load_dwordx4 v44, s[64:67], s49 offen offset:2048 nt lds
    v_mfma_f32_16x16x32_bf16 v[100:103], a[140:143], a[76:79], v[100:103]
    v_exp_f32 v50, v50
    v_mfma_f32_16x16x32_bf16 v[108:111], a[136:139], a[104:107], v[108:111]
    ds_read_b128 a[136:139], v3 offset:18688
    v_cvt_pk_bf16_f32 v160, v48, v49
    v_mfma_f32_16x16x32_bf16 v[108:111], a[140:143], a[108:111], v[108:111]
    ds_read_b128 a[140:143], v4 offset:18688
    v_fma_f32 v56, v56, s24, -v14
    v_mfma_f32_16x16x32_bf16 v[26:29], v[22:25], v[144:147], v[26:29]
    v_exp_f32 v51, v51
    v_mfma_f32_16x16x32_bf16 v[26:29], v[22:25], a[144:147], v[26:29]
    v_exp_f32 v56, v56
    v_mfma_f32_16x16x32_bf16 v[30:33], v[22:25], v[148:151], v[30:33]
    v_cvt_pk_bf16_f32 v161, v50, v51
    v_fma_f32 v57, v57, s24, -v14
    v_mfma_f32_16x16x32_bf16 v[30:33], v[22:25], a[148:151], v[30:33]
    v_exp_f32 v57, v57
    v_mfma_f32_16x16x32_bf16 v[34:37], v[22:25], v[152:155], v[34:37]
    v_fma_f32 v58, v58, s24, -v14
    v_fma_f32 v59, v59, s24, -v14
    v_mfma_f32_16x16x32_bf16 v[34:37], v[22:25], a[152:155], v[34:37]
    v_exp_f32 v58, v58
    v_mfma_f32_16x16x32_bf16 v[38:41], v[22:25], v[156:159], v[38:41]
    v_exp_f32 v59, v59
    v_mfma_f32_16x16x32_bf16 v[38:41], v[22:25], a[156:159], v[38:41]
    s_waitcnt lgkmcnt(2)
    v_cvt_pk_bf16_f32 v164, v56, v57
    v_cvt_pk_bf16_f32 v165, v58, v59
    v_mfma_f32_16x16x32_bf16 v[84:87], a[128:131], a[16:19], v[84:87]
    v_fma_f32 v64, v64, s24, -v15
    v_fma_f32 v65, v65, s24, -v15
    v_mfma_f32_16x16x32_bf16 v[84:87], a[132:135], a[20:23], v[84:87]
    v_exp_f32 v64, v64
    v_mfma_f32_16x16x32_bf16 v[92:95], a[128:131], a[48:51], v[92:95]
    v_exp_f32 v65, v65
    v_mfma_f32_16x16x32_bf16 v[92:95], a[132:135], a[52:55], v[92:95]
    v_fma_f32 v66, v66, s24, -v15
    v_fma_f32 v67, v67, s24, -v15
    v_mfma_f32_16x16x32_bf16 v[100:103], a[128:131], a[80:83], v[100:103]
    v_exp_f32 v66, v66
    v_mfma_f32_16x16x32_bf16 v[100:103], a[132:135], a[84:87], v[100:103]
    v_exp_f32 v67, v67
    v_mfma_f32_16x16x32_bf16 v[108:111], a[128:131], a[112:115], v[108:111]
    ds_read_b128 a[128:131], v1 offset:32768
    v_cvt_pk_bf16_f32 v168, v64, v65
    v_mfma_f32_16x16x32_bf16 v[108:111], a[132:135], a[116:119], v[108:111]
    s_waitcnt lgkmcnt(1)
    ds_read_b128 a[132:135], v2 offset:32768
    v_cvt_pk_bf16_f32 v169, v66, v67
    v_mfma_f32_16x16x32_bf16 v[84:87], a[136:139], a[24:27], v[84:87]
    v_fma_f32 v72, v72, s24, -v16
    v_fma_f32 v73, v73, s24, -v16
    v_mfma_f32_16x16x32_bf16 v[84:87], a[140:143], a[28:31], v[84:87]
    v_exp_f32 v72, v72
    v_mfma_f32_16x16x32_bf16 v[92:95], a[136:139], a[56:59], v[92:95]
    v_exp_f32 v73, v73
    v_mfma_f32_16x16x32_bf16 v[92:95], a[140:143], a[60:63], v[92:95]
    v_fma_f32 v74, v74, s24, -v16
    v_fma_f32 v75, v75, s24, -v16
    v_mfma_f32_16x16x32_bf16 v[100:103], a[136:139], a[88:91], v[100:103]
    v_exp_f32 v74, v74
    v_mfma_f32_16x16x32_bf16 v[100:103], a[140:143], a[92:95], v[100:103]
    v_exp_f32 v75, v75
    v_mfma_f32_16x16x32_bf16 v[108:111], a[136:139], a[120:123], v[108:111]
    ds_read_b128 a[136:139], v3 offset:32768
    v_cvt_pk_bf16_f32 v172, v72, v73
    v_mfma_f32_16x16x32_bf16 v[108:111], a[140:143], a[124:127], v[108:111]
    s_waitcnt lgkmcnt(1)
    v_cvt_pk_bf16_f32 v173, v74, v75
    v_fma_f32 v52, v52, s24, -v13
    v_mfma_f32_16x16x32_bf16 v[48:51], a[128:131], a[0:3], 0
    s_waitcnt vmcnt(9)
    ds_read_b128 a[140:143], v4 offset:32768
    v_xor_b32 v46, 192, v9
    v_mfma_f32_16x16x32_bf16 v[48:51], a[132:135], a[4:7], v[48:51]
    s_barrier
    v_exp_f32 v52, v52
    v_mfma_f32_16x16x32_bf16 v[56:59], a[128:131], a[32:35], 0
    s_add_u32 m0, s30, 16384
    v_fma_f32 v53, v53, s24, -v13
    v_fma_f32 v54, v54, s24, -v13
    v_mfma_f32_16x16x32_bf16 v[56:59], a[132:135], a[36:39], v[56:59]
    s_xor_b32 s48, s29, 147456
    v_exp_f32 v53, v53
    v_mfma_f32_16x16x32_bf16 v[64:67], a[128:131], a[64:67], 0
    buffer_load_dwordx4 v7, s[12:15], s48 offen offset:0 lds
    v_mfma_f32_16x16x32_bf16 v[64:67], a[132:135], a[68:71], v[64:67]
    s_add_u32 s49, s34, 69632
    v_exp_f32 v54, v54
    v_mfma_f32_16x16x32_bf16 v[72:75], a[128:131], a[96:99], 0
    ds_read_b128 a[128:131], v1 offset:33024
    v_fma_f32 v55, v55, s24, -v13
    v_mfma_f32_16x16x32_bf16 v[72:75], a[132:135], a[100:103], v[72:75]
    s_waitcnt lgkmcnt(1)
    ds_read_b128 a[132:135], v2 offset:33024
    v_cvt_pk_bf16_f32 v162, v52, v53
    v_mfma_f32_16x16x32_bf16 v[48:51], a[136:139], a[8:11], v[48:51]
    buffer_load_dwordx4 v7, s[12:15], s48 offen offset:1024 lds
    v_mfma_f32_16x16x32_bf16 v[48:51], a[140:143], a[12:15], v[48:51]
    v_exp_f32 v55, v55
    v_mfma_f32_16x16x32_bf16 v[56:59], a[136:139], a[40:43], v[56:59]
    v_cvt_pk_bf16_f32 v163, v54, v55
    v_fma_f32 v60, v60, s24, -v14
    v_mfma_f32_16x16x32_bf16 v[56:59], a[140:143], a[44:47], v[56:59]
    v_exp_f32 v60, v60
    v_mfma_f32_16x16x32_bf16 v[64:67], a[136:139], a[72:75], v[64:67]
    buffer_load_dwordx4 v7, s[12:15], s48 offen offset:2048 lds
    v_mfma_f32_16x16x32_bf16 v[64:67], a[140:143], a[76:79], v[64:67]
    v_fma_f32 v61, v61, s24, -v14
    v_fma_f32 v62, v62, s24, -v14
    v_mfma_f32_16x16x32_bf16 v[72:75], a[136:139], a[104:107], v[72:75]
    ds_read_b128 a[136:139], v3 offset:33024
    v_fma_f32 v63, v63, s24, -v14
    v_mfma_f32_16x16x32_bf16 v[72:75], a[140:143], a[108:111], v[72:75]
    s_waitcnt lgkmcnt(1)
    ds_read_b128 a[140:143], v4 offset:33024
    v_fma_f32 v68, v68, s24, -v15
    v_mfma_f32_16x16x32_bf16 v[48:51], a[128:131], a[16:19], v[48:51]
    buffer_load_dwordx4 v7, s[12:15], s48 offen offset:3072 lds
    v_mfma_f32_16x16x32_bf16 v[48:51], a[132:135], a[20:23], v[48:51]
    s_add_u32 m0, s54, 20480
    v_exp_f32 v61, v61
    v_mfma_f32_16x16x32_bf16 v[56:59], a[128:131], a[48:51], v[56:59]
    v_exp_f32 v62, v62
    v_mfma_f32_16x16x32_bf16 v[56:59], a[132:135], a[52:55], v[56:59]
    v_exp_f32 v63, v63
    v_mfma_f32_16x16x32_bf16 v[64:67], a[128:131], a[80:83], v[64:67]
    buffer_load_dwordx4 v46, s[64:67], s49 offen offset:3072 nt lds
    v_mfma_f32_16x16x32_bf16 v[64:67], a[132:135], a[84:87], v[64:67]
    s_add_u32 m0, s54, 0
    v_exp_f32 v68, v68
    v_mfma_f32_16x16x32_bf16 v[72:75], a[128:131], a[112:115], v[72:75]
    s_mov_b32 s49, 0
    ds_read_b128 a[128:131], v1 offset:34816
    v_cvt_pk_bf16_f32 v166, v60, v61
    v_mfma_f32_16x16x32_bf16 v[72:75], a[132:135], a[116:119], v[72:75]
    s_waitcnt lgkmcnt(1)
    ds_read_b128 a[132:135], v2 offset:34816
    v_cvt_pk_bf16_f32 v167, v62, v63
    v_mfma_f32_16x16x32_bf16 v[48:51], a[136:139], a[24:27], v[48:51]
    buffer_load_dwordx4 v9, s[64:67], s49 offen offset:0 nt lds
    v_mfma_f32_16x16x32_bf16 v[48:51], a[140:143], a[28:31], v[48:51]
    v_fma_f32 v69, v69, s24, -v15
    v_fma_f32 v70, v70, s24, -v15
    v_mfma_f32_16x16x32_bf16 v[56:59], a[136:139], a[56:59], v[56:59]
    v_exp_f32 v69, v69
    v_mfma_f32_16x16x32_bf16 v[56:59], a[140:143], a[60:63], v[56:59]
    v_exp_f32 v70, v70
    v_mfma_f32_16x16x32_bf16 v[64:67], a[136:139], a[88:91], v[64:67]
    v_fma_f32 v71, v71, s24, -v15
    v_cvt_pk_bf16_f32 v170, v68, v69
    v_mfma_f32_16x16x32_bf16 v[64:67], a[140:143], a[92:95], v[64:67]
    v_exp_f32 v71, v71
    v_mfma_f32_16x16x32_bf16 v[72:75], a[136:139], a[120:123], v[72:75]
    ds_read_b128 a[136:139], v3 offset:34816
    v_cvt_pk_bf16_f32 v171, v70, v71
    v_mfma_f32_16x16x32_bf16 v[72:75], a[140:143], a[124:127], v[72:75]
    s_waitcnt lgkmcnt(1)
    ds_read_b128 a[140:143], v4 offset:34816
    v_fma_f32 v76, v76, s24, -v16
    v_mfma_f32_16x16x32_bf16 v[52:55], a[128:131], a[0:3], 0
    v_exp_f32 v76, v76
    v_mfma_f32_16x16x32_bf16 v[52:55], a[132:135], a[4:7], v[52:55]
    v_fma_f32 v77, v77, s24, -v16
    v_fma_f32 v78, v78, s24, -v16
    v_mfma_f32_16x16x32_bf16 v[60:63], a[128:131], a[32:35], 0
    v_exp_f32 v77, v77
    v_mfma_f32_16x16x32_bf16 v[60:63], a[132:135], a[36:39], v[60:63]
    v_exp_f32 v78, v78
    v_mfma_f32_16x16x32_bf16 v[68:71], a[128:131], a[64:67], 0
    v_fma_f32 v79, v79, s24, -v16
    v_cvt_pk_bf16_f32 v174, v76, v77
    v_mfma_f32_16x16x32_bf16 v[68:71], a[132:135], a[68:71], v[68:71]
    v_exp_f32 v79, v79
    s_nop 0
    v_cvt_pk_bf16_f32 v175, v78, v79
    v_mfma_f32_16x16x32_bf16 v[76:79], a[128:131], a[96:99], 0
    ds_read_b128 a[128:131], v1 offset:35072
    v_fma_f32 v80, v80, s24, -v13
    v_mfma_f32_16x16x32_bf16 v[76:79], a[132:135], a[100:103], v[76:79]
    s_waitcnt lgkmcnt(1)
    ds_read_b128 a[132:135], v2 offset:35072
    v_fma_f32 v81, v81, s24, -v13
    v_mfma_f32_16x16x32_bf16 v[52:55], a[136:139], a[8:11], v[52:55]
    v_exp_f32 v80, v80
    v_mfma_f32_16x16x32_bf16 v[52:55], a[140:143], a[12:15], v[52:55]
    v_exp_f32 v81, v81
    v_mfma_f32_16x16x32_bf16 v[60:63], a[136:139], a[40:43], v[60:63]
    v_fma_f32 v82, v82, s24, -v13
    v_fma_f32 v83, v83, s24, -v13
    v_mfma_f32_16x16x32_bf16 v[60:63], a[140:143], a[44:47], v[60:63]
    v_exp_f32 v82, v82
    v_mfma_f32_16x16x32_bf16 v[68:71], a[136:139], a[72:75], v[68:71]
    v_exp_f32 v83, v83
    v_mfma_f32_16x16x32_bf16 v[68:71], a[140:143], a[76:79], v[68:71]
    v_cvt_pk_bf16_f32 v80, v80, v81
    v_cvt_pk_bf16_f32 v82, v82, v83
    v_mfma_f32_16x16x32_bf16 v[76:79], a[136:139], a[104:107], v[76:79]
    ds_read_b128 a[136:139], v3 offset:35072
    v_accvgpr_write_b32 a160, v80
    v_mfma_f32_16x16x32_bf16 v[76:79], a[140:143], a[108:111], v[76:79]
    s_waitcnt lgkmcnt(1)
    ds_read_b128 a[140:143], v4 offset:35072
    v_accvgpr_write_b32 a161, v82
    v_mfma_f32_16x16x32_bf16 v[52:55], a[128:131], a[16:19], v[52:55]
    v_fma_f32 v88, v88, s24, -v14
    v_fma_f32 v89, v89, s24, -v14
    v_mfma_f32_16x16x32_bf16 v[52:55], a[132:135], a[20:23], v[52:55]
    v_exp_f32 v88, v88
    v_mfma_f32_16x16x32_bf16 v[60:63], a[128:131], a[48:51], v[60:63]
    v_exp_f32 v89, v89
    v_mfma_f32_16x16x32_bf16 v[60:63], a[132:135], a[52:55], v[60:63]
    v_fma_f32 v90, v90, s24, -v14
    v_fma_f32 v91, v91, s24, -v14
    v_mfma_f32_16x16x32_bf16 v[68:71], a[128:131], a[80:83], v[68:71]
    v_exp_f32 v90, v90
    v_mfma_f32_16x16x32_bf16 v[68:71], a[132:135], a[84:87], v[68:71]
    v_exp_f32 v91, v91
    v_mfma_f32_16x16x32_bf16 v[76:79], a[128:131], a[112:115], v[76:79]
    ds_read_b128 a[128:131], v1 offset:49152
    v_cvt_pk_bf16_f32 v88, v88, v89
    v_mfma_f32_16x16x32_bf16 v[76:79], a[132:135], a[116:119], v[76:79]
    s_waitcnt lgkmcnt(1)
    ds_read_b128 a[132:135], v2 offset:49152
    v_accvgpr_write_b32 a164, v88
    v_mfma_f32_16x16x32_bf16 v[52:55], a[136:139], a[24:27], v[52:55]
    v_cvt_pk_bf16_f32 v90, v90, v91
    v_fma_f32 v96, v96, s24, -v15
    v_mfma_f32_16x16x32_bf16 v[52:55], a[140:143], a[28:31], v[52:55]
    v_exp_f32 v96, v96
    v_mfma_f32_16x16x32_bf16 v[60:63], a[136:139], a[56:59], v[60:63]
    v_accvgpr_write_b32 a165, v90
    v_fma_f32 v97, v97, s24, -v15
    v_mfma_f32_16x16x32_bf16 v[60:63], a[140:143], a[60:63], v[60:63]
    v_exp_f32 v97, v97
    v_mfma_f32_16x16x32_bf16 v[68:71], a[136:139], a[88:91], v[68:71]
    v_fma_f32 v98, v98, s24, -v15
    v_fma_f32 v99, v99, s24, -v15
    v_mfma_f32_16x16x32_bf16 v[68:71], a[140:143], a[92:95], v[68:71]
    v_exp_f32 v98, v98
    v_mfma_f32_16x16x32_bf16 v[76:79], a[136:139], a[120:123], v[76:79]
    ds_read_b128 a[136:139], v3 offset:49152
    v_cvt_pk_bf16_f32 v96, v96, v97
    v_mfma_f32_16x16x32_bf16 v[76:79], a[140:143], a[124:127], v[76:79]
    s_waitcnt lgkmcnt(1)
    v_exp_f32 v99, v99
    v_mfma_f32_16x16x32_bf16 v[80:83], a[128:131], a[0:3], 0
    s_waitcnt vmcnt(9)
    ds_read_b128 a[140:143], v4 offset:49152
    v_xor_b32 v46, 64, v9
    v_mfma_f32_16x16x32_bf16 v[80:83], a[132:135], a[4:7], v[80:83]
    s_barrier
    v_xor_b32 v44, 128, v9
    v_accvgpr_write_b32 a168, v96
    v_mfma_f32_16x16x32_bf16 v[88:91], a[128:131], a[32:35], 0
    s_add_u32 m0, s30, 32768
    v_cvt_pk_bf16_f32 v98, v98, v99
    v_fma_f32 v104, v104, s24, -v16
    v_mfma_f32_16x16x32_bf16 v[88:91], a[132:135], a[36:39], v[88:91]
    s_xor_b32 s48, s29, 163840
    v_exp_f32 v104, v104
    v_accvgpr_write_b32 a169, v98
    v_mfma_f32_16x16x32_bf16 v[96:99], a[128:131], a[64:67], 0
    buffer_load_dwordx4 v7, s[12:15], s48 offen offset:0 lds
    v_mfma_f32_16x16x32_bf16 v[96:99], a[132:135], a[68:71], v[96:99]
    s_mov_b32 s49, 0
    v_fma_f32 v105, v105, s24, -v16
    v_fma_f32 v106, v106, s24, -v16
    v_fma_f32 v107, v107, s24, -v16
    v_exp_f32 v105, v105
    v_exp_f32 v106, v106
    v_exp_f32 v107, v107
    v_cvt_pk_bf16_f32 v104, v104, v105
    v_cvt_pk_bf16_f32 v106, v106, v107
    v_accvgpr_write_b32 a172, v104
    v_accvgpr_write_b32 a173, v106
    v_mfma_f32_16x16x32_bf16 v[104:107], a[128:131], a[96:99], 0
    ds_read_b128 a[128:131], v1 offset:49408
    v_fma_f32 v84, v84, s24, -v13
    v_mfma_f32_16x16x32_bf16 v[104:107], a[132:135], a[100:103], v[104:107]
    s_waitcnt lgkmcnt(1)
    ds_read_b128 a[132:135], v2 offset:49408
    v_fma_f32 v85, v85, s24, -v13
    v_mfma_f32_16x16x32_bf16 v[80:83], a[136:139], a[8:11], v[80:83]
    buffer_load_dwordx4 v7, s[12:15], s48 offen offset:1024 lds
    v_mfma_f32_16x16x32_bf16 v[80:83], a[140:143], a[12:15], v[80:83]
    v_exp_f32 v84, v84
    v_mfma_f32_16x16x32_bf16 v[88:91], a[136:139], a[40:43], v[88:91]
    v_exp_f32 v85, v85
    v_mfma_f32_16x16x32_bf16 v[88:91], a[140:143], a[44:47], v[88:91]
    v_fma_f32 v86, v86, s24, -v13
    v_fma_f32 v87, v87, s24, -v13
    v_mfma_f32_16x16x32_bf16 v[96:99], a[136:139], a[72:75], v[96:99]
    buffer_load_dwordx4 v7, s[12:15], s48 offen offset:2048 lds
    v_mfma_f32_16x16x32_bf16 v[96:99], a[140:143], a[76:79], v[96:99]
    v_exp_f32 v86, v86
    v_mfma_f32_16x16x32_bf16 v[104:107], a[136:139], a[104:107], v[104:107]
    ds_read_b128 a[136:139], v3 offset:49408
    v_cvt_pk_bf16_f32 v84, v84, v85
    v_mfma_f32_16x16x32_bf16 v[104:107], a[140:143], a[108:111], v[104:107]
    s_waitcnt lgkmcnt(1)
    ds_read_b128 a[140:143], v4 offset:49408
    v_accvgpr_write_b32 a162, v84
    v_mfma_f32_16x16x32_bf16 v[80:83], a[128:131], a[16:19], v[80:83]
    buffer_load_dwordx4 v7, s[12:15], s48 offen offset:3072 lds
    v_mfma_f32_16x16x32_bf16 v[80:83], a[132:135], a[20:23], v[80:83]
    s_add_u32 m0, s54, 0
    v_exp_f32 v87, v87
    v_mfma_f32_16x16x32_bf16 v[88:91], a[128:131], a[48:51], v[88:91]
    v_cvt_pk_bf16_f32 v86, v86, v87
    v_fma_f32 v92, v92, s24, -v14
    v_mfma_f32_16x16x32_bf16 v[88:91], a[132:135], a[52:55], v[88:91]
    v_exp_f32 v92, v92
    v_mfma_f32_16x16x32_bf16 v[96:99], a[128:131], a[80:83], v[96:99]
    buffer_load_dwordx4 v46, s[64:67], s49 offen offset:1024 nt lds
    v_mfma_f32_16x16x32_bf16 v[96:99], a[132:135], a[84:87], v[96:99]
    v_xor_b32 v46, 192, v9
    v_accvgpr_write_b32 a163, v86
    v_mfma_f32_16x16x32_bf16 v[104:107], a[128:131], a[112:115], v[104:107]
    ds_read_b128 a[128:131], v1 offset:51200
    v_fma_f32 v93, v93, s24, -v14
    v_mfma_f32_16x16x32_bf16 v[104:107], a[132:135], a[116:119], v[104:107]
    s_waitcnt lgkmcnt(1)
    ds_read_b128 a[132:135], v2 offset:51200
    v_fma_f32 v94, v94, s24, -v14
    v_mfma_f32_16x16x32_bf16 v[80:83], a[136:139], a[24:27], v[80:83]
    buffer_load_dwordx4 v44, s[64:67], s49 offen offset:2048 nt lds
    v_mfma_f32_16x16x32_bf16 v[80:83], a[140:143], a[28:31], v[80:83]
    v_exp_f32 v93, v93
    v_mfma_f32_16x16x32_bf16 v[88:91], a[136:139], a[56:59], v[88:91]
    v_exp_f32 v94, v94
    v_mfma_f32_16x16x32_bf16 v[88:91], a[140:143], a[60:63], v[88:91]
    v_fma_f32 v95, v95, s24, -v14
    v_cvt_pk_bf16_f32 v92, v92, v93
    v_mfma_f32_16x16x32_bf16 v[96:99], a[136:139], a[88:91], v[96:99]
    buffer_load_dwordx4 v46, s[64:67], s49 offen offset:3072 nt lds
    v_mfma_f32_16x16x32_bf16 v[96:99], a[140:143], a[92:95], v[96:99]
    v_exp_f32 v95, v95
    v_mfma_f32_16x16x32_bf16 v[104:107], a[136:139], a[120:123], v[104:107]
    ds_read_b128 a[136:139], v3 offset:51200
    v_accvgpr_write_b32 a166, v92
    v_mfma_f32_16x16x32_bf16 v[104:107], a[140:143], a[124:127], v[104:107]
    s_waitcnt lgkmcnt(1)
    ds_read_b128 a[140:143], v4 offset:51200
    v_cvt_pk_bf16_f32 v94, v94, v95
    v_mfma_f32_16x16x32_bf16 v[84:87], a[128:131], a[0:3], 0
    v_accvgpr_write_b32 a167, v94
    v_fma_f32 v100, v100, s24, -v15
    v_mfma_f32_16x16x32_bf16 v[84:87], a[132:135], a[4:7], v[84:87]
    v_exp_f32 v100, v100
    v_mfma_f32_16x16x32_bf16 v[92:95], a[128:131], a[32:35], 0
    v_fma_f32 v101, v101, s24, -v15
    v_fma_f32 v102, v102, s24, -v15
    v_mfma_f32_16x16x32_bf16 v[92:95], a[132:135], a[36:39], v[92:95]
    v_exp_f32_e64 v101, v101
    v_fma_f32 v103, v103, s24, -v15
    v_exp_f32 v102, v102
    v_exp_f32 v103, v103
    v_cvt_pk_bf16_f32 v100, v100, v101
    v_cvt_pk_bf16_f32 v102, v102, v103
    v_accvgpr_write_b32 a170, v100
    v_accvgpr_write_b32 a171, v102
    v_mfma_f32_16x16x32_bf16 v[100:103], a[128:131], a[64:67], 0
    v_fma_f32 v108, v108, s24, -v16
    v_fma_f32 v109, v109, s24, -v16
    v_mfma_f32_16x16x32_bf16 v[100:103], a[132:135], a[68:71], v[100:103]
    v_exp_f32_e64 v108, v108
    v_fma_f32 v110, v110, s24, -v16
    v_fma_f32 v111, v111, s24, -v16
    v_exp_f32 v109, v109
    v_exp_f32 v110, v110
    v_exp_f32_e64 v111, v111
    v_cvt_pk_bf16_f32 v108, v108, v109
    v_cvt_pk_bf16_f32 v110, v110, v111
    v_accvgpr_write_b32 a174, v108
    v_accvgpr_write_b32 a175, v110
    v_mfma_f32_16x16x32_bf16 v[108:111], a[128:131], a[96:99], 0
    ds_read_b128 a[128:131], v1 offset:51456
    v_fma_f32 v48, v48, s24, -v13
    v_mfma_f32_16x16x32_bf16 v[108:111], a[132:135], a[100:103], v[108:111]
    s_waitcnt lgkmcnt(1)
    ds_read_b128 a[132:135], v2 offset:51456
    v_fma_f32 v49, v49, s24, -v13
    v_mfma_f32_16x16x32_bf16 v[84:87], a[136:139], a[8:11], v[84:87]
    v_exp_f32 v48, v48
    v_mfma_f32_16x16x32_bf16 v[84:87], a[140:143], a[12:15], v[84:87]
    v_exp_f32 v49, v49
    v_mfma_f32_16x16x32_bf16 v[92:95], a[136:139], a[40:43], v[92:95]
    v_fma_f32 v50, v50, s24, -v13
    v_fma_f32 v51, v51, s24, -v13
    v_mfma_f32_16x16x32_bf16 v[92:95], a[140:143], a[44:47], v[92:95]
    v_exp_f32 v50, v50
    v_mfma_f32_16x16x32_bf16 v[100:103], a[136:139], a[72:75], v[100:103]
    v_exp_f32 v51, v51
    v_mfma_f32_16x16x32_bf16 v[100:103], a[140:143], a[76:79], v[100:103]
    v_cvt_pk_bf16_f32 v176, v48, v49
    v_cvt_pk_bf16_f32 v177, v50, v51
    v_mfma_f32_16x16x32_bf16 v[108:111], a[136:139], a[104:107], v[108:111]
    ds_read_b128 a[136:139], v3 offset:51456
    v_fma_f32 v56, v56, s24, -v14
    v_mfma_f32_16x16x32_bf16 v[108:111], a[140:143], a[108:111], v[108:111]
    ds_read_b128 a[140:143], v4 offset:51456
    v_fma_f32 v57, v57, s24, -v14
    v_mfma_f32_16x16x32_bf16 v[26:29], v[22:25], v[160:163], v[26:29]
    v_exp_f32 v56, v56
    v_mfma_f32_16x16x32_bf16 v[26:29], v[22:25], a[160:163], v[26:29]
    v_exp_f32 v57, v57
    v_mfma_f32_16x16x32_bf16 v[30:33], v[22:25], v[164:167], v[30:33]
    v_fma_f32 v58, v58, s24, -v14
    v_fma_f32 v59, v59, s24, -v14
    v_mfma_f32_16x16x32_bf16 v[30:33], v[22:25], a[164:167], v[30:33]
    v_exp_f32 v58, v58
    v_mfma_f32_16x16x32_bf16 v[34:37], v[22:25], v[168:171], v[34:37]
    v_exp_f32 v59, v59
    v_mfma_f32_16x16x32_bf16 v[34:37], v[22:25], a[168:171], v[34:37]
    v_cvt_pk_bf16_f32 v180, v56, v57
    v_cvt_pk_bf16_f32 v181, v58, v59
    v_mfma_f32_16x16x32_bf16 v[38:41], v[22:25], v[172:175], v[38:41]
    v_fma_f32 v64, v64, s24, -v15
    v_fma_f32 v65, v65, s24, -v15
    v_mfma_f32_16x16x32_bf16 v[38:41], v[22:25], a[172:175], v[38:41]
    s_waitcnt lgkmcnt(2)
    v_exp_f32 v64, v64
    v_mfma_f32_16x16x32_bf16 v[84:87], a[128:131], a[16:19], v[84:87]
    v_exp_f32 v65, v65
    v_mfma_f32_16x16x32_bf16 v[84:87], a[132:135], a[20:23], v[84:87]
    v_fma_f32 v66, v66, s24, -v15
    v_fma_f32 v67, v67, s24, -v15
    v_mfma_f32_16x16x32_bf16 v[92:95], a[128:131], a[48:51], v[92:95]
    v_exp_f32 v66, v66
    v_mfma_f32_16x16x32_bf16 v[92:95], a[132:135], a[52:55], v[92:95]
    v_exp_f32 v67, v67
    v_mfma_f32_16x16x32_bf16 v[100:103], a[128:131], a[80:83], v[100:103]
    v_cvt_pk_bf16_f32 v184, v64, v65
    v_cvt_pk_bf16_f32 v185, v66, v67
    v_mfma_f32_16x16x32_bf16 v[100:103], a[132:135], a[84:87], v[100:103]
    v_fma_f32 v72, v72, s24, -v16
    v_fma_f32 v73, v73, s24, -v16
    v_mfma_f32_16x16x32_bf16 v[108:111], a[128:131], a[112:115], v[108:111]
    ds_read_b128 a[128:131], v1 offset:0
    v_fma_f32 v74, v74, s24, -v16
    v_mfma_f32_16x16x32_bf16 v[108:111], a[132:135], a[116:119], v[108:111]
    s_waitcnt lgkmcnt(1)
    ds_read_b128 a[132:135], v2 offset:0
    v_fma_f32 v75, v75, s24, -v16
    v_mfma_f32_16x16x32_bf16 v[84:87], a[136:139], a[24:27], v[84:87]
    v_exp_f32 v72, v72
    v_mfma_f32_16x16x32_bf16 v[84:87], a[140:143], a[28:31], v[84:87]
    v_exp_f32 v73, v73
    v_mfma_f32_16x16x32_bf16 v[92:95], a[136:139], a[56:59], v[92:95]
    v_exp_f32 v74, v74
    v_mfma_f32_16x16x32_bf16 v[92:95], a[140:143], a[60:63], v[92:95]
    v_exp_f32 v75, v75
    v_mfma_f32_16x16x32_bf16 v[100:103], a[136:139], a[88:91], v[100:103]
    v_cvt_pk_bf16_f32 v188, v72, v73
    v_cvt_pk_bf16_f32 v189, v74, v75
    v_mfma_f32_16x16x32_bf16 v[100:103], a[140:143], a[92:95], v[100:103]
    v_fma_f32 v52, v52, s24, -v13
    v_fma_f32 v53, v53, s24, -v13
    v_mfma_f32_16x16x32_bf16 v[108:111], a[136:139], a[120:123], v[108:111]
    ds_read_b128 a[136:139], v3 offset:0
    v_fma_f32 v54, v54, s24, -v13
    v_mfma_f32_16x16x32_bf16 v[108:111], a[140:143], a[124:127], v[108:111]
    s_waitcnt lgkmcnt(1)
    v_exp_f32 v52, v52
    v_mfma_f32_16x16x32_bf16 v[48:51], a[128:131], a[0:3], 0
    s_waitcnt vmcnt(9)
    ds_read_b128 a[140:143], v4 offset:0
    v_xor_b32 v46, 64, v9
    v_mfma_f32_16x16x32_bf16 v[48:51], a[132:135], a[4:7], v[48:51]
    s_barrier
    v_exp_f32 v53, v53
    v_mfma_f32_16x16x32_bf16 v[56:59], a[128:131], a[32:35], 0
    s_add_u32 m0, s30, 49152
    v_exp_f32 v54, v54
    v_mfma_f32_16x16x32_bf16 v[56:59], a[132:135], a[36:39], v[56:59]
    s_xor_b32 s48, s29, 180224
    v_fma_f32 v55, v55, s24, -v13
    v_cvt_pk_bf16_f32 v178, v52, v53
    v_mfma_f32_16x16x32_bf16 v[64:67], a[128:131], a[64:67], 0
    buffer_load_dwordx4 v7, s[12:15], s48 offen offset:0 lds
    v_mfma_f32_16x16x32_bf16 v[64:67], a[132:135], a[68:71], v[64:67]
    s_mov_b32 s49, 4096
    v_exp_f32 v55, v55
    v_mfma_f32_16x16x32_bf16 v[72:75], a[128:131], a[96:99], 0
    ds_read_b128 a[128:131], v1 offset:256
    v_cvt_pk_bf16_f32 v179, v54, v55
    v_mfma_f32_16x16x32_bf16 v[72:75], a[132:135], a[100:103], v[72:75]
    s_waitcnt lgkmcnt(1)
    ds_read_b128 a[132:135], v2 offset:256
    v_fma_f32 v60, v60, s24, -v14
    v_mfma_f32_16x16x32_bf16 v[48:51], a[136:139], a[8:11], v[48:51]
    buffer_load_dwordx4 v7, s[12:15], s48 offen offset:1024 lds
    v_mfma_f32_16x16x32_bf16 v[48:51], a[140:143], a[12:15], v[48:51]
    v_exp_f32 v60, v60
    v_mfma_f32_16x16x32_bf16 v[56:59], a[136:139], a[40:43], v[56:59]
    v_fma_f32 v61, v61, s24, -v14
    v_fma_f32 v62, v62, s24, -v14
    v_mfma_f32_16x16x32_bf16 v[56:59], a[140:143], a[44:47], v[56:59]
    v_exp_f32 v61, v61
    v_mfma_f32_16x16x32_bf16 v[64:67], a[136:139], a[72:75], v[64:67]
    buffer_load_dwordx4 v7, s[12:15], s48 offen offset:2048 lds
    v_mfma_f32_16x16x32_bf16 v[64:67], a[140:143], a[76:79], v[64:67]
    v_exp_f32 v62, v62
    v_mfma_f32_16x16x32_bf16 v[72:75], a[136:139], a[104:107], v[72:75]
    ds_read_b128 a[136:139], v3 offset:256
    v_fma_f32 v63, v63, s24, -v14
    v_mfma_f32_16x16x32_bf16 v[72:75], a[140:143], a[108:111], v[72:75]
    s_waitcnt lgkmcnt(1)
    ds_read_b128 a[140:143], v4 offset:256
    v_cvt_pk_bf16_f32 v182, v60, v61
    v_mfma_f32_16x16x32_bf16 v[48:51], a[128:131], a[16:19], v[48:51]
    buffer_load_dwordx4 v7, s[12:15], s48 offen offset:3072 lds
    v_mfma_f32_16x16x32_bf16 v[48:51], a[132:135], a[20:23], v[48:51]
    s_add_u32 m0, s54, 4096
    v_exp_f32 v63, v63
    v_mfma_f32_16x16x32_bf16 v[56:59], a[128:131], a[48:51], v[56:59]
    v_cvt_pk_bf16_f32 v183, v62, v63
    v_fma_f32 v68, v68, s24, -v15
    v_mfma_f32_16x16x32_bf16 v[56:59], a[132:135], a[52:55], v[56:59]
    v_exp_f32 v68, v68
    v_mfma_f32_16x16x32_bf16 v[64:67], a[128:131], a[80:83], v[64:67]
    buffer_load_dwordx4 v9, s[64:67], s49 offen offset:0 nt lds
    v_mfma_f32_16x16x32_bf16 v[64:67], a[132:135], a[84:87], v[64:67]
    v_fma_f32 v69, v69, s24, -v15
    v_fma_f32 v70, v70, s24, -v15
    v_mfma_f32_16x16x32_bf16 v[72:75], a[128:131], a[112:115], v[72:75]
    ds_read_b128 a[128:131], v1 offset:2048
    v_fma_f32 v71, v71, s24, -v15
    v_mfma_f32_16x16x32_bf16 v[72:75], a[132:135], a[116:119], v[72:75]
    s_waitcnt lgkmcnt(1)
    ds_read_b128 a[132:135], v2 offset:2048
    v_fma_f32 v76, v76, s24, -v16
    v_mfma_f32_16x16x32_bf16 v[48:51], a[136:139], a[24:27], v[48:51]
    buffer_load_dwordx4 v46, s[64:67], s49 offen offset:1024 nt lds
    v_mfma_f32_16x16x32_bf16 v[48:51], a[140:143], a[28:31], v[48:51]
    v_exp_f32 v69, v69
    v_mfma_f32_16x16x32_bf16 v[56:59], a[136:139], a[56:59], v[56:59]
    v_exp_f32 v70, v70
    v_mfma_f32_16x16x32_bf16 v[56:59], a[140:143], a[60:63], v[56:59]
    v_exp_f32 v71, v71
    v_mfma_f32_16x16x32_bf16 v[64:67], a[136:139], a[88:91], v[64:67]
    v_exp_f32 v76, v76
    v_mfma_f32_16x16x32_bf16 v[64:67], a[140:143], a[92:95], v[64:67]
    v_cvt_pk_bf16_f32 v186, v68, v69
    v_cvt_pk_bf16_f32 v187, v70, v71
    v_mfma_f32_16x16x32_bf16 v[72:75], a[136:139], a[120:123], v[72:75]
    ds_read_b128 a[136:139], v3 offset:2048
    v_fma_f32 v77, v77, s24, -v16
    v_mfma_f32_16x16x32_bf16 v[72:75], a[140:143], a[124:127], v[72:75]
    s_waitcnt lgkmcnt(1)
    ds_read_b128 a[140:143], v4 offset:2048
    v_fma_f32 v78, v78, s24, -v16
L_t4_3:
    s_cbranch_execz L_t4_7
    v_mfma_f32_16x16x32_bf16 v[52:55], a[128:131], a[0:3], 0
    v_exp_f32 v77, v77
    v_mfma_f32_16x16x32_bf16 v[52:55], a[132:135], a[4:7], v[52:55]
    v_exp_f32 v78, v78
    v_mfma_f32_16x16x32_bf16 v[60:63], a[128:131], a[32:35], 0
    v_fma_f32 v79, v79, s24, -v16
    v_cvt_pk_bf16_f32 v190, v76, v77
    v_mfma_f32_16x16x32_bf16 v[60:63], a[132:135], a[36:39], v[60:63]
    v_exp_f32 v79, v79
    v_mfma_f32_16x16x32_bf16 v[68:71], a[128:131], a[64:67], 0
    v_cvt_pk_bf16_f32 v191, v78, v79
    v_fma_f32 v80, v80, s24, -v13
    v_mfma_f32_16x16x32_bf16 v[68:71], a[132:135], a[68:71], v[68:71]
    v_exp_f32 v80, v80
    v_mfma_f32_16x16x32_bf16 v[76:79], a[128:131], a[96:99], 0
    ds_read_b128 a[128:131], v1 offset:2304
    v_fma_f32 v81, v81, s24, -v13
    v_mfma_f32_16x16x32_bf16 v[76:79], a[132:135], a[100:103], v[76:79]
    s_waitcnt lgkmcnt(1)
    ds_read_b128 a[132:135], v2 offset:2304
    v_fma_f32 v82, v82, s24, -v13
    v_mfma_f32_16x16x32_bf16 v[52:55], a[136:139], a[8:11], v[52:55]
    v_exp_f32 v81, v81
    v_mfma_f32_16x16x32_bf16 v[52:55], a[140:143], a[12:15], v[52:55]
    v_exp_f32 v82, v82
    v_mfma_f32_16x16x32_bf16 v[60:63], a[136:139], a[40:43], v[60:63]
    v_fma_f32 v83, v83, s24, -v13
    v_cvt_pk_bf16_f32 v80, v80, v81
    v_mfma_f32_16x16x32_bf16 v[60:63], a[140:143], a[44:47], v[60:63]
    v_exp_f32 v83, v83
    v_mfma_f32_16x16x32_bf16 v[68:71], a[136:139], a[72:75], v[68:71]
    v_accvgpr_write_b32 a176, v80
    v_cvt_pk_bf16_f32 v82, v82, v83
    v_mfma_f32_16x16x32_bf16 v[68:71], a[140:143], a[76:79], v[68:71]
    v_accvgpr_write_b32 a177, v82
    v_fma_f32 v88, v88, s24, -v14
    v_mfma_f32_16x16x32_bf16 v[76:79], a[136:139], a[104:107], v[76:79]
    ds_read_b128 a[136:139], v3 offset:2304
    v_fma_f32 v89, v89, s24, -v14
    v_mfma_f32_16x16x32_bf16 v[76:79], a[140:143], a[108:111], v[76:79]
    s_waitcnt lgkmcnt(1)
    ds_read_b128 a[140:143], v4 offset:2304
    v_fma_f32 v90, v90, s24, -v14
    v_mfma_f32_16x16x32_bf16 v[52:55], a[128:131], a[16:19], v[52:55]
    v_exp_f32 v88, v88
    v_mfma_f32_16x16x32_bf16 v[52:55], a[132:135], a[20:23], v[52:55]
    v_exp_f32 v89, v89
    v_mfma_f32_16x16x32_bf16 v[60:63], a[128:131], a[48:51], v[60:63]
    v_exp_f32 v90, v90
    v_mfma_f32_16x16x32_bf16 v[60:63], a[132:135], a[52:55], v[60:63]
    v_fma_f32 v91, v91, s24, -v14
    v_cvt_pk_bf16_f32 v88, v88, v89
    v_mfma_f32_16x16x32_bf16 v[68:71], a[128:131], a[80:83], v[68:71]
    v_exp_f32 v91, v91
    v_mfma_f32_16x16x32_bf16 v[68:71], a[132:135], a[84:87], v[68:71]
    v_accvgpr_write_b32 a180, v88
    v_cvt_pk_bf16_f32 v90, v90, v91
    v_mfma_f32_16x16x32_bf16 v[76:79], a[128:131], a[112:115], v[76:79]
    ds_read_b128 a[128:131], v1 offset:16384
    v_accvgpr_write_b32 a181, v90
    v_mfma_f32_16x16x32_bf16 v[76:79], a[132:135], a[116:119], v[76:79]
    s_waitcnt lgkmcnt(1)
    ds_read_b128 a[132:135], v2 offset:16384
    v_fma_f32 v96, v96, s24, -v15
    v_mfma_f32_16x16x32_bf16 v[52:55], a[136:139], a[24:27], v[52:55]
    v_exp_f32 v96, v96
    v_mfma_f32_16x16x32_bf16 v[52:55], a[140:143], a[28:31], v[52:55]
    v_fma_f32 v97, v97, s24, -v15
    v_fma_f32 v98, v98, s24, -v15
    v_mfma_f32_16x16x32_bf16 v[60:63], a[136:139], a[56:59], v[60:63]
    v_exp_f32 v97, v97
    v_mfma_f32_16x16x32_bf16 v[60:63], a[140:143], a[60:63], v[60:63]
    v_exp_f32 v98, v98
    v_mfma_f32_16x16x32_bf16 v[68:71], a[136:139], a[88:91], v[68:71]
    v_fma_f32 v99, v99, s24, -v15
    v_cvt_pk_bf16_f32 v96, v96, v97
    v_mfma_f32_16x16x32_bf16 v[68:71], a[140:143], a[92:95], v[68:71]
    v_exp_f32 v99, v99
    v_mfma_f32_16x16x32_bf16 v[76:79], a[136:139], a[120:123], v[76:79]
    ds_read_b128 a[136:139], v3 offset:16384
    v_accvgpr_write_b32 a184, v96
    v_mfma_f32_16x16x32_bf16 v[76:79], a[140:143], a[124:127], v[76:79]
    s_waitcnt lgkmcnt(1)
    v_cvt_pk_bf16_f32 v98, v98, v99
    v_fma_f32 v104, v104, s24, -v16
    v_mfma_f32_16x16x32_bf16 v[80:83], a[128:131], a[0:3], 0
    s_waitcnt vmcnt(9)
    ds_read_b128 a[140:143], v4 offset:16384
    v_xor_b32 v44, 128, v9
    v_mfma_f32_16x16x32_bf16 v[80:83], a[132:135], a[4:7], v[80:83]
    s_barrier
    v_exp_f32 v104, v104
    v_mfma_f32_16x16x32_bf16 v[88:91], a[128:131], a[32:35], 0
    s_add_u32 m0, s30, 0
    v_xor_b32 v46, 192, v9
    v_accvgpr_write_b32 a185, v98
    v_mfma_f32_16x16x32_bf16 v[88:91], a[132:135], a[36:39], v[88:91]
    s_xor_b32 s48, s29, 196608
    v_fma_f32 v105, v105, s24, -v16
    v_fma_f32 v106, v106, s24, -v16
    v_mfma_f32_16x16x32_bf16 v[96:99], a[128:131], a[64:67], 0
    buffer_load_dwordx4 v7, s[12:15], s48 offen offset:0 lds
    v_mfma_f32_16x16x32_bf16 v[96:99], a[132:135], a[68:71], v[96:99]
    s_mov_b32 s49, 4096
    v_exp_f32_e64 v105, v105
    v_fma_f32 v107, v107, s24, -v16
    v_exp_f32 v106, v106
    v_exp_f32 v107, v107
    v_cvt_pk_bf16_f32 v104, v104, v105
    v_cvt_pk_bf16_f32 v106, v106, v107
    v_accvgpr_write_b32 a188, v104
    v_accvgpr_write_b32 a189, v106
    v_mfma_f32_16x16x32_bf16 v[104:107], a[128:131], a[96:99], 0
    ds_read_b128 a[128:131], v1 offset:16640
    v_fma_f32 v84, v84, s24, -v13
    v_mfma_f32_16x16x32_bf16 v[104:107], a[132:135], a[100:103], v[104:107]
    s_waitcnt lgkmcnt(1)
    ds_read_b128 a[132:135], v2 offset:16640
    v_fma_f32 v85, v85, s24, -v13
    v_mfma_f32_16x16x32_bf16 v[80:83], a[136:139], a[8:11], v[80:83]
    buffer_load_dwordx4 v7, s[12:15], s48 offen offset:1024 lds
    v_mfma_f32_16x16x32_bf16 v[80:83], a[140:143], a[12:15], v[80:83]
    v_exp_f32 v84, v84
    v_mfma_f32_16x16x32_bf16 v[88:91], a[136:139], a[40:43], v[88:91]
    v_exp_f32 v85, v85
    v_mfma_f32_16x16x32_bf16 v[88:91], a[140:143], a[44:47], v[88:91]
    v_fma_f32 v86, v86, s24, -v13
    v_fma_f32 v87, v87, s24, -v13
    v_mfma_f32_16x16x32_bf16 v[96:99], a[136:139], a[72:75], v[96:99]
    buffer_load_dwordx4 v7, s[12:15], s48 offen offset:2048 lds
    v_mfma_f32_16x16x32_bf16 v[96:99], a[140:143], a[76:79], v[96:99]
    v_exp_f32 v86, v86
    v_mfma_f32_16x16x32_bf16 v[104:107], a[136:139], a[104:107], v[104:107]
    ds_read_b128 a[136:139], v3 offset:16640
    v_cvt_pk_bf16_f32 v84, v84, v85
    v_mfma_f32_16x16x32_bf16 v[104:107], a[140:143], a[108:111], v[104:107]
    s_waitcnt lgkmcnt(1)
    ds_read_b128 a[140:143], v4 offset:16640
    v_accvgpr_write_b32 a178, v84
    v_mfma_f32_16x16x32_bf16 v[80:83], a[128:131], a[16:19], v[80:83]
    buffer_load_dwordx4 v7, s[12:15], s48 offen offset:3072 lds
    v_mfma_f32_16x16x32_bf16 v[80:83], a[132:135], a[20:23], v[80:83]
    s_add_u32 m0, s54, 4096
    v_exp_f32 v87, v87
    v_mfma_f32_16x16x32_bf16 v[88:91], a[128:131], a[48:51], v[88:91]
    v_cvt_pk_bf16_f32 v86, v86, v87
    v_fma_f32 v92, v92, s24, -v14
    v_mfma_f32_16x16x32_bf16 v[88:91], a[132:135], a[52:55], v[88:91]
    v_exp_f32 v92, v92
    v_mfma_f32_16x16x32_bf16 v[96:99], a[128:131], a[80:83], v[96:99]
    buffer_load_dwordx4 v44, s[64:67], s49 offen offset:2048 nt lds
    v_mfma_f32_16x16x32_bf16 v[96:99], a[132:135], a[84:87], v[96:99]
    v_accvgpr_write_b32 a179, v86
    v_fma_f32 v93, v93, s24, -v14
    v_mfma_f32_16x16x32_bf16 v[104:107], a[128:131], a[112:115], v[104:107]
    ds_read_b128 a[128:131], v1 offset:18432
    v_fma_f32 v94, v94, s24, -v14
    v_mfma_f32_16x16x32_bf16 v[104:107], a[132:135], a[116:119], v[104:107]
    s_waitcnt lgkmcnt(1)
    ds_read_b128 a[132:135], v2 offset:18432
    v_fma_f32 v95, v95, s24, -v14
    v_mfma_f32_16x16x32_bf16 v[80:83], a[136:139], a[24:27], v[80:83]
    buffer_load_dwordx4 v46, s[64:67], s49 offen offset:3072 nt lds
    v_mfma_f32_16x16x32_bf16 v[80:83], a[140:143], a[28:31], v[80:83]
    v_exp_f32 v93, v93
    v_mfma_f32_16x16x32_bf16 v[88:91], a[136:139], a[56:59], v[88:91]
    v_exp_f32 v94, v94
    v_mfma_f32_16x16x32_bf16 v[88:91], a[140:143], a[60:63], v[88:91]
    v_exp_f32 v95, v95
    v_mfma_f32_16x16x32_bf16 v[96:99], a[136:139], a[88:91], v[96:99]
    v_cvt_pk_bf16_f32 v92, v92, v93
    v_cvt_pk_bf16_f32 v94, v94, v95
    v_mfma_f32_16x16x32_bf16 v[96:99], a[140:143], a[92:95], v[96:99]
    v_accvgpr_write_b32 a182, v92
    v_accvgpr_write_b32 a183, v94
    v_mfma_f32_16x16x32_bf16 v[104:107], a[136:139], a[120:123], v[104:107]
    ds_read_b128 a[136:139], v3 offset:18432
    v_fma_f32 v100, v100, s24, -v15
    v_mfma_f32_16x16x32_bf16 v[104:107], a[140:143], a[124:127], v[104:107]
    s_waitcnt lgkmcnt(1)
    ds_read_b128 a[140:143], v4 offset:18432
    v_fma_f32 v101, v101, s24, -v15
    v_mfma_f32_16x16x32_bf16 v[84:87], a[128:131], a[0:3], 0
    v_exp_f32 v100, v100
    v_mfma_f32_16x16x32_bf16 v[84:87], a[132:135], a[4:7], v[84:87]
    v_exp_f32 v101, v101
    v_mfma_f32_16x16x32_bf16 v[92:95], a[128:131], a[32:35], 0
    v_fma_f32 v102, v102, s24, -v15
    v_fma_f32 v103, v103, s24, -v15
    v_mfma_f32_16x16x32_bf16 v[92:95], a[132:135], a[36:39], v[92:95]
    v_exp_f32 v102, v102
    v_exp_f32 v103, v103
    v_cvt_pk_bf16_f32 v100, v100, v101
    v_cvt_pk_bf16_f32 v102, v102, v103
    v_accvgpr_write_b32 a186, v100
    v_accvgpr_write_b32 a187, v102
    v_mfma_f32_16x16x32_bf16 v[100:103], a[128:131], a[64:67], 0
    v_fma_f32 v108, v108, s24, -v16
    v_fma_f32 v109, v109, s24, -v16
    v_mfma_f32_16x16x32_bf16 v[100:103], a[132:135], a[68:71], v[100:103]
    v_exp_f32_e64 v108, v108
    v_fma_f32 v110, v110, s24, -v16
    v_fma_f32 v111, v111, s24, -v16
    v_exp_f32 v109, v109
    v_exp_f32 v110, v110
    v_exp_f32_e64 v111, v111
    v_cvt_pk_bf16_f32 v108, v108, v109
    v_cvt_pk_bf16_f32 v110, v110, v111
    v_accvgpr_write_b32 a190, v108
    v_accvgpr_write_b32 a191, v110
    v_mfma_f32_16x16x32_bf16 v[108:111], a[128:131], a[96:99], 0
    ds_read_b128 a[128:131], v1 offset:18688
    v_fma_f32 v48, v48, s24, -v13
    v_mfma_f32_16x16x32_bf16 v[108:111], a[132:135], a[100:103], v[108:111]
    s_waitcnt lgkmcnt(1)
    ds_read_b128 a[132:135], v2 offset:18688
    v_fma_f32 v49, v49, s24, -v13
    v_mfma_f32_16x16x32_bf16 v[84:87], a[136:139], a[8:11], v[84:87]
    v_exp_f32 v48, v48
    v_mfma_f32_16x16x32_bf16 v[84:87], a[140:143], a[12:15], v[84:87]
    v_exp_f32 v49, v49
    v_mfma_f32_16x16x32_bf16 v[92:95], a[136:139], a[40:43], v[92:95]
    v_fma_f32 v50, v50, s24, -v13
    v_fma_f32 v51, v51, s24, -v13
    v_mfma_f32_16x16x32_bf16 v[92:95], a[140:143], a[44:47], v[92:95]
    v_exp_f32 v50, v50
    v_mfma_f32_16x16x32_bf16 v[100:103], a[136:139], a[72:75], v[100:103]
    v_exp_f32 v51, v51
    v_mfma_f32_16x16x32_bf16 v[100:103], a[140:143], a[76:79], v[100:103]
    v_cvt_pk_bf16_f32 v192, v48, v49
    v_cvt_pk_bf16_f32 v193, v50, v51
    v_mfma_f32_16x16x32_bf16 v[108:111], a[136:139], a[104:107], v[108:111]
    ds_read_b128 a[136:139], v3 offset:18688
    v_fma_f32 v56, v56, s24, -v14
    v_mfma_f32_16x16x32_bf16 v[108:111], a[140:143], a[108:111], v[108:111]
    ds_read_b128 a[140:143], v4 offset:18688
    v_fma_f32 v57, v57, s24, -v14
    v_mfma_f32_16x16x32_bf16 v[26:29], v[22:25], v[176:179], v[26:29]
    v_exp_f32 v56, v56
    v_mfma_f32_16x16x32_bf16 v[26:29], v[22:25], a[176:179], v[26:29]
    v_exp_f32 v57, v57
    v_mfma_f32_16x16x32_bf16 v[30:33], v[22:25], v[180:183], v[30:33]
    v_fma_f32 v58, v58, s24, -v14
    v_fma_f32 v59, v59, s24, -v14
    v_mfma_f32_16x16x32_bf16 v[30:33], v[22:25], a[180:183], v[30:33]
    v_exp_f32 v58, v58
    v_mfma_f32_16x16x32_bf16 v[34:37], v[22:25], v[184:187], v[34:37]
    v_exp_f32 v59, v59
    v_mfma_f32_16x16x32_bf16 v[34:37], v[22:25], a[184:187], v[34:37]
    v_cvt_pk_bf16_f32 v196, v56, v57
    v_cvt_pk_bf16_f32 v197, v58, v59
    v_mfma_f32_16x16x32_bf16 v[38:41], v[22:25], v[188:191], v[38:41]
    v_fma_f32 v64, v64, s24, -v15
    v_fma_f32 v65, v65, s24, -v15
    v_mfma_f32_16x16x32_bf16 v[38:41], v[22:25], a[188:191], v[38:41]
    s_waitcnt lgkmcnt(2)
    v_exp_f32 v64, v64
    v_mfma_f32_16x16x32_bf16 v[84:87], a[128:131], a[16:19], v[84:87]
    v_exp_f32 v65, v65
    v_mfma_f32_16x16x32_bf16 v[84:87], a[132:135], a[20:23], v[84:87]
    v_fma_f32 v66, v66, s24, -v15
    v_fma_f32 v67, v67, s24, -v15
    v_mfma_f32_16x16x32_bf16 v[92:95], a[128:131], a[48:51], v[92:95]
    v_exp_f32 v66, v66
    v_mfma_f32_16x16x32_bf16 v[92:95], a[132:135], a[52:55], v[92:95]
    v_exp_f32 v67, v67
    v_mfma_f32_16x16x32_bf16 v[100:103], a[128:131], a[80:83], v[100:103]
    v_cvt_pk_bf16_f32 v200, v64, v65
    v_cvt_pk_bf16_f32 v201, v66, v67
    v_mfma_f32_16x16x32_bf16 v[100:103], a[132:135], a[84:87], v[100:103]
    v_fma_f32 v72, v72, s24, -v16
    v_fma_f32 v73, v73, s24, -v16
    v_mfma_f32_16x16x32_bf16 v[108:111], a[128:131], a[112:115], v[108:111]
    ds_read_b128 a[128:131], v1 offset:32768
    v_fma_f32 v74, v74, s24, -v16
    v_mfma_f32_16x16x32_bf16 v[108:111], a[132:135], a[116:119], v[108:111]
    s_waitcnt lgkmcnt(1)
    ds_read_b128 a[132:135], v2 offset:32768
    v_fma_f32 v75, v75, s24, -v16
    v_mfma_f32_16x16x32_bf16 v[84:87], a[136:139], a[24:27], v[84:87]
    v_exp_f32 v72, v72
    v_mfma_f32_16x16x32_bf16 v[84:87], a[140:143], a[28:31], v[84:87]
    v_exp_f32 v73, v73
    v_mfma_f32_16x16x32_bf16 v[92:95], a[136:139], a[56:59], v[92:95]
    v_exp_f32 v74, v74
    v_mfma_f32_16x16x32_bf16 v[92:95], a[140:143], a[60:63], v[92:95]
    v_exp_f32 v75, v75
    v_mfma_f32_16x16x32_bf16 v[100:103], a[136:139], a[88:91], v[100:103]
    v_cvt_pk_bf16_f32 v204, v72, v73
    v_cvt_pk_bf16_f32 v205, v74, v75
    v_mfma_f32_16x16x32_bf16 v[100:103], a[140:143], a[92:95], v[100:103]
    v_fma_f32 v52, v52, s24, -v13
    v_fma_f32 v53, v53, s24, -v13
    v_mfma_f32_16x16x32_bf16 v[108:111], a[136:139], a[120:123], v[108:111]
    ds_read_b128 a[136:139], v3 offset:32768
    v_fma_f32 v54, v54, s24, -v13
    v_mfma_f32_16x16x32_bf16 v[108:111], a[140:143], a[124:127], v[108:111]
    s_waitcnt lgkmcnt(1)
    v_exp_f32 v52, v52
    v_mfma_f32_16x16x32_bf16 v[48:51], a[128:131], a[0:3], 0
    s_waitcnt vmcnt(8)
    ds_read_b128 a[140:143], v4 offset:32768
    v_xor_b32 v46, 64, v9
    v_mfma_f32_16x16x32_bf16 v[48:51], a[132:135], a[4:7], v[48:51]
    s_barrier
    v_exp_f32 v53, v53
    v_mfma_f32_16x16x32_bf16 v[56:59], a[128:131], a[32:35], 0
    s_add_u32 m0, s30, 16384
    v_exp_f32 v54, v54
    v_mfma_f32_16x16x32_bf16 v[56:59], a[132:135], a[36:39], v[56:59]
    s_xor_b32 s48, s29, 212992
    v_xor_b32 v44, 128, v9
    v_fma_f32 v55, v55, s24, -v13
    v_mfma_f32_16x16x32_bf16 v[64:67], a[128:131], a[64:67], 0
    buffer_load_dwordx4 v7, s[12:15], s48 offen offset:0 lds
    v_mfma_f32_16x16x32_bf16 v[64:67], a[132:135], a[68:71], v[64:67]
    s_mov_b32 s49, 32768
    v_exp_f32 v55, v55
    v_mfma_f32_16x16x32_bf16 v[72:75], a[128:131], a[96:99], 0
    ds_read_b128 a[128:131], v1 offset:33024
    v_cvt_pk_bf16_f32 v194, v52, v53
    v_mfma_f32_16x16x32_bf16 v[72:75], a[132:135], a[100:103], v[72:75]
    s_waitcnt lgkmcnt(1)
    ds_read_b128 a[132:135], v2 offset:33024
    v_cvt_pk_bf16_f32 v195, v54, v55
    v_mfma_f32_16x16x32_bf16 v[48:51], a[136:139], a[8:11], v[48:51]
    buffer_load_dwordx4 v7, s[12:15], s48 offen offset:1024 lds
    v_mfma_f32_16x16x32_bf16 v[48:51], a[140:143], a[12:15], v[48:51]
    v_fma_f32 v60, v60, s24, -v14
    v_fma_f32 v61, v61, s24, -v14
    v_mfma_f32_16x16x32_bf16 v[56:59], a[136:139], a[40:43], v[56:59]
    v_exp_f32 v60, v60
    v_mfma_f32_16x16x32_bf16 v[56:59], a[140:143], a[44:47], v[56:59]
    v_exp_f32 v61, v61
    v_mfma_f32_16x16x32_bf16 v[64:67], a[136:139], a[72:75], v[64:67]
    buffer_load_dwordx4 v7, s[12:15], s48 offen offset:2048 lds
    v_mfma_f32_16x16x32_bf16 v[64:67], a[140:143], a[76:79], v[64:67]
    v_fma_f32 v62, v62, s24, -v14
    v_fma_f32 v63, v63, s24, -v14
    v_mfma_f32_16x16x32_bf16 v[72:75], a[136:139], a[104:107], v[72:75]
    ds_read_b128 a[136:139], v3 offset:33024
    v_cvt_pk_bf16_f32 v198, v60, v61
    v_mfma_f32_16x16x32_bf16 v[72:75], a[140:143], a[108:111], v[72:75]
    s_waitcnt lgkmcnt(1)
    ds_read_b128 a[140:143], v4 offset:33024
    v_fma_f32 v68, v68, s24, -v15
    v_mfma_f32_16x16x32_bf16 v[48:51], a[128:131], a[16:19], v[48:51]
    buffer_load_dwordx4 v7, s[12:15], s48 offen offset:3072 lds
    v_mfma_f32_16x16x32_bf16 v[48:51], a[132:135], a[20:23], v[48:51]
    s_add_u32 m0, s54, 8192
    v_exp_f32 v62, v62
    v_mfma_f32_16x16x32_bf16 v[56:59], a[128:131], a[48:51], v[56:59]
    v_exp_f32 v63, v63
    v_mfma_f32_16x16x32_bf16 v[56:59], a[132:135], a[52:55], v[56:59]
    v_exp_f32 v68, v68
    v_mfma_f32_16x16x32_bf16 v[64:67], a[128:131], a[80:83], v[64:67]
    buffer_load_dwordx4 v9, s[64:67], s49 offen offset:0 nt lds
    v_mfma_f32_16x16x32_bf16 v[64:67], a[132:135], a[84:87], v[64:67]
    v_cvt_pk_bf16_f32 v199, v62, v63
    v_fma_f32 v69, v69, s24, -v15
    v_mfma_f32_16x16x32_bf16 v[72:75], a[128:131], a[112:115], v[72:75]
    ds_read_b128 a[128:131], v1 offset:34816
    v_fma_f32 v70, v70, s24, -v15
    v_mfma_f32_16x16x32_bf16 v[72:75], a[132:135], a[116:119], v[72:75]
    s_waitcnt lgkmcnt(1)
    ds_read_b128 a[132:135], v2 offset:34816
    v_fma_f32 v71, v71, s24, -v15
    v_mfma_f32_16x16x32_bf16 v[48:51], a[136:139], a[24:27], v[48:51]
    buffer_load_dwordx4 v46, s[64:67], s49 offen offset:1024 nt lds
    v_mfma_f32_16x16x32_bf16 v[48:51], a[140:143], a[28:31], v[48:51]
    v_exp_f32 v69, v69
    v_mfma_f32_16x16x32_bf16 v[56:59], a[136:139], a[56:59], v[56:59]
    v_exp_f32 v70, v70
    v_mfma_f32_16x16x32_bf16 v[56:59], a[140:143], a[60:63], v[56:59]
    v_exp_f32 v71, v71
    v_mfma_f32_16x16x32_bf16 v[64:67], a[136:139], a[88:91], v[64:67]
    buffer_load_dwordx4 v44, s[64:67], s49 offen offset:2048 nt lds
    v_mfma_f32_16x16x32_bf16 v[64:67], a[140:143], a[92:95], v[64:67]
    v_cvt_pk_bf16_f32 v202, v68, v69
    v_cvt_pk_bf16_f32 v203, v70, v71
    v_mfma_f32_16x16x32_bf16 v[72:75], a[136:139], a[120:123], v[72:75]
    ds_read_b128 a[136:139], v3 offset:34816
    v_fma_f32 v76, v76, s24, -v16
    v_mfma_f32_16x16x32_bf16 v[72:75], a[140:143], a[124:127], v[72:75]
    s_waitcnt lgkmcnt(1)
    ds_read_b128 a[140:143], v4 offset:34816
    v_fma_f32 v77, v77, s24, -v16
    v_mfma_f32_16x16x32_bf16 v[52:55], a[128:131], a[0:3], 0
    v_exp_f32 v76, v76
    v_mfma_f32_16x16x32_bf16 v[52:55], a[132:135], a[4:7], v[52:55]
    v_exp_f32 v77, v77
    v_mfma_f32_16x16x32_bf16 v[60:63], a[128:131], a[32:35], 0
    v_fma_f32 v78, v78, s24, -v16
    v_fma_f32 v79, v79, s24, -v16
    v_mfma_f32_16x16x32_bf16 v[60:63], a[132:135], a[36:39], v[60:63]
    v_exp_f32 v78, v78
    v_mfma_f32_16x16x32_bf16 v[68:71], a[128:131], a[64:67], 0
    v_exp_f32 v79, v79
    v_mfma_f32_16x16x32_bf16 v[68:71], a[132:135], a[68:71], v[68:71]
    v_cvt_pk_bf16_f32 v206, v76, v77
    v_cvt_pk_bf16_f32 v207, v78, v79
    v_mfma_f32_16x16x32_bf16 v[76:79], a[128:131], a[96:99], 0
    ds_read_b128 a[128:131], v1 offset:35072
    v_fma_f32 v80, v80, s24, -v13
    v_mfma_f32_16x16x32_bf16 v[76:79], a[132:135], a[100:103], v[76:79]
    s_waitcnt lgkmcnt(1)
    ds_read_b128 a[132:135], v2 offset:35072
    v_fma_f32 v81, v81, s24, -v13
    v_mfma_f32_16x16x32_bf16 v[52:55], a[136:139], a[8:11], v[52:55]
    v_exp_f32 v80, v80
    v_mfma_f32_16x16x32_bf16 v[52:55], a[140:143], a[12:15], v[52:55]
    v_exp_f32 v81, v81
    v_mfma_f32_16x16x32_bf16 v[60:63], a[136:139], a[40:43], v[60:63]
    v_fma_f32 v82, v82, s24, -v13
    v_fma_f32 v83, v83, s24, -v13
    v_mfma_f32_16x16x32_bf16 v[60:63], a[140:143], a[44:47], v[60:63]
    v_exp_f32 v82, v82
    v_mfma_f32_16x16x32_bf16 v[68:71], a[136:139], a[72:75], v[68:71]
    v_exp_f32 v83, v83
    v_mfma_f32_16x16x32_bf16 v[68:71], a[140:143], a[76:79], v[68:71]
    v_cvt_pk_bf16_f32 v80, v80, v81
    v_cvt_pk_bf16_f32 v82, v82, v83
    v_mfma_f32_16x16x32_bf16 v[76:79], a[136:139], a[104:107], v[76:79]
    ds_read_b128 a[136:139], v3 offset:35072
    v_accvgpr_write_b32 a192, v80
    v_mfma_f32_16x16x32_bf16 v[76:79], a[140:143], a[108:111], v[76:79]
    s_waitcnt lgkmcnt(1)
    ds_read_b128 a[140:143], v4 offset:35072
    v_accvgpr_write_b32 a193, v82
    v_mfma_f32_16x16x32_bf16 v[52:55], a[128:131], a[16:19], v[52:55]
    v_fma_f32 v88, v88, s24, -v14
    v_fma_f32 v89, v89, s24, -v14
    v_mfma_f32_16x16x32_bf16 v[52:55], a[132:135], a[20:23], v[52:55]
    v_exp_f32 v88, v88
    v_mfma_f32_16x16x32_bf16 v[60:63], a[128:131], a[48:51], v[60:63]
    v_exp_f32 v89, v89
    v_mfma_f32_16x16x32_bf16 v[60:63], a[132:135], a[52:55], v[60:63]
    v_fma_f32 v90, v90, s24, -v14
    v_fma_f32 v91, v91, s24, -v14
    v_mfma_f32_16x16x32_bf16 v[68:71], a[128:131], a[80:83], v[68:71]
    v_exp_f32 v90, v90
    v_mfma_f32_16x16x32_bf16 v[68:71], a[132:135], a[84:87], v[68:71]
    v_exp_f32 v91, v91
    v_mfma_f32_16x16x32_bf16 v[76:79], a[128:131], a[112:115], v[76:79]
    ds_read_b128 a[128:131], v1 offset:49152
    v_cvt_pk_bf16_f32 v88, v88, v89
    v_mfma_f32_16x16x32_bf16 v[76:79], a[132:135], a[116:119], v[76:79]
    s_waitcnt lgkmcnt(1)
    ds_read_b128 a[132:135], v2 offset:49152
    v_accvgpr_write_b32 a196, v88
    v_mfma_f32_16x16x32_bf16 v[52:55], a[136:139], a[24:27], v[52:55]
    v_cvt_pk_bf16_f32 v90, v90, v91
    v_fma_f32 v96, v96, s24, -v15
    v_mfma_f32_16x16x32_bf16 v[52:55], a[140:143], a[28:31], v[52:55]
    v_exp_f32 v96, v96
    v_mfma_f32_16x16x32_bf16 v[60:63], a[136:139], a[56:59], v[60:63]
    v_accvgpr_write_b32 a197, v90
    v_fma_f32 v97, v97, s24, -v15
    v_mfma_f32_16x16x32_bf16 v[60:63], a[140:143], a[60:63], v[60:63]
    v_exp_f32 v97, v97
    v_mfma_f32_16x16x32_bf16 v[68:71], a[136:139], a[88:91], v[68:71]
    v_fma_f32 v98, v98, s24, -v15
    v_fma_f32 v99, v99, s24, -v15
    v_mfma_f32_16x16x32_bf16 v[68:71], a[140:143], a[92:95], v[68:71]
    v_exp_f32 v98, v98
    v_mfma_f32_16x16x32_bf16 v[76:79], a[136:139], a[120:123], v[76:79]
    ds_read_b128 a[136:139], v3 offset:49152
    v_cvt_pk_bf16_f32 v96, v96, v97
    v_mfma_f32_16x16x32_bf16 v[76:79], a[140:143], a[124:127], v[76:79]
    s_waitcnt lgkmcnt(1)
    v_exp_f32 v99, v99
    v_mfma_f32_16x16x32_bf16 v[80:83], a[128:131], a[0:3], 0
    s_waitcnt vmcnt(9)
    ds_read_b128 a[140:143], v4 offset:49152
    v_xor_b32 v46, 192, v9
    v_mfma_f32_16x16x32_bf16 v[80:83], a[132:135], a[4:7], v[80:83]
    s_barrier
    v_accvgpr_write_b32 a200, v96
    v_cvt_pk_bf16_f32 v98, v98, v99
    v_mfma_f32_16x16x32_bf16 v[88:91], a[128:131], a[32:35], 0
    s_add_u32 m0, s30, 32768
    v_accvgpr_write_b32 a201, v98
    v_fma_f32 v104, v104, s24, -v16
    v_mfma_f32_16x16x32_bf16 v[88:91], a[132:135], a[36:39], v[88:91]
    s_xor_b32 s48, s29, 229376
    v_exp_f32 v104, v104
    v_mfma_f32_16x16x32_bf16 v[96:99], a[128:131], a[64:67], 0
    buffer_load_dwordx4 v7, s[12:15], s48 offen offset:0 lds
    v_mfma_f32_16x16x32_bf16 v[96:99], a[132:135], a[68:71], v[96:99]
    s_mov_b32 s49, 32768
    v_fma_f32 v105, v105, s24, -v16
    v_fma_f32 v106, v106, s24, -v16
    v_fma_f32 v107, v107, s24, -v16
    v_exp_f32 v105, v105
    v_exp_f32 v106, v106
    v_exp_f32_e64 v107, v107
    v_cvt_pk_bf16_f32 v104, v104, v105
    v_cvt_pk_bf16_f32 v106, v106, v107
    v_accvgpr_write_b32 a204, v104
    v_accvgpr_write_b32 a205, v106
    v_mfma_f32_16x16x32_bf16 v[104:107], a[128:131], a[96:99], 0
    ds_read_b128 a[128:131], v1 offset:49408
    v_fma_f32 v84, v84, s24, -v13
    v_mfma_f32_16x16x32_bf16 v[104:107], a[132:135], a[100:103], v[104:107]
    s_waitcnt lgkmcnt(1)
    ds_read_b128 a[132:135], v2 offset:49408
    v_fma_f32 v85, v85, s24, -v13
    v_mfma_f32_16x16x32_bf16 v[80:83], a[136:139], a[8:11], v[80:83]
    buffer_load_dwordx4 v7, s[12:15], s48 offen offset:1024 lds
    v_mfma_f32_16x16x32_bf16 v[80:83], a[140:143], a[12:15], v[80:83]
    v_exp_f32 v84, v84
    v_mfma_f32_16x16x32_bf16 v[88:91], a[136:139], a[40:43], v[88:91]
    v_exp_f32 v85, v85
    v_mfma_f32_16x16x32_bf16 v[88:91], a[140:143], a[44:47], v[88:91]
    v_fma_f32 v86, v86, s24, -v13
    v_fma_f32 v87, v87, s24, -v13
    v_mfma_f32_16x16x32_bf16 v[96:99], a[136:139], a[72:75], v[96:99]
    buffer_load_dwordx4 v7, s[12:15], s48 offen offset:2048 lds
    v_mfma_f32_16x16x32_bf16 v[96:99], a[140:143], a[76:79], v[96:99]
    v_exp_f32 v86, v86
    v_mfma_f32_16x16x32_bf16 v[104:107], a[136:139], a[104:107], v[104:107]
    ds_read_b128 a[136:139], v3 offset:49408
    v_cvt_pk_bf16_f32 v84, v84, v85
    v_mfma_f32_16x16x32_bf16 v[104:107], a[140:143], a[108:111], v[104:107]
    s_waitcnt lgkmcnt(1)
    ds_read_b128 a[140:143], v4 offset:49408
    v_accvgpr_write_b32 a194, v84
    v_mfma_f32_16x16x32_bf16 v[80:83], a[128:131], a[16:19], v[80:83]
    buffer_load_dwordx4 v7, s[12:15], s48 offen offset:3072 lds
    v_mfma_f32_16x16x32_bf16 v[80:83], a[132:135], a[20:23], v[80:83]
    s_add_u32 m0, s54, 8192
    v_exp_f32 v87, v87
    v_mfma_f32_16x16x32_bf16 v[88:91], a[128:131], a[48:51], v[88:91]
    v_cvt_pk_bf16_f32 v86, v86, v87
    v_fma_f32 v92, v92, s24, -v14
    v_mfma_f32_16x16x32_bf16 v[88:91], a[132:135], a[52:55], v[88:91]
    v_exp_f32 v92, v92
    v_mfma_f32_16x16x32_bf16 v[96:99], a[128:131], a[80:83], v[96:99]
    buffer_load_dwordx4 v46, s[64:67], s49 offen offset:3072 nt lds
    v_mfma_f32_16x16x32_bf16 v[96:99], a[132:135], a[84:87], v[96:99]
    s_add_u32 m0, s54, 12288
    v_accvgpr_write_b32 a195, v86
    v_fma_f32 v93, v93, s24, -v14
    v_mfma_f32_16x16x32_bf16 v[104:107], a[128:131], a[112:115], v[104:107]
    s_mov_b32 s49, 36864
    ds_read_b128 a[128:131], v1 offset:51200
    v_fma_f32 v94, v94, s24, -v14
    v_mfma_f32_16x16x32_bf16 v[104:107], a[132:135], a[116:119], v[104:107]
    s_waitcnt lgkmcnt(1)
    ds_read_b128 a[132:135], v2 offset:51200
    v_fma_f32 v95, v95, s24, -v14
    v_mfma_f32_16x16x32_bf16 v[80:83], a[136:139], a[24:27], v[80:83]
    buffer_load_dwordx4 v9, s[64:67], s49 offen offset:0 nt lds
    v_mfma_f32_16x16x32_bf16 v[80:83], a[140:143], a[28:31], v[80:83]
    v_exp_f32 v93, v93
    v_mfma_f32_16x16x32_bf16 v[88:91], a[136:139], a[56:59], v[88:91]
    v_exp_f32 v94, v94
    v_mfma_f32_16x16x32_bf16 v[88:91], a[140:143], a[60:63], v[88:91]
    v_exp_f32 v95, v95
    v_mfma_f32_16x16x32_bf16 v[96:99], a[136:139], a[88:91], v[96:99]
    v_cvt_pk_bf16_f32 v92, v92, v93
    v_cvt_pk_bf16_f32 v94, v94, v95
    v_mfma_f32_16x16x32_bf16 v[96:99], a[140:143], a[92:95], v[96:99]
    v_accvgpr_write_b32 a198, v92
    v_accvgpr_write_b32 a199, v94
    v_mfma_f32_16x16x32_bf16 v[104:107], a[136:139], a[120:123], v[104:107]
L_t4_4:
    s_cbranch_execz L_t4_8
    ds_read_b128 a[136:139], v3 offset:51200
    v_fma_f32 v100, v100, s24, -v15
    v_mfma_f32_16x16x32_bf16 v[104:107], a[140:143], a[124:127], v[104:107]
    s_waitcnt lgkmcnt(1)
    ds_read_b128 a[140:143], v4 offset:51200
    v_fma_f32 v101, v101, s24, -v15
    v_mfma_f32_16x16x32_bf16 v[84:87], a[128:131], a[0:3], 0
    v_exp_f32 v100, v100
    v_mfma_f32_16x16x32_bf16 v[84:87], a[132:135], a[4:7], v[84:87]
    v_exp_f32 v101, v101
    v_mfma_f32_16x16x32_bf16 v[92:95], a[128:131], a[32:35], 0
    v_fma_f32 v102, v102, s24, -v15
    v_fma_f32 v103, v103, s24, -v15
    v_mfma_f32_16x16x32_bf16 v[92:95], a[132:135], a[36:39], v[92:95]
    v_exp_f32 v102, v102
    v_exp_f32_e64 v103, v103
    v_cvt_pk_bf16_f32 v100, v100, v101
    v_cvt_pk_bf16_f32 v102, v102, v103
    v_accvgpr_write_b32 a202, v100
    v_accvgpr_write_b32 a203, v102
    v_mfma_f32_16x16x32_bf16 v[100:103], a[128:131], a[64:67], 0
    v_fma_f32 v108, v108, s24, -v16
    v_fma_f32 v109, v109, s24, -v16
    v_mfma_f32_16x16x32_bf16 v[100:103], a[132:135], a[68:71], v[100:103]
    v_exp_f32_e64 v108, v108
    v_fma_f32 v110, v110, s24, -v16
    v_fma_f32 v111, v111, s24, -v16
    v_exp_f32 v109, v109
    v_exp_f32 v110, v110
    v_exp_f32_e64 v111, v111
    v_cvt_pk_bf16_f32 v108, v108, v109
    v_cvt_pk_bf16_f32 v110, v110, v111
    v_accvgpr_write_b32 a206, v108
    v_accvgpr_write_b32 a207, v110
    v_mfma_f32_16x16x32_bf16 v[108:111], a[128:131], a[96:99], 0
    ds_read_b128 a[128:131], v1 offset:51456
    v_fma_f32 v48, v48, s24, -v13
    v_mfma_f32_16x16x32_bf16 v[108:111], a[132:135], a[100:103], v[108:111]
    s_waitcnt lgkmcnt(1)
    ds_read_b128 a[132:135], v2 offset:51456
    v_fma_f32 v49, v49, s24, -v13
    v_mfma_f32_16x16x32_bf16 v[84:87], a[136:139], a[8:11], v[84:87]
    v_exp_f32 v48, v48
    v_mfma_f32_16x16x32_bf16 v[84:87], a[140:143], a[12:15], v[84:87]
    v_exp_f32 v49, v49
    v_mfma_f32_16x16x32_bf16 v[92:95], a[136:139], a[40:43], v[92:95]
    v_fma_f32 v50, v50, s24, -v13
    v_fma_f32 v51, v51, s24, -v13
    v_mfma_f32_16x16x32_bf16 v[92:95], a[140:143], a[44:47], v[92:95]
    v_exp_f32 v50, v50
    v_mfma_f32_16x16x32_bf16 v[100:103], a[136:139], a[72:75], v[100:103]
    v_exp_f32 v51, v51
    v_mfma_f32_16x16x32_bf16 v[100:103], a[140:143], a[76:79], v[100:103]
    v_cvt_pk_bf16_f32 v208, v48, v49
    v_cvt_pk_bf16_f32 v209, v50, v51
    v_mfma_f32_16x16x32_bf16 v[108:111], a[136:139], a[104:107], v[108:111]
    ds_read_b128 a[136:139], v3 offset:51456
    v_fma_f32 v56, v56, s24, -v14
    v_mfma_f32_16x16x32_bf16 v[108:111], a[140:143], a[108:111], v[108:111]
    ds_read_b128 a[140:143], v4 offset:51456
    v_fma_f32 v57, v57, s24, -v14
    v_mfma_f32_16x16x32_bf16 v[26:29], v[22:25], v[192:195], v[26:29]
    v_exp_f32 v56, v56
    v_mfma_f32_16x16x32_bf16 v[26:29], v[22:25], a[192:195], v[26:29]
    v_exp_f32 v57, v57
    v_mfma_f32_16x16x32_bf16 v[30:33], v[22:25], v[196:199], v[30:33]
    v_fma_f32 v58, v58, s24, -v14
    v_fma_f32 v59, v59, s24, -v14
    v_mfma_f32_16x16x32_bf16 v[30:33], v[22:25], a[196:199], v[30:33]
    v_exp_f32 v58, v58
    v_mfma_f32_16x16x32_bf16 v[34:37], v[22:25], v[200:203], v[34:37]
    v_exp_f32 v59, v59
    v_mfma_f32_16x16x32_bf16 v[34:37], v[22:25], a[200:203], v[34:37]
    v_cvt_pk_bf16_f32 v212, v56, v57
    v_cvt_pk_bf16_f32 v213, v58, v59
    v_mfma_f32_16x16x32_bf16 v[38:41], v[22:25], v[204:207], v[38:41]
    v_fma_f32 v64, v64, s24, -v15
    v_fma_f32 v65, v65, s24, -v15
    v_mfma_f32_16x16x32_bf16 v[38:41], v[22:25], a[204:207], v[38:41]
    s_waitcnt lgkmcnt(2)
    v_exp_f32 v64, v64
    v_mfma_f32_16x16x32_bf16 v[84:87], a[128:131], a[16:19], v[84:87]
    v_exp_f32 v65, v65
    v_mfma_f32_16x16x32_bf16 v[84:87], a[132:135], a[20:23], v[84:87]
    v_fma_f32 v66, v66, s24, -v15
    v_fma_f32 v67, v67, s24, -v15
    v_mfma_f32_16x16x32_bf16 v[92:95], a[128:131], a[48:51], v[92:95]
    v_exp_f32 v66, v66
    v_mfma_f32_16x16x32_bf16 v[92:95], a[132:135], a[52:55], v[92:95]
    v_exp_f32 v67, v67
    v_mfma_f32_16x16x32_bf16 v[100:103], a[128:131], a[80:83], v[100:103]
    v_cvt_pk_bf16_f32 v216, v64, v65
    v_cvt_pk_bf16_f32 v217, v66, v67
    v_mfma_f32_16x16x32_bf16 v[100:103], a[132:135], a[84:87], v[100:103]
    v_fma_f32 v72, v72, s24, -v16
    v_fma_f32 v73, v73, s24, -v16
    v_mfma_f32_16x16x32_bf16 v[108:111], a[128:131], a[112:115], v[108:111]
    ds_read_b128 a[128:131], v1 offset:0
    v_fma_f32 v74, v74, s24, -v16
    v_mfma_f32_16x16x32_bf16 v[108:111], a[132:135], a[116:119], v[108:111]
    s_waitcnt lgkmcnt(1)
    ds_read_b128 a[132:135], v2 offset:0
    v_fma_f32 v75, v75, s24, -v16
    v_mfma_f32_16x16x32_bf16 v[84:87], a[136:139], a[24:27], v[84:87]
    v_exp_f32 v72, v72
    v_mfma_f32_16x16x32_bf16 v[84:87], a[140:143], a[28:31], v[84:87]
    v_exp_f32 v73, v73
    v_mfma_f32_16x16x32_bf16 v[92:95], a[136:139], a[56:59], v[92:95]
    v_exp_f32 v74, v74
    v_mfma_f32_16x16x32_bf16 v[92:95], a[140:143], a[60:63], v[92:95]
    v_exp_f32 v75, v75
    v_mfma_f32_16x16x32_bf16 v[100:103], a[136:139], a[88:91], v[100:103]
    v_cvt_pk_bf16_f32 v220, v72, v73
    v_cvt_pk_bf16_f32 v221, v74, v75
    v_mfma_f32_16x16x32_bf16 v[100:103], a[140:143], a[92:95], v[100:103]
    v_fma_f32 v52, v52, s24, -v13
    v_fma_f32 v53, v53, s24, -v13
    v_mfma_f32_16x16x32_bf16 v[108:111], a[136:139], a[120:123], v[108:111]
    ds_read_b128 a[136:139], v3 offset:0
    v_fma_f32 v54, v54, s24, -v13
    v_mfma_f32_16x16x32_bf16 v[108:111], a[140:143], a[124:127], v[108:111]
    s_waitcnt lgkmcnt(1)
    v_exp_f32 v52, v52
    v_mfma_f32_16x16x32_bf16 v[48:51], a[128:131], a[0:3], 0
    s_waitcnt vmcnt(9)
    ds_read_b128 a[140:143], v4 offset:0
    v_xor_b32 v46, 64, v9
    v_mfma_f32_16x16x32_bf16 v[48:51], a[132:135], a[4:7], v[48:51]
    s_barrier
    v_exp_f32 v53, v53
    v_mfma_f32_16x16x32_bf16 v[56:59], a[128:131], a[32:35], 0
    s_add_u32 m0, s30, 49152
    v_exp_f32 v54, v54
    v_mfma_f32_16x16x32_bf16 v[56:59], a[132:135], a[36:39], v[56:59]
    s_xor_b32 s48, s29, 245760
    v_xor_b32 v44, 128, v9
    v_fma_f32 v55, v55, s24, -v13
    v_mfma_f32_16x16x32_bf16 v[64:67], a[128:131], a[64:67], 0
    buffer_load_dwordx4 v7, s[12:15], s48 offen offset:0 lds
    v_mfma_f32_16x16x32_bf16 v[64:67], a[132:135], a[68:71], v[64:67]
    s_mov_b32 s49, 36864
    v_exp_f32 v55, v55
    v_mfma_f32_16x16x32_bf16 v[72:75], a[128:131], a[96:99], 0
    ds_read_b128 a[128:131], v1 offset:256
    v_cvt_pk_bf16_f32 v210, v52, v53
    v_mfma_f32_16x16x32_bf16 v[72:75], a[132:135], a[100:103], v[72:75]
    s_waitcnt lgkmcnt(1)
    ds_read_b128 a[132:135], v2 offset:256
    v_cvt_pk_bf16_f32 v211, v54, v55
    v_mfma_f32_16x16x32_bf16 v[48:51], a[136:139], a[8:11], v[48:51]
    buffer_load_dwordx4 v7, s[12:15], s48 offen offset:1024 lds
    v_mfma_f32_16x16x32_bf16 v[48:51], a[140:143], a[12:15], v[48:51]
    v_fma_f32 v60, v60, s24, -v14
    v_fma_f32 v61, v61, s24, -v14
    v_mfma_f32_16x16x32_bf16 v[56:59], a[136:139], a[40:43], v[56:59]
    v_exp_f32 v60, v60
    v_mfma_f32_16x16x32_bf16 v[56:59], a[140:143], a[44:47], v[56:59]
    v_exp_f32 v61, v61
    v_mfma_f32_16x16x32_bf16 v[64:67], a[136:139], a[72:75], v[64:67]
    buffer_load_dwordx4 v7, s[12:15], s48 offen offset:2048 lds
    v_mfma_f32_16x16x32_bf16 v[64:67], a[140:143], a[76:79], v[64:67]
    v_fma_f32 v62, v62, s24, -v14
    v_fma_f32 v63, v63, s24, -v14
    v_mfma_f32_16x16x32_bf16 v[72:75], a[136:139], a[104:107], v[72:75]
    ds_read_b128 a[136:139], v3 offset:256
    v_cvt_pk_bf16_f32 v214, v60, v61
    v_mfma_f32_16x16x32_bf16 v[72:75], a[140:143], a[108:111], v[72:75]
    s_waitcnt lgkmcnt(1)
    ds_read_b128 a[140:143], v4 offset:256
    v_fma_f32 v68, v68, s24, -v15
    v_mfma_f32_16x16x32_bf16 v[48:51], a[128:131], a[16:19], v[48:51]
    buffer_load_dwordx4 v7, s[12:15], s48 offen offset:3072 lds
    v_mfma_f32_16x16x32_bf16 v[48:51], a[132:135], a[20:23], v[48:51]
    s_add_u32 m0, s54, 12288
    v_exp_f32 v62, v62
    v_mfma_f32_16x16x32_bf16 v[56:59], a[128:131], a[48:51], v[56:59]
    v_exp_f32 v63, v63
    v_mfma_f32_16x16x32_bf16 v[56:59], a[132:135], a[52:55], v[56:59]
    v_exp_f32 v68, v68
    v_mfma_f32_16x16x32_bf16 v[64:67], a[128:131], a[80:83], v[64:67]
    buffer_load_dwordx4 v46, s[64:67], s49 offen offset:1024 nt lds
    v_mfma_f32_16x16x32_bf16 v[64:67], a[132:135], a[84:87], v[64:67]
    v_xor_b32 v46, 192, v9
    v_cvt_pk_bf16_f32 v215, v62, v63
    v_mfma_f32_16x16x32_bf16 v[72:75], a[128:131], a[112:115], v[72:75]
    ds_read_b128 a[128:131], v1 offset:2048
    v_fma_f32 v69, v69, s24, -v15
    v_mfma_f32_16x16x32_bf16 v[72:75], a[132:135], a[116:119], v[72:75]
    s_waitcnt lgkmcnt(1)
    ds_read_b128 a[132:135], v2 offset:2048
    v_fma_f32 v70, v70, s24, -v15
    v_mfma_f32_16x16x32_bf16 v[48:51], a[136:139], a[24:27], v[48:51]
    buffer_load_dwordx4 v44, s[64:67], s49 offen offset:2048 nt lds
    v_mfma_f32_16x16x32_bf16 v[48:51], a[140:143], a[28:31], v[48:51]
    v_exp_f32 v69, v69
    v_mfma_f32_16x16x32_bf16 v[56:59], a[136:139], a[56:59], v[56:59]
    v_exp_f32 v70, v70
    v_mfma_f32_16x16x32_bf16 v[56:59], a[140:143], a[60:63], v[56:59]
    v_fma_f32 v71, v71, s24, -v15
    v_cvt_pk_bf16_f32 v218, v68, v69
    v_mfma_f32_16x16x32_bf16 v[64:67], a[136:139], a[88:91], v[64:67]
    buffer_load_dwordx4 v46, s[64:67], s49 offen offset:3072 nt lds
    v_mfma_f32_16x16x32_bf16 v[64:67], a[140:143], a[92:95], v[64:67]
    v_exp_f32 v71, v71
    v_mfma_f32_16x16x32_bf16 v[72:75], a[136:139], a[120:123], v[72:75]
    ds_read_b128 a[136:139], v3 offset:2048
    v_cvt_pk_bf16_f32 v219, v70, v71
    v_mfma_f32_16x16x32_bf16 v[72:75], a[140:143], a[124:127], v[72:75]
    s_waitcnt lgkmcnt(1)
    ds_read_b128 a[140:143], v4 offset:2048
    v_fma_f32 v76, v76, s24, -v16
    v_mfma_f32_16x16x32_bf16 v[52:55], a[128:131], a[0:3], 0
    v_exp_f32 v76, v76
    v_mfma_f32_16x16x32_bf16 v[52:55], a[132:135], a[4:7], v[52:55]
    v_fma_f32 v77, v77, s24, -v16
    v_fma_f32 v78, v78, s24, -v16
    v_mfma_f32_16x16x32_bf16 v[60:63], a[128:131], a[32:35], 0
    v_exp_f32 v77, v77
    v_mfma_f32_16x16x32_bf16 v[60:63], a[132:135], a[36:39], v[60:63]
    v_exp_f32 v78, v78
    v_mfma_f32_16x16x32_bf16 v[68:71], a[128:131], a[64:67], 0
    v_fma_f32 v79, v79, s24, -v16
    v_cvt_pk_bf16_f32 v222, v76, v77
    v_mfma_f32_16x16x32_bf16 v[68:71], a[132:135], a[68:71], v[68:71]
    v_exp_f32 v79, v79
    s_nop 0
    v_cvt_pk_bf16_f32 v223, v78, v79
    v_mfma_f32_16x16x32_bf16 v[76:79], a[128:131], a[96:99], 0
    ds_read_b128 a[128:131], v1 offset:2304
    v_fma_f32 v80, v80, s24, -v13
    v_mfma_f32_16x16x32_bf16 v[76:79], a[132:135], a[100:103], v[76:79]
    s_waitcnt lgkmcnt(1)
    ds_read_b128 a[132:135], v2 offset:2304
    v_fma_f32 v81, v81, s24, -v13
    v_mfma_f32_16x16x32_bf16 v[52:55], a[136:139], a[8:11], v[52:55]
    v_exp_f32 v80, v80
    v_mfma_f32_16x16x32_bf16 v[52:55], a[140:143], a[12:15], v[52:55]
    v_exp_f32 v81, v81
    v_mfma_f32_16x16x32_bf16 v[60:63], a[136:139], a[40:43], v[60:63]
    v_fma_f32 v82, v82, s24, -v13
    v_fma_f32 v83, v83, s24, -v13
    v_mfma_f32_16x16x32_bf16 v[60:63], a[140:143], a[44:47], v[60:63]
    v_exp_f32 v82, v82
    v_mfma_f32_16x16x32_bf16 v[68:71], a[136:139], a[72:75], v[68:71]
    v_exp_f32 v83, v83
    v_mfma_f32_16x16x32_bf16 v[68:71], a[140:143], a[76:79], v[68:71]
    v_cvt_pk_bf16_f32 v80, v80, v81
    v_cvt_pk_bf16_f32 v82, v82, v83
    v_mfma_f32_16x16x32_bf16 v[76:79], a[136:139], a[104:107], v[76:79]
    ds_read_b128 a[136:139], v3 offset:2304
    v_accvgpr_write_b32 a208, v80
    v_mfma_f32_16x16x32_bf16 v[76:79], a[140:143], a[108:111], v[76:79]
    s_waitcnt lgkmcnt(1)
    ds_read_b128 a[140:143], v4 offset:2304
    v_accvgpr_write_b32 a209, v82
    v_mfma_f32_16x16x32_bf16 v[52:55], a[128:131], a[16:19], v[52:55]
    v_fma_f32 v88, v88, s24, -v14
    v_fma_f32 v89, v89, s24, -v14
    v_mfma_f32_16x16x32_bf16 v[52:55], a[132:135], a[20:23], v[52:55]
    v_exp_f32 v88, v88
    v_mfma_f32_16x16x32_bf16 v[60:63], a[128:131], a[48:51], v[60:63]
    v_exp_f32 v89, v89
    v_mfma_f32_16x16x32_bf16 v[60:63], a[132:135], a[52:55], v[60:63]
    v_fma_f32 v90, v90, s24, -v14
    v_fma_f32 v91, v91, s24, -v14
    v_mfma_f32_16x16x32_bf16 v[68:71], a[128:131], a[80:83], v[68:71]
    v_exp_f32 v90, v90
    v_mfma_f32_16x16x32_bf16 v[68:71], a[132:135], a[84:87], v[68:71]
    v_exp_f32 v91, v91
    v_mfma_f32_16x16x32_bf16 v[76:79], a[128:131], a[112:115], v[76:79]
    ds_read_b128 a[128:131], v1 offset:16384
    v_cvt_pk_bf16_f32 v88, v88, v89
    v_mfma_f32_16x16x32_bf16 v[76:79], a[132:135], a[116:119], v[76:79]
    s_waitcnt lgkmcnt(1)
    ds_read_b128 a[132:135], v2 offset:16384
    v_accvgpr_write_b32 a212, v88
    v_mfma_f32_16x16x32_bf16 v[52:55], a[136:139], a[24:27], v[52:55]
    v_cvt_pk_bf16_f32 v90, v90, v91
    v_fma_f32 v96, v96, s24, -v15
    v_mfma_f32_16x16x32_bf16 v[52:55], a[140:143], a[28:31], v[52:55]
    v_exp_f32 v96, v96
    v_mfma_f32_16x16x32_bf16 v[60:63], a[136:139], a[56:59], v[60:63]
    v_accvgpr_write_b32 a213, v90
    v_fma_f32 v97, v97, s24, -v15
    v_mfma_f32_16x16x32_bf16 v[60:63], a[140:143], a[60:63], v[60:63]
    v_exp_f32 v97, v97
    v_mfma_f32_16x16x32_bf16 v[68:71], a[136:139], a[88:91], v[68:71]
    v_fma_f32 v98, v98, s24, -v15
    v_fma_f32 v99, v99, s24, -v15
    v_mfma_f32_16x16x32_bf16 v[68:71], a[140:143], a[92:95], v[68:71]
    v_exp_f32 v98, v98
    v_mfma_f32_16x16x32_bf16 v[76:79], a[136:139], a[120:123], v[76:79]
    ds_read_b128 a[136:139], v3 offset:16384
    v_cvt_pk_bf16_f32 v96, v96, v97
    v_mfma_f32_16x16x32_bf16 v[76:79], a[140:143], a[124:127], v[76:79]
    s_waitcnt lgkmcnt(1)
    v_exp_f32 v99, v99
    v_mfma_f32_16x16x32_bf16 v[80:83], a[128:131], a[0:3], 0
    s_waitcnt vmcnt(9)
    ds_read_b128 a[140:143], v4 offset:16384
    v_accvgpr_write_b32 a216, v96
    v_mfma_f32_16x16x32_bf16 v[80:83], a[132:135], a[4:7], v[80:83]
    s_barrier
    v_cvt_pk_bf16_f32 v98, v98, v99
    v_fma_f32 v104, v104, s24, -v16
    v_mfma_f32_16x16x32_bf16 v[88:91], a[128:131], a[32:35], 0
    s_add_u32 m0, s30, 0
    v_exp_f32 v104, v104
    v_mfma_f32_16x16x32_bf16 v[88:91], a[132:135], a[36:39], v[88:91]
    s_xor_b32 s48, s4, 0
    v_accvgpr_write_b32 a217, v98
    v_fma_f32 v105, v105, s24, -v16
    v_mfma_f32_16x16x32_bf16 v[96:99], a[128:131], a[64:67], 0
    buffer_load_dwordx4 v8, s[16:19], s48 offen offset:0 lds
    v_mfma_f32_16x16x32_bf16 v[96:99], a[132:135], a[68:71], v[96:99]
    v_exp_f32 v105, v105
    v_fma_f32 v106, v106, s24, -v16
    v_fma_f32 v107, v107, s24, -v16
    v_exp_f32 v106, v106
    v_exp_f32 v107, v107
    v_cvt_pk_bf16_f32 v104, v104, v105
    v_cvt_pk_bf16_f32 v106, v106, v107
    v_accvgpr_write_b32 a220, v104
    v_accvgpr_write_b32 a221, v106
    v_mfma_f32_16x16x32_bf16 v[104:107], a[128:131], a[96:99], 0
    ds_read_b128 a[128:131], v1 offset:16640
    v_fma_f32 v84, v84, s24, -v13
    v_mfma_f32_16x16x32_bf16 v[104:107], a[132:135], a[100:103], v[104:107]
    s_waitcnt lgkmcnt(1)
    ds_read_b128 a[132:135], v2 offset:16640
    v_fma_f32 v85, v85, s24, -v13
    v_mfma_f32_16x16x32_bf16 v[80:83], a[136:139], a[8:11], v[80:83]
    buffer_load_dwordx4 v8, s[16:19], s48 offen offset:1024 lds
    v_mfma_f32_16x16x32_bf16 v[80:83], a[140:143], a[12:15], v[80:83]
    v_exp_f32 v84, v84
    v_mfma_f32_16x16x32_bf16 v[88:91], a[136:139], a[40:43], v[88:91]
    v_exp_f32 v85, v85
    v_mfma_f32_16x16x32_bf16 v[88:91], a[140:143], a[44:47], v[88:91]
    v_fma_f32 v86, v86, s24, -v13
    v_fma_f32 v87, v87, s24, -v13
    v_mfma_f32_16x16x32_bf16 v[96:99], a[136:139], a[72:75], v[96:99]
    buffer_load_dwordx4 v8, s[16:19], s48 offen offset:2048 lds
    v_mfma_f32_16x16x32_bf16 v[96:99], a[140:143], a[76:79], v[96:99]
    v_exp_f32 v86, v86
    v_mfma_f32_16x16x32_bf16 v[104:107], a[136:139], a[104:107], v[104:107]
    ds_read_b128 a[136:139], v3 offset:16640
    v_cvt_pk_bf16_f32 v84, v84, v85
    v_mfma_f32_16x16x32_bf16 v[104:107], a[140:143], a[108:111], v[104:107]
    s_waitcnt lgkmcnt(1)
    ds_read_b128 a[140:143], v4 offset:16640
    v_accvgpr_write_b32 a210, v84
    v_mfma_f32_16x16x32_bf16 v[80:83], a[128:131], a[16:19], v[80:83]
    buffer_load_dwordx4 v8, s[16:19], s48 offen offset:3072 lds
    v_mfma_f32_16x16x32_bf16 v[80:83], a[132:135], a[20:23], v[80:83]
    v_exp_f32 v87, v87
    v_mfma_f32_16x16x32_bf16 v[88:91], a[128:131], a[48:51], v[88:91]
    v_cvt_pk_bf16_f32 v86, v86, v87
    v_fma_f32 v92, v92, s24, -v14
    v_mfma_f32_16x16x32_bf16 v[88:91], a[132:135], a[52:55], v[88:91]
    v_exp_f32 v92, v92
    v_mfma_f32_16x16x32_bf16 v[96:99], a[128:131], a[80:83], v[96:99]
    v_accvgpr_write_b32 a211, v86
    v_fma_f32 v93, v93, s24, -v14
    v_mfma_f32_16x16x32_bf16 v[96:99], a[132:135], a[84:87], v[96:99]
    v_exp_f32 v93, v93
    v_mfma_f32_16x16x32_bf16 v[104:107], a[128:131], a[112:115], v[104:107]
    ds_read_b128 a[128:131], v1 offset:18432
    v_fma_f32 v94, v94, s24, -v14
    v_mfma_f32_16x16x32_bf16 v[104:107], a[132:135], a[116:119], v[104:107]
    s_waitcnt lgkmcnt(1)
    ds_read_b128 a[132:135], v2 offset:18432
    v_fma_f32 v95, v95, s24, -v14
    v_mfma_f32_16x16x32_bf16 v[80:83], a[136:139], a[24:27], v[80:83]
    v_exp_f32 v94, v94
    v_mfma_f32_16x16x32_bf16 v[80:83], a[140:143], a[28:31], v[80:83]
    v_exp_f32 v95, v95
    v_mfma_f32_16x16x32_bf16 v[88:91], a[136:139], a[56:59], v[88:91]
    v_cvt_pk_bf16_f32 v92, v92, v93
    v_cvt_pk_bf16_f32 v94, v94, v95
    v_mfma_f32_16x16x32_bf16 v[88:91], a[140:143], a[60:63], v[88:91]
    v_accvgpr_write_b32 a214, v92
    v_accvgpr_write_b32 a215, v94
    v_mfma_f32_16x16x32_bf16 v[96:99], a[136:139], a[88:91], v[96:99]
    v_fma_f32 v100, v100, s24, -v15
    v_fma_f32 v101, v101, s24, -v15
    v_mfma_f32_16x16x32_bf16 v[96:99], a[140:143], a[92:95], v[96:99]
    v_exp_f32 v100, v100
    v_mfma_f32_16x16x32_bf16 v[104:107], a[136:139], a[120:123], v[104:107]
    ds_read_b128 a[136:139], v3 offset:18432
    v_fma_f32 v102, v102, s24, -v15
    v_mfma_f32_16x16x32_bf16 v[104:107], a[140:143], a[124:127], v[104:107]
    s_waitcnt lgkmcnt(1)
    ds_read_b128 a[140:143], v4 offset:18432
    v_fma_f32 v103, v103, s24, -v15
    v_mfma_f32_16x16x32_bf16 v[84:87], a[128:131], a[0:3], 0
    v_exp_f32 v101, v101
    v_mfma_f32_16x16x32_bf16 v[84:87], a[132:135], a[4:7], v[84:87]
    v_exp_f32 v102, v102
    v_mfma_f32_16x16x32_bf16 v[92:95], a[128:131], a[32:35], 0
    v_exp_f32 v103, v103
    v_mfma_f32_16x16x32_bf16 v[92:95], a[132:135], a[36:39], v[92:95]
    v_cvt_pk_bf16_f32 v100, v100, v101
    v_cvt_pk_bf16_f32 v102, v102, v103
    v_accvgpr_write_b32 a218, v100
    v_accvgpr_write_b32 a219, v102
    v_mfma_f32_16x16x32_bf16 v[100:103], a[128:131], a[64:67], 0
    v_fma_f32 v108, v108, s24, -v16
    v_fma_f32 v109, v109, s24, -v16
    v_mfma_f32_16x16x32_bf16 v[100:103], a[132:135], a[68:71], v[100:103]
    v_exp_f32_e64 v108, v108
    v_fma_f32 v110, v110, s24, -v16
    v_fma_f32 v111, v111, s24, -v16
    v_exp_f32 v109, v109
    v_exp_f32 v110, v110
    v_exp_f32_e64 v111, v111
    v_cvt_pk_bf16_f32 v108, v108, v109
    v_cvt_pk_bf16_f32 v110, v110, v111
    v_accvgpr_write_b32 a222, v108
    v_accvgpr_write_b32 a223, v110
    v_mfma_f32_16x16x32_bf16 v[108:111], a[128:131], a[96:99], 0
    ds_read_b128 a[128:131], v1 offset:18688
    v_fma_f32 v48, v48, s24, -v13
    v_mfma_f32_16x16x32_bf16 v[108:111], a[132:135], a[100:103], v[108:111]
    s_waitcnt lgkmcnt(1)
    ds_read_b128 a[132:135], v2 offset:18688
    v_fma_f32 v49, v49, s24, -v13
    v_mfma_f32_16x16x32_bf16 v[84:87], a[136:139], a[8:11], v[84:87]
    v_exp_f32 v48, v48
    v_mfma_f32_16x16x32_bf16 v[84:87], a[140:143], a[12:15], v[84:87]
    v_exp_f32 v49, v49
    v_mfma_f32_16x16x32_bf16 v[92:95], a[136:139], a[40:43], v[92:95]
    v_fma_f32 v50, v50, s24, -v13
    v_fma_f32 v51, v51, s24, -v13
    v_mfma_f32_16x16x32_bf16 v[92:95], a[140:143], a[44:47], v[92:95]
    v_exp_f32 v50, v50
    v_mfma_f32_16x16x32_bf16 v[100:103], a[136:139], a[72:75], v[100:103]
    v_exp_f32 v51, v51
    v_mfma_f32_16x16x32_bf16 v[100:103], a[140:143], a[76:79], v[100:103]
    v_cvt_pk_bf16_f32 v48, v48, v49
    v_cvt_pk_bf16_f32 v50, v50, v51
    v_mfma_f32_16x16x32_bf16 v[108:111], a[136:139], a[104:107], v[108:111]
    ds_read_b128 a[136:139], v3 offset:18688
    v_accvgpr_write_b32 a224, v48
    v_mfma_f32_16x16x32_bf16 v[108:111], a[140:143], a[108:111], v[108:111]
    ds_read_b128 a[140:143], v4 offset:18688
    v_accvgpr_write_b32 a225, v50
    v_mfma_f32_16x16x32_bf16 v[26:29], v[22:25], v[208:211], v[26:29]
    v_fma_f32 v56, v56, s24, -v14
    v_fma_f32 v57, v57, s24, -v14
    v_mfma_f32_16x16x32_bf16 v[26:29], v[22:25], a[208:211], v[26:29]
    v_exp_f32 v56, v56
    v_mfma_f32_16x16x32_bf16 v[30:33], v[22:25], v[212:215], v[30:33]
    v_exp_f32 v57, v57
    v_mfma_f32_16x16x32_bf16 v[30:33], v[22:25], a[212:215], v[30:33]
    v_fma_f32 v58, v58, s24, -v14
    v_fma_f32 v59, v59, s24, -v14
    v_mfma_f32_16x16x32_bf16 v[34:37], v[22:25], v[216:219], v[34:37]
    v_exp_f32 v58, v58
    v_mfma_f32_16x16x32_bf16 v[34:37], v[22:25], a[216:219], v[34:37]
    v_exp_f32 v59, v59
    v_mfma_f32_16x16x32_bf16 v[38:41], v[22:25], v[220:223], v[38:41]
    v_cvt_pk_bf16_f32 v56, v56, v57
    v_cvt_pk_bf16_f32 v58, v58, v59
    v_mfma_f32_16x16x32_bf16 v[38:41], v[22:25], a[220:223], v[38:41]
    s_waitcnt lgkmcnt(2)
    v_accvgpr_write_b32 a228, v56
    v_accvgpr_write_b32 a229, v58
    v_mfma_f32_16x16x32_bf16 v[84:87], a[128:131], a[16:19], v[84:87]
    v_fma_f32 v64, v64, s24, -v15
    v_fma_f32 v65, v65, s24, -v15
    v_mfma_f32_16x16x32_bf16 v[84:87], a[132:135], a[20:23], v[84:87]
    v_exp_f32 v64, v64
    v_mfma_f32_16x16x32_bf16 v[92:95], a[128:131], a[48:51], v[92:95]
    v_exp_f32 v65, v65
    v_mfma_f32_16x16x32_bf16 v[92:95], a[132:135], a[52:55], v[92:95]
    v_fma_f32 v66, v66, s24, -v15
    v_fma_f32 v67, v67, s24, -v15
    v_mfma_f32_16x16x32_bf16 v[100:103], a[128:131], a[80:83], v[100:103]
    v_exp_f32 v66, v66
    v_mfma_f32_16x16x32_bf16 v[100:103], a[132:135], a[84:87], v[100:103]
    v_exp_f32 v67, v67
    v_mfma_f32_16x16x32_bf16 v[108:111], a[128:131], a[112:115], v[108:111]
    ds_read_b128 a[128:131], v1 offset:32768
    v_cvt_pk_bf16_f32 v64, v64, v65
    v_mfma_f32_16x16x32_bf16 v[108:111], a[132:135], a[116:119], v[108:111]
    s_waitcnt lgkmcnt(1)
    ds_read_b128 a[132:135], v2 offset:32768
    v_accvgpr_write_b32 a232, v64
    v_mfma_f32_16x16x32_bf16 v[84:87], a[136:139], a[24:27], v[84:87]
    v_cvt_pk_bf16_f32 v66, v66, v67
    v_fma_f32 v72, v72, s24, -v16
    v_mfma_f32_16x16x32_bf16 v[84:87], a[140:143], a[28:31], v[84:87]
    v_exp_f32 v72, v72
    v_mfma_f32_16x16x32_bf16 v[92:95], a[136:139], a[56:59], v[92:95]
    v_accvgpr_write_b32 a233, v66
    v_fma_f32 v73, v73, s24, -v16
    v_mfma_f32_16x16x32_bf16 v[92:95], a[140:143], a[60:63], v[92:95]
    v_exp_f32 v73, v73
    v_mfma_f32_16x16x32_bf16 v[100:103], a[136:139], a[88:91], v[100:103]
    v_fma_f32 v74, v74, s24, -v16
    v_fma_f32 v75, v75, s24, -v16
    v_mfma_f32_16x16x32_bf16 v[100:103], a[140:143], a[92:95], v[100:103]
    v_exp_f32 v74, v74
    v_mfma_f32_16x16x32_bf16 v[108:111], a[136:139], a[120:123], v[108:111]
    ds_read_b128 a[136:139], v3 offset:32768
    v_cvt_pk_bf16_f32 v72, v72, v73
    v_mfma_f32_16x16x32_bf16 v[108:111], a[140:143], a[124:127], v[108:111]
    s_waitcnt lgkmcnt(1)
    v_exp_f32 v75, v75
    v_mfma_f32_16x16x32_bf16 v[48:51], a[128:131], a[0:3], 0
    s_waitcnt vmcnt(7)
    ds_read_b128 a[140:143], v4 offset:32768
    v_accvgpr_write_b32 a236, v72
    v_mfma_f32_16x16x32_bf16 v[48:51], a[132:135], a[4:7], v[48:51]
    s_barrier
    v_cvt_pk_bf16_f32 v74, v74, v75
    v_fma_f32 v52, v52, s24, -v13
    v_mfma_f32_16x16x32_bf16 v[56:59], a[128:131], a[32:35], 0
    s_add_u32 m0, s30, 16384
    v_exp_f32 v52, v52
    v_mfma_f32_16x16x32_bf16 v[56:59], a[132:135], a[36:39], v[56:59]
    s_xor_b32 s48, s4, 65536
    v_accvgpr_write_b32 a237, v74
    v_fma_f32 v53, v53, s24, -v13
    v_mfma_f32_16x16x32_bf16 v[64:67], a[128:131], a[64:67], 0
    buffer_load_dwordx4 v8, s[16:19], s48 offen offset:0 lds
    v_mfma_f32_16x16x32_bf16 v[64:67], a[132:135], a[68:71], v[64:67]
    v_exp_f32 v53, v53
    v_mfma_f32_16x16x32_bf16 v[72:75], a[128:131], a[96:99], 0
    ds_read_b128 a[128:131], v1 offset:33024
    v_fma_f32 v54, v54, s24, -v13
    v_mfma_f32_16x16x32_bf16 v[72:75], a[132:135], a[100:103], v[72:75]
    s_waitcnt lgkmcnt(1)
    ds_read_b128 a[132:135], v2 offset:33024
    v_fma_f32 v55, v55, s24, -v13
    v_mfma_f32_16x16x32_bf16 v[48:51], a[136:139], a[8:11], v[48:51]
    buffer_load_dwordx4 v8, s[16:19], s48 offen offset:1024 lds
    v_mfma_f32_16x16x32_bf16 v[48:51], a[140:143], a[12:15], v[48:51]
    v_exp_f32 v54, v54
    v_mfma_f32_16x16x32_bf16 v[56:59], a[136:139], a[40:43], v[56:59]
    v_exp_f32 v55, v55
    v_mfma_f32_16x16x32_bf16 v[56:59], a[140:143], a[44:47], v[56:59]
    v_cvt_pk_bf16_f32 v52, v52, v53
    v_cvt_pk_bf16_f32 v54, v54, v55
    v_mfma_f32_16x16x32_bf16 v[64:67], a[136:139], a[72:75], v[64:67]
    buffer_load_dwordx4 v8, s[16:19], s48 offen offset:2048 lds
    v_mfma_f32_16x16x32_bf16 v[64:67], a[140:143], a[76:79], v[64:67]
    v_accvgpr_write_b32 a226, v52
    v_accvgpr_write_b32 a227, v54
    v_mfma_f32_16x16x32_bf16 v[72:75], a[136:139], a[104:107], v[72:75]
    ds_read_b128 a[136:139], v3 offset:33024
    v_fma_f32 v60, v60, s24, -v14
    v_mfma_f32_16x16x32_bf16 v[72:75], a[140:143], a[108:111], v[72:75]
    s_waitcnt lgkmcnt(1)
    ds_read_b128 a[140:143], v4 offset:33024
    v_fma_f32 v61, v61, s24, -v14
    v_mfma_f32_16x16x32_bf16 v[48:51], a[128:131], a[16:19], v[48:51]
    buffer_load_dwordx4 v8, s[16:19], s48 offen offset:3072 lds
    v_mfma_f32_16x16x32_bf16 v[48:51], a[132:135], a[20:23], v[48:51]
    v_exp_f32 v60, v60
    v_mfma_f32_16x16x32_bf16 v[56:59], a[128:131], a[48:51], v[56:59]
    v_exp_f32 v61, v61
    v_mfma_f32_16x16x32_bf16 v[56:59], a[132:135], a[52:55], v[56:59]
    v_fma_f32 v62, v62, s24, -v14
    v_fma_f32 v63, v63, s24, -v14
    v_mfma_f32_16x16x32_bf16 v[64:67], a[128:131], a[80:83], v[64:67]
    v_exp_f32 v62, v62
    v_mfma_f32_16x16x32_bf16 v[64:67], a[132:135], a[84:87], v[64:67]
    v_exp_f32 v63, v63
    v_mfma_f32_16x16x32_bf16 v[72:75], a[128:131], a[112:115], v[72:75]
    ds_read_b128 a[128:131], v1 offset:34816
    v_cvt_pk_bf16_f32 v60, v60, v61
    v_mfma_f32_16x16x32_bf16 v[72:75], a[132:135], a[116:119], v[72:75]
    s_waitcnt lgkmcnt(1)
    ds_read_b128 a[132:135], v2 offset:34816
    v_accvgpr_write_b32 a230, v60
    v_mfma_f32_16x16x32_bf16 v[48:51], a[136:139], a[24:27], v[48:51]
L_t4_5:
    s_cbranch_execz L_t4_9
    v_cvt_pk_bf16_f32 v62, v62, v63
    v_fma_f32 v68, v68, s24, -v15
    v_mfma_f32_16x16x32_bf16 v[48:51], a[140:143], a[28:31], v[48:51]
    v_exp_f32 v68, v68
    v_mfma_f32_16x16x32_bf16 v[56:59], a[136:139], a[56:59], v[56:59]
    v_accvgpr_write_b32 a231, v62
    v_fma_f32 v69, v69, s24, -v15
    v_mfma_f32_16x16x32_bf16 v[56:59], a[140:143], a[60:63], v[56:59]
    v_exp_f32 v69, v69
    v_mfma_f32_16x16x32_bf16 v[64:67], a[136:139], a[88:91], v[64:67]
    v_fma_f32 v70, v70, s24, -v15
    v_fma_f32 v71, v71, s24, -v15
    v_mfma_f32_16x16x32_bf16 v[64:67], a[140:143], a[92:95], v[64:67]
    v_exp_f32 v70, v70
    v_mfma_f32_16x16x32_bf16 v[72:75], a[136:139], a[120:123], v[72:75]
    ds_read_b128 a[136:139], v3 offset:34816
    v_cvt_pk_bf16_f32 v68, v68, v69
    v_mfma_f32_16x16x32_bf16 v[72:75], a[140:143], a[124:127], v[72:75]
    s_waitcnt lgkmcnt(1)
    ds_read_b128 a[140:143], v4 offset:34816
    v_accvgpr_write_b32 a234, v68
    v_mfma_f32_16x16x32_bf16 v[52:55], a[128:131], a[0:3], 0
    v_exp_f32 v71, v71
    v_mfma_f32_16x16x32_bf16 v[52:55], a[132:135], a[4:7], v[52:55]
    v_cvt_pk_bf16_f32 v70, v70, v71
    v_fma_f32 v76, v76, s24, -v16
    v_mfma_f32_16x16x32_bf16 v[60:63], a[128:131], a[32:35], 0
    v_exp_f32 v76, v76
    v_mfma_f32_16x16x32_bf16 v[60:63], a[132:135], a[36:39], v[60:63]
    v_accvgpr_write_b32 a235, v70
    v_fma_f32 v77, v77, s24, -v16
    v_mfma_f32_16x16x32_bf16 v[68:71], a[128:131], a[64:67], 0
    v_exp_f32 v77, v77
    v_mfma_f32_16x16x32_bf16 v[68:71], a[132:135], a[68:71], v[68:71]
    v_fma_f32 v78, v78, s24, -v16
    v_fma_f32 v79, v79, s24, -v16
    v_exp_f32 v78, v78
    v_exp_f32_e64 v79, v79
    v_cvt_pk_bf16_f32 v76, v76, v77
    v_cvt_pk_bf16_f32 v78, v78, v79
    v_accvgpr_write_b32 a238, v76
    v_accvgpr_write_b32 a239, v78
    v_mfma_f32_16x16x32_bf16 v[76:79], a[128:131], a[96:99], 0
    ds_read_b128 a[128:131], v1 offset:35072
    v_fma_f32 v80, v80, s24, -v13
    v_mfma_f32_16x16x32_bf16 v[76:79], a[132:135], a[100:103], v[76:79]
    s_waitcnt lgkmcnt(1)
    ds_read_b128 a[132:135], v2 offset:35072
    v_fma_f32 v81, v81, s24, -v13
    v_mfma_f32_16x16x32_bf16 v[52:55], a[136:139], a[8:11], v[52:55]
    v_exp_f32 v80, v80
    v_mfma_f32_16x16x32_bf16 v[52:55], a[140:143], a[12:15], v[52:55]
    v_exp_f32 v81, v81
    v_mfma_f32_16x16x32_bf16 v[60:63], a[136:139], a[40:43], v[60:63]
    v_fma_f32 v82, v82, s24, -v13
    v_fma_f32 v83, v83, s24, -v13
    v_mfma_f32_16x16x32_bf16 v[60:63], a[140:143], a[44:47], v[60:63]
    v_exp_f32 v82, v82
    v_mfma_f32_16x16x32_bf16 v[68:71], a[136:139], a[72:75], v[68:71]
    v_exp_f32 v83, v83
    v_mfma_f32_16x16x32_bf16 v[68:71], a[140:143], a[76:79], v[68:71]
    v_cvt_pk_bf16_f32 v80, v80, v81
    v_cvt_pk_bf16_f32 v82, v82, v83
    v_mfma_f32_16x16x32_bf16 v[76:79], a[136:139], a[104:107], v[76:79]
    ds_read_b128 a[136:139], v3 offset:35072
    v_accvgpr_write_b32 a240, v80
    v_mfma_f32_16x16x32_bf16 v[76:79], a[140:143], a[108:111], v[76:79]
    s_waitcnt lgkmcnt(1)
    ds_read_b128 a[140:143], v4 offset:35072
    v_accvgpr_write_b32 a241, v82
    v_mfma_f32_16x16x32_bf16 v[52:55], a[128:131], a[16:19], v[52:55]
    v_fma_f32 v88, v88, s24, -v14
    v_fma_f32 v89, v89, s24, -v14
    v_mfma_f32_16x16x32_bf16 v[52:55], a[132:135], a[20:23], v[52:55]
    v_exp_f32 v88, v88
    v_mfma_f32_16x16x32_bf16 v[60:63], a[128:131], a[48:51], v[60:63]
    v_exp_f32 v89, v89
    v_mfma_f32_16x16x32_bf16 v[60:63], a[132:135], a[52:55], v[60:63]
    v_fma_f32 v90, v90, s24, -v14
    v_fma_f32 v91, v91, s24, -v14
    v_mfma_f32_16x16x32_bf16 v[68:71], a[128:131], a[80:83], v[68:71]
    v_exp_f32 v90, v90
    v_mfma_f32_16x16x32_bf16 v[68:71], a[132:135], a[84:87], v[68:71]
    v_exp_f32 v91, v91
    v_mfma_f32_16x16x32_bf16 v[76:79], a[128:131], a[112:115], v[76:79]
    ds_read_b128 a[128:131], v1 offset:49152
    v_cvt_pk_bf16_f32 v88, v88, v89
    v_mfma_f32_16x16x32_bf16 v[76:79], a[132:135], a[116:119], v[76:79]
    s_waitcnt lgkmcnt(1)
    ds_read_b128 a[132:135], v2 offset:49152
    v_accvgpr_write_b32 a244, v88
    v_mfma_f32_16x16x32_bf16 v[52:55], a[136:139], a[24:27], v[52:55]
    v_cvt_pk_bf16_f32 v90, v90, v91
    v_fma_f32 v96, v96, s24, -v15
    v_mfma_f32_16x16x32_bf16 v[52:55], a[140:143], a[28:31], v[52:55]
    v_exp_f32 v96, v96
    v_mfma_f32_16x16x32_bf16 v[60:63], a[136:139], a[56:59], v[60:63]
    v_accvgpr_write_b32 a245, v90
    v_fma_f32 v97, v97, s24, -v15
    v_mfma_f32_16x16x32_bf16 v[60:63], a[140:143], a[60:63], v[60:63]
    v_exp_f32 v97, v97
    v_mfma_f32_16x16x32_bf16 v[68:71], a[136:139], a[88:91], v[68:71]
    v_fma_f32 v98, v98, s24, -v15
    v_fma_f32 v99, v99, s24, -v15
    v_mfma_f32_16x16x32_bf16 v[68:71], a[140:143], a[92:95], v[68:71]
    v_exp_f32 v98, v98
    v_mfma_f32_16x16x32_bf16 v[76:79], a[136:139], a[120:123], v[76:79]
    ds_read_b128 a[136:139], v3 offset:49152
    v_cvt_pk_bf16_f32 v96, v96, v97
    v_mfma_f32_16x16x32_bf16 v[76:79], a[140:143], a[124:127], v[76:79]
    s_waitcnt lgkmcnt(1)
    v_exp_f32 v99, v99
    v_mfma_f32_16x16x32_bf16 v[80:83], a[128:131], a[0:3], 0
    s_waitcnt vmcnt(4)
    ds_read_b128 a[140:143], v4 offset:49152
    v_accvgpr_write_b32 a248, v96
    v_mfma_f32_16x16x32_bf16 v[80:83], a[132:135], a[4:7], v[80:83]
    s_barrier
    v_cvt_pk_bf16_f32 v98, v98, v99
    v_fma_f32 v104, v104, s24, -v16
    v_mfma_f32_16x16x32_bf16 v[88:91], a[128:131], a[32:35], 0
    s_add_u32 m0, s30, 32768
    v_exp_f32 v104, v104
    v_mfma_f32_16x16x32_bf16 v[88:91], a[132:135], a[36:39], v[88:91]
    s_xor_b32 s48, s4, 131072
    v_accvgpr_write_b32 a249, v98
    v_fma_f32 v105, v105, s24, -v16
    v_mfma_f32_16x16x32_bf16 v[96:99], a[128:131], a[64:67], 0
    buffer_load_dwordx4 v8, s[16:19], s48 offen offset:0 lds
    v_mfma_f32_16x16x32_bf16 v[96:99], a[132:135], a[68:71], v[96:99]
    v_exp_f32 v105, v105
    v_fma_f32 v106, v106, s24, -v16
    v_fma_f32 v107, v107, s24, -v16
    v_exp_f32 v106, v106
    v_exp_f32 v107, v107
    v_cvt_pk_bf16_f32 v104, v104, v105
    v_cvt_pk_bf16_f32 v106, v106, v107
    v_accvgpr_write_b32 a252, v104
    v_accvgpr_write_b32 a253, v106
    v_mfma_f32_16x16x32_bf16 v[104:107], a[128:131], a[96:99], 0
    ds_read_b128 a[128:131], v1 offset:49408
    v_fma_f32 v84, v84, s24, -v13
    v_mfma_f32_16x16x32_bf16 v[104:107], a[132:135], a[100:103], v[104:107]
    s_waitcnt lgkmcnt(1)
    ds_read_b128 a[132:135], v2 offset:49408
    v_fma_f32 v85, v85, s24, -v13
    v_mfma_f32_16x16x32_bf16 v[80:83], a[136:139], a[8:11], v[80:83]
    buffer_load_dwordx4 v8, s[16:19], s48 offen offset:1024 lds
    v_mfma_f32_16x16x32_bf16 v[80:83], a[140:143], a[12:15], v[80:83]
    v_exp_f32 v84, v84
    v_mfma_f32_16x16x32_bf16 v[88:91], a[136:139], a[40:43], v[88:91]
    v_exp_f32 v85, v85
    v_mfma_f32_16x16x32_bf16 v[88:91], a[140:143], a[44:47], v[88:91]
    v_fma_f32 v86, v86, s24, -v13
    v_fma_f32 v87, v87, s24, -v13
    v_mfma_f32_16x16x32_bf16 v[96:99], a[136:139], a[72:75], v[96:99]
    buffer_load_dwordx4 v8, s[16:19], s48 offen offset:2048 lds
    v_mfma_f32_16x16x32_bf16 v[96:99], a[140:143], a[76:79], v[96:99]
    v_exp_f32 v86, v86
    v_mfma_f32_16x16x32_bf16 v[104:107], a[136:139], a[104:107], v[104:107]
    ds_read_b128 a[136:139], v3 offset:49408
    v_cvt_pk_bf16_f32 v84, v84, v85
    v_mfma_f32_16x16x32_bf16 v[104:107], a[140:143], a[108:111], v[104:107]
    s_waitcnt lgkmcnt(1)
    ds_read_b128 a[140:143], v4 offset:49408
    v_accvgpr_write_b32 a242, v84
    v_mfma_f32_16x16x32_bf16 v[80:83], a[128:131], a[16:19], v[80:83]
    buffer_load_dwordx4 v8, s[16:19], s48 offen offset:3072 lds
    v_mfma_f32_16x16x32_bf16 v[80:83], a[132:135], a[20:23], v[80:83]
    v_exp_f32 v87, v87
    v_mfma_f32_16x16x32_bf16 v[88:91], a[128:131], a[48:51], v[88:91]
    v_cvt_pk_bf16_f32 v86, v86, v87
    v_fma_f32 v92, v92, s24, -v14
    v_mfma_f32_16x16x32_bf16 v[88:91], a[132:135], a[52:55], v[88:91]
    v_exp_f32 v92, v92
    v_mfma_f32_16x16x32_bf16 v[96:99], a[128:131], a[80:83], v[96:99]
    v_accvgpr_write_b32 a243, v86
    v_fma_f32 v93, v93, s24, -v14
    v_mfma_f32_16x16x32_bf16 v[96:99], a[132:135], a[84:87], v[96:99]
    v_exp_f32 v93, v93
    v_mfma_f32_16x16x32_bf16 v[104:107], a[128:131], a[112:115], v[104:107]
    ds_read_b128 a[128:131], v1 offset:51200
    v_fma_f32 v94, v94, s24, -v14
    v_mfma_f32_16x16x32_bf16 v[104:107], a[132:135], a[116:119], v[104:107]
    s_waitcnt lgkmcnt(1)
    ds_read_b128 a[132:135], v2 offset:51200
    v_fma_f32 v95, v95, s24, -v14
    v_mfma_f32_16x16x32_bf16 v[80:83], a[136:139], a[24:27], v[80:83]
    v_exp_f32 v94, v94
    v_mfma_f32_16x16x32_bf16 v[80:83], a[140:143], a[28:31], v[80:83]
    v_exp_f32 v95, v95
    v_mfma_f32_16x16x32_bf16 v[88:91], a[136:139], a[56:59], v[88:91]
    v_cvt_pk_bf16_f32 v92, v92, v93
    v_cvt_pk_bf16_f32 v94, v94, v95
    v_mfma_f32_16x16x32_bf16 v[88:91], a[140:143], a[60:63], v[88:91]
    v_accvgpr_write_b32 a246, v92
    v_accvgpr_write_b32 a247, v94
    v_mfma_f32_16x16x32_bf16 v[96:99], a[136:139], a[88:91], v[96:99]
    v_fma_f32 v100, v100, s24, -v15
    v_fma_f32 v101, v101, s24, -v15
    v_mfma_f32_16x16x32_bf16 v[96:99], a[140:143], a[92:95], v[96:99]
    v_exp_f32 v100, v100
    v_mfma_f32_16x16x32_bf16 v[104:107], a[136:139], a[120:123], v[104:107]
    ds_read_b128 a[136:139], v3 offset:51200
    v_fma_f32 v102, v102, s24, -v15
    v_mfma_f32_16x16x32_bf16 v[104:107], a[140:143], a[124:127], v[104:107]
    s_waitcnt lgkmcnt(1)
    ds_read_b128 a[140:143], v4 offset:51200
    v_fma_f32 v103, v103, s24, -v15
    v_mfma_f32_16x16x32_bf16 v[84:87], a[128:131], a[0:3], 0
    v_exp_f32 v101, v101
    v_mfma_f32_16x16x32_bf16 v[84:87], a[132:135], a[4:7], v[84:87]
    v_exp_f32 v102, v102
    v_mfma_f32_16x16x32_bf16 v[92:95], a[128:131], a[32:35], 0
    v_exp_f32 v103, v103
    v_mfma_f32_16x16x32_bf16 v[92:95], a[132:135], a[36:39], v[92:95]
    v_cvt_pk_bf16_f32 v100, v100, v101
    v_cvt_pk_bf16_f32 v102, v102, v103
    v_accvgpr_write_b32 a250, v100
    v_accvgpr_write_b32 a251, v102
    v_mfma_f32_16x16x32_bf16 v[100:103], a[128:131], a[64:67], 0
    v_fma_f32 v108, v108, s24, -v16
    v_fma_f32 v109, v109, s24, -v16
    v_mfma_f32_16x16x32_bf16 v[100:103], a[132:135], a[68:71], v[100:103]
    v_exp_f32_e64 v108, v108
    v_fma_f32 v110, v110, s24, -v16
    v_fma_f32 v111, v111, s24, -v16
    v_exp_f32 v109, v109
    v_exp_f32 v110, v110
    v_exp_f32_e64 v111, v111
    v_cvt_pk_bf16_f32 v108, v108, v109
    v_cvt_pk_bf16_f32 v110, v110, v111
    v_accvgpr_write_b32 a254, v108
    v_accvgpr_write_b32 a255, v110
    v_mfma_f32_16x16x32_bf16 v[108:111], a[128:131], a[96:99], 0
    ds_read_b128 a[128:131], v1 offset:51456
    v_fma_f32 v48, v48, s24, -v13
    v_mfma_f32_16x16x32_bf16 v[108:111], a[132:135], a[100:103], v[108:111]
    s_waitcnt lgkmcnt(1)
    ds_read_b128 a[132:135], v2 offset:51456
    v_fma_f32 v49, v49, s24, -v13
    v_mfma_f32_16x16x32_bf16 v[84:87], a[136:139], a[8:11], v[84:87]
    v_exp_f32 v48, v48
    v_mfma_f32_16x16x32_bf16 v[84:87], a[140:143], a[12:15], v[84:87]
    v_exp_f32 v49, v49
    v_mfma_f32_16x16x32_bf16 v[92:95], a[136:139], a[40:43], v[92:95]
    v_fma_f32 v50, v50, s24, -v13
    v_fma_f32 v51, v51, s24, -v13
    v_mfma_f32_16x16x32_bf16 v[92:95], a[140:143], a[44:47], v[92:95]
    v_exp_f32 v50, v50
    v_mfma_f32_16x16x32_bf16 v[100:103], a[136:139], a[72:75], v[100:103]
    v_exp_f32 v51, v51
    v_mfma_f32_16x16x32_bf16 v[100:103], a[140:143], a[76:79], v[100:103]
    v_cvt_pk_bf16_f32 v224, v48, v49
    v_cvt_pk_bf16_f32 v225, v50, v51
    v_mfma_f32_16x16x32_bf16 v[108:111], a[136:139], a[104:107], v[108:111]
    ds_read_b128 a[136:139], v3 offset:51456
    v_fma_f32 v56, v56, s24, -v14
    v_mfma_f32_16x16x32_bf16 v[108:111], a[140:143], a[108:111], v[108:111]
    ds_read_b128 a[140:143], v4 offset:51456
    v_fma_f32 v57, v57, s24, -v14
    v_mfma_f32_16x16x32_bf16 v[26:29], v[22:25], a[224:227], v[26:29]
    v_exp_f32 v56, v56
    v_mfma_f32_16x16x32_bf16 v[26:29], v[22:25], a[240:243], v[26:29]
    v_exp_f32 v57, v57
    v_mfma_f32_16x16x32_bf16 v[30:33], v[22:25], a[228:231], v[30:33]
    v_fma_f32 v58, v58, s24, -v14
    v_fma_f32 v59, v59, s24, -v14
    v_mfma_f32_16x16x32_bf16 v[30:33], v[22:25], a[244:247], v[30:33]
    v_exp_f32 v58, v58
    v_mfma_f32_16x16x32_bf16 v[34:37], v[22:25], a[232:235], v[34:37]
    v_exp_f32 v59, v59
    v_mfma_f32_16x16x32_bf16 v[34:37], v[22:25], a[248:251], v[34:37]
    v_cvt_pk_bf16_f32 v228, v56, v57
    v_cvt_pk_bf16_f32 v229, v58, v59
    v_mfma_f32_16x16x32_bf16 v[38:41], v[22:25], a[236:239], v[38:41]
    v_fma_f32 v64, v64, s24, -v15
    v_fma_f32 v65, v65, s24, -v15
    v_mfma_f32_16x16x32_bf16 v[38:41], v[22:25], a[252:255], v[38:41]
    s_waitcnt lgkmcnt(2)
    v_exp_f32 v64, v64
    v_mfma_f32_16x16x32_bf16 v[84:87], a[128:131], a[16:19], v[84:87]
    v_exp_f32 v65, v65
    v_mfma_f32_16x16x32_bf16 v[84:87], a[132:135], a[20:23], v[84:87]
    v_fma_f32 v66, v66, s24, -v15
    v_fma_f32 v67, v67, s24, -v15
    v_mfma_f32_16x16x32_bf16 v[92:95], a[128:131], a[48:51], v[92:95]
    v_exp_f32 v66, v66
    v_mfma_f32_16x16x32_bf16 v[92:95], a[132:135], a[52:55], v[92:95]
    v_exp_f32 v67, v67
    v_mfma_f32_16x16x32_bf16 v[100:103], a[128:131], a[80:83], v[100:103]
    v_cvt_pk_bf16_f32 v232, v64, v65
    v_cvt_pk_bf16_f32 v233, v66, v67
    v_mfma_f32_16x16x32_bf16 v[100:103], a[132:135], a[84:87], v[100:103]
    v_fma_f32 v72, v72, s24, -v16
    v_fma_f32 v73, v73, s24, -v16
    v_mfma_f32_16x16x32_bf16 v[108:111], a[128:131], a[112:115], v[108:111]
    ds_read_b64_tr_b16 a[128:129], v5 offset:0
    v_fma_f32 v74, v74, s24, -v16
    v_mfma_f32_16x16x32_bf16 v[108:111], a[132:135], a[116:119], v[108:111]
    s_waitcnt lgkmcnt(1)
    ds_read_b64_tr_b16 a[130:131], v5 offset:2048
    v_fma_f32 v75, v75, s24, -v16
    v_mfma_f32_16x16x32_bf16 v[84:87], a[136:139], a[24:27], v[84:87]
    ds_read_b64_tr_b16 a[132:133], v5 offset:4096
    v_fma_f32 v52, v52, s24, -v13
    v_mfma_f32_16x16x32_bf16 v[84:87], a[140:143], a[28:31], v[84:87]
    ds_read_b64_tr_b16 a[134:135], v5 offset:6144
    v_fma_f32 v53, v53, s24, -v13
    v_mfma_f32_16x16x32_bf16 v[92:95], a[136:139], a[56:59], v[92:95]
    v_exp_f32 v72, v72
    v_mfma_f32_16x16x32_bf16 v[92:95], a[140:143], a[60:63], v[92:95]
    v_exp_f32 v73, v73
    v_mfma_f32_16x16x32_bf16 v[100:103], a[136:139], a[88:91], v[100:103]
    v_exp_f32 v74, v74
    v_mfma_f32_16x16x32_bf16 v[100:103], a[140:143], a[92:95], v[100:103]
    v_exp_f32 v75, v75
    v_mfma_f32_16x16x32_bf16 v[108:111], a[136:139], a[120:123], v[108:111]
    ds_read_b64_tr_b16 a[136:137], v5 offset:8192
    v_cvt_pk_bf16_f32 v236, v72, v73
    v_mfma_f32_16x16x32_bf16 v[108:111], a[140:143], a[124:127], v[108:111]
    s_waitcnt lgkmcnt(1)
    ds_read_b64_tr_b16 a[138:139], v5 offset:10240
    v_cvt_pk_bf16_f32 v237, v74, v75
    v_mfma_f32_16x16x32_bf16 v[48:51], a[128:131], v[112:115], 0
    s_waitcnt vmcnt(4)
    ds_read_b64_tr_b16 a[140:141], v5 offset:12288
    v_fma_f32 v54, v54, s24, -v13
    v_mfma_f32_16x16x32_bf16 v[48:51], a[132:135], v[128:131], v[48:51]
    s_barrier
    ds_read_b64_tr_b16 a[142:143], v5 offset:14336
    v_fma_f32 v55, v55, s24, -v13
    v_mfma_f32_16x16x32_bf16 v[56:59], a[128:131], v[116:119], 0
    s_add_u32 m0, s30, 49152
    v_exp_f32 v52, v52
    v_mfma_f32_16x16x32_bf16 v[56:59], a[132:135], v[132:135], v[56:59]
    s_xor_b32 s48, s4, 196608
    v_exp_f32 v53, v53
    v_mfma_f32_16x16x32_bf16 v[64:67], a[128:131], v[120:123], 0
    buffer_load_dwordx4 v8, s[16:19], s48 offen offset:0 lds
    v_mfma_f32_16x16x32_bf16 v[64:67], a[132:135], v[136:139], v[64:67]
    v_exp_f32 v54, v54
    v_mfma_f32_16x16x32_bf16 v[72:75], a[128:131], v[124:127], 0
    ds_read_b64_tr_b16 a[128:129], v6 offset:0
    v_cvt_pk_bf16_f32 v226, v52, v53
    v_mfma_f32_16x16x32_bf16 v[72:75], a[132:135], v[140:143], v[72:75]
    s_waitcnt lgkmcnt(1)
    ds_read_b64_tr_b16 a[130:131], v6 offset:2048
    v_fma_f32 v60, v60, s24, -v14
    v_mfma_f32_16x16x32_bf16 v[48:51], a[136:139], v[144:147], v[48:51]
    ds_read_b64_tr_b16 a[132:133], v6 offset:4096
    v_fma_f32 v61, v61, s24, -v14
    v_mfma_f32_16x16x32_bf16 v[48:51], a[140:143], a[144:147], v[48:51]
    ds_read_b64_tr_b16 a[134:135], v6 offset:6144
    v_fma_f32 v62, v62, s24, -v14
    v_mfma_f32_16x16x32_bf16 v[56:59], a[136:139], v[148:151], v[56:59]
    buffer_load_dwordx4 v8, s[16:19], s48 offen offset:1024 lds
    v_mfma_f32_16x16x32_bf16 v[56:59], a[140:143], a[148:151], v[56:59]
    v_exp_f32 v55, v55
    v_mfma_f32_16x16x32_bf16 v[64:67], a[136:139], v[152:155], v[64:67]
    v_exp_f32 v60, v60
    v_mfma_f32_16x16x32_bf16 v[64:67], a[140:143], a[152:155], v[64:67]
    v_exp_f32 v61, v61
    v_mfma_f32_16x16x32_bf16 v[72:75], a[136:139], v[156:159], v[72:75]
    ds_read_b64_tr_b16 a[136:137], v6 offset:8192
    v_cvt_pk_bf16_f32 v227, v54, v55
    v_mfma_f32_16x16x32_bf16 v[72:75], a[140:143], a[156:159], v[72:75]
    s_waitcnt lgkmcnt(1)
    ds_read_b64_tr_b16 a[138:139], v6 offset:10240
    v_fma_f32 v63, v63, s24, -v14
    v_mfma_f32_16x16x32_bf16 v[52:55], a[128:131], v[112:115], 0
    ds_read_b64_tr_b16 a[140:141], v6 offset:12288
    v_cvt_pk_bf16_f32 v230, v60, v61
    v_mfma_f32_16x16x32_bf16 v[52:55], a[132:135], v[128:131], v[52:55]
    ds_read_b64_tr_b16 a[142:143], v6 offset:14336
    v_fma_f32 v68, v68, s24, -v15
    v_exp_f32 v62, v62
    v_exp_f32 v63, v63
    s_nop 0
    v_cvt_pk_bf16_f32 v231, v62, v63
    v_mfma_f32_16x16x32_bf16 v[60:63], a[128:131], v[116:119], 0
    buffer_load_dwordx4 v8, s[16:19], s48 offen offset:2048 lds
    v_mfma_f32_16x16x32_bf16 v[60:63], a[132:135], v[132:135], v[60:63]
    v_exp_f32 v68, v68
    v_fma_f32 v69, v69, s24, -v15
    v_fma_f32 v70, v70, s24, -v15
    v_fma_f32 v71, v71, s24, -v15
    v_exp_f32 v69, v69
    v_exp_f32 v70, v70
    v_exp_f32 v71, v71
    v_cvt_pk_bf16_f32 v234, v68, v69
    v_cvt_pk_bf16_f32 v235, v70, v71
    v_mfma_f32_16x16x32_bf16 v[68:71], a[128:131], v[120:123], 0
    v_fma_f32 v76, v76, s24, -v16
    v_fma_f32 v77, v77, s24, -v16
    v_mfma_f32_16x16x32_bf16 v[68:71], a[132:135], v[136:139], v[68:71]
    v_exp_f32 v76, v76
    v_fma_f32 v78, v78, s24, -v16
    v_fma_f32 v79, v79, s24, -v16
    v_exp_f32 v77, v77
    v_exp_f32 v78, v78
    v_exp_f32 v79, v79
    v_cvt_pk_bf16_f32 v238, v76, v77
    v_cvt_pk_bf16_f32 v239, v78, v79
    v_mfma_f32_16x16x32_bf16 v[76:79], a[128:131], v[124:127], 0
    ds_read_b64_tr_b16 a[128:129], v21 offset:0
    v_fma_f32 v80, v80, s24, -v13
    v_mfma_f32_16x16x32_bf16 v[76:79], a[132:135], v[140:143], v[76:79]
    s_waitcnt lgkmcnt(1)
    ds_read_b64_tr_b16 a[130:131], v21 offset:2048
    v_fma_f32 v81, v81, s24, -v13
    v_mfma_f32_16x16x32_bf16 v[52:55], a[136:139], v[144:147], v[52:55]
    ds_read_b64_tr_b16 a[132:133], v21 offset:4096
    v_fma_f32 v82, v82, s24, -v13
    v_mfma_f32_16x16x32_bf16 v[52:55], a[140:143], a[144:147], v[52:55]
    ds_read_b64_tr_b16 a[134:135], v21 offset:6144
    v_fma_f32 v83, v83, s24, -v13
    v_mfma_f32_16x16x32_bf16 v[60:63], a[136:139], v[148:151], v[60:63]
    buffer_load_dwordx4 v8, s[16:19], s48 offen offset:3072 lds
    v_mfma_f32_16x16x32_bf16 v[60:63], a[140:143], a[148:151], v[60:63]
    v_exp_f32 v80, v80
    v_mfma_f32_16x16x32_bf16 v[68:71], a[136:139], v[152:155], v[68:71]
    v_exp_f32 v81, v81
    v_mfma_f32_16x16x32_bf16 v[68:71], a[140:143], a[152:155], v[68:71]
    v_exp_f32 v82, v82
    v_mfma_f32_16x16x32_bf16 v[76:79], a[136:139], v[156:159], v[76:79]
    ds_read_b64_tr_b16 a[136:137], v21 offset:8192
    v_cvt_pk_bf16_f32 v240, v80, v81
    v_mfma_f32_16x16x32_bf16 v[76:79], a[140:143], a[156:159], v[76:79]
    s_waitcnt lgkmcnt(1)
    ds_read_b64_tr_b16 a[138:139], v21 offset:10240
    v_fma_f32 v88, v88, s24, -v14
    v_exp_f32 v83, v83
    s_nop 0
    v_cvt_pk_bf16_f32 v241, v82, v83
    v_mfma_f32_16x16x32_bf16 v[80:83], a[128:131], v[112:115], 0
    ds_read_b64_tr_b16 a[140:141], v21 offset:12288
    v_fma_f32 v89, v89, s24, -v14
    v_mfma_f32_16x16x32_bf16 v[80:83], a[132:135], v[128:131], v[80:83]
    ds_read_b64_tr_b16 a[142:143], v21 offset:14336
    v_fma_f32 v90, v90, s24, -v14
    v_fma_f32 v91, v91, s24, -v14
    v_exp_f32 v88, v88
    v_exp_f32 v89, v89
    v_exp_f32 v90, v90
    v_exp_f32 v91, v91
    v_cvt_pk_bf16_f32 v244, v88, v89
    v_cvt_pk_bf16_f32 v245, v90, v91
    v_mfma_f32_16x16x32_bf16 v[88:91], a[128:131], v[116:119], 0
    v_fma_f32 v96, v96, s24, -v15
    v_fma_f32 v97, v97, s24, -v15
    v_mfma_f32_16x16x32_bf16 v[88:91], a[132:135], v[132:135], v[88:91]
    v_exp_f32_e64 v96, v96
    v_fma_f32 v98, v98, s24, -v15
    v_fma_f32 v99, v99, s24, -v15
    v_exp_f32 v97, v97
    v_exp_f32 v98, v98
    v_exp_f32 v99, v99
    v_cvt_pk_bf16_f32 v248, v96, v97
    v_cvt_pk_bf16_f32 v249, v98, v99
    v_mfma_f32_16x16x32_bf16 v[96:99], a[128:131], v[120:123], 0
    v_fma_f32 v104, v104, s24, -v16
    v_fma_f32 v105, v105, s24, -v16
    v_mfma_f32_16x16x32_bf16 v[96:99], a[132:135], v[136:139], v[96:99]
    v_exp_f32 v104, v104
    v_fma_f32 v106, v106, s24, -v16
    v_fma_f32 v107, v107, s24, -v16
    v_exp_f32 v105, v105
    v_exp_f32 v106, v106
    v_exp_f32 v107, v107
    v_cvt_pk_bf16_f32 v252, v104, v105
    v_cvt_pk_bf16_f32 v253, v106, v107
    v_mfma_f32_16x16x32_bf16 v[104:107], a[128:131], v[124:127], 0
    ds_read_b64_tr_b16 a[128:129], v45 offset:0
    v_fma_f32 v84, v84, s24, -v13
    v_mfma_f32_16x16x32_bf16 v[104:107], a[132:135], v[140:143], v[104:107]
    s_waitcnt lgkmcnt(1)
    ds_read_b64_tr_b16 a[130:131], v45 offset:2048
    v_fma_f32 v85, v85, s24, -v13
    v_mfma_f32_16x16x32_bf16 v[80:83], a[136:139], v[144:147], v[80:83]
    ds_read_b64_tr_b16 a[132:133], v45 offset:4096
    v_fma_f32 v86, v86, s24, -v13
    v_mfma_f32_16x16x32_bf16 v[80:83], a[140:143], a[144:147], v[80:83]
    ds_read_b64_tr_b16 a[134:135], v45 offset:6144
    v_fma_f32 v87, v87, s24, -v13
    v_mfma_f32_16x16x32_bf16 v[88:91], a[136:139], v[148:151], v[88:91]
    v_exp_f32 v84, v84
    v_mfma_f32_16x16x32_bf16 v[88:91], a[140:143], a[148:151], v[88:91]
    v_exp_f32 v85, v85
    v_mfma_f32_16x16x32_bf16 v[96:99], a[136:139], v[152:155], v[96:99]
    v_exp_f32 v86, v86
    v_mfma_f32_16x16x32_bf16 v[96:99], a[140:143], a[152:155], v[96:99]
    v_exp_f32 v87, v87
    v_mfma_f32_16x16x32_bf16 v[104:107], a[136:139], v[156:159], v[104:107]
    ds_read_b64_tr_b16 a[136:137], v45 offset:8192
    v_cvt_pk_bf16_f32 v242, v84, v85
    v_mfma_f32_16x16x32_bf16 v[104:107], a[140:143], a[156:159], v[104:107]
    s_waitcnt lgkmcnt(1)
    ds_read_b64_tr_b16 a[138:139], v45 offset:10240
    v_cvt_pk_bf16_f32 v243, v86, v87
    v_mfma_f32_16x16x32_bf16 v[84:87], a[128:131], v[112:115], 0
    ds_read_b64_tr_b16 a[140:141], v45 offset:12288
    v_fma_f32 v92, v92, s24, -v14
    v_mfma_f32_16x16x32_bf16 v[84:87], a[132:135], v[128:131], v[84:87]
    ds_read_b64_tr_b16 a[142:143], v45 offset:14336
    v_fma_f32 v93, v93, s24, -v14
    v_fma_f32 v94, v94, s24, -v14
    v_fma_f32 v95, v95, s24, -v14
    v_exp_f32 v92, v92
    v_exp_f32 v93, v93
    v_exp_f32 v94, v94
    v_exp_f32 v95, v95
    v_cvt_pk_bf16_f32 v246, v92, v93
    v_cvt_pk_bf16_f32 v247, v94, v95
    v_mfma_f32_16x16x32_bf16 v[92:95], a[128:131], v[116:119], 0
    v_fma_f32 v100, v100, s24, -v15
    v_fma_f32 v101, v101, s24, -v15
    v_mfma_f32_16x16x32_bf16 v[92:95], a[132:135], v[132:135], v[92:95]
    v_exp_f32 v100, v100
    v_fma_f32 v102, v102, s24, -v15
    v_fma_f32 v103, v103, s24, -v15
    v_exp_f32 v101, v101
    v_exp_f32 v102, v102
    v_exp_f32 v103, v103
    v_cvt_pk_bf16_f32 v250, v100, v101
    v_cvt_pk_bf16_f32 v251, v102, v103
    v_mfma_f32_16x16x32_bf16 v[100:103], a[128:131], v[120:123], 0
    v_fma_f32 v108, v108, s24, -v16
    v_fma_f32 v109, v109, s24, -v16
    v_mfma_f32_16x16x32_bf16 v[100:103], a[132:135], v[136:139], v[100:103]
    v_exp_f32 v108, v108
    v_fma_f32 v110, v110, s24, -v16
    v_fma_f32 v111, v111, s24, -v16
    v_exp_f32 v109, v109
    v_exp_f32 v110, v110
    v_exp_f32 v111, v111
    v_cvt_pk_bf16_f32 v254, v108, v109
    v_cvt_pk_bf16_f32 v255, v110, v111
    v_mfma_f32_16x16x32_bf16 v[108:111], a[128:131], v[124:127], 0
    ds_read_b64_tr_b16 a[128:129], v5 offset:16384
    v_mfma_f32_16x16x32_bf16 v[108:111], a[132:135], v[140:143], v[108:111]
    s_waitcnt lgkmcnt(1)
    ds_read_b64_tr_b16 a[130:131], v5 offset:18432
    v_mfma_f32_16x16x32_bf16 v[84:87], a[136:139], v[144:147], v[84:87]
    ds_read_b64_tr_b16 a[132:133], v5 offset:20480
    v_mfma_f32_16x16x32_bf16 v[84:87], a[140:143], a[144:147], v[84:87]
    ds_read_b64_tr_b16 a[134:135], v5 offset:22528
    v_mfma_f32_16x16x32_bf16 v[92:95], a[136:139], v[148:151], v[92:95]
    v_mfma_f32_16x16x32_bf16 v[92:95], a[140:143], a[148:151], v[92:95]
    v_mfma_f32_16x16x32_bf16 v[100:103], a[136:139], v[152:155], v[100:103]
    v_mfma_f32_16x16x32_bf16 v[100:103], a[140:143], a[152:155], v[100:103]
    v_mfma_f32_16x16x32_bf16 v[108:111], a[136:139], v[156:159], v[108:111]
    ds_read_b64_tr_b16 a[136:137], v5 offset:24576
    v_mfma_f32_16x16x32_bf16 v[108:111], a[140:143], a[156:159], v[108:111]
    ds_read_b64_tr_b16 a[138:139], v5 offset:26624
    v_mfma_f32_16x16x32_bf16 v[26:29], v[22:25], v[224:227], v[26:29]
    v_mfma_f32_16x16x32_bf16 v[26:29], v[22:25], v[240:243], v[26:29]
    v_mfma_f32_16x16x32_bf16 v[30:33], v[22:25], v[228:231], v[30:33]
    v_mfma_f32_16x16x32_bf16 v[30:33], v[22:25], v[244:247], v[30:33]
    v_mfma_f32_16x16x32_bf16 v[34:37], v[22:25], v[232:235], v[34:37]
    v_mfma_f32_16x16x32_bf16 v[34:37], v[22:25], v[248:251], v[34:37]
    v_mfma_f32_16x16x32_bf16 v[38:41], v[22:25], v[236:239], v[38:41]
    v_mfma_f32_16x16x32_bf16 v[38:41], v[22:25], v[252:255], v[38:41]
    s_waitcnt lgkmcnt(2)
    s_nop 0
    s_nop 0
    s_nop 0
    v_add_f32 v46, v26, v30
    s_nop 0
    v_add_f32 v46, v46, v34
    s_nop 0
    v_add_f32 v46, v46, v38
    s_nop 0
    v_cmp_nge_f32 vcc, s25, v46
    s_nop 0
    s_cbranch_vccnz L_slow_4
L_ret_4:
    v_mfma_f32_16x16x32_bf16 v[48:51], a[128:131], v[160:163], v[48:51]
    s_waitcnt vmcnt(4)
    ds_read_b64_tr_b16 a[140:141], v5 offset:28672
    v_xor_b32 v46, 64, v10
    v_mfma_f32_16x16x32_bf16 v[48:51], a[132:135], a[160:163], v[48:51]
    s_barrier
    ds_read_b64_tr_b16 a[142:143], v5 offset:30720
    v_xor_b32 v43, 64, v9
    v_mfma_f32_16x16x32_bf16 v[56:59], a[128:131], v[164:167], v[56:59]
L_t4_6:
    s_cbranch_execz L_tback4
    s_add_u32 m0, s30, 0
    ds_read_b128 a[64:67], v10 offset:16384
    v_xor_b32 v44, 128, v9
    v_mfma_f32_16x16x32_bf16 v[56:59], a[132:135], a[164:167], v[56:59]
    s_xor_b32 s48, s5, 0
    ds_read_b128 a[80:83], v10 offset:16640
    v_mfma_f32_16x16x32_bf16 v[64:67], a[128:131], v[168:171], v[64:67]
    buffer_load_dwordx4 v8, s[16:19], s48 offen offset:0 lds
    v_mfma_f32_16x16x32_bf16 v[64:67], a[132:135], a[168:171], v[64:67]
    s_mov_b32 s49, 98304
    ds_read_b128 a[68:71], v46 offset:16384
    v_mfma_f32_16x16x32_bf16 v[72:75], a[128:131], v[172:175], v[72:75]
    ds_read_b64_tr_b16 a[128:129], v6 offset:16384
    v_mfma_f32_16x16x32_bf16 v[72:75], a[132:135], a[172:175], v[72:75]
    s_waitcnt lgkmcnt(4)
    ds_read_b64_tr_b16 a[130:131], v6 offset:18432
    v_mfma_f32_16x16x32_bf16 v[48:51], a[136:139], v[176:179], v[48:51]
    ds_read_b64_tr_b16 a[132:133], v6 offset:20480
    v_mfma_f32_16x16x32_bf16 v[48:51], a[140:143], a[176:179], v[48:51]
    ds_read_b64_tr_b16 a[134:135], v6 offset:22528
    v_mfma_f32_16x16x32_bf16 v[56:59], a[136:139], v[180:183], v[56:59]
    buffer_load_dwordx4 v8, s[16:19], s48 offen offset:1024 lds
    v_mfma_f32_16x16x32_bf16 v[56:59], a[140:143], a[180:183], v[56:59]
    ds_read_b128 a[84:87], v46 offset:16640
    v_xor_b32 v46, 128, v10
    v_mfma_f32_16x16x32_bf16 v[64:67], a[136:139], v[184:187], v[64:67]
    ds_read_b128 a[72:75], v46 offset:16384
    v_mfma_f32_16x16x32_bf16 v[64:67], a[140:143], a[184:187], v[64:67]
    ds_read_b128 a[88:91], v46 offset:16640
    v_xor_b32 v46, 192, v10
    v_mfma_f32_16x16x32_bf16 v[72:75], a[136:139], v[188:191], v[72:75]
    ds_read_b64_tr_b16 a[136:137], v6 offset:24576
    v_mfma_f32_16x16x32_bf16 v[72:75], a[140:143], a[188:191], v[72:75]
    s_waitcnt lgkmcnt(4)
    ds_read_b64_tr_b16 a[138:139], v6 offset:26624
    v_mfma_f32_16x16x32_bf16 v[52:55], a[128:131], v[160:163], v[52:55]
    ds_read_b64_tr_b16 a[140:141], v6 offset:28672
    v_mfma_f32_16x16x32_bf16 v[52:55], a[132:135], a[160:163], v[52:55]
    ds_read_b64_tr_b16 a[142:143], v6 offset:30720
    v_mfma_f32_16x16x32_bf16 v[60:63], a[128:131], v[164:167], v[60:63]
    buffer_load_dwordx4 v8, s[16:19], s48 offen offset:2048 lds
    v_mfma_f32_16x16x32_bf16 v[60:63], a[132:135], a[164:167], v[60:63]
    ds_read_b128 a[76:79], v46 offset:16384
    v_mfma_f32_16x16x32_bf16 v[68:71], a[128:131], v[168:171], v[68:71]
    ds_read_b128 a[92:95], v46 offset:16640
    v_xor_b32 v46, 64, v10
    v_mfma_f32_16x16x32_bf16 v[68:71], a[132:135], a[168:171], v[68:71]
    ds_read_b128 a[0:3], v10 offset:0
    v_mfma_f32_16x16x32_bf16 v[76:79], a[128:131], v[172:175], v[76:79]
    ds_read_b64_tr_b16 a[128:129], v21 offset:16384
    v_mfma_f32_16x16x32_bf16 v[76:79], a[132:135], a[172:175], v[76:79]
    s_waitcnt lgkmcnt(4)
    ds_read_b64_tr_b16 a[130:131], v21 offset:18432
    v_mfma_f32_16x16x32_bf16 v[52:55], a[136:139], v[176:179], v[52:55]
    ds_read_b64_tr_b16 a[132:133], v21 offset:20480
    v_mfma_f32_16x16x32_bf16 v[52:55], a[140:143], a[176:179], v[52:55]
    ds_read_b64_tr_b16 a[134:135], v21 offset:22528
    v_mfma_f32_16x16x32_bf16 v[60:63], a[136:139], v[180:183], v[60:63]
    buffer_load_dwordx4 v8, s[16:19], s48 offen offset:3072 lds
    v_mfma_f32_16x16x32_bf16 v[60:63], a[140:143], a[180:183], v[60:63]
    s_add_u32 m0, s54, 16384
    ds_read_b128 a[16:19], v10 offset:256
    v_mfma_f32_16x16x32_bf16 v[68:71], a[136:139], v[184:187], v[68:71]
    ds_read_b128 a[4:7], v46 offset:0
    v_mfma_f32_16x16x32_bf16 v[68:71], a[140:143], a[184:187], v[68:71]
    ds_read_b128 a[20:23], v46 offset:256
    v_xor_b32 v46, 128, v10
    v_mfma_f32_16x16x32_bf16 v[76:79], a[136:139], v[188:191], v[76:79]
    ds_read_b64_tr_b16 a[136:137], v21 offset:24576
    v_mfma_f32_16x16x32_bf16 v[76:79], a[140:143], a[188:191], v[76:79]
    s_waitcnt lgkmcnt(4)
    ds_read_b64_tr_b16 a[138:139], v21 offset:26624
    v_mfma_f32_16x16x32_bf16 v[80:83], a[128:131], v[160:163], v[80:83]
    ds_read_b64_tr_b16 a[140:141], v21 offset:28672
    v_mfma_f32_16x16x32_bf16 v[80:83], a[132:135], a[160:163], v[80:83]
    ds_read_b64_tr_b16 a[142:143], v21 offset:30720
    v_mfma_f32_16x16x32_bf16 v[88:91], a[128:131], v[164:167], v[88:91]
    buffer_load_dwordx4 v9, s[64:67], s49 offen offset:0 nt lds
    v_mfma_f32_16x16x32_bf16 v[88:91], a[132:135], a[164:167], v[88:91]
    ds_read_b128 a[8:11], v46 offset:0
    v_mfma_f32_16x16x32_bf16 v[96:99], a[128:131], v[168:171], v[96:99]
    ds_read_b128 a[24:27], v46 offset:256
    v_xor_b32 v46, 192, v10
    v_mfma_f32_16x16x32_bf16 v[96:99], a[132:135], a[168:171], v[96:99]
    ds_read_b128 a[12:15], v46 offset:0
    v_mfma_f32_16x16x32_bf16 v[104:107], a[128:131], v[172:175], v[104:107]
    ds_read_b64_tr_b16 a[128:129], v45 offset:16384
    v_mfma_f32_16x16x32_bf16 v[104:107], a[132:135], a[172:175], v[104:107]
    s_waitcnt lgkmcnt(4)
    ds_read_b64_tr_b16 a[130:131], v45 offset:18432
    v_mfma_f32_16x16x32_bf16 v[80:83], a[136:139], v[176:179], v[80:83]
    ds_read_b64_tr_b16 a[132:133], v45 offset:20480
    v_mfma_f32_16x16x32_bf16 v[80:83], a[140:143], a[176:179], v[80:83]
    ds_read_b64_tr_b16 a[134:135], v45 offset:22528
    v_mfma_f32_16x16x32_bf16 v[88:91], a[136:139], v[180:183], v[88:91]
    buffer_load_dwordx4 v43, s[64:67], s49 offen offset:1024 nt lds
    v_mfma_f32_16x16x32_bf16 v[88:91], a[140:143], a[180:183], v[88:91]
    ds_read_b128 a[28:31], v46 offset:256
    v_xor_b32 v46, 64, v10
    v_mfma_f32_16x16x32_bf16 v[96:99], a[136:139], v[184:187], v[96:99]
    ds_read_b128 a[32:35], v10 offset:8192
    v_xor_b32 v43, 192, v9
    v_mfma_f32_16x16x32_bf16 v[96:99], a[140:143], a[184:187], v[96:99]
    ds_read_b128 a[48:51], v10 offset:8448
    v_mfma_f32_16x16x32_bf16 v[104:107], a[136:139], v[188:191], v[104:107]
    ds_read_b64_tr_b16 a[136:137], v45 offset:24576
    v_mfma_f32_16x16x32_bf16 v[104:107], a[140:143], a[188:191], v[104:107]
    s_waitcnt lgkmcnt(4)
    ds_read_b64_tr_b16 a[138:139], v45 offset:26624
    v_mfma_f32_16x16x32_bf16 v[84:87], a[128:131], v[160:163], v[84:87]
    ds_read_b64_tr_b16 a[140:141], v45 offset:28672
    v_mfma_f32_16x16x32_bf16 v[84:87], a[132:135], a[160:163], v[84:87]
    ds_read_b64_tr_b16 a[142:143], v45 offset:30720
    v_mfma_f32_16x16x32_bf16 v[92:95], a[128:131], v[164:167], v[92:95]
    buffer_load_dwordx4 v44, s[64:67], s49 offen offset:2048 nt lds
    v_mfma_f32_16x16x32_bf16 v[92:95], a[132:135], a[164:167], v[92:95]
    ds_read_b128 a[36:39], v46 offset:8192
    v_mfma_f32_16x16x32_bf16 v[100:103], a[128:131], v[168:171], v[100:103]
    ds_read_b128 a[52:55], v46 offset:8448
    v_xor_b32 v46, 128, v10
    v_mfma_f32_16x16x32_bf16 v[100:103], a[132:135], a[168:171], v[100:103]
    ds_read_b128 a[40:43], v46 offset:8192
    v_mfma_f32_16x16x32_bf16 v[108:111], a[128:131], v[172:175], v[108:111]
    ds_read_b64_tr_b16 a[128:129], v5 offset:32768
    v_mfma_f32_16x16x32_bf16 v[108:111], a[132:135], a[172:175], v[108:111]
    s_waitcnt lgkmcnt(4)
    ds_read_b64_tr_b16 a[130:131], v5 offset:34816
    v_mfma_f32_16x16x32_bf16 v[84:87], a[136:139], v[176:179], v[84:87]
    ds_read_b64_tr_b16 a[132:133], v5 offset:36864
    v_mfma_f32_16x16x32_bf16 v[84:87], a[140:143], a[176:179], v[84:87]
    ds_read_b64_tr_b16 a[134:135], v5 offset:38912
    v_mfma_f32_16x16x32_bf16 v[92:95], a[136:139], v[180:183], v[92:95]
    buffer_load_dwordx4 v43, s[64:67], s49 offen offset:3072 nt lds
    v_mfma_f32_16x16x32_bf16 v[92:95], a[140:143], a[180:183], v[92:95]
    ds_read_b128 a[56:59], v46 offset:8448
    v_xor_b32 v46, 192, v10
    v_mfma_f32_16x16x32_bf16 v[100:103], a[136:139], v[184:187], v[100:103]
    ds_read_b128 a[44:47], v46 offset:8192
    v_mfma_f32_16x16x32_bf16 v[100:103], a[140:143], a[184:187], v[100:103]
    ds_read_b128 a[60:63], v46 offset:8448
    v_mfma_f32_16x16x32_bf16 v[108:111], a[136:139], v[188:191], v[108:111]
    ds_read_b64_tr_b16 a[136:137], v5 offset:40960
    v_mfma_f32_16x16x32_bf16 v[108:111], a[140:143], a[188:191], v[108:111]
    s_waitcnt lgkmcnt(4)
    ds_read_b64_tr_b16 a[138:139], v5 offset:43008
    v_mfma_f32_16x16x32_bf16 v[48:51], a[128:131], v[192:195], v[48:51]
    s_waitcnt vmcnt(8)
    ds_read_b64_tr_b16 a[140:141], v5 offset:45056
    v_xor_b32 v43, 64, v9
    v_mfma_f32_16x16x32_bf16 v[48:51], a[132:135], a[192:195], v[48:51]
    s_barrier
    ds_read_b64_tr_b16 a[142:143], v5 offset:47104
    v_xor_b32 v44, 128, v9
    v_mfma_f32_16x16x32_bf16 v[56:59], a[128:131], v[196:199], v[56:59]
    s_add_u32 m0, s30, 16384
    v_rcp_f32 v17, v26
    v_mfma_f32_16x16x32_bf16 v[56:59], a[132:135], a[196:199], v[56:59]
    s_xor_b32 s48, s5, 65536
    v_rcp_f32 v18, v30
    v_mfma_f32_16x16x32_bf16 v[64:67], a[128:131], v[200:203], v[64:67]
    buffer_load_dwordx4 v8, s[16:19], s48 offen offset:0 lds
    v_mfma_f32_16x16x32_bf16 v[64:67], a[132:135], a[200:203], v[64:67]
    s_mov_b32 s49, 102400
    v_rcp_f32 v19, v34
    v_mfma_f32_16x16x32_bf16 v[72:75], a[128:131], v[204:207], v[72:75]
    ds_read_b64_tr_b16 a[128:129], v6 offset:32768
    v_mfma_f32_16x16x32_bf16 v[72:75], a[132:135], a[204:207], v[72:75]
    s_waitcnt lgkmcnt(1)
    ds_read_b64_tr_b16 a[130:131], v6 offset:34816
    v_mfma_f32_16x16x32_bf16 v[48:51], a[136:139], v[208:211], v[48:51]
    ds_read_b64_tr_b16 a[132:133], v6 offset:36864
    v_mfma_f32_16x16x32_bf16 v[48:51], a[140:143], a[208:211], v[48:51]
    ds_read_b64_tr_b16 a[134:135], v6 offset:38912
    v_mfma_f32_16x16x32_bf16 v[56:59], a[136:139], v[212:215], v[56:59]
    buffer_load_dwordx4 v8, s[16:19], s48 offen offset:1024 lds
    v_mfma_f32_16x16x32_bf16 v[56:59], a[140:143], a[212:215], v[56:59]
    v_rcp_f32 v20, v38
    v_mfma_f32_16x16x32_bf16 v[64:67], a[136:139], v[216:219], v[64:67]
    v_mfma_f32_16x16x32_bf16 v[64:67], a[140:143], a[216:219], v[64:67]
    v_mfma_f32_16x16x32_bf16 v[72:75], a[136:139], v[220:223], v[72:75]
    ds_read_b64_tr_b16 a[136:137], v6 offset:40960
    v_mfma_f32_16x16x32_bf16 v[72:75], a[140:143], a[220:223], v[72:75]
    s_waitcnt lgkmcnt(1)
    ds_read_b64_tr_b16 a[138:139], v6 offset:43008
    v_mfma_f32_16x16x32_bf16 v[52:55], a[128:131], v[192:195], v[52:55]
    ds_read_b64_tr_b16 a[140:141], v6 offset:45056
    v_mfma_f32_16x16x32_bf16 v[52:55], a[132:135], a[192:195], v[52:55]
    ds_read_b64_tr_b16 a[142:143], v6 offset:47104
    v_mfma_f32_16x16x32_bf16 v[60:63], a[128:131], v[196:199], v[60:63]
    buffer_load_dwordx4 v8, s[16:19], s48 offen offset:2048 lds
    v_mfma_f32_16x16x32_bf16 v[60:63], a[132:135], a[196:199], v[60:63]
    v_mfma_f32_16x16x32_bf16 v[68:71], a[128:131], v[200:203], v[68:71]
    v_mfma_f32_16x16x32_bf16 v[68:71], a[132:135], a[200:203], v[68:71]
    v_mfma_f32_16x16x32_bf16 v[76:79], a[128:131], v[204:207], v[76:79]
    ds_read_b64_tr_b16 a[128:129], v21 offset:32768
    v_mfma_f32_16x16x32_bf16 v[76:79], a[132:135], a[204:207], v[76:79]
    s_waitcnt lgkmcnt(1)
    ds_read_b64_tr_b16 a[130:131], v21 offset:34816
    v_mfma_f32_16x16x32_bf16 v[52:55], a[136:139], v[208:211], v[52:55]
    ds_read_b64_tr_b16 a[132:133], v21 offset:36864
    v_mfma_f32_16x16x32_bf16 v[52:55], a[140:143], a[208:211], v[52:55]
    ds_read_b64_tr_b16 a[134:135], v21 offset:38912
    v_mfma_f32_16x16x32_bf16 v[60:63], a[136:139], v[212:215], v[60:63]
    buffer_load_dwordx4 v8, s[16:19], s48 offen offset:3072 lds
    v_mfma_f32_16x16x32_bf16 v[60:63], a[140:143], a[212:215], v[60:63]
    s_add_u32 m0, s54, 20480
    v_mfma_f32_16x16x32_bf16 v[68:71], a[136:139], v[216:219], v[68:71]
    v_mfma_f32_16x16x32_bf16 v[68:71], a[140:143], a[216:219], v[68:71]
    v_mfma_f32_16x16x32_bf16 v[76:79], a[136:139], v[220:223], v[76:79]
    ds_read_b64_tr_b16 a[136:137], v21 offset:40960
    v_mfma_f32_16x16x32_bf16 v[76:79], a[140:143], a[220:223], v[76:79]
    s_waitcnt lgkmcnt(1)
    ds_read_b64_tr_b16 a[138:139], v21 offset:43008
    v_mfma_f32_16x16x32_bf16 v[80:83], a[128:131], v[192:195], v[80:83]
    ds_read_b64_tr_b16 a[140:141], v21 offset:45056
    v_mfma_f32_16x16x32_bf16 v[80:83], a[132:135], a[192:195], v[80:83]
    ds_read_b64_tr_b16 a[142:143], v21 offset:47104
    v_mfma_f32_16x16x32_bf16 v[88:91], a[128:131], v[196:199], v[88:91]
    buffer_load_dwordx4 v9, s[64:67], s49 offen offset:0 nt lds
    v_mfma_f32_16x16x32_bf16 v[88:91], a[132:135], a[196:199], v[88:91]
    v_mfma_f32_16x16x32_bf16 v[96:99], a[128:131], v[200:203], v[96:99]
    v_mfma_f32_16x16x32_bf16 v[96:99], a[132:135], a[200:203], v[96:99]
    v_mfma_f32_16x16x32_bf16 v[104:107], a[128:131], v[204:207], v[104:107]
    ds_read_b64_tr_b16 a[128:129], v45 offset:32768
    v_mfma_f32_16x16x32_bf16 v[104:107], a[132:135], a[204:207], v[104:107]
    s_waitcnt lgkmcnt(1)
    ds_read_b64_tr_b16 a[130:131], v45 offset:34816
    v_mfma_f32_16x16x32_bf16 v[80:83], a[136:139], v[208:211], v[80:83]
    ds_read_b64_tr_b16 a[132:133], v45 offset:36864
    v_mfma_f32_16x16x32_bf16 v[80:83], a[140:143], a[208:211], v[80:83]
    ds_read_b64_tr_b16 a[134:135], v45 offset:38912
    v_mfma_f32_16x16x32_bf16 v[88:91], a[136:139], v[212:215], v[88:91]
    buffer_load_dwordx4 v43, s[64:67], s49 offen offset:1024 nt lds
    v_mfma_f32_16x16x32_bf16 v[88:91], a[140:143], a[212:215], v[88:91]
    v_xor_b32 v43, 192, v9
    v_mfma_f32_16x16x32_bf16 v[96:99], a[136:139], v[216:219], v[96:99]
    v_mfma_f32_16x16x32_bf16 v[96:99], a[140:143], a[216:219], v[96:99]
    v_mfma_f32_16x16x32_bf16 v[104:107], a[136:139], v[220:223], v[104:107]
    ds_read_b64_tr_b16 a[136:137], v45 offset:40960
    v_mfma_f32_16x16x32_bf16 v[104:107], a[140:143], a[220:223], v[104:107]
    s_waitcnt lgkmcnt(1)
    ds_read_b64_tr_b16 a[138:139], v45 offset:43008
    v_mfma_f32_16x16x32_bf16 v[84:87], a[128:131], v[192:195], v[84:87]
    ds_read_b64_tr_b16 a[140:141], v45 offset:45056
    v_mfma_f32_16x16x32_bf16 v[84:87], a[132:135], a[192:195], v[84:87]
    ds_read_b64_tr_b16 a[142:143], v45 offset:47104
    v_mfma_f32_16x16x32_bf16 v[92:95], a[128:131], v[196:199], v[92:95]
    buffer_load_dwordx4 v44, s[64:67], s49 offen offset:2048 nt lds
    v_mfma_f32_16x16x32_bf16 v[92:95], a[132:135], a[196:199], v[92:95]
    v_mfma_f32_16x16x32_bf16 v[100:103], a[128:131], v[200:203], v[100:103]
    v_mfma_f32_16x16x32_bf16 v[100:103], a[132:135], a[200:203], v[100:103]
    v_mfma_f32_16x16x32_bf16 v[108:111], a[128:131], v[204:207], v[108:111]
    ds_read_b64_tr_b16 a[128:129], v5 offset:49152
    v_mfma_f32_16x16x32_bf16 v[108:111], a[132:135], a[204:207], v[108:111]
    s_waitcnt lgkmcnt(1)
    ds_read_b64_tr_b16 a[130:131], v5 offset:51200
    v_mfma_f32_16x16x32_bf16 v[84:87], a[136:139], v[208:211], v[84:87]
    ds_read_b64_tr_b16 a[132:133], v5 offset:53248
    v_mfma_f32_16x16x32_bf16 v[84:87], a[140:143], a[208:211], v[84:87]
    ds_read_b64_tr_b16 a[134:135], v5 offset:55296
    v_mfma_f32_16x16x32_bf16 v[92:95], a[136:139], v[212:215], v[92:95]
    buffer_load_dwordx4 v43, s[64:67], s49 offen offset:3072 nt lds
    v_mfma_f32_16x16x32_bf16 v[92:95], a[140:143], a[212:215], v[92:95]
    v_mfma_f32_16x16x32_bf16 v[100:103], a[136:139], v[216:219], v[100:103]
    v_mfma_f32_16x16x32_bf16 v[100:103], a[140:143], a[216:219], v[100:103]
    v_mfma_f32_16x16x32_bf16 v[108:111], a[136:139], v[220:223], v[108:111]
    ds_read_b64_tr_b16 a[136:137], v5 offset:57344
    v_mfma_f32_16x16x32_bf16 v[108:111], a[140:143], a[220:223], v[108:111]
    s_waitcnt lgkmcnt(1)
    ds_read_b64_tr_b16 a[138:139], v5 offset:59392
    v_mfma_f32_16x16x32_bf16 v[48:51], a[128:131], a[224:227], v[48:51]
    s_waitcnt vmcnt(12)
    ds_read_b64_tr_b16 a[140:141], v5 offset:61440
    v_xor_b32 v43, 32, v11
    v_mfma_f32_16x16x32_bf16 v[48:51], a[132:135], a[240:243], v[48:51]
    s_barrier
    ds_read_b64_tr_b16 a[142:143], v5 offset:63488
    v_xor_b32 v42, 64, v11
    v_mfma_f32_16x16x32_bf16 v[56:59], a[128:131], a[228:231], v[56:59]
    s_add_u32 m0, s30, 32768
    v_mfma_f32_16x16x32_bf16 v[56:59], a[132:135], a[244:247], v[56:59]
    s_xor_b32 s48, s5, 131072
    v_mfma_f32_16x16x32_bf16 v[64:67], a[128:131], a[232:235], v[64:67]
    buffer_load_dwordx4 v8, s[16:19], s48 offen offset:0 lds
    v_mfma_f32_16x16x32_bf16 v[64:67], a[132:135], a[248:251], v[64:67]
    s_add_u32 s50, s8, 0
    v_mfma_f32_16x16x32_bf16 v[72:75], a[128:131], a[236:239], v[72:75]
    ds_read_b64_tr_b16 a[128:129], v6 offset:49152
    v_mfma_f32_16x16x32_bf16 v[72:75], a[132:135], a[252:255], v[72:75]
    s_waitcnt lgkmcnt(1)
    ds_read_b64_tr_b16 a[130:131], v6 offset:51200
    v_mfma_f32_16x16x32_bf16 v[48:51], a[136:139], v[224:227], v[48:51]
    ds_read_b64_tr_b16 a[132:133], v6 offset:53248
    v_mfma_f32_16x16x32_bf16 v[48:51], a[140:143], v[240:243], v[48:51]
    ds_read_b64_tr_b16 a[134:135], v6 offset:55296
    v_mfma_f32_16x16x32_bf16 v[56:59], a[136:139], v[228:231], v[56:59]
    buffer_load_dwordx4 v8, s[16:19], s48 offen offset:1024 lds
    v_mfma_f32_16x16x32_bf16 v[56:59], a[140:143], v[244:247], v[56:59]
    v_mfma_f32_16x16x32_bf16 v[64:67], a[136:139], v[232:235], v[64:67]
    v_mfma_f32_16x16x32_bf16 v[64:67], a[140:143], v[248:251], v[64:67]
    v_mfma_f32_16x16x32_bf16 v[72:75], a[136:139], v[236:239], v[72:75]
    ds_read_b64_tr_b16 a[136:137], v6 offset:57344
    v_mul_f32 v48, v48, v17
    v_mfma_f32_16x16x32_bf16 v[72:75], a[140:143], v[252:255], v[72:75]
    s_waitcnt lgkmcnt(1)
    ds_read_b64_tr_b16 a[138:139], v6 offset:59392
    v_mul_f32 v49, v49, v17
    v_mfma_f32_16x16x32_bf16 v[52:55], a[128:131], a[224:227], v[52:55]
    ds_read_b64_tr_b16 a[140:141], v6 offset:61440
    v_mul_f32 v50, v50, v17
    v_mfma_f32_16x16x32_bf16 v[52:55], a[132:135], a[240:243], v[52:55]
    ds_read_b64_tr_b16 a[142:143], v6 offset:63488
    v_mul_f32 v51, v51, v17
    v_mfma_f32_16x16x32_bf16 v[60:63], a[128:131], a[228:231], v[60:63]
    buffer_load_dwordx4 v8, s[16:19], s48 offen offset:2048 lds
    v_mfma_f32_16x16x32_bf16 v[60:63], a[132:135], a[244:247], v[60:63]
    v_cvt_pk_bf16_f32 v48, v48, v49
    v_cvt_pk_bf16_f32 v49, v50, v51
    v_mfma_f32_16x16x32_bf16 v[68:71], a[128:131], a[232:235], v[68:71]
    ds_write_b64 v11, v[48:49] offset:0
    v_mfma_f32_16x16x32_bf16 v[68:71], a[132:135], a[248:251], v[68:71]
    v_mul_f32 v56, v56, v18
    v_mul_f32 v57, v57, v18
    v_mfma_f32_16x16x32_bf16 v[76:79], a[128:131], a[236:239], v[76:79]
    ds_read_b64_tr_b16 a[128:129], v21 offset:49152
    v_mul_f32 v58, v58, v18
    v_mfma_f32_16x16x32_bf16 v[76:79], a[132:135], a[252:255], v[76:79]
    s_waitcnt lgkmcnt(2)
    ds_read_b64_tr_b16 a[130:131], v21 offset:51200
    v_mul_f32 v59, v59, v18
    v_mfma_f32_16x16x32_bf16 v[52:55], a[136:139], v[224:227], v[52:55]
    ds_read_b64_tr_b16 a[132:133], v21 offset:53248
    v_cvt_pk_bf16_f32 v56, v56, v57
    v_mfma_f32_16x16x32_bf16 v[52:55], a[140:143], v[240:243], v[52:55]
    ds_read_b64_tr_b16 a[134:135], v21 offset:55296
    v_cvt_pk_bf16_f32 v57, v58, v59
    v_mfma_f32_16x16x32_bf16 v[60:63], a[136:139], v[228:231], v[60:63]
    buffer_load_dwordx4 v8, s[16:19], s48 offen offset:3072 lds
    v_mfma_f32_16x16x32_bf16 v[60:63], a[140:143], v[244:247], v[60:63]
    ds_write_b64 v11, v[56:57] offset:2048
    v_mfma_f32_16x16x32_bf16 v[68:71], a[136:139], v[232:235], v[68:71]
    v_mul_f32 v64, v64, v19
    v_mul_f32 v65, v65, v19
    v_mfma_f32_16x16x32_bf16 v[68:71], a[140:143], v[248:251], v[68:71]
    v_mul_f32 v66, v66, v19
    v_mul_f32 v67, v67, v19
    v_mfma_f32_16x16x32_bf16 v[76:79], a[136:139], v[236:239], v[76:79]
    ds_read_b64_tr_b16 a[136:137], v21 offset:57344
    v_cvt_pk_bf16_f32 v64, v64, v65
    v_mfma_f32_16x16x32_bf16 v[76:79], a[140:143], v[252:255], v[76:79]
    s_waitcnt lgkmcnt(2)
    ds_read_b64_tr_b16 a[138:139], v21 offset:59392
    v_cvt_pk_bf16_f32 v65, v66, v67
    v_mfma_f32_16x16x32_bf16 v[80:83], a[128:131], a[224:227], v[80:83]
    ds_read_b64_tr_b16 a[140:141], v21 offset:61440
    v_mul_f32 v72, v72, v20
    v_mfma_f32_16x16x32_bf16 v[80:83], a[132:135], a[240:243], v[80:83]
    ds_read_b64_tr_b16 a[142:143], v21 offset:63488
    v_mul_f32 v73, v73, v20
    v_mfma_f32_16x16x32_bf16 v[88:91], a[128:131], a[228:231], v[88:91]
    ds_write_b64 v11, v[64:65] offset:4096
    v_mfma_f32_16x16x32_bf16 v[88:91], a[132:135], a[244:247], v[88:91]
    v_mul_f32 v74, v74, v20
    v_mul_f32 v75, v75, v20
    v_mfma_f32_16x16x32_bf16 v[96:99], a[128:131], a[232:235], v[96:99]
    v_cvt_pk_bf16_f32 v72, v72, v73
    v_cvt_pk_bf16_f32 v73, v74, v75
    v_mfma_f32_16x16x32_bf16 v[96:99], a[132:135], a[248:251], v[96:99]
    ds_write_b64 v11, v[72:73] offset:6144
    v_mfma_f32_16x16x32_bf16 v[104:107], a[128:131], a[236:239], v[104:107]
    ds_read_b64_tr_b16 a[128:129], v45 offset:49152
    v_mul_f32 v52, v52, v17
    v_mfma_f32_16x16x32_bf16 v[104:107], a[132:135], a[252:255], v[104:107]
    s_waitcnt lgkmcnt(3)
    ds_read_b64_tr_b16 a[130:131], v45 offset:51200
    v_mul_f32 v53, v53, v17
    v_mfma_f32_16x16x32_bf16 v[80:83], a[136:139], v[224:227], v[80:83]
    ds_read_b64_tr_b16 a[132:133], v45 offset:53248
    v_mul_f32 v54, v54, v17
    v_mfma_f32_16x16x32_bf16 v[80:83], a[140:143], v[240:243], v[80:83]
    ds_read_b64_tr_b16 a[134:135], v45 offset:55296
    v_mul_f32 v55, v55, v17
    v_mfma_f32_16x16x32_bf16 v[88:91], a[136:139], v[228:231], v[88:91]
    v_cvt_pk_bf16_f32 v52, v52, v53
    v_cvt_pk_bf16_f32 v53, v54, v55
    v_mfma_f32_16x16x32_bf16 v[88:91], a[140:143], v[244:247], v[88:91]
    ds_write_b64 v43, v[52:53] offset:0
    v_mfma_f32_16x16x32_bf16 v[96:99], a[136:139], v[232:235], v[96:99]
    v_mul_f32 v60, v60, v18
    v_mul_f32 v61, v61, v18
    v_mfma_f32_16x16x32_bf16 v[96:99], a[140:143], v[248:251], v[96:99]
    v_mul_f32 v62, v62, v18
    v_mul_f32 v63, v63, v18
    v_mfma_f32_16x16x32_bf16 v[104:107], a[136:139], v[236:239], v[104:107]
    ds_read_b64_tr_b16 a[136:137], v45 offset:57344
    v_cvt_pk_bf16_f32 v60, v60, v61
    v_mfma_f32_16x16x32_bf16 v[104:107], a[140:143], v[252:255], v[104:107]
    s_waitcnt lgkmcnt(2)
    ds_read_b64_tr_b16 a[138:139], v45 offset:59392
    v_cvt_pk_bf16_f32 v61, v62, v63
    v_mfma_f32_16x16x32_bf16 v[84:87], a[128:131], a[224:227], v[84:87]
    ds_read_b64_tr_b16 a[140:141], v45 offset:61440
    v_mul_f32 v68, v68, v19
    v_mfma_f32_16x16x32_bf16 v[84:87], a[132:135], a[240:243], v[84:87]
    ds_read_b64_tr_b16 a[142:143], v45 offset:63488
    v_mul_f32 v69, v69, v19
    v_mfma_f32_16x16x32_bf16 v[92:95], a[128:131], a[228:231], v[92:95]
    ds_write_b64 v43, v[60:61] offset:2048
    v_mfma_f32_16x16x32_bf16 v[92:95], a[132:135], a[244:247], v[92:95]
    v_mul_f32 v70, v70, v19
    v_mul_f32 v71, v71, v19
    v_mfma_f32_16x16x32_bf16 v[100:103], a[128:131], a[232:235], v[100:103]
    v_cvt_pk_bf16_f32 v68, v68, v69
    v_cvt_pk_bf16_f32 v69, v70, v71
    v_mfma_f32_16x16x32_bf16 v[100:103], a[132:135], a[248:251], v[100:103]
    ds_write_b64 v43, v[68:69] offset:4096
    v_mfma_f32_16x16x32_bf16 v[108:111], a[128:131], a[236:239], v[108:111]
    ds_read_b64_tr_b16 a[128:129], v5 offset:0
    v_mul_f32 v76, v76, v20
    v_mfma_f32_16x16x32_bf16 v[108:111], a[132:135], a[252:255], v[108:111]
    s_waitcnt lgkmcnt(3)
    ds_read_b64_tr_b16 a[130:131], v5 offset:2048
    v_mul_f32 v77, v77, v20
    v_mfma_f32_16x16x32_bf16 v[84:87], a[136:139], v[224:227], v[84:87]
    ds_read_b64_tr_b16 a[132:133], v5 offset:4096
    v_mul_f32 v78, v78, v20
    v_mfma_f32_16x16x32_bf16 v[84:87], a[140:143], v[240:243], v[84:87]
    ds_read_b64_tr_b16 a[134:135], v5 offset:6144
    v_mul_f32 v79, v79, v20
    v_mfma_f32_16x16x32_bf16 v[92:95], a[136:139], v[228:231], v[92:95]
    v_cvt_pk_bf16_f32 v76, v76, v77
    v_cvt_pk_bf16_f32 v77, v78, v79
    v_mfma_f32_16x16x32_bf16 v[92:95], a[140:143], v[244:247], v[92:95]
    ds_write_b64 v43, v[76:77] offset:6144
    v_mfma_f32_16x16x32_bf16 v[100:103], a[136:139], v[232:235], v[100:103]
    v_xor_b32 v43, 96, v11
    v_mul_f32 v80, v80, v17
    v_mfma_f32_16x16x32_bf16 v[100:103], a[140:143], v[248:251], v[100:103]
    v_mul_f32 v81, v81, v17
    v_mul_f32 v82, v82, v17
    v_mfma_f32_16x16x32_bf16 v[108:111], a[136:139], v[236:239], v[108:111]
    ds_read_b64_tr_b16 a[136:137], v5 offset:8192
    v_mul_f32 v83, v83, v17
    v_mfma_f32_16x16x32_bf16 v[108:111], a[140:143], v[252:255], v[108:111]
    s_waitcnt lgkmcnt(2)
    ds_read_b64_tr_b16 a[138:139], v5 offset:10240
    v_cvt_pk_bf16_f32 v80, v80, v81
    v_mfma_f32_16x16x32_bf16 v[48:51], a[128:131], v[112:115], 0
    s_waitcnt vmcnt(8)
    ds_read_b64_tr_b16 a[140:141], v5 offset:12288
    v_cvt_pk_bf16_f32 v81, v82, v83
    v_mfma_f32_16x16x32_bf16 v[48:51], a[132:135], v[128:131], v[48:51]
    s_barrier
    ds_read_b64_tr_b16 a[142:143], v5 offset:14336
    v_mul_f32 v88, v88, v18
    v_mfma_f32_16x16x32_bf16 v[56:59], a[128:131], v[116:119], 0
    s_add_u32 m0, s30, 49152
    ds_write_b64 v42, v[80:81] offset:0
    v_mfma_f32_16x16x32_bf16 v[56:59], a[132:135], v[132:135], v[56:59]
    s_xor_b32 s48, s5, 196608
    v_mul_f32 v89, v89, v18
    v_mul_f32 v90, v90, v18
    v_mfma_f32_16x16x32_bf16 v[64:67], a[128:131], v[120:123], 0
    buffer_load_dwordx4 v8, s[16:19], s48 offen offset:0 lds
    v_mfma_f32_16x16x32_bf16 v[64:67], a[132:135], v[136:139], v[64:67]
    v_mul_f32 v91, v91, v18
    v_cvt_pk_bf16_f32 v88, v88, v89
    v_mfma_f32_16x16x32_bf16 v[72:75], a[128:131], v[124:127], 0
    ds_read_b64_tr_b16 a[128:129], v6 offset:0
    v_cvt_pk_bf16_f32 v89, v90, v91
    v_mfma_f32_16x16x32_bf16 v[72:75], a[132:135], v[140:143], v[72:75]
    s_waitcnt lgkmcnt(2)
    ds_read_b64_tr_b16 a[130:131], v6 offset:2048
    v_mul_f32 v96, v96, v19
    v_mfma_f32_16x16x32_bf16 v[48:51], a[136:139], v[144:147], v[48:51]
    ds_read_b64_tr_b16 a[132:133], v6 offset:4096
    v_mul_f32 v97, v97, v19
    v_mfma_f32_16x16x32_bf16 v[48:51], a[140:143], a[144:147], v[48:51]
    ds_read_b64_tr_b16 a[134:135], v6 offset:6144
    v_mul_f32 v98, v98, v19
    v_mfma_f32_16x16x32_bf16 v[56:59], a[136:139], v[148:151], v[56:59]
    ds_write_b64 v42, v[88:89] offset:2048
    v_mfma_f32_16x16x32_bf16 v[56:59], a[140:143], a[148:151], v[56:59]
    buffer_load_dwordx4 v8, s[16:19], s48 offen offset:1024 lds
    v_mfma_f32_16x16x32_bf16 v[64:67], a[136:139], v[152:155], v[64:67]
    v_mul_f32 v99, v99, v19
    v_cvt_pk_bf16_f32 v96, v96, v97
    v_mfma_f32_16x16x32_bf16 v[64:67], a[140:143], a[152:155], v[64:67]
    v_cvt_pk_bf16_f32 v97, v98, v99
    v_mul_f32 v104, v104, v20
    v_mfma_f32_16x16x32_bf16 v[72:75], a[136:139], v[156:159], v[72:75]
    ds_read_b64_tr_b16 a[136:137], v6 offset:8192
    v_mul_f32 v105, v105, v20
    v_mfma_f32_16x16x32_bf16 v[72:75], a[140:143], a[156:159], v[72:75]
    s_waitcnt lgkmcnt(2)
    ds_read_b64_tr_b16 a[138:139], v6 offset:10240
    v_mul_f32 v106, v106, v20
    v_mfma_f32_16x16x32_bf16 v[52:55], a[128:131], v[112:115], 0
    ds_read_b64_tr_b16 a[140:141], v6 offset:12288
    v_mul_f32 v107, v107, v20
    v_mfma_f32_16x16x32_bf16 v[52:55], a[132:135], v[128:131], v[52:55]
    ds_read_b64_tr_b16 a[142:143], v6 offset:14336
    v_cvt_pk_bf16_f32 v104, v104, v105
    v_mfma_f32_16x16x32_bf16 v[60:63], a[128:131], v[116:119], 0
    ds_write_b64 v42, v[96:97] offset:4096
    v_mfma_f32_16x16x32_bf16 v[60:63], a[132:135], v[132:135], v[60:63]
    buffer_load_dwordx4 v8, s[16:19], s48 offen offset:2048 lds
    v_mfma_f32_16x16x32_bf16 v[68:71], a[128:131], v[120:123], 0
    v_cvt_pk_bf16_f32 v105, v106, v107
    v_mul_f32 v84, v84, v17
    v_mfma_f32_16x16x32_bf16 v[68:71], a[132:135], v[136:139], v[68:71]
    ds_write_b64 v42, v[104:105] offset:6144
    v_mfma_f32_16x16x32_bf16 v[76:79], a[128:131], v[124:127], 0
    ds_read_b64_tr_b16 a[128:129], v21 offset:0
    v_mul_f32 v85, v85, v17
    v_mfma_f32_16x16x32_bf16 v[76:79], a[132:135], v[140:143], v[76:79]
    s_waitcnt lgkmcnt(3)
    ds_read_b64_tr_b16 a[130:131], v21 offset:2048
    v_mul_f32 v86, v86, v17
    v_mfma_f32_16x16x32_bf16 v[52:55], a[136:139], v[144:147], v[52:55]
    ds_read_b64_tr_b16 a[132:133], v21 offset:4096
    v_mul_f32 v87, v87, v17
    v_mfma_f32_16x16x32_bf16 v[52:55], a[140:143], a[144:147], v[52:55]
    ds_read_b64_tr_b16 a[134:135], v21 offset:6144
    v_cvt_pk_bf16_f32 v84, v84, v85
    v_mfma_f32_16x16x32_bf16 v[60:63], a[136:139], v[148:151], v[60:63]
    buffer_load_dwordx4 v8, s[16:19], s48 offen offset:3072 lds
    v_mfma_f32_16x16x32_bf16 v[60:63], a[140:143], a[148:151], v[60:63]
    v_cvt_pk_bf16_f32 v85, v86, v87
    v_mul_f32 v92, v92, v18
    v_mfma_f32_16x16x32_bf16 v[68:71], a[136:139], v[152:155], v[68:71]
    ds_write_b64 v43, v[84:85] offset:0
    v_mfma_f32_16x16x32_bf16 v[68:71], a[140:143], a[152:155], v[68:71]
    v_mul_f32 v93, v93, v18
    v_mul_f32 v94, v94, v18
    v_mfma_f32_16x16x32_bf16 v[76:79], a[136:139], v[156:159], v[76:79]
    ds_read_b64_tr_b16 a[136:137], v21 offset:8192
    v_mul_f32 v95, v95, v18
    v_mfma_f32_16x16x32_bf16 v[76:79], a[140:143], a[156:159], v[76:79]
    s_waitcnt lgkmcnt(2)
    ds_read_b64_tr_b16 a[138:139], v21 offset:10240
    v_cvt_pk_bf16_f32 v92, v92, v93
    v_mfma_f32_16x16x32_bf16 v[80:83], a[128:131], v[112:115], 0
    ds_read_b64_tr_b16 a[140:141], v21 offset:12288
    v_cvt_pk_bf16_f32 v93, v94, v95
    v_mfma_f32_16x16x32_bf16 v[80:83], a[132:135], v[128:131], v[80:83]
    ds_read_b64_tr_b16 a[142:143], v21 offset:14336
    v_mul_f32 v100, v100, v19
    v_mfma_f32_16x16x32_bf16 v[88:91], a[128:131], v[116:119], 0
    ds_write_b64 v43, v[92:93] offset:2048
    v_mfma_f32_16x16x32_bf16 v[88:91], a[132:135], v[132:135], v[88:91]
    v_mul_f32 v101, v101, v19
    v_mul_f32 v102, v102, v19
    v_mfma_f32_16x16x32_bf16 v[96:99], a[128:131], v[120:123], 0
    v_mul_f32 v103, v103, v19
    v_cvt_pk_bf16_f32 v100, v100, v101
    v_mfma_f32_16x16x32_bf16 v[96:99], a[132:135], v[136:139], v[96:99]
    v_cvt_pk_bf16_f32 v101, v102, v103
    v_mul_f32 v108, v108, v20
    v_mfma_f32_16x16x32_bf16 v[104:107], a[128:131], v[124:127], 0
L_t4_7:
    s_cbranch_execz L_tback4
    ds_read_b64_tr_b16 a[128:129], v45 offset:0
    v_mul_f32 v109, v109, v20
    v_mfma_f32_16x16x32_bf16 v[104:107], a[132:135], v[140:143], v[104:107]
    s_waitcnt lgkmcnt(2)
    ds_read_b64_tr_b16 a[130:131], v45 offset:2048
    v_mul_f32 v110, v110, v20
    v_mfma_f32_16x16x32_bf16 v[80:83], a[136:139], v[144:147], v[80:83]
    ds_read_b64_tr_b16 a[132:133], v45 offset:4096
    v_mul_f32 v111, v111, v20
    v_mfma_f32_16x16x32_bf16 v[80:83], a[140:143], a[144:147], v[80:83]
    ds_read_b64_tr_b16 a[134:135], v45 offset:6144
    v_cvt_pk_bf16_f32 v108, v108, v109
    v_mfma_f32_16x16x32_bf16 v[88:91], a[136:139], v[148:151], v[88:91]
    ds_write_b64 v43, v[100:101] offset:4096
    v_mfma_f32_16x16x32_bf16 v[88:91], a[140:143], a[148:151], v[88:91]
    v_cvt_pk_bf16_f32 v109, v110, v111
    v_mfma_f32_16x16x32_bf16 v[96:99], a[136:139], v[152:155], v[96:99]
    v_mfma_f32_16x16x32_bf16 v[96:99], a[140:143], a[152:155], v[96:99]
    ds_write_b64 v43, v[108:109] offset:6144
    v_mfma_f32_16x16x32_bf16 v[104:107], a[136:139], v[156:159], v[104:107]
    ds_read_b64_tr_b16 a[136:137], v45 offset:8192
    v_mfma_f32_16x16x32_bf16 v[104:107], a[140:143], a[156:159], v[104:107]
    s_waitcnt lgkmcnt(3)
    ds_read_b64_tr_b16 a[138:139], v45 offset:10240
    v_mfma_f32_16x16x32_bf16 v[84:87], a[128:131], v[112:115], 0
    ds_read_b64_tr_b16 a[140:141], v45 offset:12288
    v_mfma_f32_16x16x32_bf16 v[84:87], a[132:135], v[128:131], v[84:87]
    ds_read_b64_tr_b16 a[142:143], v45 offset:14336
    v_mfma_f32_16x16x32_bf16 v[92:95], a[128:131], v[116:119], 0
    ds_read_b128 v[26:29], v0 offset:0
    v_mfma_f32_16x16x32_bf16 v[92:95], a[132:135], v[132:135], v[92:95]
    ds_read_b64 v[30:31], v0 offset:1032
    v_mfma_f32_16x16x32_bf16 v[100:103], a[128:131], v[120:123], 0
    ds_read_b64 v[32:33], v0 offset:1024
    v_mfma_f32_16x16x32_bf16 v[100:103], a[132:135], v[136:139], v[100:103]
    ds_read_b128 v[34:37], v0 offset:2048
    v_mfma_f32_16x16x32_bf16 v[108:111], a[128:131], v[124:127], 0
    ds_read_b64_tr_b16 a[128:129], v5 offset:16384
    v_mfma_f32_16x16x32_bf16 v[108:111], a[132:135], v[140:143], v[108:111]
    s_waitcnt lgkmcnt(5)
    ds_read_b64_tr_b16 a[130:131], v5 offset:18432
    v_mfma_f32_16x16x32_bf16 v[84:87], a[136:139], v[144:147], v[84:87]
    ds_read_b64_tr_b16 a[132:133], v5 offset:20480
    v_mfma_f32_16x16x32_bf16 v[84:87], a[140:143], a[144:147], v[84:87]
    ds_read_b64_tr_b16 a[134:135], v5 offset:22528
    v_mfma_f32_16x16x32_bf16 v[92:95], a[136:139], v[148:151], v[92:95]
    ds_read_b64 v[38:39], v0 offset:3080
    v_mfma_f32_16x16x32_bf16 v[92:95], a[140:143], a[148:151], v[92:95]
    ds_read_b64 v[40:41], v0 offset:3072
    v_mfma_f32_16x16x32_bf16 v[100:103], a[136:139], v[152:155], v[100:103]
    v_mfma_f32_16x16x32_bf16 v[100:103], a[140:143], a[152:155], v[100:103]
    v_mfma_f32_16x16x32_bf16 v[108:111], a[136:139], v[156:159], v[108:111]
    ds_read_b64_tr_b16 a[136:137], v5 offset:24576
    v_mfma_f32_16x16x32_bf16 v[108:111], a[140:143], a[156:159], v[108:111]
    s_waitcnt lgkmcnt(3)
    ds_read_b64_tr_b16 a[138:139], v5 offset:26624
    v_mfma_f32_16x16x32_bf16 v[48:51], a[128:131], v[160:163], v[48:51]
    s_waitcnt vmcnt(4)
    ds_read_b64_tr_b16 a[140:141], v5 offset:28672
    v_mfma_f32_16x16x32_bf16 v[48:51], a[132:135], a[160:163], v[48:51]
    s_barrier
    ds_read_b64_tr_b16 a[142:143], v5 offset:30720
    v_mfma_f32_16x16x32_bf16 v[56:59], a[128:131], v[164:167], v[56:59]
    buffer_store_dwordx4 v[26:29], v12, s[20:23], s50 offen nt
    v_mfma_f32_16x16x32_bf16 v[56:59], a[132:135], a[164:167], v[56:59]
    s_add_u32 s50, s8, 4096
    ds_read_b128 v[26:29], v0 offset:4096
    v_mfma_f32_16x16x32_bf16 v[64:67], a[128:131], v[168:171], v[64:67]
    s_add_u32 m0, s30, 0
    v_mfma_f32_16x16x32_bf16 v[64:67], a[132:135], a[168:171], v[64:67]
    s_xor_b32 s48, s6, 0
    v_mfma_f32_16x16x32_bf16 v[72:75], a[128:131], v[172:175], v[72:75]
    ds_read_b64_tr_b16 a[128:129], v6 offset:16384
    v_mfma_f32_16x16x32_bf16 v[72:75], a[132:135], a[172:175], v[72:75]
    s_waitcnt lgkmcnt(2)
    ds_read_b64_tr_b16 a[130:131], v6 offset:18432
    v_mfma_f32_16x16x32_bf16 v[48:51], a[136:139], v[176:179], v[48:51]
    ds_read_b64_tr_b16 a[132:133], v6 offset:20480
    v_mfma_f32_16x16x32_bf16 v[48:51], a[140:143], a[176:179], v[48:51]
    ds_read_b64_tr_b16 a[134:135], v6 offset:22528
    v_mfma_f32_16x16x32_bf16 v[56:59], a[136:139], v[180:183], v[56:59]
    buffer_load_dwordx4 v8, s[16:19], s48 offen offset:0 lds
    v_mfma_f32_16x16x32_bf16 v[56:59], a[140:143], a[180:183], v[56:59]
    v_mfma_f32_16x16x32_bf16 v[64:67], a[136:139], v[184:187], v[64:67]
    v_mfma_f32_16x16x32_bf16 v[64:67], a[140:143], a[184:187], v[64:67]
    v_mfma_f32_16x16x32_bf16 v[72:75], a[136:139], v[188:191], v[72:75]
    ds_read_b64_tr_b16 a[136:137], v6 offset:24576
    v_mfma_f32_16x16x32_bf16 v[72:75], a[140:143], a[188:191], v[72:75]
    s_waitcnt lgkmcnt(1)
    ds_read_b64_tr_b16 a[138:139], v6 offset:26624
    v_mfma_f32_16x16x32_bf16 v[52:55], a[128:131], v[160:163], v[52:55]
    ds_read_b64_tr_b16 a[140:141], v6 offset:28672
    v_mfma_f32_16x16x32_bf16 v[52:55], a[132:135], a[160:163], v[52:55]
    ds_read_b64_tr_b16 a[142:143], v6 offset:30720
    v_mfma_f32_16x16x32_bf16 v[60:63], a[128:131], v[164:167], v[60:63]
    buffer_load_dwordx4 v8, s[16:19], s48 offen offset:1024 lds
    v_mfma_f32_16x16x32_bf16 v[60:63], a[132:135], a[164:167], v[60:63]
    v_mfma_f32_16x16x32_bf16 v[68:71], a[128:131], v[168:171], v[68:71]
    v_mfma_f32_16x16x32_bf16 v[68:71], a[132:135], a[168:171], v[68:71]
    v_mfma_f32_16x16x32_bf16 v[76:79], a[128:131], v[172:175], v[76:79]
    ds_read_b64_tr_b16 a[128:129], v21 offset:16384
    v_mfma_f32_16x16x32_bf16 v[76:79], a[132:135], a[172:175], v[76:79]
    s_waitcnt lgkmcnt(1)
    ds_read_b64_tr_b16 a[130:131], v21 offset:18432
    v_mfma_f32_16x16x32_bf16 v[52:55], a[136:139], v[176:179], v[52:55]
    ds_read_b64_tr_b16 a[132:133], v21 offset:20480
    v_mfma_f32_16x16x32_bf16 v[52:55], a[140:143], a[176:179], v[52:55]
    ds_read_b64_tr_b16 a[134:135], v21 offset:22528
    v_mfma_f32_16x16x32_bf16 v[60:63], a[136:139], v[180:183], v[60:63]
    buffer_load_dwordx4 v8, s[16:19], s48 offen offset:2048 lds
    v_mfma_f32_16x16x32_bf16 v[60:63], a[140:143], a[180:183], v[60:63]
    v_mfma_f32_16x16x32_bf16 v[68:71], a[136:139], v[184:187], v[68:71]
    v_mfma_f32_16x16x32_bf16 v[68:71], a[140:143], a[184:187], v[68:71]
    v_mfma_f32_16x16x32_bf16 v[76:79], a[136:139], v[188:191], v[76:79]
    ds_read_b64_tr_b16 a[136:137], v21 offset:24576
    v_mfma_f32_16x16x32_bf16 v[76:79], a[140:143], a[188:191], v[76:79]
    s_waitcnt lgkmcnt(1)
    ds_read_b64_tr_b16 a[138:139], v21 offset:26624
    v_mfma_f32_16x16x32_bf16 v[80:83], a[128:131], v[160:163], v[80:83]
    ds_read_b64_tr_b16 a[140:141], v21 offset:28672
    v_mfma_f32_16x16x32_bf16 v[80:83], a[132:135], a[160:163], v[80:83]
    ds_read_b64_tr_b16 a[142:143], v21 offset:30720
    v_mfma_f32_16x16x32_bf16 v[88:91], a[128:131], v[164:167], v[88:91]
    buffer_store_dwordx4 v[30:33], v12, s[20:23], s50 offen nt
    v_mfma_f32_16x16x32_bf16 v[88:91], a[132:135], a[164:167], v[88:91]
    s_add_u32 s50, s8, 32768
    ds_read_b64 v[30:31], v0 offset:5128
    v_mfma_f32_16x16x32_bf16 v[96:99], a[128:131], v[168:171], v[96:99]
    ds_read_b64 v[32:33], v0 offset:5120
    v_mfma_f32_16x16x32_bf16 v[96:99], a[132:135], a[168:171], v[96:99]
    v_mfma_f32_16x16x32_bf16 v[104:107], a[128:131], v[172:175], v[104:107]
    ds_read_b64_tr_b16 a[128:129], v45 offset:16384
    v_mfma_f32_16x16x32_bf16 v[104:107], a[132:135], a[172:175], v[104:107]
    s_waitcnt lgkmcnt(3)
    ds_read_b64_tr_b16 a[130:131], v45 offset:18432
    v_mfma_f32_16x16x32_bf16 v[80:83], a[136:139], v[176:179], v[80:83]
    ds_read_b64_tr_b16 a[132:133], v45 offset:20480
    v_mfma_f32_16x16x32_bf16 v[80:83], a[140:143], a[176:179], v[80:83]
    ds_read_b64_tr_b16 a[134:135], v45 offset:22528
    v_mfma_f32_16x16x32_bf16 v[88:91], a[136:139], v[180:183], v[88:91]
    buffer_load_dwordx4 v8, s[16:19], s48 offen offset:3072 lds
    v_mfma_f32_16x16x32_bf16 v[88:91], a[140:143], a[180:183], v[88:91]
    v_mfma_f32_16x16x32_bf16 v[96:99], a[136:139], v[184:187], v[96:99]
    v_mfma_f32_16x16x32_bf16 v[96:99], a[140:143], a[184:187], v[96:99]
    v_mfma_f32_16x16x32_bf16 v[104:107], a[136:139], v[188:191], v[104:107]
    ds_read_b64_tr_b16 a[136:137], v45 offset:24576
    v_mfma_f32_16x16x32_bf16 v[104:107], a[140:143], a[188:191], v[104:107]
    s_waitcnt lgkmcnt(1)
    ds_read_b64_tr_b16 a[138:139], v45 offset:26624
    v_mfma_f32_16x16x32_bf16 v[84:87], a[128:131], v[160:163], v[84:87]
    ds_read_b64_tr_b16 a[140:141], v45 offset:28672
    v_mfma_f32_16x16x32_bf16 v[84:87], a[132:135], a[160:163], v[84:87]
    ds_read_b64_tr_b16 a[142:143], v45 offset:30720
    v_mfma_f32_16x16x32_bf16 v[92:95], a[128:131], v[164:167], v[92:95]
    v_mfma_f32_16x16x32_bf16 v[92:95], a[132:135], a[164:167], v[92:95]
    v_mfma_f32_16x16x32_bf16 v[100:103], a[128:131], v[168:171], v[100:103]
    v_mfma_f32_16x16x32_bf16 v[100:103], a[132:135], a[168:171], v[100:103]
    v_mfma_f32_16x16x32_bf16 v[108:111], a[128:131], v[172:175], v[108:111]
    ds_read_b64_tr_b16 a[128:129], v5 offset:32768
    v_mfma_f32_16x16x32_bf16 v[108:111], a[132:135], a[172:175], v[108:111]
    s_waitcnt lgkmcnt(1)
    ds_read_b64_tr_b16 a[130:131], v5 offset:34816
    v_mfma_f32_16x16x32_bf16 v[84:87], a[136:139], v[176:179], v[84:87]
    ds_read_b64_tr_b16 a[132:133], v5 offset:36864
    v_mfma_f32_16x16x32_bf16 v[84:87], a[140:143], a[176:179], v[84:87]
    ds_read_b64_tr_b16 a[134:135], v5 offset:38912
    v_mfma_f32_16x16x32_bf16 v[92:95], a[136:139], v[180:183], v[92:95]
    v_mfma_f32_16x16x32_bf16 v[92:95], a[140:143], a[180:183], v[92:95]
    v_mfma_f32_16x16x32_bf16 v[100:103], a[136:139], v[184:187], v[100:103]
    v_mfma_f32_16x16x32_bf16 v[100:103], a[140:143], a[184:187], v[100:103]
    v_mfma_f32_16x16x32_bf16 v[108:111], a[136:139], v[188:191], v[108:111]
    ds_read_b64_tr_b16 a[136:137], v5 offset:40960
    v_mfma_f32_16x16x32_bf16 v[108:111], a[140:143], a[188:191], v[108:111]
    s_waitcnt lgkmcnt(1)
    ds_read_b64_tr_b16 a[138:139], v5 offset:43008
    v_mfma_f32_16x16x32_bf16 v[48:51], a[128:131], v[192:195], v[48:51]
    s_waitcnt vmcnt(6)
    ds_read_b64_tr_b16 a[140:141], v5 offset:45056
    v_mfma_f32_16x16x32_bf16 v[48:51], a[132:135], a[192:195], v[48:51]
    s_barrier
    ds_read_b64_tr_b16 a[142:143], v5 offset:47104
    v_mfma_f32_16x16x32_bf16 v[56:59], a[128:131], v[196:199], v[56:59]
    buffer_store_dwordx4 v[34:37], v12, s[20:23], s50 offen nt
    v_mfma_f32_16x16x32_bf16 v[56:59], a[132:135], a[196:199], v[56:59]
    s_add_u32 s50, s8, 36864
    ds_read_b128 v[34:37], v0 offset:6144
    v_mfma_f32_16x16x32_bf16 v[64:67], a[128:131], v[200:203], v[64:67]
    s_add_u32 m0, s30, 16384
    v_mfma_f32_16x16x32_bf16 v[64:67], a[132:135], a[200:203], v[64:67]
    s_xor_b32 s48, s6, 65536
    v_mfma_f32_16x16x32_bf16 v[72:75], a[128:131], v[204:207], v[72:75]
    ds_read_b64_tr_b16 a[128:129], v6 offset:32768
    v_mfma_f32_16x16x32_bf16 v[72:75], a[132:135], a[204:207], v[72:75]
    s_waitcnt lgkmcnt(2)
    ds_read_b64_tr_b16 a[130:131], v6 offset:34816
    v_mfma_f32_16x16x32_bf16 v[48:51], a[136:139], v[208:211], v[48:51]
    ds_read_b64_tr_b16 a[132:133], v6 offset:36864
    v_mfma_f32_16x16x32_bf16 v[48:51], a[140:143], a[208:211], v[48:51]
    ds_read_b64_tr_b16 a[134:135], v6 offset:38912
    v_mfma_f32_16x16x32_bf16 v[56:59], a[136:139], v[212:215], v[56:59]
    buffer_load_dwordx4 v8, s[16:19], s48 offen offset:0 lds
    v_mfma_f32_16x16x32_bf16 v[56:59], a[140:143], a[212:215], v[56:59]
    v_mfma_f32_16x16x32_bf16 v[64:67], a[136:139], v[216:219], v[64:67]
    v_mfma_f32_16x16x32_bf16 v[64:67], a[140:143], a[216:219], v[64:67]
    v_mfma_f32_16x16x32_bf16 v[72:75], a[136:139], v[220:223], v[72:75]
    ds_read_b64_tr_b16 a[136:137], v6 offset:40960
    v_mfma_f32_16x16x32_bf16 v[72:75], a[140:143], a[220:223], v[72:75]
    s_waitcnt lgkmcnt(1)
    ds_read_b64_tr_b16 a[138:139], v6 offset:43008
    v_mfma_f32_16x16x32_bf16 v[52:55], a[128:131], v[192:195], v[52:55]
    ds_read_b64_tr_b16 a[140:141], v6 offset:45056
    v_mfma_f32_16x16x32_bf16 v[52:55], a[132:135], a[192:195], v[52:55]
    ds_read_b64_tr_b16 a[142:143], v6 offset:47104
    v_mfma_f32_16x16x32_bf16 v[60:63], a[128:131], v[196:199], v[60:63]
    buffer_load_dwordx4 v8, s[16:19], s48 offen offset:1024 lds
    v_mfma_f32_16x16x32_bf16 v[60:63], a[132:135], a[196:199], v[60:63]
    v_mfma_f32_16x16x32_bf16 v[68:71], a[128:131], v[200:203], v[68:71]
    v_mfma_f32_16x16x32_bf16 v[68:71], a[132:135], a[200:203], v[68:71]
    v_mfma_f32_16x16x32_bf16 v[76:79], a[128:131], v[204:207], v[76:79]
    ds_read_b64_tr_b16 a[128:129], v21 offset:32768
    v_mfma_f32_16x16x32_bf16 v[76:79], a[132:135], a[204:207], v[76:79]
    s_waitcnt lgkmcnt(1)
    ds_read_b64_tr_b16 a[130:131], v21 offset:34816
    v_mfma_f32_16x16x32_bf16 v[52:55], a[136:139], v[208:211], v[52:55]
    ds_read_b64_tr_b16 a[132:133], v21 offset:36864
    v_mfma_f32_16x16x32_bf16 v[52:55], a[140:143], a[208:211], v[52:55]
    ds_read_b64_tr_b16 a[134:135], v21 offset:38912
    v_mfma_f32_16x16x32_bf16 v[60:63], a[136:139], v[212:215], v[60:63]
    buffer_load_dwordx4 v8, s[16:19], s48 offen offset:2048 lds
    v_mfma_f32_16x16x32_bf16 v[60:63], a[140:143], a[212:215], v[60:63]
    v_mfma_f32_16x16x32_bf16 v[68:71], a[136:139], v[216:219], v[68:71]
    v_mfma_f32_16x16x32_bf16 v[68:71], a[140:143], a[216:219], v[68:71]
    v_mfma_f32_16x16x32_bf16 v[76:79], a[136:139], v[220:223], v[76:79]
    ds_read_b64_tr_b16 a[136:137], v21 offset:40960
    v_mfma_f32_16x16x32_bf16 v[76:79], a[140:143], a[220:223], v[76:79]
    s_waitcnt lgkmcnt(1)
    ds_read_b64_tr_b16 a[138:139], v21 offset:43008
    v_mfma_f32_16x16x32_bf16 v[80:83], a[128:131], v[192:195], v[80:83]
    ds_read_b64_tr_b16 a[140:141], v21 offset:45056
    v_mfma_f32_16x16x32_bf16 v[80:83], a[132:135], a[192:195], v[80:83]
    ds_read_b64_tr_b16 a[142:143], v21 offset:47104
    v_mfma_f32_16x16x32_bf16 v[88:91], a[128:131], v[196:199], v[88:91]
    buffer_store_dwordx4 v[38:41], v12, s[20:23], s50 offen nt
    v_mfma_f32_16x16x32_bf16 v[88:91], a[132:135], a[196:199], v[88:91]
    s_add_u32 s50, s8, 65536
    ds_read_b64 v[38:39], v0 offset:7176
    v_mfma_f32_16x16x32_bf16 v[96:99], a[128:131], v[200:203], v[96:99]
    ds_read_b64 v[40:41], v0 offset:7168
    v_mfma_f32_16x16x32_bf16 v[96:99], a[132:135], a[200:203], v[96:99]
    v_mfma_f32_16x16x32_bf16 v[104:107], a[128:131], v[204:207], v[104:107]
    ds_read_b64_tr_b16 a[128:129], v45 offset:32768
    v_mfma_f32_16x16x32_bf16 v[104:107], a[132:135], a[204:207], v[104:107]
    s_waitcnt lgkmcnt(3)
    ds_read_b64_tr_b16 a[130:131], v45 offset:34816
    v_mfma_f32_16x16x32_bf16 v[80:83], a[136:139], v[208:211], v[80:83]
    ds_read_b64_tr_b16 a[132:133], v45 offset:36864
    v_mfma_f32_16x16x32_bf16 v[80:83], a[140:143], a[208:211], v[80:83]
    ds_read_b64_tr_b16 a[134:135], v45 offset:38912
    v_mfma_f32_16x16x32_bf16 v[88:91], a[136:139], v[212:215], v[88:91]
    buffer_load_dwordx4 v8, s[16:19], s48 offen offset:3072 lds
    v_mfma_f32_16x16x32_bf16 v[88:91], a[140:143], a[212:215], v[88:91]
    v_mfma_f32_16x16x32_bf16 v[96:99], a[136:139], v[216:219], v[96:99]
    v_mfma_f32_16x16x32_bf16 v[96:99], a[140:143], a[216:219], v[96:99]
    v_mfma_f32_16x16x32_bf16 v[104:107], a[136:139], v[220:223], v[104:107]
    ds_read_b64_tr_b16 a[136:137], v45 offset:40960
    v_mfma_f32_16x16x32_bf16 v[104:107], a[140:143], a[220:223], v[104:107]
    s_waitcnt lgkmcnt(1)
    ds_read_b64_tr_b16 a[138:139], v45 offset:43008
    v_mfma_f32_16x16x32_bf16 v[84:87], a[128:131], v[192:195], v[84:87]
    ds_read_b64_tr_b16 a[140:141], v45 offset:45056
    v_mfma_f32_16x16x32_bf16 v[84:87], a[132:135], a[192:195], v[84:87]
    ds_read_b64_tr_b16 a[142:143], v45 offset:47104
    v_mfma_f32_16x16x32_bf16 v[92:95], a[128:131], v[196:199], v[92:95]
    v_mfma_f32_16x16x32_bf16 v[92:95], a[132:135], a[196:199], v[92:95]
    v_mfma_f32_16x16x32_bf16 v[100:103], a[128:131], v[200:203], v[100:103]
    v_mfma_f32_16x16x32_bf16 v[100:103], a[132:135], a[200:203], v[100:103]
    v_mfma_f32_16x16x32_bf16 v[108:111], a[128:131], v[204:207], v[108:111]
    ds_read_b64_tr_b16 a[128:129], v5 offset:49152
    v_mfma_f32_16x16x32_bf16 v[108:111], a[132:135], a[204:207], v[108:111]
    s_waitcnt lgkmcnt(1)
    ds_read_b64_tr_b16 a[130:131], v5 offset:51200
    v_mfma_f32_16x16x32_bf16 v[84:87], a[136:139], v[208:211], v[84:87]
    ds_read_b64_tr_b16 a[132:133], v5 offset:53248
    v_mfma_f32_16x16x32_bf16 v[84:87], a[140:143], a[208:211], v[84:87]
    ds_read_b64_tr_b16 a[134:135], v5 offset:55296
    v_mfma_f32_16x16x32_bf16 v[92:95], a[136:139], v[212:215], v[92:95]
    v_mfma_f32_16x16x32_bf16 v[92:95], a[140:143], a[212:215], v[92:95]
    v_mfma_f32_16x16x32_bf16 v[100:103], a[136:139], v[216:219], v[100:103]
    v_mfma_f32_16x16x32_bf16 v[100:103], a[140:143], a[216:219], v[100:103]
    v_mfma_f32_16x16x32_bf16 v[108:111], a[136:139], v[220:223], v[108:111]
    ds_read_b64_tr_b16 a[136:137], v5 offset:57344
    v_mfma_f32_16x16x32_bf16 v[108:111], a[140:143], a[220:223], v[108:111]
    s_waitcnt lgkmcnt(1)
    ds_read_b64_tr_b16 a[138:139], v5 offset:59392
    v_mfma_f32_16x16x32_bf16 v[48:51], a[128:131], a[224:227], v[48:51]
    s_waitcnt vmcnt(6)
    ds_read_b64_tr_b16 a[140:141], v5 offset:61440
    v_xor_b32 v43, 32, v11
    v_mfma_f32_16x16x32_bf16 v[48:51], a[132:135], a[240:243], v[48:51]
    s_barrier
    ds_read_b64_tr_b16 a[142:143], v5 offset:63488
    v_xor_b32 v42, 64, v11
    v_mfma_f32_16x16x32_bf16 v[56:59], a[128:131], a[228:231], v[56:59]
    buffer_store_dwordx4 v[26:29], v12, s[20:23], s50 offen nt
    v_mfma_f32_16x16x32_bf16 v[56:59], a[132:135], a[244:247], v[56:59]
    s_add_u32 s50, s8, 69632
    v_mfma_f32_16x16x32_bf16 v[64:67], a[128:131], a[232:235], v[64:67]
    s_add_u32 m0, s30, 32768
    v_mfma_f32_16x16x32_bf16 v[64:67], a[132:135], a[248:251], v[64:67]
    s_xor_b32 s48, s6, 131072
    v_mfma_f32_16x16x32_bf16 v[72:75], a[128:131], a[236:239], v[72:75]
    ds_read_b64_tr_b16 a[128:129], v6 offset:49152
    v_mfma_f32_16x16x32_bf16 v[72:75], a[132:135], a[252:255], v[72:75]
    s_waitcnt lgkmcnt(1)
    ds_read_b64_tr_b16 a[130:131], v6 offset:51200
    v_mfma_f32_16x16x32_bf16 v[48:51], a[136:139], v[224:227], v[48:51]
    ds_read_b64_tr_b16 a[132:133], v6 offset:53248
    v_mfma_f32_16x16x32_bf16 v[48:51], a[140:143], v[240:243], v[48:51]
    ds_read_b64_tr_b16 a[134:135], v6 offset:55296
    v_mfma_f32_16x16x32_bf16 v[56:59], a[136:139], v[228:231], v[56:59]
    buffer_load_dwordx4 v8, s[16:19], s48 offen offset:0 lds
    v_mfma_f32_16x16x32_bf16 v[56:59], a[140:143], v[244:247], v[56:59]
    v_mfma_f32_16x16x32_bf16 v[64:67], a[136:139], v[232:235], v[64:67]
    v_mfma_f32_16x16x32_bf16 v[64:67], a[140:143], v[248:251], v[64:67]
    v_mfma_f32_16x16x32_bf16 v[72:75], a[136:139], v[236:239], v[72:75]
    ds_read_b64_tr_b16 a[136:137], v6 offset:57344
    v_mul_f32 v48, v48, v17
    v_mfma_f32_16x16x32_bf16 v[72:75], a[140:143], v[252:255], v[72:75]
    s_waitcnt lgkmcnt(1)
    ds_read_b64_tr_b16 a[138:139], v6 offset:59392
    v_mul_f32 v49, v49, v17
    v_mfma_f32_16x16x32_bf16 v[52:55], a[128:131], a[224:227], v[52:55]
    ds_read_b64_tr_b16 a[140:141], v6 offset:61440
    v_mul_f32 v50, v50, v17
    v_mfma_f32_16x16x32_bf16 v[52:55], a[132:135], a[240:243], v[52:55]
    ds_read_b64_tr_b16 a[142:143], v6 offset:63488
    v_mul_f32 v51, v51, v17
    v_mfma_f32_16x16x32_bf16 v[60:63], a[128:131], a[228:231], v[60:63]
    buffer_load_dwordx4 v8, s[16:19], s48 offen offset:1024 lds
    v_mfma_f32_16x16x32_bf16 v[60:63], a[132:135], a[244:247], v[60:63]
    v_cvt_pk_bf16_f32 v48, v48, v49
    v_cvt_pk_bf16_f32 v49, v50, v51
    v_mfma_f32_16x16x32_bf16 v[68:71], a[128:131], a[232:235], v[68:71]
    ds_write_b64 v11, v[48:49] offset:8192
    v_mfma_f32_16x16x32_bf16 v[68:71], a[132:135], a[248:251], v[68:71]
    v_mul_f32 v56, v56, v18
    v_mul_f32 v57, v57, v18
    v_mfma_f32_16x16x32_bf16 v[76:79], a[128:131], a[236:239], v[76:79]
    ds_read_b64_tr_b16 a[128:129], v21 offset:49152
    v_mul_f32 v58, v58, v18
    v_mfma_f32_16x16x32_bf16 v[76:79], a[132:135], a[252:255], v[76:79]
    s_waitcnt lgkmcnt(2)
    ds_read_b64_tr_b16 a[130:131], v21 offset:51200
    v_mul_f32 v59, v59, v18
    v_mfma_f32_16x16x32_bf16 v[52:55], a[136:139], v[224:227], v[52:55]
    ds_read_b64_tr_b16 a[132:133], v21 offset:53248
    v_cvt_pk_bf16_f32 v56, v56, v57
    v_mfma_f32_16x16x32_bf16 v[52:55], a[140:143], v[240:243], v[52:55]
    ds_read_b64_tr_b16 a[134:135], v21 offset:55296
    v_cvt_pk_bf16_f32 v57, v58, v59
    v_mfma_f32_16x16x32_bf16 v[60:63], a[136:139], v[228:231], v[60:63]
    buffer_load_dwordx4 v8, s[16:19], s48 offen offset:2048 lds
    v_mfma_f32_16x16x32_bf16 v[60:63], a[140:143], v[244:247], v[60:63]
    ds_write_b64 v11, v[56:57] offset:10240
    v_mfma_f32_16x16x32_bf16 v[68:71], a[136:139], v[232:235], v[68:71]
    v_mul_f32 v64, v64, v19
    v_mul_f32 v65, v65, v19
    v_mfma_f32_16x16x32_bf16 v[68:71], a[140:143], v[248:251], v[68:71]
    v_mul_f32 v66, v66, v19
    v_mul_f32 v67, v67, v19
    v_mfma_f32_16x16x32_bf16 v[76:79], a[136:139], v[236:239], v[76:79]
    ds_read_b64_tr_b16 a[136:137], v21 offset:57344
    v_cvt_pk_bf16_f32 v64, v64, v65
    v_mfma_f32_16x16x32_bf16 v[76:79], a[140:143], v[252:255], v[76:79]
    s_waitcnt lgkmcnt(2)
    ds_read_b64_tr_b16 a[138:139], v21 offset:59392
    v_cvt_pk_bf16_f32 v65, v66, v67
    v_mfma_f32_16x16x32_bf16 v[80:83], a[128:131], a[224:227], v[80:83]
    ds_read_b64_tr_b16 a[140:141], v21 offset:61440
    v_mul_f32 v72, v72, v20
    v_mfma_f32_16x16x32_bf16 v[80:83], a[132:135], a[240:243], v[80:83]
    ds_read_b64_tr_b16 a[142:143], v21 offset:63488
    v_mul_f32 v73, v73, v20
    v_mfma_f32_16x16x32_bf16 v[88:91], a[128:131], a[228:231], v[88:91]
    buffer_store_dwordx4 v[30:33], v12, s[20:23], s50 offen nt
    v_mfma_f32_16x16x32_bf16 v[88:91], a[132:135], a[244:247], v[88:91]
    s_add_u32 s50, s8, 98304
    v_mul_f32 v74, v74, v20
    v_mul_f32 v75, v75, v20
    v_mfma_f32_16x16x32_bf16 v[96:99], a[128:131], a[232:235], v[96:99]
    v_cvt_pk_bf16_f32 v72, v72, v73
    v_cvt_pk_bf16_f32 v73, v74, v75
    v_mfma_f32_16x16x32_bf16 v[96:99], a[132:135], a[248:251], v[96:99]
    ds_write_b64 v11, v[64:65] offset:12288
    v_mfma_f32_16x16x32_bf16 v[104:107], a[128:131], a[236:239], v[104:107]
    ds_read_b64_tr_b16 a[128:129], v45 offset:49152
    v_mul_f32 v52, v52, v17
    v_mfma_f32_16x16x32_bf16 v[104:107], a[132:135], a[252:255], v[104:107]
    s_waitcnt lgkmcnt(2)
    ds_read_b64_tr_b16 a[130:131], v45 offset:51200
    v_mul_f32 v53, v53, v17
    v_mfma_f32_16x16x32_bf16 v[80:83], a[136:139], v[224:227], v[80:83]
    ds_read_b64_tr_b16 a[132:133], v45 offset:53248
    v_mul_f32 v54, v54, v17
    v_mfma_f32_16x16x32_bf16 v[80:83], a[140:143], v[240:243], v[80:83]
    ds_read_b64_tr_b16 a[134:135], v45 offset:55296
    v_mul_f32 v55, v55, v17
    v_mfma_f32_16x16x32_bf16 v[88:91], a[136:139], v[228:231], v[88:91]
    buffer_load_dwordx4 v8, s[16:19], s48 offen offset:3072 lds
    v_mfma_f32_16x16x32_bf16 v[88:91], a[140:143], v[244:247], v[88:91]
    ds_write_b64 v11, v[72:73] offset:14336
    v_mfma_f32_16x16x32_bf16 v[96:99], a[136:139], v[232:235], v[96:99]
    v_cvt_pk_bf16_f32 v52, v52, v53
    v_cvt_pk_bf16_f32 v53, v54, v55
    v_mfma_f32_16x16x32_bf16 v[96:99], a[140:143], v[248:251], v[96:99]
    v_mul_f32 v60, v60, v18
    v_mul_f32 v61, v61, v18
    v_mfma_f32_16x16x32_bf16 v[104:107], a[136:139], v[236:239], v[104:107]
    ds_read_b64_tr_b16 a[136:137], v45 offset:57344
    v_mul_f32 v62, v62, v18
    v_mfma_f32_16x16x32_bf16 v[104:107], a[140:143], v[252:255], v[104:107]
    s_waitcnt lgkmcnt(2)
    ds_read_b64_tr_b16 a[138:139], v45 offset:59392
    v_mul_f32 v63, v63, v18
    v_mfma_f32_16x16x32_bf16 v[84:87], a[128:131], a[224:227], v[84:87]
    ds_read_b64_tr_b16 a[140:141], v45 offset:61440
    v_cvt_pk_bf16_f32 v60, v60, v61
    v_mfma_f32_16x16x32_bf16 v[84:87], a[132:135], a[240:243], v[84:87]
    ds_read_b64_tr_b16 a[142:143], v45 offset:63488
    v_cvt_pk_bf16_f32 v61, v62, v63
    v_mfma_f32_16x16x32_bf16 v[92:95], a[128:131], a[228:231], v[92:95]
    ds_write_b64 v43, v[52:53] offset:8192
    v_mfma_f32_16x16x32_bf16 v[92:95], a[132:135], a[244:247], v[92:95]
    v_mul_f32 v68, v68, v19
    v_mul_f32 v69, v69, v19
    v_mfma_f32_16x16x32_bf16 v[100:103], a[128:131], a[232:235], v[100:103]
    v_mul_f32 v70, v70, v19
    v_mul_f32 v71, v71, v19
    v_mfma_f32_16x16x32_bf16 v[100:103], a[132:135], a[248:251], v[100:103]
    ds_write_b64 v43, v[60:61] offset:10240
    v_mfma_f32_16x16x32_bf16 v[108:111], a[128:131], a[236:239], v[108:111]
    ds_read_b64_tr_b16 a[128:129], v5 offset:0
    v_cvt_pk_bf16_f32 v68, v68, v69
    v_mfma_f32_16x16x32_bf16 v[108:111], a[132:135], a[252:255], v[108:111]
    s_waitcnt lgkmcnt(3)
    ds_read_b64_tr_b16 a[130:131], v5 offset:2048
    v_cvt_pk_bf16_f32 v69, v70, v71
    v_mfma_f32_16x16x32_bf16 v[84:87], a[136:139], v[224:227], v[84:87]
    ds_read_b64_tr_b16 a[132:133], v5 offset:4096
    v_mul_f32 v76, v76, v20
    v_mfma_f32_16x16x32_bf16 v[84:87], a[140:143], v[240:243], v[84:87]
    ds_read_b64_tr_b16 a[134:135], v5 offset:6144
    v_mul_f32 v77, v77, v20
    v_mfma_f32_16x16x32_bf16 v[92:95], a[136:139], v[228:231], v[92:95]
    ds_write_b64 v43, v[68:69] offset:12288
    v_mfma_f32_16x16x32_bf16 v[92:95], a[140:143], v[244:247], v[92:95]
    v_mul_f32 v78, v78, v20
    v_mul_f32 v79, v79, v20
    v_mfma_f32_16x16x32_bf16 v[100:103], a[136:139], v[232:235], v[100:103]
    v_cvt_pk_bf16_f32 v76, v76, v77
    v_cvt_pk_bf16_f32 v77, v78, v79
    v_mfma_f32_16x16x32_bf16 v[100:103], a[140:143], v[248:251], v[100:103]
    ds_write_b64 v43, v[76:77] offset:14336
    v_mfma_f32_16x16x32_bf16 v[108:111], a[136:139], v[236:239], v[108:111]
    ds_read_b64_tr_b16 a[136:137], v5 offset:8192
    v_xor_b32 v43, 96, v11
    v_mfma_f32_16x16x32_bf16 v[108:111], a[140:143], v[252:255], v[108:111]
    s_waitcnt lgkmcnt(3)
    ds_read_b64_tr_b16 a[138:139], v5 offset:10240
    v_mul_f32 v80, v80, v17
    v_mfma_f32_16x16x32_bf16 v[48:51], a[128:131], v[112:115], 0
    s_waitcnt vmcnt(6)
    ds_read_b64_tr_b16 a[140:141], v5 offset:12288
    v_mul_f32 v81, v81, v17
    v_mfma_f32_16x16x32_bf16 v[48:51], a[132:135], v[128:131], v[48:51]
    s_barrier
    ds_read_b64_tr_b16 a[142:143], v5 offset:14336
    v_mul_f32 v82, v82, v17
    v_mfma_f32_16x16x32_bf16 v[56:59], a[128:131], v[116:119], 0
    buffer_store_dwordx4 v[34:37], v12, s[20:23], s50 offen nt
    v_mfma_f32_16x16x32_bf16 v[56:59], a[132:135], v[132:135], v[56:59]
    s_add_u32 s50, s8, 102400
    v_mul_f32 v83, v83, v17
    v_cvt_pk_bf16_f32 v80, v80, v81
    v_mfma_f32_16x16x32_bf16 v[64:67], a[128:131], v[120:123], 0
    s_add_u32 m0, s30, 49152
    v_cvt_pk_bf16_f32 v81, v82, v83
    v_mul_f32 v88, v88, v18
    v_mfma_f32_16x16x32_bf16 v[64:67], a[132:135], v[136:139], v[64:67]
    s_xor_b32 s48, s6, 196608
    ds_write_b64 v42, v[80:81] offset:8192
    v_mfma_f32_16x16x32_bf16 v[72:75], a[128:131], v[124:127], 0
    ds_read_b64_tr_b16 a[128:129], v6 offset:0
    v_mul_f32 v89, v89, v18
    v_mfma_f32_16x16x32_bf16 v[72:75], a[132:135], v[140:143], v[72:75]
    s_waitcnt lgkmcnt(2)
    ds_read_b64_tr_b16 a[130:131], v6 offset:2048
    v_mul_f32 v90, v90, v18
    v_mfma_f32_16x16x32_bf16 v[48:51], a[136:139], v[144:147], v[48:51]
    ds_read_b64_tr_b16 a[132:133], v6 offset:4096
    v_mul_f32 v91, v91, v18
    v_mfma_f32_16x16x32_bf16 v[48:51], a[140:143], a[144:147], v[48:51]
    ds_read_b64_tr_b16 a[134:135], v6 offset:6144
    v_cvt_pk_bf16_f32 v88, v88, v89
    v_mfma_f32_16x16x32_bf16 v[56:59], a[136:139], v[148:151], v[56:59]
    buffer_load_dwordx4 v8, s[16:19], s48 offen offset:0 lds
    v_mfma_f32_16x16x32_bf16 v[56:59], a[140:143], a[148:151], v[56:59]
    v_cvt_pk_bf16_f32 v89, v90, v91
    v_mul_f32 v96, v96, v19
    v_mfma_f32_16x16x32_bf16 v[64:67], a[136:139], v[152:155], v[64:67]
    ds_write_b64 v42, v[88:89] offset:10240
    v_mfma_f32_16x16x32_bf16 v[64:67], a[140:143], a[152:155], v[64:67]
    v_mul_f32 v97, v97, v19
    v_mul_f32 v98, v98, v19
    v_mfma_f32_16x16x32_bf16 v[72:75], a[136:139], v[156:159], v[72:75]
    ds_read_b64_tr_b16 a[136:137], v6 offset:8192
    v_mul_f32 v99, v99, v19
    v_mfma_f32_16x16x32_bf16 v[72:75], a[140:143], a[156:159], v[72:75]
    s_waitcnt lgkmcnt(2)
    ds_read_b64_tr_b16 a[138:139], v6 offset:10240
    v_cvt_pk_bf16_f32 v96, v96, v97
    v_mfma_f32_16x16x32_bf16 v[52:55], a[128:131], v[112:115], 0
    ds_read_b64_tr_b16 a[140:141], v6 offset:12288
    v_cvt_pk_bf16_f32 v97, v98, v99
    v_mfma_f32_16x16x32_bf16 v[52:55], a[132:135], v[128:131], v[52:55]
    ds_read_b64_tr_b16 a[142:143], v6 offset:14336
    v_mul_f32 v104, v104, v20
    v_mfma_f32_16x16x32_bf16 v[60:63], a[128:131], v[116:119], 0
    ds_write_b64 v42, v[96:97] offset:12288
    v_mfma_f32_16x16x32_bf16 v[60:63], a[132:135], v[132:135], v[60:63]
    buffer_load_dwordx4 v8, s[16:19], s48 offen offset:1024 lds
    v_mfma_f32_16x16x32_bf16 v[68:71], a[128:131], v[120:123], 0
    v_mul_f32 v105, v105, v20
    v_mul_f32 v106, v106, v20
    v_mfma_f32_16x16x32_bf16 v[68:71], a[132:135], v[136:139], v[68:71]
    v_mul_f32 v107, v107, v20
    v_cvt_pk_bf16_f32 v104, v104, v105
    v_mfma_f32_16x16x32_bf16 v[76:79], a[128:131], v[124:127], 0
    ds_read_b64_tr_b16 a[128:129], v21 offset:0
    v_cvt_pk_bf16_f32 v105, v106, v107
    v_mfma_f32_16x16x32_bf16 v[76:79], a[132:135], v[140:143], v[76:79]
    s_waitcnt lgkmcnt(2)
    ds_read_b64_tr_b16 a[130:131], v21 offset:2048
    v_mul_f32 v84, v84, v17
    v_mfma_f32_16x16x32_bf16 v[52:55], a[136:139], v[144:147], v[52:55]
    ds_read_b64_tr_b16 a[132:133], v21 offset:4096
    v_mul_f32 v85, v85, v17
    v_mfma_f32_16x16x32_bf16 v[52:55], a[140:143], a[144:147], v[52:55]
    ds_read_b64_tr_b16 a[134:135], v21 offset:6144
    v_mul_f32 v86, v86, v17
    v_mfma_f32_16x16x32_bf16 v[60:63], a[136:139], v[148:151], v[60:63]
    ds_write_b64 v42, v[104:105] offset:14336
    v_mfma_f32_16x16x32_bf16 v[60:63], a[140:143], a[148:151], v[60:63]
    buffer_load_dwordx4 v8, s[16:19], s48 offen offset:2048 lds
    v_mfma_f32_16x16x32_bf16 v[68:71], a[136:139], v[152:155], v[68:71]
    v_mul_f32 v87, v87, v17
    v_cvt_pk_bf16_f32 v84, v84, v85
    v_mfma_f32_16x16x32_bf16 v[68:71], a[140:143], a[152:155], v[68:71]
    v_cvt_pk_bf16_f32 v85, v86, v87
    v_mul_f32 v92, v92, v18
    v_mfma_f32_16x16x32_bf16 v[76:79], a[136:139], v[156:159], v[76:79]
L_t4_8:
    s_cbranch_execz L_tback4
    ds_read_b64_tr_b16 a[136:137], v21 offset:8192
    v_mul_f32 v93, v93, v18
    v_mfma_f32_16x16x32_bf16 v[76:79], a[140:143], a[156:159], v[76:79]
    s_waitcnt lgkmcnt(2)
    ds_read_b64_tr_b16 a[138:139], v21 offset:10240
    v_mul_f32 v94, v94, v18
    v_mfma_f32_16x16x32_bf16 v[80:83], a[128:131], v[112:115], 0
    ds_read_b64_tr_b16 a[140:141], v21 offset:12288
    v_mul_f32 v95, v95, v18
    v_mfma_f32_16x16x32_bf16 v[80:83], a[132:135], v[128:131], v[80:83]
    ds_read_b64_tr_b16 a[142:143], v21 offset:14336
    v_cvt_pk_bf16_f32 v92, v92, v93
    v_mfma_f32_16x16x32_bf16 v[88:91], a[128:131], v[116:119], 0
    buffer_store_dwordx4 v[38:41], v12, s[20:23], s50 offen nt
    v_mfma_f32_16x16x32_bf16 v[88:91], a[132:135], v[132:135], v[88:91]
    s_add_u32 s50, s9, 0
    v_cvt_pk_bf16_f32 v93, v94, v95
    v_mul_f32 v100, v100, v19
    v_mfma_f32_16x16x32_bf16 v[96:99], a[128:131], v[120:123], 0
    v_mul_f32 v101, v101, v19
    v_mul_f32 v102, v102, v19
    v_mfma_f32_16x16x32_bf16 v[96:99], a[132:135], v[136:139], v[96:99]
    ds_write_b64 v43, v[84:85] offset:8192
    v_mfma_f32_16x16x32_bf16 v[104:107], a[128:131], v[124:127], 0
    ds_read_b64_tr_b16 a[128:129], v45 offset:0
    v_mul_f32 v103, v103, v19
    v_mfma_f32_16x16x32_bf16 v[104:107], a[132:135], v[140:143], v[104:107]
    s_waitcnt lgkmcnt(2)
    ds_read_b64_tr_b16 a[130:131], v45 offset:2048
    v_cvt_pk_bf16_f32 v100, v100, v101
    v_mfma_f32_16x16x32_bf16 v[80:83], a[136:139], v[144:147], v[80:83]
    ds_read_b64_tr_b16 a[132:133], v45 offset:4096
    v_cvt_pk_bf16_f32 v101, v102, v103
    v_mfma_f32_16x16x32_bf16 v[80:83], a[140:143], a[144:147], v[80:83]
    ds_read_b64_tr_b16 a[134:135], v45 offset:6144
    v_mul_f32 v108, v108, v20
    v_mfma_f32_16x16x32_bf16 v[88:91], a[136:139], v[148:151], v[88:91]
    ds_write_b64 v43, v[92:93] offset:10240
    v_mfma_f32_16x16x32_bf16 v[88:91], a[140:143], a[148:151], v[88:91]
    buffer_load_dwordx4 v8, s[16:19], s48 offen offset:3072 lds
    v_mfma_f32_16x16x32_bf16 v[96:99], a[136:139], v[152:155], v[96:99]
    v_mul_f32 v109, v109, v20
    v_mul_f32 v110, v110, v20
    v_mfma_f32_16x16x32_bf16 v[96:99], a[140:143], a[152:155], v[96:99]
    ds_write_b64 v43, v[100:101] offset:12288
    v_mfma_f32_16x16x32_bf16 v[104:107], a[136:139], v[156:159], v[104:107]
    ds_read_b64_tr_b16 a[136:137], v45 offset:8192
    v_mul_f32 v111, v111, v20
    v_mfma_f32_16x16x32_bf16 v[104:107], a[140:143], a[156:159], v[104:107]
    s_waitcnt lgkmcnt(3)
    ds_read_b64_tr_b16 a[138:139], v45 offset:10240
    v_cvt_pk_bf16_f32 v108, v108, v109
    v_mfma_f32_16x16x32_bf16 v[84:87], a[128:131], v[112:115], 0
    ds_read_b64_tr_b16 a[140:141], v45 offset:12288
    v_cvt_pk_bf16_f32 v109, v110, v111
    v_mfma_f32_16x16x32_bf16 v[84:87], a[132:135], v[128:131], v[84:87]
    ds_read_b64_tr_b16 a[142:143], v45 offset:14336
    v_mfma_f32_16x16x32_bf16 v[92:95], a[128:131], v[116:119], 0
    ds_write_b64 v43, v[108:109] offset:14336
    v_mfma_f32_16x16x32_bf16 v[92:95], a[132:135], v[132:135], v[92:95]
    ds_read_b128 v[26:29], v0 offset:8192
    v_mfma_f32_16x16x32_bf16 v[100:103], a[128:131], v[120:123], 0
    ds_read_b64 v[30:31], v0 offset:9224
    v_mfma_f32_16x16x32_bf16 v[100:103], a[132:135], v[136:139], v[100:103]
    ds_read_b64 v[32:33], v0 offset:9216
    v_mfma_f32_16x16x32_bf16 v[108:111], a[128:131], v[124:127], 0
    ds_read_b64_tr_b16 a[128:129], v5 offset:16384
    v_mfma_f32_16x16x32_bf16 v[108:111], a[132:135], v[140:143], v[108:111]
    s_waitcnt lgkmcnt(5)
    ds_read_b64_tr_b16 a[130:131], v5 offset:18432
    v_mfma_f32_16x16x32_bf16 v[84:87], a[136:139], v[144:147], v[84:87]
    ds_read_b64_tr_b16 a[132:133], v5 offset:20480
    v_mfma_f32_16x16x32_bf16 v[84:87], a[140:143], a[144:147], v[84:87]
    ds_read_b64_tr_b16 a[134:135], v5 offset:22528
    v_mfma_f32_16x16x32_bf16 v[92:95], a[136:139], v[148:151], v[92:95]
    ds_read_b128 v[34:37], v0 offset:10240
    v_mfma_f32_16x16x32_bf16 v[92:95], a[140:143], a[148:151], v[92:95]
    ds_read_b64 v[38:39], v0 offset:11272
    v_mfma_f32_16x16x32_bf16 v[100:103], a[136:139], v[152:155], v[100:103]
    ds_read_b64 v[40:41], v0 offset:11264
    v_mfma_f32_16x16x32_bf16 v[100:103], a[140:143], a[152:155], v[100:103]
    v_mfma_f32_16x16x32_bf16 v[108:111], a[136:139], v[156:159], v[108:111]
    ds_read_b64_tr_b16 a[136:137], v5 offset:24576
    v_mfma_f32_16x16x32_bf16 v[108:111], a[140:143], a[156:159], v[108:111]
    s_waitcnt lgkmcnt(4)
    ds_read_b64_tr_b16 a[138:139], v5 offset:26624
    v_mfma_f32_16x16x32_bf16 v[48:51], a[128:131], v[160:163], v[48:51]
    s_waitcnt vmcnt(6)
    ds_read_b64_tr_b16 a[140:141], v5 offset:28672
    v_xor_b32 v46, 64, v10
    v_mfma_f32_16x16x32_bf16 v[48:51], a[132:135], a[160:163], v[48:51]
    s_barrier
    ds_read_b64_tr_b16 a[142:143], v5 offset:30720
    v_mfma_f32_16x16x32_bf16 v[56:59], a[128:131], v[164:167], v[56:59]
    buffer_store_dwordx4 v[26:29], v12, s[20:23], s50 offen nt
    v_mfma_f32_16x16x32_bf16 v[56:59], a[132:135], a[164:167], v[56:59]
    s_add_u32 s50, s9, 4096
    ds_read_b128 v[26:29], v0 offset:12288
    v_mfma_f32_16x16x32_bf16 v[64:67], a[128:131], v[168:171], v[64:67]
    s_add_u32 m0, s30, 0
    ds_read_b128 a[96:99], v10 offset:16384
    v_mfma_f32_16x16x32_bf16 v[64:67], a[132:135], a[168:171], v[64:67]
    s_xor_b32 s48, s7, 0
    ds_read_b128 a[112:115], v10 offset:16640
    v_mfma_f32_16x16x32_bf16 v[72:75], a[128:131], v[172:175], v[72:75]
    ds_read_b64_tr_b16 a[128:129], v6 offset:16384
    v_mfma_f32_16x16x32_bf16 v[72:75], a[132:135], a[172:175], v[72:75]
    s_waitcnt lgkmcnt(4)
    ds_read_b64_tr_b16 a[130:131], v6 offset:18432
    v_mfma_f32_16x16x32_bf16 v[48:51], a[136:139], v[176:179], v[48:51]
    ds_read_b64_tr_b16 a[132:133], v6 offset:20480
    v_mfma_f32_16x16x32_bf16 v[48:51], a[140:143], a[176:179], v[48:51]
    ds_read_b64_tr_b16 a[134:135], v6 offset:22528
    v_mfma_f32_16x16x32_bf16 v[56:59], a[136:139], v[180:183], v[56:59]
    buffer_load_dwordx4 v8, s[16:19], s48 offen offset:0 lds
    v_mfma_f32_16x16x32_bf16 v[56:59], a[140:143], a[180:183], v[56:59]
    ds_read_b128 a[100:103], v46 offset:16384
    v_mfma_f32_16x16x32_bf16 v[64:67], a[136:139], v[184:187], v[64:67]
    ds_read_b128 a[116:119], v46 offset:16640
    v_xor_b32 v46, 128, v10
    v_mfma_f32_16x16x32_bf16 v[64:67], a[140:143], a[184:187], v[64:67]
    ds_read_b128 a[104:107], v46 offset:16384
    v_mfma_f32_16x16x32_bf16 v[72:75], a[136:139], v[188:191], v[72:75]
    ds_read_b64_tr_b16 a[136:137], v6 offset:24576
    v_mfma_f32_16x16x32_bf16 v[72:75], a[140:143], a[188:191], v[72:75]
    s_waitcnt lgkmcnt(4)
    ds_read_b64_tr_b16 a[138:139], v6 offset:26624
    v_mfma_f32_16x16x32_bf16 v[52:55], a[128:131], v[160:163], v[52:55]
    ds_read_b64_tr_b16 a[140:141], v6 offset:28672
    v_mfma_f32_16x16x32_bf16 v[52:55], a[132:135], a[160:163], v[52:55]
    ds_read_b64_tr_b16 a[142:143], v6 offset:30720
    v_mfma_f32_16x16x32_bf16 v[60:63], a[128:131], v[164:167], v[60:63]
    buffer_load_dwordx4 v8, s[16:19], s48 offen offset:1024 lds
    v_mfma_f32_16x16x32_bf16 v[60:63], a[132:135], a[164:167], v[60:63]
    ds_read_b128 a[120:123], v46 offset:16640
    v_xor_b32 v46, 192, v10
    v_mfma_f32_16x16x32_bf16 v[68:71], a[128:131], v[168:171], v[68:71]
    ds_read_b128 a[108:111], v46 offset:16384
    v_mfma_f32_16x16x32_bf16 v[68:71], a[132:135], a[168:171], v[68:71]
    ds_read_b128 a[124:127], v46 offset:16640
    v_mfma_f32_16x16x32_bf16 v[76:79], a[128:131], v[172:175], v[76:79]
    ds_read_b64_tr_b16 a[128:129], v21 offset:16384
    v_mfma_f32_16x16x32_bf16 v[76:79], a[132:135], a[172:175], v[76:79]
    s_waitcnt lgkmcnt(4)
    ds_read_b64_tr_b16 a[130:131], v21 offset:18432
    v_mfma_f32_16x16x32_bf16 v[52:55], a[136:139], v[176:179], v[52:55]
    ds_read_b64_tr_b16 a[132:133], v21 offset:20480
    v_mfma_f32_16x16x32_bf16 v[52:55], a[140:143], a[176:179], v[52:55]
    ds_read_b64_tr_b16 a[134:135], v21 offset:22528
    v_mfma_f32_16x16x32_bf16 v[60:63], a[136:139], v[180:183], v[60:63]
    buffer_load_dwordx4 v8, s[16:19], s48 offen offset:2048 lds
    v_mfma_f32_16x16x32_bf16 v[60:63], a[140:143], a[180:183], v[60:63]
    v_mfma_f32_16x16x32_bf16 v[68:71], a[136:139], v[184:187], v[68:71]
    v_mfma_f32_16x16x32_bf16 v[68:71], a[140:143], a[184:187], v[68:71]
    v_mfma_f32_16x16x32_bf16 v[76:79], a[136:139], v[188:191], v[76:79]
    ds_read_b64_tr_b16 a[136:137], v21 offset:24576
    v_mfma_f32_16x16x32_bf16 v[76:79], a[140:143], a[188:191], v[76:79]
    s_waitcnt lgkmcnt(1)
    ds_read_b64_tr_b16 a[138:139], v21 offset:26624
    v_mfma_f32_16x16x32_bf16 v[80:83], a[128:131], v[160:163], v[80:83]
    ds_read_b64_tr_b16 a[140:141], v21 offset:28672
    v_mfma_f32_16x16x32_bf16 v[80:83], a[132:135], a[160:163], v[80:83]
    ds_read_b64_tr_b16 a[142:143], v21 offset:30720
    v_mfma_f32_16x16x32_bf16 v[88:91], a[128:131], v[164:167], v[88:91]
    buffer_store_dwordx4 v[30:33], v12, s[20:23], s50 offen nt
    v_mfma_f32_16x16x32_bf16 v[88:91], a[132:135], a[164:167], v[88:91]
    s_add_u32 s50, s9, 32768
    ds_read_b64 v[30:31], v0 offset:13320
    v_mfma_f32_16x16x32_bf16 v[96:99], a[128:131], v[168:171], v[96:99]
    ds_read_b64 v[32:33], v0 offset:13312
    v_mfma_f32_16x16x32_bf16 v[96:99], a[132:135], a[168:171], v[96:99]
    v_mfma_f32_16x16x32_bf16 v[104:107], a[128:131], v[172:175], v[104:107]
    ds_read_b64_tr_b16 a[128:129], v45 offset:16384
    v_mfma_f32_16x16x32_bf16 v[104:107], a[132:135], a[172:175], v[104:107]
    s_waitcnt lgkmcnt(3)
    ds_read_b64_tr_b16 a[130:131], v45 offset:18432
    v_mfma_f32_16x16x32_bf16 v[80:83], a[136:139], v[176:179], v[80:83]
    ds_read_b64_tr_b16 a[132:133], v45 offset:20480
    v_mfma_f32_16x16x32_bf16 v[80:83], a[140:143], a[176:179], v[80:83]
    ds_read_b64_tr_b16 a[134:135], v45 offset:22528
    v_mfma_f32_16x16x32_bf16 v[88:91], a[136:139], v[180:183], v[88:91]
    buffer_load_dwordx4 v8, s[16:19], s48 offen offset:3072 lds
    v_mfma_f32_16x16x32_bf16 v[88:91], a[140:143], a[180:183], v[88:91]
    v_mfma_f32_16x16x32_bf16 v[96:99], a[136:139], v[184:187], v[96:99]
    v_mfma_f32_16x16x32_bf16 v[96:99], a[140:143], a[184:187], v[96:99]
    v_mfma_f32_16x16x32_bf16 v[104:107], a[136:139], v[188:191], v[104:107]
    ds_read_b64_tr_b16 a[136:137], v45 offset:24576
    v_mfma_f32_16x16x32_bf16 v[104:107], a[140:143], a[188:191], v[104:107]
    s_waitcnt lgkmcnt(1)
    ds_read_b64_tr_b16 a[138:139], v45 offset:26624
    v_mfma_f32_16x16x32_bf16 v[84:87], a[128:131], v[160:163], v[84:87]
    ds_read_b64_tr_b16 a[140:141], v45 offset:28672
    v_mfma_f32_16x16x32_bf16 v[84:87], a[132:135], a[160:163], v[84:87]
    ds_read_b64_tr_b16 a[142:143], v45 offset:30720
    v_mfma_f32_16x16x32_bf16 v[92:95], a[128:131], v[164:167], v[92:95]
    v_mfma_f32_16x16x32_bf16 v[92:95], a[132:135], a[164:167], v[92:95]
    v_mfma_f32_16x16x32_bf16 v[100:103], a[128:131], v[168:171], v[100:103]
    v_mfma_f32_16x16x32_bf16 v[100:103], a[132:135], a[168:171], v[100:103]
    v_mfma_f32_16x16x32_bf16 v[108:111], a[128:131], v[172:175], v[108:111]
    ds_read_b64_tr_b16 a[128:129], v5 offset:32768
    v_mfma_f32_16x16x32_bf16 v[108:111], a[132:135], a[172:175], v[108:111]
    s_waitcnt lgkmcnt(1)
    ds_read_b64_tr_b16 a[130:131], v5 offset:34816
    v_mfma_f32_16x16x32_bf16 v[84:87], a[136:139], v[176:179], v[84:87]
    ds_read_b64_tr_b16 a[132:133], v5 offset:36864
    v_mfma_f32_16x16x32_bf16 v[84:87], a[140:143], a[176:179], v[84:87]
    ds_read_b64_tr_b16 a[134:135], v5 offset:38912
    v_mfma_f32_16x16x32_bf16 v[92:95], a[136:139], v[180:183], v[92:95]
    v_mfma_f32_16x16x32_bf16 v[92:95], a[140:143], a[180:183], v[92:95]
    v_mfma_f32_16x16x32_bf16 v[100:103], a[136:139], v[184:187], v[100:103]
    v_mfma_f32_16x16x32_bf16 v[100:103], a[140:143], a[184:187], v[100:103]
    v_mfma_f32_16x16x32_bf16 v[108:111], a[136:139], v[188:191], v[108:111]
    ds_read_b64_tr_b16 a[136:137], v5 offset:40960
    v_mfma_f32_16x16x32_bf16 v[108:111], a[140:143], a[188:191], v[108:111]
    s_waitcnt lgkmcnt(1)
    ds_read_b64_tr_b16 a[138:139], v5 offset:43008
    v_mfma_f32_16x16x32_bf16 v[48:51], a[128:131], v[192:195], v[48:51]
    s_waitcnt vmcnt(6)
    ds_read_b64_tr_b16 a[140:141], v5 offset:45056
    v_mfma_f32_16x16x32_bf16 v[48:51], a[132:135], a[192:195], v[48:51]
    s_barrier
    ds_read_b64_tr_b16 a[142:143], v5 offset:47104
    v_mfma_f32_16x16x32_bf16 v[56:59], a[128:131], v[196:199], v[56:59]
    buffer_store_dwordx4 v[34:37], v12, s[20:23], s50 offen nt
    v_mfma_f32_16x16x32_bf16 v[56:59], a[132:135], a[196:199], v[56:59]
    s_add_u32 s50, s9, 36864
    ds_read_b128 v[34:37], v0 offset:14336
    v_mfma_f32_16x16x32_bf16 v[64:67], a[128:131], v[200:203], v[64:67]
    s_add_u32 m0, s30, 16384
    v_mfma_f32_16x16x32_bf16 v[64:67], a[132:135], a[200:203], v[64:67]
    s_xor_b32 s48, s7, 65536
    v_mfma_f32_16x16x32_bf16 v[72:75], a[128:131], v[204:207], v[72:75]
    ds_read_b64_tr_b16 a[128:129], v6 offset:32768
    v_mfma_f32_16x16x32_bf16 v[72:75], a[132:135], a[204:207], v[72:75]
    s_waitcnt lgkmcnt(2)
    ds_read_b64_tr_b16 a[130:131], v6 offset:34816
    v_mfma_f32_16x16x32_bf16 v[48:51], a[136:139], v[208:211], v[48:51]
    ds_read_b64_tr_b16 a[132:133], v6 offset:36864
    v_mfma_f32_16x16x32_bf16 v[48:51], a[140:143], a[208:211], v[48:51]
    ds_read_b64_tr_b16 a[134:135], v6 offset:38912
    v_mfma_f32_16x16x32_bf16 v[56:59], a[136:139], v[212:215], v[56:59]
    buffer_load_dwordx4 v8, s[16:19], s48 offen offset:0 lds
    v_mfma_f32_16x16x32_bf16 v[56:59], a[140:143], a[212:215], v[56:59]
    v_mfma_f32_16x16x32_bf16 v[64:67], a[136:139], v[216:219], v[64:67]
    v_mfma_f32_16x16x32_bf16 v[64:67], a[140:143], a[216:219], v[64:67]
    v_mfma_f32_16x16x32_bf16 v[72:75], a[136:139], v[220:223], v[72:75]
    ds_read_b64_tr_b16 a[136:137], v6 offset:40960
    v_mfma_f32_16x16x32_bf16 v[72:75], a[140:143], a[220:223], v[72:75]
    s_waitcnt lgkmcnt(1)
    ds_read_b64_tr_b16 a[138:139], v6 offset:43008
    v_mfma_f32_16x16x32_bf16 v[52:55], a[128:131], v[192:195], v[52:55]
    ds_read_b64_tr_b16 a[140:141], v6 offset:45056
    v_mfma_f32_16x16x32_bf16 v[52:55], a[132:135], a[192:195], v[52:55]
    ds_read_b64_tr_b16 a[142:143], v6 offset:47104
    v_mfma_f32_16x16x32_bf16 v[60:63], a[128:131], v[196:199], v[60:63]
    buffer_load_dwordx4 v8, s[16:19], s48 offen offset:1024 lds
    v_mfma_f32_16x16x32_bf16 v[60:63], a[132:135], a[196:199], v[60:63]
    v_mfma_f32_16x16x32_bf16 v[68:71], a[128:131], v[200:203], v[68:71]
    v_mfma_f32_16x16x32_bf16 v[68:71], a[132:135], a[200:203], v[68:71]
    v_mfma_f32_16x16x32_bf16 v[76:79], a[128:131], v[204:207], v[76:79]
    ds_read_b64_tr_b16 a[128:129], v21 offset:32768
    v_mfma_f32_16x16x32_bf16 v[76:79], a[132:135], a[204:207], v[76:79]
    s_waitcnt lgkmcnt(1)
    ds_read_b64_tr_b16 a[130:131], v21 offset:34816
    v_mfma_f32_16x16x32_bf16 v[52:55], a[136:139], v[208:211], v[52:55]
    ds_read_b64_tr_b16 a[132:133], v21 offset:36864
    v_mfma_f32_16x16x32_bf16 v[52:55], a[140:143], a[208:211], v[52:55]
    ds_read_b64_tr_b16 a[134:135], v21 offset:38912
    v_mfma_f32_16x16x32_bf16 v[60:63], a[136:139], v[212:215], v[60:63]
    buffer_load_dwordx4 v8, s[16:19], s48 offen offset:2048 lds
    v_mfma_f32_16x16x32_bf16 v[60:63], a[140:143], a[212:215], v[60:63]
    v_mfma_f32_16x16x32_bf16 v[68:71], a[136:139], v[216:219], v[68:71]
    v_mfma_f32_16x16x32_bf16 v[68:71], a[140:143], a[216:219], v[68:71]
    v_mfma_f32_16x16x32_bf16 v[76:79], a[136:139], v[220:223], v[76:79]
    ds_read_b64_tr_b16 a[136:137], v21 offset:40960
    v_mfma_f32_16x16x32_bf16 v[76:79], a[140:143], a[220:223], v[76:79]
    s_waitcnt lgkmcnt(1)
    ds_read_b64_tr_b16 a[138:139], v21 offset:43008
    v_mfma_f32_16x16x32_bf16 v[80:83], a[128:131], v[192:195], v[80:83]
    ds_read_b64_tr_b16 a[140:141], v21 offset:45056
    v_mfma_f32_16x16x32_bf16 v[80:83], a[132:135], a[192:195], v[80:83]
    ds_read_b64_tr_b16 a[142:143], v21 offset:47104
    v_mfma_f32_16x16x32_bf16 v[88:91], a[128:131], v[196:199], v[88:91]
    buffer_store_dwordx4 v[38:41], v12, s[20:23], s50 offen nt
    v_mfma_f32_16x16x32_bf16 v[88:91], a[132:135], a[196:199], v[88:91]
    s_add_u32 s50, s9, 65536
    ds_read_b64 v[38:39], v0 offset:15368
    v_mfma_f32_16x16x32_bf16 v[96:99], a[128:131], v[200:203], v[96:99]
    ds_read_b64 v[40:41], v0 offset:15360
    v_mfma_f32_16x16x32_bf16 v[96:99], a[132:135], a[200:203], v[96:99]
    v_mfma_f32_16x16x32_bf16 v[104:107], a[128:131], v[204:207], v[104:107]
    ds_read_b64_tr_b16 a[128:129], v45 offset:32768
    v_mfma_f32_16x16x32_bf16 v[104:107], a[132:135], a[204:207], v[104:107]
    s_waitcnt lgkmcnt(3)
    ds_read_b64_tr_b16 a[130:131], v45 offset:34816
    v_mfma_f32_16x16x32_bf16 v[80:83], a[136:139], v[208:211], v[80:83]
    ds_read_b64_tr_b16 a[132:133], v45 offset:36864
    v_mfma_f32_16x16x32_bf16 v[80:83], a[140:143], a[208:211], v[80:83]
    ds_read_b64_tr_b16 a[134:135], v45 offset:38912
    v_mfma_f32_16x16x32_bf16 v[88:91], a[136:139], v[212:215], v[88:91]
    buffer_load_dwordx4 v8, s[16:19], s48 offen offset:3072 lds
    v_mfma_f32_16x16x32_bf16 v[88:91], a[140:143], a[212:215], v[88:91]
    v_mfma_f32_16x16x32_bf16 v[96:99], a[136:139], v[216:219], v[96:99]
    v_mfma_f32_16x16x32_bf16 v[96:99], a[140:143], a[216:219], v[96:99]
    v_mfma_f32_16x16x32_bf16 v[104:107], a[136:139], v[220:223], v[104:107]
    ds_read_b64_tr_b16 a[136:137], v45 offset:40960
    v_mfma_f32_16x16x32_bf16 v[104:107], a[140:143], a[220:223], v[104:107]
    s_waitcnt lgkmcnt(1)
    ds_read_b64_tr_b16 a[138:139], v45 offset:43008
    v_mfma_f32_16x16x32_bf16 v[84:87], a[128:131], v[192:195], v[84:87]
    ds_read_b64_tr_b16 a[140:141], v45 offset:45056
    v_mfma_f32_16x16x32_bf16 v[84:87], a[132:135], a[192:195], v[84:87]
    ds_read_b64_tr_b16 a[142:143], v45 offset:47104
    v_mfma_f32_16x16x32_bf16 v[92:95], a[128:131], v[196:199], v[92:95]
    v_mfma_f32_16x16x32_bf16 v[92:95], a[132:135], a[196:199], v[92:95]
    v_mfma_f32_16x16x32_bf16 v[100:103], a[128:131], v[200:203], v[100:103]
    v_mfma_f32_16x16x32_bf16 v[100:103], a[132:135], a[200:203], v[100:103]
    v_mfma_f32_16x16x32_bf16 v[108:111], a[128:131], v[204:207], v[108:111]
    ds_read_b64_tr_b16 a[128:129], v5 offset:49152
    v_mfma_f32_16x16x32_bf16 v[108:111], a[132:135], a[204:207], v[108:111]
    s_waitcnt lgkmcnt(1)
    ds_read_b64_tr_b16 a[130:131], v5 offset:51200
    v_mfma_f32_16x16x32_bf16 v[84:87], a[136:139], v[208:211], v[84:87]
    ds_read_b64_tr_b16 a[132:133], v5 offset:53248
    v_mfma_f32_16x16x32_bf16 v[84:87], a[140:143], a[208:211], v[84:87]
    ds_read_b64_tr_b16 a[134:135], v5 offset:55296
    v_mfma_f32_16x16x32_bf16 v[92:95], a[136:139], v[212:215], v[92:95]
    v_mfma_f32_16x16x32_bf16 v[92:95], a[140:143], a[212:215], v[92:95]
    v_mfma_f32_16x16x32_bf16 v[100:103], a[136:139], v[216:219], v[100:103]
    v_mfma_f32_16x16x32_bf16 v[100:103], a[140:143], a[216:219], v[100:103]
    v_mfma_f32_16x16x32_bf16 v[108:111], a[136:139], v[220:223], v[108:111]
    ds_read_b64_tr_b16 a[136:137], v5 offset:57344
    v_mfma_f32_16x16x32_bf16 v[108:111], a[140:143], a[220:223], v[108:111]
    s_waitcnt lgkmcnt(1)
    ds_read_b64_tr_b16 a[138:139], v5 offset:59392
    v_mfma_f32_16x16x32_bf16 v[48:51], a[128:131], a[224:227], v[48:51]
    s_waitcnt vmcnt(6)
    ds_read_b64_tr_b16 a[140:141], v5 offset:61440
    v_xor_b32 v43, 32, v11
    v_mfma_f32_16x16x32_bf16 v[48:51], a[132:135], a[240:243], v[48:51]
    s_barrier
    ds_read_b64_tr_b16 a[142:143], v5 offset:63488
    v_xor_b32 v42, 64, v11
    v_mfma_f32_16x16x32_bf16 v[56:59], a[128:131], a[228:231], v[56:59]
    buffer_store_dwordx4 v[26:29], v12, s[20:23], s50 offen nt
    v_mfma_f32_16x16x32_bf16 v[56:59], a[132:135], a[244:247], v[56:59]
    s_add_u32 s50, s9, 69632
    v_mfma_f32_16x16x32_bf16 v[64:67], a[128:131], a[232:235], v[64:67]
    s_add_u32 m0, s30, 32768
    v_mfma_f32_16x16x32_bf16 v[64:67], a[132:135], a[248:251], v[64:67]
    s_xor_b32 s48, s7, 131072
    v_mfma_f32_16x16x32_bf16 v[72:75], a[128:131], a[236:239], v[72:75]
    ds_read_b64_tr_b16 a[128:129], v6 offset:49152
    v_mfma_f32_16x16x32_bf16 v[72:75], a[132:135], a[252:255], v[72:75]
    s_waitcnt lgkmcnt(1)
    ds_read_b64_tr_b16 a[130:131], v6 offset:51200
    v_mfma_f32_16x16x32_bf16 v[48:51], a[136:139], v[224:227], v[48:51]
    ds_read_b64_tr_b16 a[132:133], v6 offset:53248
    v_mfma_f32_16x16x32_bf16 v[48:51], a[140:143], v[240:243], v[48:51]
    ds_read_b64_tr_b16 a[134:135], v6 offset:55296
    v_mfma_f32_16x16x32_bf16 v[56:59], a[136:139], v[228:231], v[56:59]
    buffer_load_dwordx4 v8, s[16:19], s48 offen offset:0 lds
    v_mfma_f32_16x16x32_bf16 v[56:59], a[140:143], v[244:247], v[56:59]
    v_mfma_f32_16x16x32_bf16 v[64:67], a[136:139], v[232:235], v[64:67]
    v_mfma_f32_16x16x32_bf16 v[64:67], a[140:143], v[248:251], v[64:67]
    v_mfma_f32_16x16x32_bf16 v[72:75], a[136:139], v[236:239], v[72:75]
    ds_read_b64_tr_b16 a[136:137], v6 offset:57344
    v_mul_f32 v48, v48, v17
    v_mfma_f32_16x16x32_bf16 v[72:75], a[140:143], v[252:255], v[72:75]
    s_waitcnt lgkmcnt(1)
    ds_read_b64_tr_b16 a[138:139], v6 offset:59392
    v_mul_f32 v49, v49, v17
    v_mfma_f32_16x16x32_bf16 v[52:55], a[128:131], a[224:227], v[52:55]
    ds_read_b64_tr_b16 a[140:141], v6 offset:61440
    v_mul_f32 v50, v50, v17
    v_mfma_f32_16x16x32_bf16 v[52:55], a[132:135], a[240:243], v[52:55]
    ds_read_b64_tr_b16 a[142:143], v6 offset:63488
    v_mul_f32 v51, v51, v17
    v_mfma_f32_16x16x32_bf16 v[60:63], a[128:131], a[228:231], v[60:63]
    buffer_load_dwordx4 v8, s[16:19], s48 offen offset:1024 lds
    v_mfma_f32_16x16x32_bf16 v[60:63], a[132:135], a[244:247], v[60:63]
    v_cvt_pk_bf16_f32 v48, v48, v49
    v_cvt_pk_bf16_f32 v49, v50, v51
    v_mfma_f32_16x16x32_bf16 v[68:71], a[128:131], a[232:235], v[68:71]
    ds_write_b64 v11, v[48:49] offset:0
    v_mfma_f32_16x16x32_bf16 v[68:71], a[132:135], a[248:251], v[68:71]
    v_mul_f32 v56, v56, v18
    v_mul_f32 v57, v57, v18
    v_mfma_f32_16x16x32_bf16 v[76:79], a[128:131], a[236:239], v[76:79]
    ds_read_b64_tr_b16 a[128:129], v21 offset:49152
    v_mul_f32 v58, v58, v18
    v_mfma_f32_16x16x32_bf16 v[76:79], a[132:135], a[252:255], v[76:79]
    s_waitcnt lgkmcnt(2)
    ds_read_b64_tr_b16 a[130:131], v21 offset:51200
    v_mul_f32 v59, v59, v18
    v_mfma_f32_16x16x32_bf16 v[52:55], a[136:139], v[224:227], v[52:55]
    ds_read_b64_tr_b16 a[132:133], v21 offset:53248
    v_cvt_pk_bf16_f32 v56, v56, v57
    v_mfma_f32_16x16x32_bf16 v[52:55], a[140:143], v[240:243], v[52:55]
    ds_read_b64_tr_b16 a[134:135], v21 offset:55296
    v_cvt_pk_bf16_f32 v57, v58, v59
    v_mfma_f32_16x16x32_bf16 v[60:63], a[136:139], v[228:231], v[60:63]
    buffer_load_dwordx4 v8, s[16:19], s48 offen offset:2048 lds
    v_mfma_f32_16x16x32_bf16 v[60:63], a[140:143], v[244:247], v[60:63]
    ds_write_b64 v11, v[56:57] offset:2048
    v_mfma_f32_16x16x32_bf16 v[68:71], a[136:139], v[232:235], v[68:71]
    v_mul_f32 v64, v64, v19
    v_mul_f32 v65, v65, v19
    v_mfma_f32_16x16x32_bf16 v[68:71], a[140:143], v[248:251], v[68:71]
    v_mul_f32 v66, v66, v19
    v_mul_f32 v67, v67, v19
    v_mfma_f32_16x16x32_bf16 v[76:79], a[136:139], v[236:239], v[76:79]
    ds_read_b64_tr_b16 a[136:137], v21 offset:57344
    v_cvt_pk_bf16_f32 v64, v64, v65
    v_mfma_f32_16x16x32_bf16 v[76:79], a[140:143], v[252:255], v[76:79]
    s_waitcnt lgkmcnt(2)
    ds_read_b64_tr_b16 a[138:139], v21 offset:59392
    v_cvt_pk_bf16_f32 v65, v66, v67
    v_mfma_f32_16x16x32_bf16 v[80:83], a[128:131], a[224:227], v[80:83]
    ds_read_b64_tr_b16 a[140:141], v21 offset:61440
    v_mul_f32 v72, v72, v20
    v_mfma_f32_16x16x32_bf16 v[80:83], a[132:135], a[240:243], v[80:83]
    ds_read_b64_tr_b16 a[142:143], v21 offset:63488
    v_mul_f32 v73, v73, v20
    v_mfma_f32_16x16x32_bf16 v[88:91], a[128:131], a[228:231], v[88:91]
    buffer_store_dwordx4 v[30:33], v12, s[20:23], s50 offen nt
    v_mfma_f32_16x16x32_bf16 v[88:91], a[132:135], a[244:247], v[88:91]
    s_add_u32 s50, s9, 98304
    v_mul_f32 v74, v74, v20
    v_mul_f32 v75, v75, v20
    v_mfma_f32_16x16x32_bf16 v[96:99], a[128:131], a[232:235], v[96:99]
    v_cvt_pk_bf16_f32 v72, v72, v73
    v_cvt_pk_bf16_f32 v73, v74, v75
    v_mfma_f32_16x16x32_bf16 v[96:99], a[132:135], a[248:251], v[96:99]
    ds_write_b64 v11, v[64:65] offset:4096
    v_mfma_f32_16x16x32_bf16 v[104:107], a[128:131], a[236:239], v[104:107]
    ds_read_b64_tr_b16 a[128:129], v45 offset:49152
    v_mul_f32 v52, v52, v17
    v_mfma_f32_16x16x32_bf16 v[104:107], a[132:135], a[252:255], v[104:107]
    s_waitcnt lgkmcnt(2)
    ds_read_b64_tr_b16 a[130:131], v45 offset:51200
    v_mul_f32 v53, v53, v17
    v_mfma_f32_16x16x32_bf16 v[80:83], a[136:139], v[224:227], v[80:83]
    ds_read_b64_tr_b16 a[132:133], v45 offset:53248
    v_mul_f32 v54, v54, v17
    v_mfma_f32_16x16x32_bf16 v[80:83], a[140:143], v[240:243], v[80:83]
    ds_read_b64_tr_b16 a[134:135], v45 offset:55296
    v_mul_f32 v55, v55, v17
    v_mfma_f32_16x16x32_bf16 v[88:91], a[136:139], v[228:231], v[88:91]
    buffer_load_dwordx4 v8, s[16:19], s48 offen offset:3072 lds
    v_mfma_f32_16x16x32_bf16 v[88:91], a[140:143], v[244:247], v[88:91]
    ds_write_b64 v11, v[72:73] offset:6144
    v_mfma_f32_16x16x32_bf16 v[96:99], a[136:139], v[232:235], v[96:99]
    v_cvt_pk_bf16_f32 v52, v52, v53
    v_cvt_pk_bf16_f32 v53, v54, v55
    v_mfma_f32_16x16x32_bf16 v[96:99], a[140:143], v[248:251], v[96:99]
    v_mul_f32 v60, v60, v18
    v_mul_f32 v61, v61, v18
    v_mfma_f32_16x16x32_bf16 v[104:107], a[136:139], v[236:239], v[104:107]
    ds_read_b64_tr_b16 a[136:137], v45 offset:57344
    v_mul_f32 v62, v62, v18
    v_mfma_f32_16x16x32_bf16 v[104:107], a[140:143], v[252:255], v[104:107]
    s_waitcnt lgkmcnt(2)
    ds_read_b64_tr_b16 a[138:139], v45 offset:59392
    v_mul_f32 v63, v63, v18
    v_mfma_f32_16x16x32_bf16 v[84:87], a[128:131], a[224:227], v[84:87]
    ds_read_b64_tr_b16 a[140:141], v45 offset:61440
    v_cvt_pk_bf16_f32 v60, v60, v61
    v_mfma_f32_16x16x32_bf16 v[84:87], a[132:135], a[240:243], v[84:87]
    ds_read_b64_tr_b16 a[142:143], v45 offset:63488
    v_cvt_pk_bf16_f32 v61, v62, v63
    v_mfma_f32_16x16x32_bf16 v[92:95], a[128:131], a[228:231], v[92:95]
    ds_write_b64 v43, v[52:53] offset:0
    v_mfma_f32_16x16x32_bf16 v[92:95], a[132:135], a[244:247], v[92:95]
    v_mul_f32 v68, v68, v19
    v_mul_f32 v69, v69, v19
    v_mfma_f32_16x16x32_bf16 v[100:103], a[128:131], a[232:235], v[100:103]
    v_mul_f32 v70, v70, v19
    v_mul_f32 v71, v71, v19
    v_mfma_f32_16x16x32_bf16 v[100:103], a[132:135], a[248:251], v[100:103]
    ds_write_b64 v43, v[60:61] offset:2048
    v_mfma_f32_16x16x32_bf16 v[108:111], a[128:131], a[236:239], v[108:111]
    ds_read_b64_tr_b16 a[128:129], v5 offset:0
    v_cvt_pk_bf16_f32 v68, v68, v69
    v_mfma_f32_16x16x32_bf16 v[108:111], a[132:135], a[252:255], v[108:111]
    s_waitcnt lgkmcnt(3)
    ds_read_b64_tr_b16 a[130:131], v5 offset:2048
    v_cvt_pk_bf16_f32 v69, v70, v71
    v_mfma_f32_16x16x32_bf16 v[84:87], a[136:139], v[224:227], v[84:87]
    ds_read_b64_tr_b16 a[132:133], v5 offset:4096
    v_mul_f32 v76, v76, v20
    v_mfma_f32_16x16x32_bf16 v[84:87], a[140:143], v[240:243], v[84:87]
    ds_read_b64_tr_b16 a[134:135], v5 offset:6144
    v_mul_f32 v77, v77, v20
    v_mfma_f32_16x16x32_bf16 v[92:95], a[136:139], v[228:231], v[92:95]
    ds_write_b64 v43, v[68:69] offset:4096
    v_mfma_f32_16x16x32_bf16 v[92:95], a[140:143], v[244:247], v[92:95]
    v_mul_f32 v78, v78, v20
    v_mul_f32 v79, v79, v20
    v_mfma_f32_16x16x32_bf16 v[100:103], a[136:139], v[232:235], v[100:103]
    v_cvt_pk_bf16_f32 v76, v76, v77
    v_cvt_pk_bf16_f32 v77, v78, v79
    v_mfma_f32_16x16x32_bf16 v[100:103], a[140:143], v[248:251], v[100:103]
    ds_write_b64 v43, v[76:77] offset:6144
    v_mfma_f32_16x16x32_bf16 v[108:111], a[136:139], v[236:239], v[108:111]
    ds_read_b64_tr_b16 a[136:137], v5 offset:8192
    v_xor_b32 v43, 96, v11
    v_mfma_f32_16x16x32_bf16 v[108:111], a[140:143], v[252:255], v[108:111]
    s_waitcnt lgkmcnt(3)
    ds_read_b64_tr_b16 a[138:139], v5 offset:10240
    v_mul_f32 v80, v80, v17
    v_mfma_f32_16x16x32_bf16 v[48:51], a[128:131], v[112:115], 0
    s_waitcnt vmcnt(6)
    ds_read_b64_tr_b16 a[140:141], v5 offset:12288
    v_mul_f32 v81, v81, v17
    v_mfma_f32_16x16x32_bf16 v[48:51], a[132:135], v[128:131], v[48:51]
    s_barrier
    ds_read_b64_tr_b16 a[142:143], v5 offset:14336
    v_mul_f32 v82, v82, v17
    v_mfma_f32_16x16x32_bf16 v[56:59], a[128:131], v[116:119], 0
    buffer_store_dwordx4 v[34:37], v12, s[20:23], s50 offen nt
    v_mfma_f32_16x16x32_bf16 v[56:59], a[132:135], v[132:135], v[56:59]
    s_add_u32 s50, s9, 102400
    v_mul_f32 v83, v83, v17
    v_cvt_pk_bf16_f32 v80, v80, v81
    v_mfma_f32_16x16x32_bf16 v[64:67], a[128:131], v[120:123], 0
    s_add_u32 m0, s30, 49152
    v_cvt_pk_bf16_f32 v81, v82, v83
    v_mul_f32 v88, v88, v18
    v_mfma_f32_16x16x32_bf16 v[64:67], a[132:135], v[136:139], v[64:67]
    s_xor_b32 s48, s7, 196608
    ds_write_b64 v42, v[80:81] offset:0
    v_mfma_f32_16x16x32_bf16 v[72:75], a[128:131], v[124:127], 0
    ds_read_b64_tr_b16 a[128:129], v6 offset:0
    v_mul_f32 v89, v89, v18
    v_mfma_f32_16x16x32_bf16 v[72:75], a[132:135], v[140:143], v[72:75]
    s_waitcnt lgkmcnt(2)
    ds_read_b64_tr_b16 a[130:131], v6 offset:2048
    v_mul_f32 v90, v90, v18
    v_mfma_f32_16x16x32_bf16 v[48:51], a[136:139], v[144:147], v[48:51]
    ds_read_b64_tr_b16 a[132:133], v6 offset:4096
    v_mul_f32 v91, v91, v18
    v_mfma_f32_16x16x32_bf16 v[48:51], a[140:143], a[144:147], v[48:51]
    ds_read_b64_tr_b16 a[134:135], v6 offset:6144
    v_cvt_pk_bf16_f32 v88, v88, v89
    v_mfma_f32_16x16x32_bf16 v[56:59], a[136:139], v[148:151], v[56:59]
    buffer_load_dwordx4 v8, s[16:19], s48 offen offset:0 lds
    v_mfma_f32_16x16x32_bf16 v[56:59], a[140:143], a[148:151], v[56:59]
    v_cvt_pk_bf16_f32 v89, v90, v91
    v_mul_f32 v96, v96, v19
    v_mfma_f32_16x16x32_bf16 v[64:67], a[136:139], v[152:155], v[64:67]
    ds_write_b64 v42, v[88:89] offset:2048
    v_mfma_f32_16x16x32_bf16 v[64:67], a[140:143], a[152:155], v[64:67]
    v_mul_f32 v97, v97, v19
    v_mul_f32 v98, v98, v19
    v_mfma_f32_16x16x32_bf16 v[72:75], a[136:139], v[156:159], v[72:75]
    ds_read_b64_tr_b16 a[136:137], v6 offset:8192
    v_mul_f32 v99, v99, v19
    v_mfma_f32_16x16x32_bf16 v[72:75], a[140:143], a[156:159], v[72:75]
    s_waitcnt lgkmcnt(2)
    ds_read_b64_tr_b16 a[138:139], v6 offset:10240
    v_cvt_pk_bf16_f32 v96, v96, v97
    v_mfma_f32_16x16x32_bf16 v[52:55], a[128:131], v[112:115], 0
L_t4_9:
    s_cbranch_execz L_tback4
    ds_read_b64_tr_b16 a[140:141], v6 offset:12288
    v_cvt_pk_bf16_f32 v97, v98, v99
    v_mfma_f32_16x16x32_bf16 v[52:55], a[132:135], v[128:131], v[52:55]
    ds_read_b64_tr_b16 a[142:143], v6 offset:14336
    v_mul_f32 v104, v104, v20
    v_mfma_f32_16x16x32_bf16 v[60:63], a[128:131], v[116:119], 0
    ds_write_b64 v42, v[96:97] offset:4096
    v_mfma_f32_16x16x32_bf16 v[60:63], a[132:135], v[132:135], v[60:63]
    buffer_load_dwordx4 v8, s[16:19], s48 offen offset:1024 lds
    v_mfma_f32_16x16x32_bf16 v[68:71], a[128:131], v[120:123], 0
    v_mul_f32 v105, v105, v20
    v_mul_f32 v106, v106, v20
    v_mfma_f32_16x16x32_bf16 v[68:71], a[132:135], v[136:139], v[68:71]
    v_mul_f32 v107, v107, v20
    v_cvt_pk_bf16_f32 v104, v104, v105
    v_mfma_f32_16x16x32_bf16 v[76:79], a[128:131], v[124:127], 0
    ds_read_b64_tr_b16 a[128:129], v21 offset:0
    v_cvt_pk_bf16_f32 v105, v106, v107
    v_mfma_f32_16x16x32_bf16 v[76:79], a[132:135], v[140:143], v[76:79]
    s_waitcnt lgkmcnt(2)
    ds_read_b64_tr_b16 a[130:131], v21 offset:2048
    v_mul_f32 v84, v84, v17
    v_mfma_f32_16x16x32_bf16 v[52:55], a[136:139], v[144:147], v[52:55]
    ds_read_b64_tr_b16 a[132:133], v21 offset:4096
    v_mul_f32 v85, v85, v17
    v_mfma_f32_16x16x32_bf16 v[52:55], a[140:143], a[144:147], v[52:55]
    ds_read_b64_tr_b16 a[134:135], v21 offset:6144
    v_mul_f32 v86, v86, v17
    v_mfma_f32_16x16x32_bf16 v[60:63], a[136:139], v[148:151], v[60:63]
    ds_write_b64 v42, v[104:105] offset:6144
    v_mfma_f32_16x16x32_bf16 v[60:63], a[140:143], a[148:151], v[60:63]
    buffer_load_dwordx4 v8, s[16:19], s48 offen offset:2048 lds
    v_mfma_f32_16x16x32_bf16 v[68:71], a[136:139], v[152:155], v[68:71]
    v_mul_f32 v87, v87, v17
    v_cvt_pk_bf16_f32 v84, v84, v85
    v_mfma_f32_16x16x32_bf16 v[68:71], a[140:143], a[152:155], v[68:71]
    v_cvt_pk_bf16_f32 v85, v86, v87
    v_mul_f32 v92, v92, v18
    v_mfma_f32_16x16x32_bf16 v[76:79], a[136:139], v[156:159], v[76:79]
    ds_read_b64_tr_b16 a[136:137], v21 offset:8192
    v_mul_f32 v93, v93, v18
    v_mfma_f32_16x16x32_bf16 v[76:79], a[140:143], a[156:159], v[76:79]
    s_waitcnt lgkmcnt(2)
    ds_read_b64_tr_b16 a[138:139], v21 offset:10240
    v_mul_f32 v94, v94, v18
    v_mfma_f32_16x16x32_bf16 v[80:83], a[128:131], v[112:115], 0
    ds_read_b64_tr_b16 a[140:141], v21 offset:12288
    v_mul_f32 v95, v95, v18
    v_mfma_f32_16x16x32_bf16 v[80:83], a[132:135], v[128:131], v[80:83]
    ds_read_b64_tr_b16 a[142:143], v21 offset:14336
    v_cvt_pk_bf16_f32 v92, v92, v93
    v_mfma_f32_16x16x32_bf16 v[88:91], a[128:131], v[116:119], 0
    buffer_store_dwordx4 v[38:41], v12, s[20:23], s50 offen nt
    v_mfma_f32_16x16x32_bf16 v[88:91], a[132:135], v[132:135], v[88:91]
    s_add_u32 s50, s10, 0
    v_cvt_pk_bf16_f32 v93, v94, v95
    v_mul_f32 v100, v100, v19
    v_mfma_f32_16x16x32_bf16 v[96:99], a[128:131], v[120:123], 0
    v_mul_f32 v101, v101, v19
    v_mul_f32 v102, v102, v19
    v_mfma_f32_16x16x32_bf16 v[96:99], a[132:135], v[136:139], v[96:99]
    ds_write_b64 v43, v[84:85] offset:0
    v_mfma_f32_16x16x32_bf16 v[104:107], a[128:131], v[124:127], 0
    ds_read_b64_tr_b16 a[128:129], v45 offset:0
    v_mul_f32 v103, v103, v19
    v_mfma_f32_16x16x32_bf16 v[104:107], a[132:135], v[140:143], v[104:107]
    s_waitcnt lgkmcnt(2)
    ds_read_b64_tr_b16 a[130:131], v45 offset:2048
    v_cvt_pk_bf16_f32 v100, v100, v101
    v_mfma_f32_16x16x32_bf16 v[80:83], a[136:139], v[144:147], v[80:83]
    ds_read_b64_tr_b16 a[132:133], v45 offset:4096
    v_cvt_pk_bf16_f32 v101, v102, v103
    v_mfma_f32_16x16x32_bf16 v[80:83], a[140:143], a[144:147], v[80:83]
    ds_read_b64_tr_b16 a[134:135], v45 offset:6144
    v_mul_f32 v108, v108, v20
    v_mfma_f32_16x16x32_bf16 v[88:91], a[136:139], v[148:151], v[88:91]
    ds_write_b64 v43, v[92:93] offset:2048
    v_mfma_f32_16x16x32_bf16 v[88:91], a[140:143], a[148:151], v[88:91]
    buffer_load_dwordx4 v8, s[16:19], s48 offen offset:3072 lds
    v_mfma_f32_16x16x32_bf16 v[96:99], a[136:139], v[152:155], v[96:99]
    v_mul_f32 v109, v109, v20
    v_mul_f32 v110, v110, v20
    v_mfma_f32_16x16x32_bf16 v[96:99], a[140:143], a[152:155], v[96:99]
    ds_write_b64 v43, v[100:101] offset:4096
    v_mfma_f32_16x16x32_bf16 v[104:107], a[136:139], v[156:159], v[104:107]
    ds_read_b64_tr_b16 a[136:137], v45 offset:8192
    v_mul_f32 v111, v111, v20
    v_mfma_f32_16x16x32_bf16 v[104:107], a[140:143], a[156:159], v[104:107]
    s_waitcnt lgkmcnt(3)
    ds_read_b64_tr_b16 a[138:139], v45 offset:10240
    v_cvt_pk_bf16_f32 v108, v108, v109
    v_mfma_f32_16x16x32_bf16 v[84:87], a[128:131], v[112:115], 0
    ds_read_b64_tr_b16 a[140:141], v45 offset:12288
    v_cvt_pk_bf16_f32 v109, v110, v111
    v_mfma_f32_16x16x32_bf16 v[84:87], a[132:135], v[128:131], v[84:87]
    ds_read_b64_tr_b16 a[142:143], v45 offset:14336
    v_mfma_f32_16x16x32_bf16 v[92:95], a[128:131], v[116:119], 0
    ds_write_b64 v43, v[108:109] offset:6144
    v_mfma_f32_16x16x32_bf16 v[92:95], a[132:135], v[132:135], v[92:95]
    ds_read_b128 v[26:29], v0 offset:0
    v_mfma_f32_16x16x32_bf16 v[100:103], a[128:131], v[120:123], 0
    ds_read_b64 v[30:31], v0 offset:1032
    v_mfma_f32_16x16x32_bf16 v[100:103], a[132:135], v[136:139], v[100:103]
    ds_read_b64 v[32:33], v0 offset:1024
    v_mfma_f32_16x16x32_bf16 v[108:111], a[128:131], v[124:127], 0
    ds_read_b64_tr_b16 a[128:129], v5 offset:16384
    v_mfma_f32_16x16x32_bf16 v[108:111], a[132:135], v[140:143], v[108:111]
    s_waitcnt lgkmcnt(5)
    ds_read_b64_tr_b16 a[130:131], v5 offset:18432
    v_mfma_f32_16x16x32_bf16 v[84:87], a[136:139], v[144:147], v[84:87]
    ds_read_b64_tr_b16 a[132:133], v5 offset:20480
    v_mfma_f32_16x16x32_bf16 v[84:87], a[140:143], a[144:147], v[84:87]
    ds_read_b64_tr_b16 a[134:135], v5 offset:22528
    v_mfma_f32_16x16x32_bf16 v[92:95], a[136:139], v[148:151], v[92:95]
    ds_read_b128 v[34:37], v0 offset:2048
    v_mfma_f32_16x16x32_bf16 v[92:95], a[140:143], a[148:151], v[92:95]
    ds_read_b64 v[38:39], v0 offset:3080
    v_mfma_f32_16x16x32_bf16 v[100:103], a[136:139], v[152:155], v[100:103]
    ds_read_b64 v[40:41], v0 offset:3072
    v_mfma_f32_16x16x32_bf16 v[100:103], a[140:143], a[152:155], v[100:103]
    v_mfma_f32_16x16x32_bf16 v[108:111], a[136:139], v[156:159], v[108:111]
    ds_read_b64_tr_b16 a[136:137], v5 offset:24576
    v_mfma_f32_16x16x32_bf16 v[108:111], a[140:143], a[156:159], v[108:111]
    s_waitcnt lgkmcnt(4)
    ds_read_b64_tr_b16 a[138:139], v5 offset:26624
    v_mfma_f32_16x16x32_bf16 v[48:51], a[128:131], v[160:163], v[48:51]
    s_waitcnt vmcnt(6)
    ds_read_b64_tr_b16 a[140:141], v5 offset:28672
    v_mfma_f32_16x16x32_bf16 v[48:51], a[132:135], a[160:163], v[48:51]
    s_barrier
    ds_read_b64_tr_b16 a[142:143], v5 offset:30720
    v_mfma_f32_16x16x32_bf16 v[56:59], a[128:131], v[164:167], v[56:59]
    buffer_store_dwordx4 v[26:29], v12, s[20:23], s50 offen nt
    v_mfma_f32_16x16x32_bf16 v[56:59], a[132:135], a[164:167], v[56:59]
    s_add_u32 s50, s10, 4096
    ds_read_b128 v[26:29], v0 offset:4096
    v_mfma_f32_16x16x32_bf16 v[64:67], a[128:131], v[168:171], v[64:67]
    s_add_u32 m0, s30, 0
    v_mfma_f32_16x16x32_bf16 v[64:67], a[132:135], a[168:171], v[64:67]
    s_xor_b32 s48, s28, 0
    v_mfma_f32_16x16x32_bf16 v[72:75], a[128:131], v[172:175], v[72:75]
    ds_read_b64_tr_b16 a[128:129], v6 offset:16384
    v_mfma_f32_16x16x32_bf16 v[72:75], a[132:135], a[172:175], v[72:75]
    s_waitcnt lgkmcnt(2)
    ds_read_b64_tr_b16 a[130:131], v6 offset:18432
    v_mfma_f32_16x16x32_bf16 v[48:51], a[136:139], v[176:179], v[48:51]
    ds_read_b64_tr_b16 a[132:133], v6 offset:20480
    v_mfma_f32_16x16x32_bf16 v[48:51], a[140:143], a[176:179], v[48:51]
    ds_read_b64_tr_b16 a[134:135], v6 offset:22528
    v_mfma_f32_16x16x32_bf16 v[56:59], a[136:139], v[180:183], v[56:59]
    buffer_load_dwordx4 v7, s[12:15], s48 offen offset:0 lds
    v_mfma_f32_16x16x32_bf16 v[56:59], a[140:143], a[180:183], v[56:59]
    v_mfma_f32_16x16x32_bf16 v[64:67], a[136:139], v[184:187], v[64:67]
    v_mfma_f32_16x16x32_bf16 v[64:67], a[140:143], a[184:187], v[64:67]
    v_mfma_f32_16x16x32_bf16 v[72:75], a[136:139], v[188:191], v[72:75]
    ds_read_b64_tr_b16 a[136:137], v6 offset:24576
    v_mfma_f32_16x16x32_bf16 v[72:75], a[140:143], a[188:191], v[72:75]
    s_waitcnt lgkmcnt(1)
    ds_read_b64_tr_b16 a[138:139], v6 offset:26624
    v_mfma_f32_16x16x32_bf16 v[52:55], a[128:131], v[160:163], v[52:55]
    ds_read_b64_tr_b16 a[140:141], v6 offset:28672
    v_mfma_f32_16x16x32_bf16 v[52:55], a[132:135], a[160:163], v[52:55]
    ds_read_b64_tr_b16 a[142:143], v6 offset:30720
    v_mfma_f32_16x16x32_bf16 v[60:63], a[128:131], v[164:167], v[60:63]
    buffer_load_dwordx4 v7, s[12:15], s48 offen offset:1024 lds
    v_mfma_f32_16x16x32_bf16 v[60:63], a[132:135], a[164:167], v[60:63]
    v_mfma_f32_16x16x32_bf16 v[68:71], a[128:131], v[168:171], v[68:71]
    v_mfma_f32_16x16x32_bf16 v[68:71], a[132:135], a[168:171], v[68:71]
    v_mfma_f32_16x16x32_bf16 v[76:79], a[128:131], v[172:175], v[76:79]
    ds_read_b64_tr_b16 a[128:129], v21 offset:16384
    v_mfma_f32_16x16x32_bf16 v[76:79], a[132:135], a[172:175], v[76:79]
    s_waitcnt lgkmcnt(1)
    ds_read_b64_tr_b16 a[130:131], v21 offset:18432
    v_mfma_f32_16x16x32_bf16 v[52:55], a[136:139], v[176:179], v[52:55]
    ds_read_b64_tr_b16 a[132:133], v21 offset:20480
    v_mfma_f32_16x16x32_bf16 v[52:55], a[140:143], a[176:179], v[52:55]
    ds_read_b64_tr_b16 a[134:135], v21 offset:22528
    v_mfma_f32_16x16x32_bf16 v[60:63], a[136:139], v[180:183], v[60:63]
    buffer_store_dwordx4 v[30:33], v12, s[20:23], s50 offen nt
    v_mfma_f32_16x16x32_bf16 v[60:63], a[140:143], a[180:183], v[60:63]
    s_add_u32 s50, s10, 32768
    ds_read_b64 v[30:31], v0 offset:5128
    v_mfma_f32_16x16x32_bf16 v[68:71], a[136:139], v[184:187], v[68:71]
    ds_read_b64 v[32:33], v0 offset:5120
    v_mfma_f32_16x16x32_bf16 v[68:71], a[140:143], a[184:187], v[68:71]
    v_mfma_f32_16x16x32_bf16 v[76:79], a[136:139], v[188:191], v[76:79]
    ds_read_b64_tr_b16 a[136:137], v21 offset:24576
    v_mfma_f32_16x16x32_bf16 v[76:79], a[140:143], a[188:191], v[76:79]
    s_waitcnt lgkmcnt(3)
    ds_read_b64_tr_b16 a[138:139], v21 offset:26624
    v_mfma_f32_16x16x32_bf16 v[80:83], a[128:131], v[160:163], v[80:83]
    ds_read_b64_tr_b16 a[140:141], v21 offset:28672
    v_mfma_f32_16x16x32_bf16 v[80:83], a[132:135], a[160:163], v[80:83]
    ds_read_b64_tr_b16 a[142:143], v21 offset:30720
    v_mfma_f32_16x16x32_bf16 v[88:91], a[128:131], v[164:167], v[88:91]
    buffer_load_dwordx4 v7, s[12:15], s48 offen offset:2048 lds
    v_mfma_f32_16x16x32_bf16 v[88:91], a[132:135], a[164:167], v[88:91]
    v_mfma_f32_16x16x32_bf16 v[96:99], a[128:131], v[168:171], v[96:99]
    v_mfma_f32_16x16x32_bf16 v[96:99], a[132:135], a[168:171], v[96:99]
    v_mfma_f32_16x16x32_bf16 v[104:107], a[128:131], v[172:175], v[104:107]
    ds_read_b64_tr_b16 a[128:129], v45 offset:16384
    v_mfma_f32_16x16x32_bf16 v[104:107], a[132:135], a[172:175], v[104:107]
    s_waitcnt lgkmcnt(1)
    ds_read_b64_tr_b16 a[130:131], v45 offset:18432
    v_mfma_f32_16x16x32_bf16 v[80:83], a[136:139], v[176:179], v[80:83]
    ds_read_b64_tr_b16 a[132:133], v45 offset:20480
    v_mfma_f32_16x16x32_bf16 v[80:83], a[140:143], a[176:179], v[80:83]
    ds_read_b64_tr_b16 a[134:135], v45 offset:22528
    v_mfma_f32_16x16x32_bf16 v[88:91], a[136:139], v[180:183], v[88:91]
    buffer_load_dwordx4 v7, s[12:15], s48 offen offset:3072 lds
    v_mfma_f32_16x16x32_bf16 v[88:91], a[140:143], a[180:183], v[88:91]
    v_mfma_f32_16x16x32_bf16 v[96:99], a[136:139], v[184:187], v[96:99]
    v_mfma_f32_16x16x32_bf16 v[96:99], a[140:143], a[184:187], v[96:99]
    v_mfma_f32_16x16x32_bf16 v[104:107], a[136:139], v[188:191], v[104:107]
    ds_read_b64_tr_b16 a[136:137], v45 offset:24576
    v_mfma_f32_16x16x32_bf16 v[104:107], a[140:143], a[188:191], v[104:107]
    s_waitcnt lgkmcnt(1)
    ds_read_b64_tr_b16 a[138:139], v45 offset:26624
    v_mfma_f32_16x16x32_bf16 v[84:87], a[128:131], v[160:163], v[84:87]
    ds_read_b64_tr_b16 a[140:141], v45 offset:28672
    v_mfma_f32_16x16x32_bf16 v[84:87], a[132:135], a[160:163], v[84:87]
    ds_read_b64_tr_b16 a[142:143], v45 offset:30720
    v_mfma_f32_16x16x32_bf16 v[92:95], a[128:131], v[164:167], v[92:95]
    buffer_store_dwordx4 v[34:37], v12, s[20:23], s50 offen nt
    v_mfma_f32_16x16x32_bf16 v[92:95], a[132:135], a[164:167], v[92:95]
    s_add_u32 s50, s10, 36864
    ds_read_b128 v[34:37], v0 offset:6144
    v_mfma_f32_16x16x32_bf16 v[100:103], a[128:131], v[168:171], v[100:103]
    v_mfma_f32_16x16x32_bf16 v[100:103], a[132:135], a[168:171], v[100:103]
    v_mfma_f32_16x16x32_bf16 v[108:111], a[128:131], v[172:175], v[108:111]
    ds_read_b64_tr_b16 a[128:129], v5 offset:32768
    v_mfma_f32_16x16x32_bf16 v[108:111], a[132:135], a[172:175], v[108:111]
    s_waitcnt lgkmcnt(2)
    ds_read_b64_tr_b16 a[130:131], v5 offset:34816
    v_mfma_f32_16x16x32_bf16 v[84:87], a[136:139], v[176:179], v[84:87]
    ds_read_b64_tr_b16 a[132:133], v5 offset:36864
    v_mfma_f32_16x16x32_bf16 v[84:87], a[140:143], a[176:179], v[84:87]
    ds_read_b64_tr_b16 a[134:135], v5 offset:38912
    v_mfma_f32_16x16x32_bf16 v[92:95], a[136:139], v[180:183], v[92:95]
    v_mfma_f32_16x16x32_bf16 v[92:95], a[140:143], a[180:183], v[92:95]
    v_mfma_f32_16x16x32_bf16 v[100:103], a[136:139], v[184:187], v[100:103]
    v_mfma_f32_16x16x32_bf16 v[100:103], a[140:143], a[184:187], v[100:103]
    v_mfma_f32_16x16x32_bf16 v[108:111], a[136:139], v[188:191], v[108:111]
    ds_read_b64_tr_b16 a[136:137], v5 offset:40960
    v_mfma_f32_16x16x32_bf16 v[108:111], a[140:143], a[188:191], v[108:111]
    s_waitcnt lgkmcnt(1)
    ds_read_b64_tr_b16 a[138:139], v5 offset:43008
    v_mfma_f32_16x16x32_bf16 v[48:51], a[128:131], v[192:195], v[48:51]
    s_waitcnt vmcnt(7)
    ds_read_b64_tr_b16 a[140:141], v5 offset:45056
    v_mfma_f32_16x16x32_bf16 v[48:51], a[132:135], a[192:195], v[48:51]
    s_barrier
    ds_read_b64_tr_b16 a[142:143], v5 offset:47104
    v_mfma_f32_16x16x32_bf16 v[56:59], a[128:131], v[196:199], v[56:59]
    s_add_u32 m0, s30, 16384
    v_mfma_f32_16x16x32_bf16 v[56:59], a[132:135], a[196:199], v[56:59]
    s_xor_b32 s48, s28, 16384
    v_mfma_f32_16x16x32_bf16 v[64:67], a[128:131], v[200:203], v[64:67]
    buffer_load_dwordx4 v7, s[12:15], s48 offen offset:0 lds
    v_mfma_f32_16x16x32_bf16 v[64:67], a[132:135], a[200:203], v[64:67]
    v_mfma_f32_16x16x32_bf16 v[72:75], a[128:131], v[204:207], v[72:75]
    ds_read_b64_tr_b16 a[128:129], v6 offset:32768
    v_mfma_f32_16x16x32_bf16 v[72:75], a[132:135], a[204:207], v[72:75]
    s_waitcnt lgkmcnt(1)
    ds_read_b64_tr_b16 a[130:131], v6 offset:34816
    v_mfma_f32_16x16x32_bf16 v[48:51], a[136:139], v[208:211], v[48:51]
    ds_read_b64_tr_b16 a[132:133], v6 offset:36864
    v_mfma_f32_16x16x32_bf16 v[48:51], a[140:143], a[208:211], v[48:51]
    ds_read_b64_tr_b16 a[134:135], v6 offset:38912
    v_mfma_f32_16x16x32_bf16 v[56:59], a[136:139], v[212:215], v[56:59]
    buffer_store_dwordx4 v[38:41], v12, s[20:23], s50 offen nt
    v_mfma_f32_16x16x32_bf16 v[56:59], a[140:143], a[212:215], v[56:59]
    s_add_u32 s50, s10, 65536
    ds_read_b64 v[38:39], v0 offset:7176
    v_mfma_f32_16x16x32_bf16 v[64:67], a[136:139], v[216:219], v[64:67]
    ds_read_b64 v[40:41], v0 offset:7168
    v_mfma_f32_16x16x32_bf16 v[64:67], a[140:143], a[216:219], v[64:67]
    v_mfma_f32_16x16x32_bf16 v[72:75], a[136:139], v[220:223], v[72:75]
    ds_read_b64_tr_b16 a[136:137], v6 offset:40960
    v_mfma_f32_16x16x32_bf16 v[72:75], a[140:143], a[220:223], v[72:75]
    s_waitcnt lgkmcnt(3)
    ds_read_b64_tr_b16 a[138:139], v6 offset:43008
    v_mfma_f32_16x16x32_bf16 v[52:55], a[128:131], v[192:195], v[52:55]
    ds_read_b64_tr_b16 a[140:141], v6 offset:45056
    v_mfma_f32_16x16x32_bf16 v[52:55], a[132:135], a[192:195], v[52:55]
    ds_read_b64_tr_b16 a[142:143], v6 offset:47104
    v_mfma_f32_16x16x32_bf16 v[60:63], a[128:131], v[196:199], v[60:63]
    buffer_load_dwordx4 v7, s[12:15], s48 offen offset:1024 lds
    v_mfma_f32_16x16x32_bf16 v[60:63], a[132:135], a[196:199], v[60:63]
    v_mfma_f32_16x16x32_bf16 v[68:71], a[128:131], v[200:203], v[68:71]
    v_mfma_f32_16x16x32_bf16 v[68:71], a[132:135], a[200:203], v[68:71]
    v_mfma_f32_16x16x32_bf16 v[76:79], a[128:131], v[204:207], v[76:79]
    ds_read_b64_tr_b16 a[128:129], v21 offset:32768
    v_mfma_f32_16x16x32_bf16 v[76:79], a[132:135], a[204:207], v[76:79]
    s_waitcnt lgkmcnt(1)
    ds_read_b64_tr_b16 a[130:131], v21 offset:34816
    v_mfma_f32_16x16x32_bf16 v[52:55], a[136:139], v[208:211], v[52:55]
    ds_read_b64_tr_b16 a[132:133], v21 offset:36864
    v_mfma_f32_16x16x32_bf16 v[52:55], a[140:143], a[208:211], v[52:55]
    ds_read_b64_tr_b16 a[134:135], v21 offset:38912
    v_mfma_f32_16x16x32_bf16 v[60:63], a[136:139], v[212:215], v[60:63]
    buffer_load_dwordx4 v7, s[12:15], s48 offen offset:2048 lds
    v_mfma_f32_16x16x32_bf16 v[60:63], a[140:143], a[212:215], v[60:63]
    v_mfma_f32_16x16x32_bf16 v[68:71], a[136:139], v[216:219], v[68:71]
    v_mfma_f32_16x16x32_bf16 v[68:71], a[140:143], a[216:219], v[68:71]
    v_mfma_f32_16x16x32_bf16 v[76:79], a[136:139], v[220:223], v[76:79]
    ds_read_b64_tr_b16 a[136:137], v21 offset:40960
    v_mfma_f32_16x16x32_bf16 v[76:79], a[140:143], a[220:223], v[76:79]
    s_waitcnt lgkmcnt(1)
    ds_read_b64_tr_b16 a[138:139], v21 offset:43008
    v_mfma_f32_16x16x32_bf16 v[80:83], a[128:131], v[192:195], v[80:83]
    ds_read_b64_tr_b16 a[140:141], v21 offset:45056
    v_mfma_f32_16x16x32_bf16 v[80:83], a[132:135], a[192:195], v[80:83]
    ds_read_b64_tr_b16 a[142:143], v21 offset:47104
    v_mfma_f32_16x16x32_bf16 v[88:91], a[128:131], v[196:199], v[88:91]
    buffer_store_dwordx4 v[26:29], v12, s[20:23], s50 offen nt
    v_mfma_f32_16x16x32_bf16 v[88:91], a[132:135], a[196:199], v[88:91]
    s_add_u32 s50, s10, 69632
    v_mfma_f32_16x16x32_bf16 v[96:99], a[128:131], v[200:203], v[96:99]
    v_mfma_f32_16x16x32_bf16 v[96:99], a[132:135], a[200:203], v[96:99]
    v_mfma_f32_16x16x32_bf16 v[104:107], a[128:131], v[204:207], v[104:107]
    ds_read_b64_tr_b16 a[128:129], v45 offset:32768
    v_mfma_f32_16x16x32_bf16 v[104:107], a[132:135], a[204:207], v[104:107]
    s_waitcnt lgkmcnt(1)
    ds_read_b64_tr_b16 a[130:131], v45 offset:34816
    v_mfma_f32_16x16x32_bf16 v[80:83], a[136:139], v[208:211], v[80:83]
    ds_read_b64_tr_b16 a[132:133], v45 offset:36864
    v_mfma_f32_16x16x32_bf16 v[80:83], a[140:143], a[208:211], v[80:83]
    ds_read_b64_tr_b16 a[134:135], v45 offset:38912
    v_mfma_f32_16x16x32_bf16 v[88:91], a[136:139], v[212:215], v[88:91]
    buffer_load_dwordx4 v7, s[12:15], s48 offen offset:3072 lds
    v_mfma_f32_16x16x32_bf16 v[88:91], a[140:143], a[212:215], v[88:91]
    v_mfma_f32_16x16x32_bf16 v[96:99], a[136:139], v[216:219], v[96:99]
    v_mfma_f32_16x16x32_bf16 v[96:99], a[140:143], a[216:219], v[96:99]
    v_mfma_f32_16x16x32_bf16 v[104:107], a[136:139], v[220:223], v[104:107]
    ds_read_b64_tr_b16 a[136:137], v45 offset:40960
    v_mfma_f32_16x16x32_bf16 v[104:107], a[140:143], a[220:223], v[104:107]
    s_waitcnt lgkmcnt(1)
    ds_read_b64_tr_b16 a[138:139], v45 offset:43008
    v_mfma_f32_16x16x32_bf16 v[84:87], a[128:131], v[192:195], v[84:87]
    ds_read_b64_tr_b16 a[140:141], v45 offset:45056
    v_mfma_f32_16x16x32_bf16 v[84:87], a[132:135], a[192:195], v[84:87]
    ds_read_b64_tr_b16 a[142:143], v45 offset:47104
    v_mfma_f32_16x16x32_bf16 v[92:95], a[128:131], v[196:199], v[92:95]
    v_mfma_f32_16x16x32_bf16 v[92:95], a[132:135], a[196:199], v[92:95]
    v_mfma_f32_16x16x32_bf16 v[100:103], a[128:131], v[200:203], v[100:103]
    v_mfma_f32_16x16x32_bf16 v[100:103], a[132:135], a[200:203], v[100:103]
    v_mfma_f32_16x16x32_bf16 v[108:111], a[128:131], v[204:207], v[108:111]
    ds_read_b64_tr_b16 a[128:129], v5 offset:49152
    v_mfma_f32_16x16x32_bf16 v[108:111], a[132:135], a[204:207], v[108:111]
    s_waitcnt lgkmcnt(1)
    ds_read_b64_tr_b16 a[130:131], v5 offset:51200
    v_mfma_f32_16x16x32_bf16 v[84:87], a[136:139], v[208:211], v[84:87]
    ds_read_b64_tr_b16 a[132:133], v5 offset:53248
    v_mfma_f32_16x16x32_bf16 v[84:87], a[140:143], a[208:211], v[84:87]
    ds_read_b64_tr_b16 a[134:135], v5 offset:55296
    v_mfma_f32_16x16x32_bf16 v[92:95], a[136:139], v[212:215], v[92:95]
    buffer_store_dwordx4 v[30:33], v12, s[20:23], s50 offen nt
    v_mfma_f32_16x16x32_bf16 v[92:95], a[140:143], a[212:215], v[92:95]
    s_add_u32 s50, s10, 98304
    v_mfma_f32_16x16x32_bf16 v[100:103], a[136:139], v[216:219], v[100:103]
    v_mfma_f32_16x16x32_bf16 v[100:103], a[140:143], a[216:219], v[100:103]
    v_mfma_f32_16x16x32_bf16 v[108:111], a[136:139], v[220:223], v[108:111]
    ds_read_b64_tr_b16 a[136:137], v5 offset:57344
    v_mfma_f32_16x16x32_bf16 v[108:111], a[140:143], a[220:223], v[108:111]
    s_waitcnt lgkmcnt(1)
    ds_read_b64_tr_b16 a[138:139], v5 offset:59392
    v_mfma_f32_16x16x32_bf16 v[48:51], a[128:131], a[224:227], v[48:51]
    s_waitcnt vmcnt(8)
    ds_read_b64_tr_b16 a[140:141], v5 offset:61440
    v_xor_b32 v43, 32, v11
    v_mfma_f32_16x16x32_bf16 v[48:51], a[132:135], a[240:243], v[48:51]
    s_barrier
    ds_read_b64_tr_b16 a[142:143], v5 offset:63488
    v_mfma_f32_16x16x32_bf16 v[56:59], a[128:131], a[228:231], v[56:59]
    s_add_u32 m0, s30, 32768
    v_mfma_f32_16x16x32_bf16 v[56:59], a[132:135], a[244:247], v[56:59]
    s_xor_b32 s48, s28, 32768
    v_mfma_f32_16x16x32_bf16 v[64:67], a[128:131], a[232:235], v[64:67]
    buffer_load_dwordx4 v7, s[12:15], s48 offen offset:0 lds
    v_mfma_f32_16x16x32_bf16 v[64:67], a[132:135], a[248:251], v[64:67]
    s_mov_b64 s[72:73], s[76:77]
    v_mfma_f32_16x16x32_bf16 v[72:75], a[128:131], a[236:239], v[72:75]
    s_mov_b64 s[74:75], s[78:79]
    ds_read_b64_tr_b16 a[128:129], v6 offset:49152
    v_mfma_f32_16x16x32_bf16 v[72:75], a[132:135], a[252:255], v[72:75]
    s_waitcnt lgkmcnt(1)
    ds_read_b64_tr_b16 a[130:131], v6 offset:51200
    v_mfma_f32_16x16x32_bf16 v[48:51], a[136:139], v[224:227], v[48:51]
    s_mov_b64 s[76:77], s[80:81]
    ds_read_b64_tr_b16 a[132:133], v6 offset:53248
    v_mfma_f32_16x16x32_bf16 v[48:51], a[140:143], v[240:243], v[48:51]
    s_mov_b64 s[78:79], s[82:83]
    ds_read_b64_tr_b16 a[134:135], v6 offset:55296
    v_mfma_f32_16x16x32_bf16 v[56:59], a[136:139], v[228:231], v[56:59]
    buffer_load_dwordx4 v7, s[12:15], s48 offen offset:1024 lds
    v_mfma_f32_16x16x32_bf16 v[56:59], a[140:143], v[244:247], v[56:59]
    s_mov_b64 s[80:81], s[84:85]
    v_mfma_f32_16x16x32_bf16 v[64:67], a[136:139], v[232:235], v[64:67]
    s_mov_b64 s[82:83], s[86:87]
    v_mul_f32 v48, v48, v17
    v_mul_f32 v49, v49, v17
    v_mfma_f32_16x16x32_bf16 v[64:67], a[140:143], v[248:251], v[64:67]
    s_mov_b32 s29, s72
    v_mul_f32 v50, v50, v17
    v_mul_f32 v51, v51, v17
    v_mfma_f32_16x16x32_bf16 v[72:75], a[136:139], v[236:239], v[72:75]
    s_mov_b32 s28, s76
    ds_read_b64_tr_b16 a[136:137], v6 offset:57344
    v_cvt_pk_bf16_f32 v48, v48, v49
    v_mfma_f32_16x16x32_bf16 v[72:75], a[140:143], v[252:255], v[72:75]
    s_waitcnt lgkmcnt(1)
    ds_read_b64_tr_b16 a[138:139], v6 offset:59392
    v_cvt_pk_bf16_f32 v49, v50, v51
    v_mfma_f32_16x16x32_bf16 v[52:55], a[128:131], a[224:227], v[52:55]
    s_add_u32 s64, s44, s77
    s_addc_u32 s65, s45, 0
    ds_read_b64_tr_b16 a[140:141], v6 offset:61440
    v_mul_f32 v56, v56, v18
    v_mfma_f32_16x16x32_bf16 v[52:55], a[132:135], a[240:243], v[52:55]
    s_mov_b32 s66, s78
    ds_read_b64_tr_b16 a[142:143], v6 offset:63488
    v_mul_f32 v57, v57, v18
    v_mfma_f32_16x16x32_bf16 v[60:63], a[128:131], a[228:231], v[60:63]
    buffer_store_dwordx4 v[34:37], v12, s[20:23], s50 offen nt
    v_mfma_f32_16x16x32_bf16 v[60:63], a[132:135], a[244:247], v[60:63]
    s_add_u32 s50, s10, 102400
    v_mul_f32 v58, v58, v18
    v_mul_f32 v59, v59, v18
    v_mfma_f32_16x16x32_bf16 v[68:71], a[128:131], a[232:235], v[68:71]
    s_sub_u32 s34, 0, s31
    v_cvt_pk_bf16_f32 v56, v56, v57
    v_cvt_pk_bf16_f32 v57, v58, v59
    v_mfma_f32_16x16x32_bf16 v[68:71], a[132:135], a[248:251], v[68:71]
    s_cmp_eq_u32 s79, 3
    s_cselect_b32 s34, s34, 0
    ds_write_b64 v11, v[48:49] offset:8192
    v_mfma_f32_16x16x32_bf16 v[76:79], a[128:131], a[236:239], v[76:79]
    ds_read_b64_tr_b16 a[128:129], v21 offset:49152
    v_mul_f32 v64, v64, v19
    v_mfma_f32_16x16x32_bf16 v[76:79], a[132:135], a[252:255], v[76:79]
    s_waitcnt lgkmcnt(2)
    ds_read_b64_tr_b16 a[130:131], v21 offset:51200
    v_mul_f32 v65, v65, v19
    v_mfma_f32_16x16x32_bf16 v[52:55], a[136:139], v[224:227], v[52:55]
    ds_read_b64_tr_b16 a[132:133], v21 offset:53248
    v_mul_f32 v66, v66, v19
    v_mfma_f32_16x16x32_bf16 v[52:55], a[140:143], v[240:243], v[52:55]
    ds_read_b64_tr_b16 a[134:135], v21 offset:55296
    v_mul_f32 v67, v67, v19
    v_mfma_f32_16x16x32_bf16 v[60:63], a[136:139], v[228:231], v[60:63]
    buffer_load_dwordx4 v7, s[12:15], s48 offen offset:2048 lds
    v_mfma_f32_16x16x32_bf16 v[60:63], a[140:143], v[244:247], v[60:63]
    ds_write_b64 v11, v[56:57] offset:10240
    v_mfma_f32_16x16x32_bf16 v[68:71], a[136:139], v[232:235], v[68:71]
    v_cvt_pk_bf16_f32 v64, v64, v65
    v_cvt_pk_bf16_f32 v65, v66, v67
    v_mfma_f32_16x16x32_bf16 v[68:71], a[140:143], v[248:251], v[68:71]
    v_mul_f32 v72, v72, v20
    v_mul_f32 v73, v73, v20
    v_mfma_f32_16x16x32_bf16 v[76:79], a[136:139], v[236:239], v[76:79]
    ds_read_b64_tr_b16 a[136:137], v21 offset:57344
    v_mul_f32 v74, v74, v20
    v_mfma_f32_16x16x32_bf16 v[76:79], a[140:143], v[252:255], v[76:79]
    s_waitcnt lgkmcnt(2)
    ds_read_b64_tr_b16 a[138:139], v21 offset:59392
    v_mul_f32 v75, v75, v20
    v_mfma_f32_16x16x32_bf16 v[80:83], a[128:131], a[224:227], v[80:83]
    ds_read_b64_tr_b16 a[140:141], v21 offset:61440
    v_cvt_pk_bf16_f32 v72, v72, v73
    v_mfma_f32_16x16x32_bf16 v[80:83], a[132:135], a[240:243], v[80:83]
    ds_read_b64_tr_b16 a[142:143], v21 offset:63488
    v_cvt_pk_bf16_f32 v73, v74, v75
    v_mfma_f32_16x16x32_bf16 v[88:91], a[128:131], a[228:231], v[88:91]
    buffer_load_dwordx4 v7, s[12:15], s48 offen offset:3072 lds
    v_mfma_f32_16x16x32_bf16 v[88:91], a[132:135], a[244:247], v[88:91]
    ds_write_b64 v11, v[64:65] offset:12288
    v_mfma_f32_16x16x32_bf16 v[96:99], a[128:131], a[232:235], v[96:99]
    v_mul_f32 v52, v52, v17
    v_mul_f32 v53, v53, v17
    v_mfma_f32_16x16x32_bf16 v[96:99], a[132:135], a[248:251], v[96:99]
    v_mul_f32 v54, v54, v17
    v_mul_f32 v55, v55, v17
    v_mfma_f32_16x16x32_bf16 v[104:107], a[128:131], a[236:239], v[104:107]
    ds_read_b64_tr_b16 a[128:129], v45 offset:49152
    v_cvt_pk_bf16_f32 v52, v52, v53
    v_mfma_f32_16x16x32_bf16 v[104:107], a[132:135], a[252:255], v[104:107]
    s_waitcnt lgkmcnt(2)
    ds_read_b64_tr_b16 a[130:131], v45 offset:51200
    v_cvt_pk_bf16_f32 v53, v54, v55
    v_mfma_f32_16x16x32_bf16 v[80:83], a[136:139], v[224:227], v[80:83]
    ds_read_b64_tr_b16 a[132:133], v45 offset:53248
    v_mul_f32 v60, v60, v18
    v_mfma_f32_16x16x32_bf16 v[80:83], a[140:143], v[240:243], v[80:83]
    ds_read_b64_tr_b16 a[134:135], v45 offset:55296
    v_mul_f32 v61, v61, v18
    v_mfma_f32_16x16x32_bf16 v[88:91], a[136:139], v[228:231], v[88:91]
    buffer_store_dwordx4 v[38:41], v12, s[20:23], s50 offen nt
    v_mfma_f32_16x16x32_bf16 v[88:91], a[140:143], v[244:247], v[88:91]
    v_mul_f32 v62, v62, v18
    v_mul_f32 v63, v63, v18
    v_mfma_f32_16x16x32_bf16 v[96:99], a[136:139], v[232:235], v[96:99]
    v_cvt_pk_bf16_f32 v60, v60, v61
    v_cvt_pk_bf16_f32 v61, v62, v63
    v_mfma_f32_16x16x32_bf16 v[96:99], a[140:143], v[248:251], v[96:99]
    ds_write_b64 v11, v[72:73] offset:14336
    v_mfma_f32_16x16x32_bf16 v[104:107], a[136:139], v[236:239], v[104:107]
    ds_read_b64_tr_b16 a[136:137], v45 offset:57344
    v_mul_f32 v68, v68, v19
    v_mfma_f32_16x16x32_bf16 v[104:107], a[140:143], v[252:255], v[104:107]
    s_waitcnt lgkmcnt(2)
    ds_read_b64_tr_b16 a[138:139], v45 offset:59392
    v_mul_f32 v69, v69, v19
    v_mfma_f32_16x16x32_bf16 v[84:87], a[128:131], a[224:227], v[84:87]
    ds_read_b64_tr_b16 a[140:141], v45 offset:61440
    v_mul_f32 v70, v70, v19
    v_mfma_f32_16x16x32_bf16 v[84:87], a[132:135], a[240:243], v[84:87]
    ds_read_b64_tr_b16 a[142:143], v45 offset:63488
    v_mul_f32 v71, v71, v19
    v_mfma_f32_16x16x32_bf16 v[92:95], a[128:131], a[228:231], v[92:95]
    ds_write_b64 v43, v[52:53] offset:8192
    v_mfma_f32_16x16x32_bf16 v[92:95], a[132:135], a[244:247], v[92:95]
    v_cvt_pk_bf16_f32 v68, v68, v69
    v_cvt_pk_bf16_f32 v69, v70, v71
    v_mfma_f32_16x16x32_bf16 v[100:103], a[128:131], a[232:235], v[100:103]
    v_mul_f32 v76, v76, v20
    v_mul_f32 v77, v77, v20
    v_mfma_f32_16x16x32_bf16 v[100:103], a[132:135], a[248:251], v[100:103]
    ds_write_b64 v43, v[60:61] offset:10240
    v_mfma_f32_16x16x32_bf16 v[108:111], a[128:131], a[236:239], v[108:111]
    ds_read_b128 a[128:131], v1 offset:0
    v_mul_f32 v78, v78, v20
    v_mfma_f32_16x16x32_bf16 v[108:111], a[132:135], a[252:255], v[108:111]
    s_waitcnt lgkmcnt(3)
    ds_read_b128 a[132:135], v2 offset:0
    v_mul_f32 v79, v79, v20
    v_mfma_f32_16x16x32_bf16 v[84:87], a[136:139], v[224:227], v[84:87]
    ds_write_b64 v43, v[68:69] offset:12288
    v_mfma_f32_16x16x32_bf16 v[84:87], a[140:143], v[240:243], v[84:87]
    v_cvt_pk_bf16_f32 v76, v76, v77
    v_cvt_pk_bf16_f32 v77, v78, v79
    v_mfma_f32_16x16x32_bf16 v[92:95], a[136:139], v[228:231], v[92:95]
    v_mfma_f32_16x16x32_bf16 v[92:95], a[140:143], v[244:247], v[92:95]
    ds_write_b64 v43, v[76:77] offset:14336
    v_mfma_f32_16x16x32_bf16 v[100:103], a[136:139], v[232:235], v[100:103]
    v_mfma_f32_16x16x32_bf16 v[100:103], a[140:143], v[248:251], v[100:103]
    v_mfma_f32_16x16x32_bf16 v[108:111], a[136:139], v[236:239], v[108:111]
    ds_read_b128 a[136:139], v3 offset:0
    v_mfma_f32_16x16x32_bf16 v[108:111], a[140:143], v[252:255], v[108:111]
    s_waitcnt lgkmcnt(3)
    s_waitcnt lgkmcnt(0)
    s_nop 0
    s_nop 0
    s_nop 0
    s_nop 0
    s_cmp_eq_u32 s75, 4
    s_cbranch_scc1 L_tile_4
    s_mov_b32 s36, 0
    s_mov_b64 exec, 0
    s_cmp_eq_u32 s38, 0
    s_cbranch_scc1 L_t3_0
    s_cmp_eq_u32 s38, 1
    s_cbranch_scc1 L_t3_1
    s_cmp_eq_u32 s38, 2
    s_cbranch_scc1 L_t3_2
    s_branch L_t3_3
L_tback3:
    s_mov_b64 exec, -1
    s_cmp_lg_u32 s36, 0
    s_cbranch_scc1 L_tr1_3
.p2align 3
L_tile_3:
    v_mfma_f32_16x16x32_bf16 v[48:51], a[128:131], a[0:3], 0
    s_add_u32 s50, s11, 0
    ds_read_b128 a[140:143], v4 offset:0
    v_xor_b32 v42, 64, v11
    v_mfma_f32_16x16x32_bf16 v[48:51], a[132:135], a[4:7], v[48:51]
    s_lshr_b32 s42, s38, 1
    ds_read_b128 a[240:243], v1 offset:256
    v_xor_b32 v43, 96, v11
    v_mfma_f32_16x16x32_bf16 v[56:59], a[128:131], a[32:35], 0
    s_lshl_b32 s42, s42, 3
    ds_read_b128 a[244:247], v2 offset:256
    v_mul_f32 v80, v80, v17
    v_mfma_f32_16x16x32_bf16 v[56:59], a[132:135], a[36:39], v[56:59]
    s_and_b32 s43, s38, 1
    ds_read_b128 a[248:251], v3 offset:256
    v_mul_f32 v81, v81, v17
    v_mfma_f32_16x16x32_bf16 v[64:67], a[128:131], a[64:67], 0
    s_or_b32 s42, s42, s43
    ds_read_b128 a[252:255], v4 offset:256
    v_mul_f32 v82, v82, v17
    v_mfma_f32_16x16x32_bf16 v[64:67], a[132:135], a[68:71], v[64:67]
    s_waitcnt lgkmcnt(4)
    ds_read_b128 a[128:131], v1 offset:2048
    v_mul_f32 v83, v83, v17
    v_mfma_f32_16x16x32_bf16 v[48:51], a[136:139], a[8:11], v[48:51]
    s_lshl_b32 s42, s42, 11
    ds_read_b128 a[132:135], v2 offset:2048
    v_cvt_pk_bf16_f32 v80, v80, v81
    v_mfma_f32_16x16x32_bf16 v[48:51], a[140:143], a[12:15], v[48:51]
    s_waitcnt vmcnt(7)
    v_cvt_pk_bf16_f32 v81, v82, v83
    v_mul_f32 v88, v88, v18
    v_mfma_f32_16x16x32_bf16 v[56:59], a[136:139], a[40:43], v[56:59]
    s_barrier
    ds_write_b64 v42, v[80:81] offset:8192
    v_mfma_f32_16x16x32_bf16 v[56:59], a[140:143], a[44:47], v[56:59]
    s_add_u32 m0, s30, 49152
    v_mul_f32 v89, v89, v18
    v_mul_f32 v90, v90, v18
    v_mfma_f32_16x16x32_bf16 v[64:67], a[136:139], a[72:75], v[64:67]
    s_xor_b32 s48, s29, 49152
    ds_read_b128 a[136:139], v3 offset:2048
    v_mul_f32 v91, v91, v18
    v_mfma_f32_16x16x32_bf16 v[64:67], a[140:143], a[76:79], v[64:67]
    s_waitcnt lgkmcnt(6)
    ds_read_b128 a[140:143], v4 offset:2048
    v_cvt_pk_bf16_f32 v88, v88, v89
    v_mfma_f32_16x16x32_bf16 v[48:51], a[240:243], a[16:19], v[48:51]
    buffer_load_dwordx4 v7, s[12:15], s48 offen offset:0 lds
    v_mfma_f32_16x16x32_bf16 v[48:51], a[244:247], a[20:23], v[48:51]
L_t3_0:
    s_cbranch_execz L_t3_4
    v_cvt_pk_bf16_f32 v89, v90, v91
    v_mul_f32 v96, v96, v19
    v_mfma_f32_16x16x32_bf16 v[56:59], a[240:243], a[48:51], v[56:59]
    ds_write_b64 v42, v[88:89] offset:10240
    v_mfma_f32_16x16x32_bf16 v[56:59], a[244:247], a[52:55], v[56:59]
    buffer_load_dwordx4 v7, s[12:15], s48 offen offset:1024 lds
    v_mfma_f32_16x16x32_bf16 v[64:67], a[240:243], a[80:83], v[64:67]
    ds_read_b128 a[240:243], v1 offset:2304
    v_mul_f32 v97, v97, v19
    v_mfma_f32_16x16x32_bf16 v[64:67], a[244:247], a[84:87], v[64:67]
    s_waitcnt lgkmcnt(7)
    ds_read_b128 a[244:247], v2 offset:2304
    v_mul_f32 v98, v98, v19
    v_mfma_f32_16x16x32_bf16 v[48:51], a[248:251], a[24:27], v[48:51]
    buffer_load_dwordx4 v7, s[12:15], s48 offen offset:2048 lds
    v_mfma_f32_16x16x32_bf16 v[48:51], a[252:255], a[28:31], v[48:51]
    v_mul_f32 v99, v99, v19
    v_cvt_pk_bf16_f32 v96, v96, v97
    v_mfma_f32_16x16x32_bf16 v[56:59], a[248:251], a[56:59], v[56:59]
    v_cvt_pk_bf16_f32 v97, v98, v99
    v_mul_f32 v104, v104, v20
    v_mfma_f32_16x16x32_bf16 v[56:59], a[252:255], a[60:63], v[56:59]
    ds_write_b64 v42, v[96:97] offset:12288
    v_mfma_f32_16x16x32_bf16 v[64:67], a[248:251], a[88:91], v[64:67]
    ds_read_b128 a[248:251], v3 offset:2304
    v_mul_f32 v105, v105, v20
    v_mfma_f32_16x16x32_bf16 v[64:67], a[252:255], a[92:95], v[64:67]
    s_waitcnt lgkmcnt(8)
    ds_read_b128 a[252:255], v4 offset:2304
    v_mul_f32 v106, v106, v20
    v_mfma_f32_16x16x32_bf16 v[52:55], a[128:131], a[0:3], 0
    buffer_load_dwordx4 v7, s[12:15], s48 offen offset:3072 lds
    v_mfma_f32_16x16x32_bf16 v[52:55], a[132:135], a[4:7], v[52:55]
    v_mul_f32 v107, v107, v20
    v_cvt_pk_bf16_f32 v104, v104, v105
    v_mfma_f32_16x16x32_bf16 v[60:63], a[128:131], a[32:35], 0
    ds_read_b128 a[128:131], v1 offset:16384
    v_cvt_pk_bf16_f32 v105, v106, v107
    v_mfma_f32_16x16x32_bf16 v[60:63], a[132:135], a[36:39], v[60:63]
    s_waitcnt lgkmcnt(7)
    ds_read_b128 a[132:135], v2 offset:16384
    v_mul_f32 v84, v84, v17
    v_mfma_f32_16x16x32_bf16 v[52:55], a[136:139], a[8:11], v[52:55]
    ds_write_b64 v42, v[104:105] offset:14336
    v_mfma_f32_16x16x32_bf16 v[52:55], a[140:143], a[12:15], v[52:55]
    v_mul_f32 v85, v85, v17
    v_mul_f32 v86, v86, v17
    v_mfma_f32_16x16x32_bf16 v[60:63], a[136:139], a[40:43], v[60:63]
    ds_read_b128 a[136:139], v3 offset:16384
    v_mul_f32 v87, v87, v17
    v_mfma_f32_16x16x32_bf16 v[60:63], a[140:143], a[44:47], v[60:63]
    s_waitcnt lgkmcnt(7)
    ds_read_b128 a[140:143], v4 offset:16384
    v_cvt_pk_bf16_f32 v84, v84, v85
    v_mfma_f32_16x16x32_bf16 v[52:55], a[240:243], a[16:19], v[52:55]
    v_cvt_pk_bf16_f32 v85, v86, v87
    v_mul_f32 v92, v92, v18
    v_mfma_f32_16x16x32_bf16 v[52:55], a[244:247], a[20:23], v[52:55]
    ds_write_b64 v43, v[84:85] offset:8192
    v_mfma_f32_16x16x32_bf16 v[60:63], a[240:243], a[48:51], v[60:63]
    ds_read_b128 a[240:243], v1 offset:16640
    v_mul_f32 v93, v93, v18
    v_mfma_f32_16x16x32_bf16 v[60:63], a[244:247], a[52:55], v[60:63]
    s_waitcnt lgkmcnt(7)
    ds_read_b128 a[244:247], v2 offset:16640
    v_mul_f32 v94, v94, v18
    v_mfma_f32_16x16x32_bf16 v[52:55], a[248:251], a[24:27], v[52:55]
    v_mul_f32 v95, v95, v18
    v_cvt_pk_bf16_f32 v92, v92, v93
    v_mfma_f32_16x16x32_bf16 v[52:55], a[252:255], a[28:31], v[52:55]
    v_cvt_pk_bf16_f32 v93, v94, v95
    v_mul_f32 v100, v100, v19
    v_mfma_f32_16x16x32_bf16 v[60:63], a[248:251], a[56:59], v[60:63]
    ds_read_b128 a[248:251], v3 offset:16640
    v_mul_f32 v101, v101, v19
    v_mfma_f32_16x16x32_bf16 v[60:63], a[252:255], a[60:63], v[60:63]
    ds_write_b64 v43, v[92:93] offset:10240
    v_add_u32 v248, s42, v1
    ds_read_b128 a[208:211], v248 offset:0
    s_waitcnt lgkmcnt(0)
    v_mfma_f32_16x16x32_bf16 v[72:75], a[208:211], a[64:67], 0
    ds_read_b128 a[224:227], v248 offset:256
    v_mul_f32 v102, v102, v19
    v_add_u32 v249, s42, v2
    ds_read_b128 a[212:215], v249 offset:0
    s_waitcnt lgkmcnt(0)
    v_mfma_f32_16x16x32_bf16 v[72:75], a[212:215], a[68:71], v[72:75]
    ds_read_b128 a[228:231], v249 offset:256
    v_mul_f32 v103, v103, v19
    v_add_u32 v250, s42, v3
    ds_read_b128 a[216:219], v250 offset:0
    s_waitcnt lgkmcnt(0)
    v_mfma_f32_16x16x32_bf16 v[72:75], a[216:219], a[72:75], v[72:75]
    ds_read_b128 a[232:235], v250 offset:256
    v_cvt_pk_bf16_f32 v100, v100, v101
    v_add_u32 v251, s42, v4
    ds_read_b128 a[220:223], v251 offset:0
    s_waitcnt lgkmcnt(0)
    v_mfma_f32_16x16x32_bf16 v[72:75], a[220:223], a[76:79], v[72:75]
    s_sub_u32 s42, 86016, s54
    ds_read_b128 a[236:239], v251 offset:256
    v_cvt_pk_bf16_f32 v101, v102, v103
    v_mfma_f32_16x16x32_bf16 v[72:75], a[224:227], a[80:83], v[72:75]
    ds_write_b64 v43, v[100:101] offset:12288
    v_mfma_f32_16x16x32_bf16 v[72:75], a[228:231], a[84:87], v[72:75]
    v_mul_f32 v108, v108, v20
    v_mul_f32 v109, v109, v20
    v_mfma_f32_16x16x32_bf16 v[72:75], a[232:235], a[88:91], v[72:75]
    v_mul_f32 v110, v110, v20
    v_mul_f32 v111, v111, v20
    s_waitcnt lgkmcnt(1)
    v_mfma_f32_16x16x32_bf16 v[72:75], a[236:239], a[92:95], v[72:75]
    v_cvt_pk_bf16_f32 v108, v108, v109
    v_cvt_pk_bf16_f32 v109, v110, v111
    v_add_u32 v253, s42, v0
    s_lshr_b32 s42, s38, 1
    s_lshl_b32 s42, s42, 7
    s_or_b32 s42, s42, s43
    v_lshl_add_u32 v252, s42, 3, v253
    v_mfma_f32_16x16x32_bf16 v[80:83], a[128:131], a[0:3], 0
    s_waitcnt vmcnt(5)
    ds_read_b128 a[252:255], v4 offset:16640
    v_max3_f32 v13, v48, v49, v50
    v_mfma_f32_16x16x32_bf16 v[80:83], a[132:135], a[4:7], v[80:83]
    s_barrier
    ds_write_b64 v43, v[108:109] offset:14336
    v_mfma_f32_16x16x32_bf16 v[88:91], a[128:131], a[32:35], 0
    s_add_u32 m0, s30, 0
    ds_read_b128 a[128:131], v1 offset:18432
    ds_read_b128 v[224:227], v0 offset:8192
    v_mfma_f32_16x16x32_bf16 v[88:91], a[132:135], a[36:39], v[88:91]
    s_xor_b32 s48, s29, 65536
    ds_read_b128 a[132:135], v2 offset:18432
    ds_read_b64 v[228:229], v0 offset:9224
    v_mfma_f32_16x16x32_bf16 v[80:83], a[136:139], a[8:11], v[80:83]
    buffer_load_dwordx4 v7, s[12:15], s48 offen offset:0 lds
    v_mfma_f32_16x16x32_bf16 v[80:83], a[140:143], a[12:15], v[80:83]
    ds_read_b64 v[230:231], v0 offset:9216
    v_max3_f32 v14, v56, v57, v58
    v_mfma_f32_16x16x32_bf16 v[88:91], a[136:139], a[40:43], v[88:91]
    ds_read_b128 a[136:139], v3 offset:18432
    ds_read_b128 v[232:235], v0 offset:10240
    v_mfma_f32_16x16x32_bf16 v[88:91], a[140:143], a[44:47], v[88:91]
    ds_read_b128 a[140:143], v4 offset:18432
    ds_read_b64 v[236:237], v0 offset:11272
    v_mfma_f32_16x16x32_bf16 v[80:83], a[240:243], a[16:19], v[80:83]
    buffer_load_dwordx4 v7, s[12:15], s48 offen offset:1024 lds
    v_mfma_f32_16x16x32_bf16 v[80:83], a[244:247], a[20:23], v[80:83]
    ds_read_b64 v[238:239], v0 offset:11264
    v_max3_f32 v15, v64, v65, v66
    v_mfma_f32_16x16x32_bf16 v[88:91], a[240:243], a[48:51], v[88:91]
    ds_read_b128 a[240:243], v1 offset:18688
    v_max_f32 v13, v13, v51
    v_mfma_f32_16x16x32_bf16 v[88:91], a[244:247], a[52:55], v[88:91]
    s_waitcnt lgkmcnt(12)
    ds_read_b128 a[244:247], v2 offset:18688
    v_max_f32 v14, v14, v59
    v_mfma_f32_16x16x32_bf16 v[80:83], a[248:251], a[24:27], v[80:83]
    buffer_load_dwordx4 v7, s[12:15], s48 offen offset:2048 lds
    v_mfma_f32_16x16x32_bf16 v[80:83], a[252:255], a[28:31], v[80:83]
    v_max_f32 v15, v15, v67
    v_mov_b32 v26, v13
    v_mfma_f32_16x16x32_bf16 v[88:91], a[248:251], a[56:59], v[88:91]
    ds_read_b128 a[248:251], v3 offset:18688
    v_mov_b32 v30, v14
    v_mfma_f32_16x16x32_bf16 v[88:91], a[252:255], a[60:63], v[88:91]
    s_waitcnt lgkmcnt(10)
    ds_read_b128 a[252:255], v4 offset:18688
    v_mov_b32 v34, v15
    v_mfma_f32_16x16x32_bf16 v[84:87], a[128:131], a[0:3], 0
    buffer_store_dwordx4 v[224:227], v12, s[20:23], s50 offen nt
    v_mfma_f32_16x16x32_bf16 v[84:87], a[132:135], a[4:7], v[84:87]
    s_add_u32 s50, s11, 4096
    ds_read_b128 v[224:227], v0 offset:12288
    v_mfma_f32_16x16x32_bf16 v[92:95], a[128:131], a[32:35], 0
    ds_read_b128 a[128:131], v1 offset:32768
    v_mfma_f32_16x16x32_bf16 v[92:95], a[132:135], a[36:39], v[92:95]
    s_waitcnt lgkmcnt(8)
    ds_read_b128 a[132:135], v2 offset:32768
    v_mfma_f32_16x16x32_bf16 v[84:87], a[136:139], a[8:11], v[84:87]
    buffer_load_dwordx4 v7, s[12:15], s48 offen offset:3072 lds
    v_mfma_f32_16x16x32_bf16 v[84:87], a[140:143], a[12:15], v[84:87]
    v_permlane32_swap_b32 v13, v26
    v_mfma_f32_16x16x32_bf16 v[92:95], a[136:139], a[40:43], v[92:95]
    ds_read_b128 a[136:139], v3 offset:32768
    v_max_f32 v13, v13, v26
    v_mfma_f32_16x16x32_bf16 v[92:95], a[140:143], a[44:47], v[92:95]
    s_waitcnt lgkmcnt(6)
    ds_read_b128 a[140:143], v4 offset:32768
    v_mov_b32 v26, v13
    v_mfma_f32_16x16x32_bf16 v[84:87], a[240:243], a[16:19], v[84:87]
    v_permlane32_swap_b32 v14, v30
    v_mfma_f32_16x16x32_bf16 v[84:87], a[244:247], a[20:23], v[84:87]
    v_permlane32_swap_b32 v15, v34
    v_mfma_f32_16x16x32_bf16 v[92:95], a[240:243], a[48:51], v[92:95]
    ds_read_b128 a[240:243], v1 offset:33024
    v_max_f32 v14, v14, v30
    v_mfma_f32_16x16x32_bf16 v[92:95], a[244:247], a[52:55], v[92:95]
    s_waitcnt lgkmcnt(6)
    ds_read_b128 a[244:247], v2 offset:33024
    v_max_f32 v15, v15, v34
    v_mfma_f32_16x16x32_bf16 v[84:87], a[248:251], a[24:27], v[84:87]
    v_permlane16_swap_b32 v13, v26
    v_mfma_f32_16x16x32_bf16 v[84:87], a[252:255], a[28:31], v[84:87]
    v_mov_b32 v30, v14
    v_mov_b32 v34, v15
    v_mfma_f32_16x16x32_bf16 v[92:95], a[248:251], a[56:59], v[92:95]
    ds_read_b128 a[248:251], v3 offset:33024
    v_max_f32 v13, v13, v26
    v_mfma_f32_16x16x32_bf16 v[92:95], a[252:255], a[60:63], v[92:95]
    s_waitcnt lgkmcnt(5)
    v_permlane16_swap_b32 v14, v30
    v_permlane16_swap_b32 v15, v34
    s_nop 0
    v_max_f32 v15, v15, v34
    s_nop 0
    v_mul_f32 v15, s24, v15
    s_nop 0
    v_fma_f32 v72, v72, s24, -v15
    v_fma_f32 v73, v73, s24, -v15
    v_fma_f32 v74, v74, s24, -v15
    v_fma_f32 v75, v75, s24, -v15
    v_exp_f32 v72, v72
    v_exp_f32 v73, v73
    v_exp_f32 v74, v74
    v_exp_f32_e64 v75, v75
    v_cvt_pk_bf16_f32 v72, v72, v73
    v_cvt_pk_bf16_f32 v73, v74, v75
    ds_write_b64 v252, v[72:73] offset:0
    v_mul_f32 v13, s24, v13
    s_nop 0
    v_fma_f32 v48, v48, s24, -v13
    v_fma_f32 v49, v49, s24, -v13
    v_fma_f32 v50, v50, s24, -v13
    v_fma_f32 v51, v51, s24, -v13
    v_exp_f32 v48, v48
    v_exp_f32 v49, v49
    v_exp_f32 v50, v50
    v_exp_f32 v51, v51
    v_cvt_pk_bf16_f32 v112, v48, v49
    v_cvt_pk_bf16_f32 v113, v50, v51
    v_mfma_f32_16x16x32_bf16 v[48:51], a[128:131], a[0:3], 0
    s_waitcnt vmcnt(5)
    ds_read_b128 a[252:255], v4 offset:33024
    v_max_f32 v14, v14, v30
    v_mfma_f32_16x16x32_bf16 v[48:51], a[132:135], a[4:7], v[48:51]
    s_add_u32 m0, s30, 16384
    v_mul_f32_e64 v14, s24, v14
    v_fma_f32 v52, v52, s24, -v13
    v_fma_f32 v56, v56, s24, -v14
    v_fma_f32 v57, v57, s24, -v14
    v_fma_f32 v58, v58, s24, -v14
    v_fma_f32 v59, v59, s24, -v14
    v_exp_f32 v56, v56
    v_exp_f32 v57, v57
    v_exp_f32 v58, v58
    v_exp_f32 v59, v59
    v_cvt_pk_bf16_f32 v116, v56, v57
    v_cvt_pk_bf16_f32 v117, v58, v59
    v_mfma_f32_16x16x32_bf16 v[56:59], a[128:131], a[32:35], 0
    s_xor_b32 s48, s29, 81920
    ds_read_b128 a[128:131], v1 offset:34816
    v_fma_f32 v53, v53, s24, -v13
    v_mfma_f32_16x16x32_bf16 v[56:59], a[132:135], a[36:39], v[56:59]
    s_waitcnt lgkmcnt(6)
    ds_read_b128 a[132:135], v2 offset:34816
    v_fma_f32 v54, v54, s24, -v13
    v_mfma_f32_16x16x32_bf16 v[48:51], a[136:139], a[8:11], v[48:51]
    v_exp_f32 v52, v52
    v_mfma_f32_16x16x32_bf16 v[48:51], a[140:143], a[12:15], v[48:51]
    buffer_store_dwordx4 v[228:231], v12, s[20:23], s50 offen nt
    v_mfma_f32_16x16x32_bf16 v[56:59], a[136:139], a[40:43], v[56:59]
    s_add_u32 s50, s11, 32768
    ds_read_b128 a[136:139], v3 offset:34816
    ds_read_b64 v[228:229], v0 offset:13320
    v_mfma_f32_16x16x32_bf16 v[56:59], a[140:143], a[44:47], v[56:59]
    s_waitcnt lgkmcnt(7)
    ds_read_b128 a[140:143], v4 offset:34816
    ds_read_b64 v[230:231], v0 offset:13312
    v_mfma_f32_16x16x32_bf16 v[48:51], a[240:243], a[16:19], v[48:51]
    v_exp_f32 v53, v53
    v_mfma_f32_16x16x32_bf16 v[48:51], a[244:247], a[20:23], v[48:51]
    v_exp_f32 v54, v54
    v_mfma_f32_16x16x32_bf16 v[56:59], a[240:243], a[48:51], v[56:59]
    ds_read_b128 a[240:243], v1 offset:35072
    v_fma_f32 v55, v55, s24, -v13
    v_mfma_f32_16x16x32_bf16 v[56:59], a[244:247], a[52:55], v[56:59]
    s_waitcnt lgkmcnt(7)
    ds_read_b128 a[244:247], v2 offset:35072
    v_cvt_pk_bf16_f32 v114, v52, v53
    v_mfma_f32_16x16x32_bf16 v[48:51], a[248:251], a[24:27], v[48:51]
    s_barrier
    ds_read_b128 a[208:211], v248 offset:32768
    v_fma_f32 v60, v60, s24, -v14
    v_mfma_f32_16x16x32_bf16 v[48:51], a[252:255], a[28:31], v[48:51]
    buffer_load_dwordx4 v7, s[12:15], s48 offen offset:0 lds
    v_mfma_f32_16x16x32_bf16 v[56:59], a[248:251], a[56:59], v[56:59]
    ds_read_b128 a[248:251], v3 offset:35072
    ds_read_b128 a[212:215], v249 offset:32768
    v_mfma_f32_16x16x32_bf16 v[56:59], a[252:255], a[60:63], v[56:59]
    s_waitcnt lgkmcnt(9)
    ds_read_b128 a[252:255], v4 offset:35072
    ds_read_b128 a[216:219], v250 offset:32768
    v_exp_f32 v55, v55
    s_nop 0
    v_cvt_pk_bf16_f32 v115, v54, v55
    v_mfma_f32_16x16x32_bf16 v[52:55], a[128:131], a[0:3], 0
    buffer_load_dwordx4 v7, s[12:15], s48 offen offset:1024 lds
    v_mfma_f32_16x16x32_bf16 v[52:55], a[132:135], a[4:7], v[52:55]
    ds_read_b128 a[220:223], v251 offset:32768
    v_fma_f32 v61, v61, s24, -v14
    v_fma_f32 v62, v62, s24, -v14
    v_fma_f32 v63, v63, s24, -v14
    v_exp_f32 v60, v60
    v_exp_f32 v61, v61
    v_exp_f32 v62, v62
    v_exp_f32 v63, v63
    v_cvt_pk_bf16_f32 v118, v60, v61
    v_cvt_pk_bf16_f32 v119, v62, v63
    v_mfma_f32_16x16x32_bf16 v[60:63], a[128:131], a[32:35], 0
    ds_read_b128 a[128:131], v1 offset:49152
    ds_read_b128 a[224:227], v248 offset:33024
    v_mfma_f32_16x16x32_bf16 v[60:63], a[132:135], a[36:39], v[60:63]
    s_waitcnt lgkmcnt(11)
    ds_read_b128 a[132:135], v2 offset:49152
    ds_read_b128 a[228:231], v249 offset:33024
    v_mfma_f32_16x16x32_bf16 v[52:55], a[136:139], a[8:11], v[52:55]
    buffer_load_dwordx4 v7, s[12:15], s48 offen offset:2048 lds
    v_mfma_f32_16x16x32_bf16 v[52:55], a[140:143], a[12:15], v[52:55]
    ds_read_b128 a[232:235], v250 offset:33024
    v_fma_f32 v80, v80, s24, -v13
    v_mfma_f32_16x16x32_bf16 v[60:63], a[136:139], a[40:43], v[60:63]
    ds_read_b128 a[136:139], v3 offset:49152
    ds_read_b128 a[236:239], v251 offset:33024
    v_mfma_f32_16x16x32_bf16 v[60:63], a[140:143], a[44:47], v[60:63]
    s_waitcnt lgkmcnt(13)
    ds_read_b128 a[140:143], v4 offset:49152
    ds_read_b128 a[144:147], v253 offset:0
    v_mfma_f32_16x16x32_bf16 v[52:55], a[240:243], a[16:19], v[52:55]
    buffer_load_dwordx4 v7, s[12:15], s48 offen offset:3072 lds
    v_mfma_f32_16x16x32_bf16 v[52:55], a[244:247], a[20:23], v[52:55]
    ds_read_b128 a[148:151], v253 offset:1024
    v_fma_f32 v81, v81, s24, -v13
    v_mfma_f32_16x16x32_bf16 v[60:63], a[240:243], a[48:51], v[60:63]
    ds_read_b128 a[240:243], v1 offset:49408
    v_fma_f32 v82, v82, s24, -v13
    v_mfma_f32_16x16x32_bf16 v[60:63], a[244:247], a[52:55], v[60:63]
    s_waitcnt lgkmcnt(13)
    ds_read_b128 a[244:247], v2 offset:49408
    v_fma_f32 v83, v83, s24, -v13
    v_mfma_f32_16x16x32_bf16 v[52:55], a[248:251], a[24:27], v[52:55]
    buffer_store_dwordx4 v[232:235], v12, s[20:23], s50 offen nt
    v_mfma_f32_16x16x32_bf16 v[52:55], a[252:255], a[28:31], v[52:55]
    s_add_u32 s50, s11, 36864
    ds_read_b128 v[232:235], v0 offset:14336
    v_fma_f32 v88, v88, s24, -v14
    v_mfma_f32_16x16x32_bf16 v[60:63], a[248:251], a[56:59], v[60:63]
    ds_read_b128 a[248:251], v3 offset:49408
    v_fma_f32 v89, v89, s24, -v14
    v_mfma_f32_16x16x32_bf16 v[60:63], a[252:255], a[60:63], v[60:63]
    v_exp_f32 v80, v80
    v_mfma_f32_16x16x32_bf16 v[76:79], a[208:211], a[64:67], 0
    v_exp_f32 v81, v81
    v_mfma_f32_16x16x32_bf16 v[76:79], a[212:215], a[68:71], v[76:79]
    v_exp_f32 v82, v82
    s_waitcnt lgkmcnt(15)
    v_mfma_f32_16x16x32_bf16 v[76:79], a[216:219], a[72:75], v[76:79]
    v_exp_f32 v83, v83
    s_waitcnt lgkmcnt(14)
    v_mfma_f32_16x16x32_bf16 v[76:79], a[220:223], a[76:79], v[76:79]
    v_exp_f32 v88, v88
    s_waitcnt lgkmcnt(12)
    v_mfma_f32_16x16x32_bf16 v[76:79], a[224:227], a[80:83], v[76:79]
    v_exp_f32 v89, v89
    s_waitcnt lgkmcnt(10)
    v_mfma_f32_16x16x32_bf16 v[76:79], a[228:231], a[84:87], v[76:79]
    v_cvt_pk_bf16_f32 v120, v80, v81
    v_cvt_pk_bf16_f32 v121, v82, v83
    s_waitcnt lgkmcnt(9)
    v_mfma_f32_16x16x32_bf16 v[76:79], a[232:235], a[88:91], v[76:79]
    v_fma_f32 v90, v90, s24, -v14
    v_fma_f32 v91, v91, s24, -v14
    s_waitcnt lgkmcnt(7)
    v_mfma_f32_16x16x32_bf16 v[76:79], a[236:239], a[92:95], v[76:79]
    v_exp_f32 v90, v90
    v_mfma_f32_16x16x32_bf16 v[80:83], a[128:131], a[0:3], 0
    s_waitcnt vmcnt(6)
    ds_read_b128 a[252:255], v4 offset:49408
    v_cvt_pk_bf16_f32 v124, v88, v89
    v_mfma_f32_16x16x32_bf16 v[80:83], a[132:135], a[4:7], v[80:83]
    s_barrier
    v_exp_f32 v91, v91
    s_nop 0
    v_cvt_pk_bf16_f32 v125, v90, v91
    v_mfma_f32_16x16x32_bf16 v[88:91], a[128:131], a[32:35], 0
    s_add_u32 m0, s30, 32768
    ds_read_b128 a[128:131], v1 offset:51200
    v_fma_f32 v76, v76, s24, -v15
    v_mfma_f32_16x16x32_bf16 v[88:91], a[132:135], a[36:39], v[88:91]
    s_waitcnt lgkmcnt(8)
    ds_read_b128 a[132:135], v2 offset:51200
    v_fma_f32 v77, v77, s24, -v15
    v_mfma_f32_16x16x32_bf16 v[80:83], a[136:139], a[8:11], v[80:83]
    s_xor_b32 s48, s29, 98304
    v_exp_f32 v76, v76
    v_mfma_f32_16x16x32_bf16 v[80:83], a[140:143], a[12:15], v[80:83]
    buffer_load_dwordx4 v7, s[12:15], s48 offen offset:0 lds
    v_mfma_f32_16x16x32_bf16 v[88:91], a[136:139], a[40:43], v[88:91]
    ds_read_b128 a[136:139], v3 offset:51200
    v_fma_f32 v78, v78, s24, -v15
    v_mfma_f32_16x16x32_bf16 v[88:91], a[140:143], a[44:47], v[88:91]
    s_waitcnt lgkmcnt(6)
    ds_read_b128 a[140:143], v4 offset:51200
    v_fma_f32 v79, v79, s24, -v15
    v_mfma_f32_16x16x32_bf16 v[80:83], a[240:243], a[16:19], v[80:83]
    buffer_load_dwordx4 v7, s[12:15], s48 offen offset:1024 lds
    v_mfma_f32_16x16x32_bf16 v[80:83], a[244:247], a[20:23], v[80:83]
    v_exp_f32 v77, v77
    v_mfma_f32_16x16x32_bf16 v[88:91], a[240:243], a[48:51], v[88:91]
    ds_read_b128 a[240:243], v1 offset:51456
    v_cvt_pk_bf16_f32 v76, v76, v77
    v_mfma_f32_16x16x32_bf16 v[88:91], a[244:247], a[52:55], v[88:91]
    s_waitcnt lgkmcnt(5)
    ds_read_b128 a[244:247], v2 offset:51456
    v_fma_f32 v84, v84, s24, -v13
    v_mfma_f32_16x16x32_bf16 v[80:83], a[248:251], a[24:27], v[80:83]
    buffer_store_dwordx4 v[236:239], v12, s[20:23], s50 offen nt
    v_mfma_f32_16x16x32_bf16 v[80:83], a[252:255], a[28:31], v[80:83]
    s_add_u32 s50, s11, 65536
    ds_read_b64 v[236:237], v0 offset:15368
    v_fma_f32 v85, v85, s24, -v13
    v_mfma_f32_16x16x32_bf16 v[88:91], a[248:251], a[56:59], v[88:91]
    ds_read_b128 a[248:251], v3 offset:51456
    ds_read_b64 v[238:239], v0 offset:15360
    v_mfma_f32_16x16x32_bf16 v[88:91], a[252:255], a[60:63], v[88:91]
    s_waitcnt lgkmcnt(7)
    ds_read_b128 a[252:255], v4 offset:51456
    v_fma_f32 v86, v86, s24, -v13
    v_fma_f32 v87, v87, s24, -v13
    v_exp_f32 v84, v84
    v_exp_f32 v85, v85
    v_exp_f32 v86, v86
    v_exp_f32 v87, v87
    v_cvt_pk_bf16_f32 v122, v84, v85
    v_cvt_pk_bf16_f32 v123, v86, v87
    v_mfma_f32_16x16x32_bf16 v[84:87], a[128:131], a[0:3], 0
    buffer_load_dwordx4 v7, s[12:15], s48 offen offset:2048 lds
    v_mfma_f32_16x16x32_bf16 v[84:87], a[132:135], a[4:7], v[84:87]
    v_exp_f32_e64 v78, v78
    v_fma_f32 v92, v92, s24, -v14
    v_fma_f32 v93, v93, s24, -v14
    v_fma_f32 v94, v94, s24, -v14
    v_fma_f32 v95, v95, s24, -v14
    v_exp_f32 v92, v92
    v_exp_f32 v93, v93
    v_exp_f32 v94, v94
    v_exp_f32 v95, v95
    v_cvt_pk_bf16_f32 v126, v92, v93
    v_cvt_pk_bf16_f32 v127, v94, v95
    v_mfma_f32_16x16x32_bf16 v[92:95], a[128:131], a[32:35], 0
    ds_read_b128 a[128:131], v1 offset:0
    v_fma_f32 v48, v48, s24, -v13
    v_mfma_f32_16x16x32_bf16 v[92:95], a[132:135], a[36:39], v[92:95]
    s_waitcnt lgkmcnt(7)
    ds_read_b128 a[132:135], v2 offset:0
    v_fma_f32 v49, v49, s24, -v13
    v_mfma_f32_16x16x32_bf16 v[84:87], a[136:139], a[8:11], v[84:87]
    buffer_load_dwordx4 v7, s[12:15], s48 offen offset:3072 lds
    v_mfma_f32_16x16x32_bf16 v[84:87], a[140:143], a[12:15], v[84:87]
    v_exp_f32 v79, v79
    v_mfma_f32_16x16x32_bf16 v[92:95], a[136:139], a[40:43], v[92:95]
    ds_read_b128 a[136:139], v3 offset:0
    v_cvt_pk_bf16_f32 v77, v78, v79
    v_mfma_f32_16x16x32_bf16 v[92:95], a[140:143], a[44:47], v[92:95]
    ds_read_b128 a[140:143], v4 offset:0
    v_fma_f32 v50, v50, s24, -v13
    v_mfma_f32_16x16x32_bf16 v[26:29], v[22:25], v[112:115], 0
    ds_write_b64 v252, v[76:77] offset:2048
    v_mfma_f32_16x16x32_bf16 v[26:29], v[22:25], v[120:123], v[26:29]
    v_exp_f32 v48, v48
    v_mfma_f32_16x16x32_bf16 v[30:33], v[22:25], v[116:119], 0
    v_exp_f32 v49, v49
    v_mfma_f32_16x16x32_bf16 v[30:33], v[22:25], v[124:127], v[30:33]
    v_exp_f32 v50, v50
    v_mfma_f32_16x16x32_bf16 v[34:37], v[22:25], a[144:147], 0
    v_fma_f32 v51, v51, s24, -v13
    v_cvt_pk_bf16_f32 v128, v48, v49
    v_mfma_f32_16x16x32_bf16 v[34:37], v[22:25], a[148:151], v[34:37]
    s_waitcnt lgkmcnt(9)
    v_exp_f32 v51, v51
    v_mfma_f32_16x16x32_bf16 v[84:87], a[240:243], a[16:19], v[84:87]
    v_cvt_pk_bf16_f32 v129, v50, v51
    v_fma_f32 v56, v56, s24, -v14
    v_mfma_f32_16x16x32_bf16 v[84:87], a[244:247], a[20:23], v[84:87]
    v_exp_f32 v56, v56
    v_mfma_f32_16x16x32_bf16 v[92:95], a[240:243], a[48:51], v[92:95]
    ds_read_b128 a[240:243], v1 offset:256
    v_fma_f32 v57, v57, s24, -v14
    v_mfma_f32_16x16x32_bf16 v[92:95], a[244:247], a[52:55], v[92:95]
    s_waitcnt lgkmcnt(6)
    ds_read_b128 a[244:247], v2 offset:256
    v_fma_f32 v58, v58, s24, -v14
    v_mfma_f32_16x16x32_bf16 v[84:87], a[248:251], a[24:27], v[84:87]
    buffer_store_dwordx4 v[224:227], v12, s[20:23], s50 offen nt
    v_mfma_f32_16x16x32_bf16 v[84:87], a[252:255], a[28:31], v[84:87]
    s_add_u32 s50, s11, 69632
    v_exp_f32 v57, v57
    v_mfma_f32_16x16x32_bf16 v[92:95], a[248:251], a[56:59], v[92:95]
    ds_read_b128 a[248:251], v3 offset:256
    v_fma_f32 v59, v59, s24, -v14
    v_mfma_f32_16x16x32_bf16 v[92:95], a[252:255], a[60:63], v[92:95]
    s_waitcnt lgkmcnt(6)
    v_exp_f32 v58, v58
    v_mfma_f32_16x16x32_bf16 v[48:51], a[128:131], a[0:3], 0
    s_waitcnt vmcnt(7)
    ds_read_b128 a[252:255], v4 offset:256
    v_cvt_pk_bf16_f32 v132, v56, v57
    v_mfma_f32_16x16x32_bf16 v[48:51], a[132:135], a[4:7], v[48:51]
    s_add_u32 m0, s30, 49152
    v_exp_f32 v59, v59
    s_nop 0
    v_cvt_pk_bf16_f32 v133, v58, v59
    v_mfma_f32_16x16x32_bf16 v[56:59], a[128:131], a[32:35], 0
    s_xor_b32 s48, s29, 114688
    ds_read_b128 a[128:131], v1 offset:2048
    v_fma_f32 v52, v52, s24, -v13
    v_mfma_f32_16x16x32_bf16 v[56:59], a[132:135], a[36:39], v[56:59]
    s_waitcnt lgkmcnt(6)
    ds_read_b128 a[132:135], v2 offset:2048
    v_fma_f32 v53, v53, s24, -v13
    v_mfma_f32_16x16x32_bf16 v[48:51], a[136:139], a[8:11], v[48:51]
    v_exp_f32 v52, v52
    v_mfma_f32_16x16x32_bf16 v[48:51], a[140:143], a[12:15], v[48:51]
    v_exp_f32 v53, v53
    v_mfma_f32_16x16x32_bf16 v[56:59], a[136:139], a[40:43], v[56:59]
    ds_read_b128 a[136:139], v3 offset:2048
    v_fma_f32 v54, v54, s24, -v13
    v_mfma_f32_16x16x32_bf16 v[56:59], a[140:143], a[44:47], v[56:59]
    s_waitcnt lgkmcnt(5)
    ds_read_b128 a[140:143], v4 offset:2048
    v_fma_f32 v55, v55, s24, -v13
    v_mfma_f32_16x16x32_bf16 v[48:51], a[240:243], a[16:19], v[48:51]
    s_barrier
    ds_read_b128 a[208:211], v248 offset:0
    v_cvt_pk_bf16_f32 v130, v52, v53
    v_mfma_f32_16x16x32_bf16 v[48:51], a[244:247], a[20:23], v[48:51]
    buffer_load_dwordx4 v7, s[12:15], s48 offen offset:0 lds
    v_mfma_f32_16x16x32_bf16 v[56:59], a[240:243], a[48:51], v[56:59]
    ds_read_b128 a[240:243], v1 offset:2304
    ds_read_b128 a[212:215], v249 offset:0
    v_mfma_f32_16x16x32_bf16 v[56:59], a[244:247], a[52:55], v[56:59]
    s_waitcnt lgkmcnt(7)
    ds_read_b128 a[244:247], v2 offset:2304
    ds_read_b128 a[216:219], v250 offset:0
    v_mfma_f32_16x16x32_bf16 v[48:51], a[248:251], a[24:27], v[48:51]
    buffer_load_dwordx4 v7, s[12:15], s48 offen offset:1024 lds
    v_mfma_f32_16x16x32_bf16 v[48:51], a[252:255], a[28:31], v[48:51]
L_t3_1:
    s_cbranch_execz L_t3_5
    ds_read_b128 a[220:223], v251 offset:0
    v_fma_f32 v60, v60, s24, -v14
    v_mfma_f32_16x16x32_bf16 v[56:59], a[248:251], a[56:59], v[56:59]
    ds_read_b128 a[248:251], v3 offset:2304
    ds_read_b128 a[224:227], v248 offset:256
    v_mfma_f32_16x16x32_bf16 v[56:59], a[252:255], a[60:63], v[56:59]
    s_waitcnt lgkmcnt(10)
    ds_read_b128 a[252:255], v4 offset:2304
    ds_read_b128 a[228:231], v249 offset:256
    v_exp_f32 v54, v54
    v_exp_f32 v55, v55
    s_nop 0
    v_cvt_pk_bf16_f32 v131, v54, v55
    v_mfma_f32_16x16x32_bf16 v[52:55], a[128:131], a[0:3], 0
    buffer_load_dwordx4 v7, s[12:15], s48 offen offset:2048 lds
    v_mfma_f32_16x16x32_bf16 v[52:55], a[132:135], a[4:7], v[52:55]
    ds_read_b128 a[232:235], v250 offset:256
    v_fma_f32 v61, v61, s24, -v14
    v_fma_f32 v62, v62, s24, -v14
    v_fma_f32 v63, v63, s24, -v14
    v_exp_f32 v60, v60
    v_exp_f32 v61, v61
    v_exp_f32 v62, v62
    v_exp_f32 v63, v63
    v_cvt_pk_bf16_f32 v134, v60, v61
    v_cvt_pk_bf16_f32 v135, v62, v63
    v_mfma_f32_16x16x32_bf16 v[60:63], a[128:131], a[32:35], 0
    ds_read_b128 a[128:131], v1 offset:16384
    ds_read_b128 a[236:239], v251 offset:256
    v_mfma_f32_16x16x32_bf16 v[60:63], a[132:135], a[36:39], v[60:63]
    s_waitcnt lgkmcnt(13)
    ds_read_b128 a[132:135], v2 offset:16384
    ds_read_b128 a[152:155], v253 offset:2048
    v_mfma_f32_16x16x32_bf16 v[52:55], a[136:139], a[8:11], v[52:55]
    buffer_store_dwordx4 v[228:231], v12, s[20:23], s50 offen nt
    v_mfma_f32_16x16x32_bf16 v[52:55], a[140:143], a[12:15], v[52:55]
    s_add_u32 s50, s11, 98304
    ds_read_b128 a[156:159], v253 offset:3072
    v_fma_f32 v80, v80, s24, -v13
    v_mfma_f32_16x16x32_bf16 v[60:63], a[136:139], a[40:43], v[60:63]
    ds_read_b128 a[136:139], v3 offset:16384
    v_fma_f32 v81, v81, s24, -v13
    v_mfma_f32_16x16x32_bf16 v[60:63], a[140:143], a[44:47], v[60:63]
    s_waitcnt lgkmcnt(13)
    ds_read_b128 a[140:143], v4 offset:16384
    v_fma_f32 v82, v82, s24, -v13
    v_mfma_f32_16x16x32_bf16 v[52:55], a[240:243], a[16:19], v[52:55]
    buffer_load_dwordx4 v7, s[12:15], s48 offen offset:3072 lds
    v_mfma_f32_16x16x32_bf16 v[52:55], a[244:247], a[20:23], v[52:55]
    v_exp_f32 v80, v80
    v_mfma_f32_16x16x32_bf16 v[60:63], a[240:243], a[48:51], v[60:63]
    ds_read_b128 a[240:243], v1 offset:16640
    v_fma_f32 v83, v83, s24, -v13
    v_mfma_f32_16x16x32_bf16 v[60:63], a[244:247], a[52:55], v[60:63]
    s_waitcnt lgkmcnt(10)
    ds_read_b128 a[244:247], v2 offset:16640
    v_fma_f32 v88, v88, s24, -v14
    v_mfma_f32_16x16x32_bf16 v[52:55], a[248:251], a[24:27], v[52:55]
    v_exp_f32 v81, v81
    v_mfma_f32_16x16x32_bf16 v[52:55], a[252:255], a[28:31], v[52:55]
    v_exp_f32 v82, v82
    v_mfma_f32_16x16x32_bf16 v[60:63], a[248:251], a[56:59], v[60:63]
    ds_read_b128 a[248:251], v3 offset:16640
    v_cvt_pk_bf16_f32 v136, v80, v81
    v_mfma_f32_16x16x32_bf16 v[60:63], a[252:255], a[60:63], v[60:63]
    v_exp_f32 v83, v83
    v_mfma_f32_16x16x32_bf16 v[72:75], a[208:211], a[64:67], 0
    v_exp_f32 v88, v88
    v_mfma_f32_16x16x32_bf16 v[72:75], a[212:215], a[68:71], v[72:75]
    v_cvt_pk_bf16_f32 v137, v82, v83
    v_fma_f32 v89, v89, s24, -v14
    v_mfma_f32_16x16x32_bf16 v[72:75], a[216:219], a[72:75], v[72:75]
    v_exp_f32 v89, v89
    v_mfma_f32_16x16x32_bf16 v[72:75], a[220:223], a[76:79], v[72:75]
    v_fma_f32 v90, v90, s24, -v14
    v_fma_f32 v91, v91, s24, -v14
    v_mfma_f32_16x16x32_bf16 v[72:75], a[224:227], a[80:83], v[72:75]
    v_exp_f32 v90, v90
    s_waitcnt lgkmcnt(11)
    v_mfma_f32_16x16x32_bf16 v[72:75], a[228:231], a[84:87], v[72:75]
    v_exp_f32 v91, v91
    s_waitcnt lgkmcnt(10)
    v_mfma_f32_16x16x32_bf16 v[72:75], a[232:235], a[88:91], v[72:75]
    v_cvt_pk_bf16_f32 v140, v88, v89
    v_cvt_pk_bf16_f32 v141, v90, v91
    s_waitcnt lgkmcnt(8)
    v_mfma_f32_16x16x32_bf16 v[72:75], a[236:239], a[92:95], v[72:75]
    s_waitcnt lgkmcnt(7)
    s_nop 0
    v_fma_f32 v84, v84, s24, -v13
    v_fma_f32 v85, v85, s24, -v13
    buffer_store_dwordx4 v[232:235], v12, s[20:23], s50 offen nt
    s_add_u32 s50, s11, 102400
    buffer_store_dwordx4 v[236:239], v12, s[20:23], s50 offen nt
    v_mfma_f32_16x16x32_bf16 v[80:83], a[128:131], a[0:3], 0
    s_add_u32 s20, s46, s73
    s_addc_u32 s21, s47, 0
    ds_read_b128 a[252:255], v4 offset:16640
    v_fma_f32 v72, v72, s24, -v15
    v_mfma_f32_16x16x32_bf16 v[80:83], a[132:135], a[4:7], v[80:83]
    s_mov_b32 s22, s74
    v_exp_f32 v72, v72
    v_mfma_f32_16x16x32_bf16 v[88:91], a[128:131], a[32:35], 0
    s_lshl_b32 s41, s52, 7
    ds_read_b128 a[128:131], v1 offset:18432
    v_fma_f32 v73, v73, s24, -v15
    v_mfma_f32_16x16x32_bf16 v[88:91], a[132:135], a[36:39], v[88:91]
    s_waitcnt lgkmcnt(5)
    ds_read_b128 a[132:135], v2 offset:18432
    v_fma_f32 v74, v74, s24, -v15
    v_mfma_f32_16x16x32_bf16 v[80:83], a[136:139], a[8:11], v[80:83]
    s_and_b32 s8, s41, 384
    v_exp_f32 v73, v73
    v_mfma_f32_16x16x32_bf16 v[80:83], a[140:143], a[12:15], v[80:83]
    s_xor_b32 s9, s8, 128
    v_exp_f32 v74, v74
    v_mfma_f32_16x16x32_bf16 v[88:91], a[136:139], a[40:43], v[88:91]
    s_xor_b32 s10, s8, 256
    ds_read_b128 a[136:139], v3 offset:18432
    v_fma_f32 v75, v75, s24, -v15
    v_mfma_f32_16x16x32_bf16 v[88:91], a[140:143], a[44:47], v[88:91]
    s_waitcnt lgkmcnt(5)
    ds_read_b128 a[140:143], v4 offset:18432
    v_cvt_pk_bf16_f32 v72, v72, v73
    v_mfma_f32_16x16x32_bf16 v[80:83], a[240:243], a[16:19], v[80:83]
    s_xor_b32 s11, s8, 384
    v_exp_f32 v75, v75
    v_mfma_f32_16x16x32_bf16 v[80:83], a[244:247], a[20:23], v[80:83]
    s_andn2_b32 s41, s29, 0xc000
    v_exp_f32 v84, v84
    v_mfma_f32_16x16x32_bf16 v[88:91], a[240:243], a[48:51], v[88:91]
    s_add_u32 s4, s41, s8
    ds_read_b128 a[240:243], v1 offset:18688
    v_cvt_pk_bf16_f32 v73, v74, v75
    v_mfma_f32_16x16x32_bf16 v[88:91], a[244:247], a[52:55], v[88:91]
    s_waitcnt lgkmcnt(5)
    ds_read_b128 a[244:247], v2 offset:18688
    v_fma_f32 v86, v86, s24, -v13
    v_mfma_f32_16x16x32_bf16 v[80:83], a[248:251], a[24:27], v[80:83]
    s_add_u32 s5, s41, s9
    ds_write_b64 v252, v[72:73] offset:0
    v_mfma_f32_16x16x32_bf16 v[80:83], a[252:255], a[28:31], v[80:83]
    s_add_u32 s6, s41, s10
    v_exp_f32 v85, v85
    v_mfma_f32_16x16x32_bf16 v[88:91], a[248:251], a[56:59], v[88:91]
    s_add_u32 s7, s41, s11
    ds_read_b128 a[248:251], v3 offset:18688
    v_fma_f32 v87, v87, s24, -v13
    v_mfma_f32_16x16x32_bf16 v[88:91], a[252:255], a[60:63], v[88:91]
    s_waitcnt lgkmcnt(6)
    ds_read_b128 a[252:255], v4 offset:18688
    v_cvt_pk_bf16_f32 v138, v84, v85
    v_exp_f32 v86, v86
    v_exp_f32 v87, v87
    s_nop 0
    v_cvt_pk_bf16_f32 v139, v86, v87
    v_mfma_f32_16x16x32_bf16 v[84:87], a[128:131], a[0:3], 0
    s_waitcnt vmcnt(8)
    v_fma_f32 v92, v92, s24, -v14
    v_fma_f32 v93, v93, s24, -v14
    v_mfma_f32_16x16x32_bf16 v[84:87], a[132:135], a[4:7], v[84:87]
    s_barrier
    v_exp_f32 v92, v92
    v_fma_f32 v94, v94, s24, -v14
    v_fma_f32 v95, v95, s24, -v14
    v_exp_f32 v93, v93
    v_exp_f32 v94, v94
    v_exp_f32 v95, v95
    v_cvt_pk_bf16_f32 v142, v92, v93
    v_cvt_pk_bf16_f32 v143, v94, v95
    v_mfma_f32_16x16x32_bf16 v[92:95], a[128:131], a[32:35], 0
    s_add_u32 m0, s30, 0
    ds_read_b128 a[128:131], v1 offset:32768
    v_fma_f32 v48, v48, s24, -v13
    v_mfma_f32_16x16x32_bf16 v[92:95], a[132:135], a[36:39], v[92:95]
    s_waitcnt lgkmcnt(6)
    ds_read_b128 a[132:135], v2 offset:32768
    v_fma_f32 v49, v49, s24, -v13
    v_mfma_f32_16x16x32_bf16 v[84:87], a[136:139], a[8:11], v[84:87]
    s_xor_b32 s48, s29, 131072
    v_exp_f32 v48, v48
    v_mfma_f32_16x16x32_bf16 v[84:87], a[140:143], a[12:15], v[84:87]
    buffer_load_dwordx4 v7, s[12:15], s48 offen offset:0 lds
    v_mfma_f32_16x16x32_bf16 v[92:95], a[136:139], a[40:43], v[92:95]
    ds_read_b128 a[136:139], v3 offset:32768
    v_fma_f32 v50, v50, s24, -v13
    v_mfma_f32_16x16x32_bf16 v[92:95], a[140:143], a[44:47], v[92:95]
    ds_read_b128 a[140:143], v4 offset:32768
    v_fma_f32 v51, v51, s24, -v13
    v_mfma_f32_16x16x32_bf16 v[26:29], v[22:25], v[128:131], v[26:29]
    buffer_load_dwordx4 v7, s[12:15], s48 offen offset:1024 lds
    v_mfma_f32_16x16x32_bf16 v[26:29], v[22:25], v[136:139], v[26:29]
    v_exp_f32 v49, v49
    v_mfma_f32_16x16x32_bf16 v[30:33], v[22:25], v[132:135], v[30:33]
    v_exp_f32 v50, v50
    v_mfma_f32_16x16x32_bf16 v[30:33], v[22:25], v[140:143], v[30:33]
    buffer_load_dwordx4 v7, s[12:15], s48 offen offset:2048 lds
    v_mfma_f32_16x16x32_bf16 v[34:37], v[22:25], a[152:155], v[34:37]
    v_exp_f32 v51, v51
    v_mfma_f32_16x16x32_bf16 v[34:37], v[22:25], a[156:159], v[34:37]
    s_waitcnt lgkmcnt(7)
    v_cvt_pk_bf16_f32 v144, v48, v49
    v_cvt_pk_bf16_f32 v145, v50, v51
    v_mfma_f32_16x16x32_bf16 v[84:87], a[240:243], a[16:19], v[84:87]
    buffer_load_dwordx4 v7, s[12:15], s48 offen offset:3072 lds
    v_mfma_f32_16x16x32_bf16 v[84:87], a[244:247], a[20:23], v[84:87]
    v_fma_f32 v56, v56, s24, -v14
    v_fma_f32 v57, v57, s24, -v14
    v_mfma_f32_16x16x32_bf16 v[92:95], a[240:243], a[48:51], v[92:95]
    ds_read_b128 a[240:243], v1 offset:33024
    v_fma_f32 v58, v58, s24, -v14
    v_mfma_f32_16x16x32_bf16 v[92:95], a[244:247], a[52:55], v[92:95]
    s_waitcnt lgkmcnt(5)
    ds_read_b128 a[244:247], v2 offset:33024
    v_fma_f32 v59, v59, s24, -v14
    v_mfma_f32_16x16x32_bf16 v[84:87], a[248:251], a[24:27], v[84:87]
    v_exp_f32 v56, v56
    v_mfma_f32_16x16x32_bf16 v[84:87], a[252:255], a[28:31], v[84:87]
    v_exp_f32 v57, v57
    v_mfma_f32_16x16x32_bf16 v[92:95], a[248:251], a[56:59], v[92:95]
    ds_read_b128 a[248:251], v3 offset:33024
    v_cvt_pk_bf16_f32 v148, v56, v57
    v_mfma_f32_16x16x32_bf16 v[92:95], a[252:255], a[60:63], v[92:95]
    s_waitcnt lgkmcnt(5)
    v_exp_f32 v58, v58
    v_mfma_f32_16x16x32_bf16 v[48:51], a[128:131], a[0:3], 0
    s_waitcnt vmcnt(6)
    ds_read_b128 a[252:255], v4 offset:33024
    v_fma_f32 v52, v52, s24, -v13
    v_mfma_f32_16x16x32_bf16 v[48:51], a[132:135], a[4:7], v[48:51]
    s_barrier
    ds_read_b128 a[208:211], v248 offset:32768
    v_fma_f32 v53, v53, s24, -v13
    v_exp_f32 v59, v59
    s_nop 0
    v_cvt_pk_bf16_f32 v149, v58, v59
    v_mfma_f32_16x16x32_bf16 v[56:59], a[128:131], a[32:35], 0
    s_add_u32 m0, s30, 16384
    ds_read_b128 a[128:131], v1 offset:34816
    ds_read_b128 a[212:215], v249 offset:32768
    v_mfma_f32_16x16x32_bf16 v[56:59], a[132:135], a[36:39], v[56:59]
    s_waitcnt lgkmcnt(7)
    ds_read_b128 a[132:135], v2 offset:34816
    ds_read_b128 a[216:219], v250 offset:32768
    v_mfma_f32_16x16x32_bf16 v[48:51], a[136:139], a[8:11], v[48:51]
    s_xor_b32 s48, s29, 147456
    ds_read_b128 a[220:223], v251 offset:32768
    v_fma_f32 v54, v54, s24, -v13
    v_mfma_f32_16x16x32_bf16 v[48:51], a[140:143], a[12:15], v[48:51]
    buffer_load_dwordx4 v7, s[12:15], s48 offen offset:0 lds
    v_mfma_f32_16x16x32_bf16 v[56:59], a[136:139], a[40:43], v[56:59]
    ds_read_b128 a[136:139], v3 offset:34816
    ds_read_b128 a[224:227], v248 offset:33024
    v_mfma_f32_16x16x32_bf16 v[56:59], a[140:143], a[44:47], v[56:59]
    s_waitcnt lgkmcnt(10)
    ds_read_b128 a[140:143], v4 offset:34816
    ds_read_b128 a[228:231], v249 offset:33024
    v_mfma_f32_16x16x32_bf16 v[48:51], a[240:243], a[16:19], v[48:51]
    buffer_load_dwordx4 v7, s[12:15], s48 offen offset:1024 lds
    v_mfma_f32_16x16x32_bf16 v[48:51], a[244:247], a[20:23], v[48:51]
    ds_read_b128 a[232:235], v250 offset:33024
    v_fma_f32 v55, v55, s24, -v13
    v_mfma_f32_16x16x32_bf16 v[56:59], a[240:243], a[48:51], v[56:59]
    ds_read_b128 a[240:243], v1 offset:35072
    ds_read_b128 a[236:239], v251 offset:33024
    v_mfma_f32_16x16x32_bf16 v[56:59], a[244:247], a[52:55], v[56:59]
    s_waitcnt lgkmcnt(13)
    ds_read_b128 a[244:247], v2 offset:35072
    ds_read_b128 a[160:163], v253 offset:0
    v_mfma_f32_16x16x32_bf16 v[48:51], a[248:251], a[24:27], v[48:51]
    buffer_load_dwordx4 v7, s[12:15], s48 offen offset:2048 lds
    v_mfma_f32_16x16x32_bf16 v[48:51], a[252:255], a[28:31], v[48:51]
    ds_read_b128 a[164:167], v253 offset:1024
    v_fma_f32 v60, v60, s24, -v14
    v_mfma_f32_16x16x32_bf16 v[56:59], a[248:251], a[56:59], v[56:59]
    ds_read_b128 a[248:251], v3 offset:35072
    v_fma_f32 v61, v61, s24, -v14
    v_mfma_f32_16x16x32_bf16 v[56:59], a[252:255], a[60:63], v[56:59]
    s_waitcnt lgkmcnt(13)
    ds_read_b128 a[252:255], v4 offset:35072
    v_fma_f32 v62, v62, s24, -v14
    v_exp_f32 v52, v52
    v_exp_f32 v53, v53
    v_exp_f32 v54, v54
    v_exp_f32 v55, v55
    v_cvt_pk_bf16_f32 v146, v52, v53
    v_cvt_pk_bf16_f32 v147, v54, v55
    v_mfma_f32_16x16x32_bf16 v[52:55], a[128:131], a[0:3], 0
    buffer_load_dwordx4 v7, s[12:15], s48 offen offset:3072 lds
    v_mfma_f32_16x16x32_bf16 v[52:55], a[132:135], a[4:7], v[52:55]
    v_exp_f32 v60, v60
    v_fma_f32 v63, v63, s24, -v14
    v_exp_f32 v61, v61
    v_exp_f32 v62, v62
    v_exp_f32 v63, v63
    v_cvt_pk_bf16_f32 v150, v60, v61
    v_cvt_pk_bf16_f32 v151, v62, v63
    v_mfma_f32_16x16x32_bf16 v[60:63], a[128:131], a[32:35], 0
    ds_read_b128 a[128:131], v1 offset:49152
    v_fma_f32 v80, v80, s24, -v13
    v_mfma_f32_16x16x32_bf16 v[60:63], a[132:135], a[36:39], v[60:63]
    s_waitcnt lgkmcnt(10)
    ds_read_b128 a[132:135], v2 offset:49152
    v_fma_f32 v81, v81, s24, -v13
    v_mfma_f32_16x16x32_bf16 v[52:55], a[136:139], a[8:11], v[52:55]
    v_exp_f32 v80, v80
    v_mfma_f32_16x16x32_bf16 v[52:55], a[140:143], a[12:15], v[52:55]
    v_exp_f32 v81, v81
    v_mfma_f32_16x16x32_bf16 v[60:63], a[136:139], a[40:43], v[60:63]
    ds_read_b128 a[136:139], v3 offset:49152
    v_fma_f32 v82, v82, s24, -v13
    v_mfma_f32_16x16x32_bf16 v[60:63], a[140:143], a[44:47], v[60:63]
    s_waitcnt lgkmcnt(7)
    ds_read_b128 a[140:143], v4 offset:49152
    v_fma_f32 v83, v83, s24, -v13
    v_mfma_f32_16x16x32_bf16 v[52:55], a[240:243], a[16:19], v[52:55]
    v_exp_f32 v82, v82
    v_mfma_f32_16x16x32_bf16 v[52:55], a[244:247], a[20:23], v[52:55]
    v_exp_f32 v83, v83
    v_mfma_f32_16x16x32_bf16 v[60:63], a[240:243], a[48:51], v[60:63]
    ds_read_b128 a[240:243], v1 offset:49408
    v_cvt_pk_bf16_f32 v152, v80, v81
    v_mfma_f32_16x16x32_bf16 v[60:63], a[244:247], a[52:55], v[60:63]
    s_waitcnt lgkmcnt(5)
    ds_read_b128 a[244:247], v2 offset:49408
    v_cvt_pk_bf16_f32 v153, v82, v83
    v_mfma_f32_16x16x32_bf16 v[52:55], a[248:251], a[24:27], v[52:55]
    v_fma_f32 v88, v88, s24, -v14
    v_fma_f32 v89, v89, s24, -v14
    v_mfma_f32_16x16x32_bf16 v[52:55], a[252:255], a[28:31], v[52:55]
    v_exp_f32 v88, v88
    v_mfma_f32_16x16x32_bf16 v[60:63], a[248:251], a[56:59], v[60:63]
    ds_read_b128 a[248:251], v3 offset:49408
    v_fma_f32 v90, v90, s24, -v14
    v_mfma_f32_16x16x32_bf16 v[60:63], a[252:255], a[60:63], v[60:63]
    v_exp_f32 v89, v89
    v_mfma_f32_16x16x32_bf16 v[76:79], a[208:211], a[64:67], 0
    v_exp_f32 v90, v90
    v_mfma_f32_16x16x32_bf16 v[76:79], a[212:215], a[68:71], v[76:79]
    v_fma_f32 v91, v91, s24, -v14
    v_cvt_pk_bf16_f32 v156, v88, v89
    v_mfma_f32_16x16x32_bf16 v[76:79], a[216:219], a[72:75], v[76:79]
    v_exp_f32 v91, v91
    v_mfma_f32_16x16x32_bf16 v[76:79], a[220:223], a[76:79], v[76:79]
    v_cvt_pk_bf16_f32 v157, v90, v91
    v_fma_f32 v84, v84, s24, -v13
    v_mfma_f32_16x16x32_bf16 v[76:79], a[224:227], a[80:83], v[76:79]
    v_exp_f32 v84, v84
    v_mfma_f32_16x16x32_bf16 v[76:79], a[228:231], a[84:87], v[76:79]
    v_fma_f32 v85, v85, s24, -v13
    v_fma_f32 v86, v86, s24, -v13
    v_mfma_f32_16x16x32_bf16 v[76:79], a[232:235], a[88:91], v[76:79]
    v_exp_f32 v85, v85
    v_mfma_f32_16x16x32_bf16 v[76:79], a[236:239], a[92:95], v[76:79]
    s_waitcnt lgkmcnt(5)
    v_exp_f32 v86, v86
    v_mfma_f32_16x16x32_bf16 v[80:83], a[128:131], a[0:3], 0
    s_waitcnt vmcnt(4)
    ds_read_b128 a[252:255], v4 offset:49408
    v_fma_f32 v87, v87, s24, -v13
    v_mfma_f32_16x16x32_bf16 v[80:83], a[132:135], a[4:7], v[80:83]
    s_barrier
    v_exp_f32 v87, v87
    v_mfma_f32_16x16x32_bf16 v[88:91], a[128:131], a[32:35], 0
    s_add_u32 m0, s30, 32768
    ds_read_b128 a[128:131], v1 offset:51200
    v_fma_f32 v76, v76, s24, -v15
    v_mfma_f32_16x16x32_bf16 v[88:91], a[132:135], a[36:39], v[88:91]
    s_waitcnt lgkmcnt(5)
    ds_read_b128 a[132:135], v2 offset:51200
    v_fma_f32 v77, v77, s24, -v15
    v_mfma_f32_16x16x32_bf16 v[80:83], a[136:139], a[8:11], v[80:83]
    s_xor_b32 s48, s29, 163840
    v_exp_f32 v76, v76
    v_mfma_f32_16x16x32_bf16 v[80:83], a[140:143], a[12:15], v[80:83]
    buffer_load_dwordx4 v7, s[12:15], s48 offen offset:0 lds
    v_mfma_f32_16x16x32_bf16 v[88:91], a[136:139], a[40:43], v[88:91]
    ds_read_b128 a[136:139], v3 offset:51200
    v_fma_f32 v78, v78, s24, -v15
    v_mfma_f32_16x16x32_bf16 v[88:91], a[140:143], a[44:47], v[88:91]
    s_waitcnt lgkmcnt(5)
    ds_read_b128 a[140:143], v4 offset:51200
    v_fma_f32 v79, v79, s24, -v15
    v_mfma_f32_16x16x32_bf16 v[80:83], a[240:243], a[16:19], v[80:83]
    buffer_load_dwordx4 v7, s[12:15], s48 offen offset:1024 lds
    v_mfma_f32_16x16x32_bf16 v[80:83], a[244:247], a[20:23], v[80:83]
    v_exp_f32 v77, v77
    v_mfma_f32_16x16x32_bf16 v[88:91], a[240:243], a[48:51], v[88:91]
    ds_read_b128 a[240:243], v1 offset:51456
    v_cvt_pk_bf16_f32 v76, v76, v77
    v_mfma_f32_16x16x32_bf16 v[88:91], a[244:247], a[52:55], v[88:91]
    s_waitcnt lgkmcnt(5)
    ds_read_b128 a[244:247], v2 offset:51456
    v_cvt_pk_bf16_f32 v154, v84, v85
    v_mfma_f32_16x16x32_bf16 v[80:83], a[248:251], a[24:27], v[80:83]
    buffer_load_dwordx4 v7, s[12:15], s48 offen offset:2048 lds
    v_mfma_f32_16x16x32_bf16 v[80:83], a[252:255], a[28:31], v[80:83]
    v_exp_f32 v78, v78
    v_mfma_f32_16x16x32_bf16 v[88:91], a[248:251], a[56:59], v[88:91]
    ds_read_b128 a[248:251], v3 offset:51456
    v_cvt_pk_bf16_f32 v155, v86, v87
    v_mfma_f32_16x16x32_bf16 v[88:91], a[252:255], a[60:63], v[88:91]
    s_waitcnt lgkmcnt(5)
    ds_read_b128 a[252:255], v4 offset:51456
    v_fma_f32 v92, v92, s24, -v14
    v_mfma_f32_16x16x32_bf16 v[84:87], a[128:131], a[0:3], 0
    buffer_load_dwordx4 v7, s[12:15], s48 offen offset:3072 lds
    v_mfma_f32_16x16x32_bf16 v[84:87], a[132:135], a[4:7], v[84:87]
    v_exp_f32_e64 v79, v79
    v_fma_f32 v93, v93, s24, -v14
    v_fma_f32 v94, v94, s24, -v14
    v_fma_f32 v95, v95, s24, -v14
    v_exp_f32 v92, v92
    v_exp_f32 v93, v93
    v_exp_f32 v94, v94
    v_exp_f32 v95, v95
    v_cvt_pk_bf16_f32 v158, v92, v93
    v_cvt_pk_bf16_f32 v159, v94, v95
    v_mfma_f32_16x16x32_bf16 v[92:95], a[128:131], a[32:35], 0
    ds_read_b128 a[128:131], v1 offset:0
    v_cvt_pk_bf16_f32 v77, v78, v79
    v_mfma_f32_16x16x32_bf16 v[92:95], a[132:135], a[36:39], v[92:95]
    s_waitcnt lgkmcnt(5)
    ds_read_b128 a[132:135], v2 offset:0
    v_fma_f32 v48, v48, s24, -v13
    v_mfma_f32_16x16x32_bf16 v[84:87], a[136:139], a[8:11], v[84:87]
    ds_write_b64 v252, v[76:77] offset:2048
    v_mfma_f32_16x16x32_bf16 v[84:87], a[140:143], a[12:15], v[84:87]
    v_exp_f32 v48, v48
    v_mfma_f32_16x16x32_bf16 v[92:95], a[136:139], a[40:43], v[92:95]
    ds_read_b128 a[136:139], v3 offset:0
    v_fma_f32 v49, v49, s24, -v13
    v_mfma_f32_16x16x32_bf16 v[92:95], a[140:143], a[44:47], v[92:95]
    ds_read_b128 a[140:143], v4 offset:0
    v_fma_f32 v50, v50, s24, -v13
    v_mfma_f32_16x16x32_bf16 v[26:29], v[22:25], v[144:147], v[26:29]
    v_exp_f32 v49, v49
    v_mfma_f32_16x16x32_bf16 v[26:29], v[22:25], v[152:155], v[26:29]
    v_exp_f32 v50, v50
    v_mfma_f32_16x16x32_bf16 v[30:33], v[22:25], v[148:151], v[30:33]
    v_fma_f32 v51, v51, s24, -v13
    v_cvt_pk_bf16_f32 v160, v48, v49
    v_mfma_f32_16x16x32_bf16 v[30:33], v[22:25], v[156:159], v[30:33]
    v_exp_f32 v51, v51
    v_mfma_f32_16x16x32_bf16 v[34:37], v[22:25], a[160:163], v[34:37]
    v_cvt_pk_bf16_f32 v161, v50, v51
    v_fma_f32 v56, v56, s24, -v14
    v_mfma_f32_16x16x32_bf16 v[34:37], v[22:25], a[164:167], v[34:37]
    s_waitcnt lgkmcnt(7)
    v_exp_f32 v56, v56
    v_mfma_f32_16x16x32_bf16 v[84:87], a[240:243], a[16:19], v[84:87]
    v_fma_f32 v57, v57, s24, -v14
    v_fma_f32 v58, v58, s24, -v14
    v_mfma_f32_16x16x32_bf16 v[84:87], a[244:247], a[20:23], v[84:87]
    v_exp_f32 v57, v57
    v_mfma_f32_16x16x32_bf16 v[92:95], a[240:243], a[48:51], v[92:95]
    ds_read_b128 a[240:243], v1 offset:256
    v_fma_f32 v59, v59, s24, -v14
    v_mfma_f32_16x16x32_bf16 v[92:95], a[244:247], a[52:55], v[92:95]
    s_waitcnt lgkmcnt(6)
    ds_read_b128 a[244:247], v2 offset:256
    v_cvt_pk_bf16_f32 v164, v56, v57
    v_mfma_f32_16x16x32_bf16 v[84:87], a[248:251], a[24:27], v[84:87]
    v_exp_f32 v58, v58
    v_mfma_f32_16x16x32_bf16 v[84:87], a[252:255], a[28:31], v[84:87]
    v_exp_f32 v59, v59
    v_mfma_f32_16x16x32_bf16 v[92:95], a[248:251], a[56:59], v[92:95]
    ds_read_b128 a[248:251], v3 offset:256
    v_cvt_pk_bf16_f32 v165, v58, v59
    v_mfma_f32_16x16x32_bf16 v[92:95], a[252:255], a[60:63], v[92:95]
    s_waitcnt lgkmcnt(6)
    v_fma_f32 v52, v52, s24, -v13
    v_fma_f32 v53, v53, s24, -v13
    v_mfma_f32_16x16x32_bf16 v[48:51], a[128:131], a[0:3], 0
    s_waitcnt vmcnt(4)
    ds_read_b128 a[252:255], v4 offset:256
    v_fma_f32 v54, v54, s24, -v13
    v_mfma_f32_16x16x32_bf16 v[48:51], a[132:135], a[4:7], v[48:51]
    s_add_u32 m0, s30, 49152
    v_exp_f32 v52, v52
    v_mfma_f32_16x16x32_bf16 v[56:59], a[128:131], a[32:35], 0
    s_xor_b32 s48, s29, 180224
    ds_read_b128 a[128:131], v1 offset:2048
    v_fma_f32 v55, v55, s24, -v13
    v_mfma_f32_16x16x32_bf16 v[56:59], a[132:135], a[36:39], v[56:59]
    s_waitcnt lgkmcnt(5)
    ds_read_b128 a[132:135], v2 offset:2048
    v_fma_f32 v60, v60, s24, -v14
    v_mfma_f32_16x16x32_bf16 v[48:51], a[136:139], a[8:11], v[48:51]
    s_barrier
    ds_read_b128 a[208:211], v248 offset:0
    v_fma_f32 v61, v61, s24, -v14
    v_mfma_f32_16x16x32_bf16 v[48:51], a[140:143], a[12:15], v[48:51]
    buffer_load_dwordx4 v7, s[12:15], s48 offen offset:0 lds
    v_mfma_f32_16x16x32_bf16 v[56:59], a[136:139], a[40:43], v[56:59]
    ds_read_b128 a[136:139], v3 offset:2048
    ds_read_b128 a[212:215], v249 offset:0
    v_mfma_f32_16x16x32_bf16 v[56:59], a[140:143], a[44:47], v[56:59]
    s_waitcnt lgkmcnt(7)
    ds_read_b128 a[140:143], v4 offset:2048
    ds_read_b128 a[216:219], v250 offset:0
    v_mfma_f32_16x16x32_bf16 v[48:51], a[240:243], a[16:19], v[48:51]
    buffer_load_dwordx4 v7, s[12:15], s48 offen offset:1024 lds
    v_mfma_f32_16x16x32_bf16 v[48:51], a[244:247], a[20:23], v[48:51]
    ds_read_b128 a[220:223], v251 offset:0
    v_fma_f32 v62, v62, s24, -v14
    v_mfma_f32_16x16x32_bf16 v[56:59], a[240:243], a[48:51], v[56:59]
    ds_read_b128 a[240:243], v1 offset:2304
    ds_read_b128 a[224:227], v248 offset:256
    v_mfma_f32_16x16x32_bf16 v[56:59], a[244:247], a[52:55], v[56:59]
    s_waitcnt lgkmcnt(10)
    ds_read_b128 a[244:247], v2 offset:2304
    ds_read_b128 a[228:231], v249 offset:256
    v_mfma_f32_16x16x32_bf16 v[48:51], a[248:251], a[24:27], v[48:51]
    buffer_load_dwordx4 v7, s[12:15], s48 offen offset:2048 lds
    v_mfma_f32_16x16x32_bf16 v[48:51], a[252:255], a[28:31], v[48:51]
    ds_read_b128 a[232:235], v250 offset:256
    v_fma_f32 v63, v63, s24, -v14
    v_mfma_f32_16x16x32_bf16 v[56:59], a[248:251], a[56:59], v[56:59]
    ds_read_b128 a[248:251], v3 offset:2304
    ds_read_b128 a[236:239], v251 offset:256
    v_mfma_f32_16x16x32_bf16 v[56:59], a[252:255], a[60:63], v[56:59]
    s_waitcnt lgkmcnt(13)
    ds_read_b128 a[252:255], v4 offset:2304
    ds_read_b128 a[168:171], v253 offset:2048
    v_exp_f32 v53, v53
    v_exp_f32 v54, v54
    v_exp_f32 v55, v55
    v_cvt_pk_bf16_f32 v162, v52, v53
    v_cvt_pk_bf16_f32 v163, v54, v55
    v_mfma_f32_16x16x32_bf16 v[52:55], a[128:131], a[0:3], 0
    buffer_load_dwordx4 v7, s[12:15], s48 offen offset:3072 lds
    v_mfma_f32_16x16x32_bf16 v[52:55], a[132:135], a[4:7], v[52:55]
    ds_read_b128 a[172:175], v253 offset:3072
    v_fma_f32 v80, v80, s24, -v13
    v_exp_f32 v60, v60
    v_exp_f32 v61, v61
    v_exp_f32 v62, v62
    v_exp_f32 v63, v63
    v_cvt_pk_bf16_f32 v166, v60, v61
    v_cvt_pk_bf16_f32 v167, v62, v63
    v_mfma_f32_16x16x32_bf16 v[60:63], a[128:131], a[32:35], 0
    ds_read_b128 a[128:131], v1 offset:16384
    v_fma_f32 v81, v81, s24, -v13
    v_mfma_f32_16x16x32_bf16 v[60:63], a[132:135], a[36:39], v[60:63]
    s_waitcnt lgkmcnt(13)
    ds_read_b128 a[132:135], v2 offset:16384
    v_fma_f32 v82, v82, s24, -v13
    v_mfma_f32_16x16x32_bf16 v[52:55], a[136:139], a[8:11], v[52:55]
    v_exp_f32 v80, v80
    v_mfma_f32_16x16x32_bf16 v[52:55], a[140:143], a[12:15], v[52:55]
    v_exp_f32 v81, v81
    v_mfma_f32_16x16x32_bf16 v[60:63], a[136:139], a[40:43], v[60:63]
    ds_read_b128 a[136:139], v3 offset:16384
    v_fma_f32 v83, v83, s24, -v13
    v_mfma_f32_16x16x32_bf16 v[60:63], a[140:143], a[44:47], v[60:63]
    s_waitcnt lgkmcnt(10)
    ds_read_b128 a[140:143], v4 offset:16384
    v_cvt_pk_bf16_f32 v168, v80, v81
    v_mfma_f32_16x16x32_bf16 v[52:55], a[240:243], a[16:19], v[52:55]
    v_exp_f32 v82, v82
    v_mfma_f32_16x16x32_bf16 v[52:55], a[244:247], a[20:23], v[52:55]
    v_exp_f32 v83, v83
    v_mfma_f32_16x16x32_bf16 v[60:63], a[240:243], a[48:51], v[60:63]
    ds_read_b128 a[240:243], v1 offset:16640
    v_cvt_pk_bf16_f32 v169, v82, v83
    v_mfma_f32_16x16x32_bf16 v[60:63], a[244:247], a[52:55], v[60:63]
    s_waitcnt lgkmcnt(7)
    ds_read_b128 a[244:247], v2 offset:16640
    v_fma_f32 v88, v88, s24, -v14
    v_mfma_f32_16x16x32_bf16 v[52:55], a[248:251], a[24:27], v[52:55]
    v_exp_f32 v88, v88
    v_mfma_f32_16x16x32_bf16 v[52:55], a[252:255], a[28:31], v[52:55]
    v_fma_f32 v89, v89, s24, -v14
    v_fma_f32 v90, v90, s24, -v14
    v_mfma_f32_16x16x32_bf16 v[60:63], a[248:251], a[56:59], v[60:63]
    ds_read_b128 a[248:251], v3 offset:16640
    v_fma_f32 v91, v91, s24, -v14
    v_mfma_f32_16x16x32_bf16 v[60:63], a[252:255], a[60:63], v[60:63]
L_t3_2:
    s_cbranch_execz L_t3_6
    v_exp_f32 v89, v89
    v_mfma_f32_16x16x32_bf16 v[72:75], a[208:211], a[64:67], 0
    v_exp_f32 v90, v90
    v_mfma_f32_16x16x32_bf16 v[72:75], a[212:215], a[68:71], v[72:75]
    v_exp_f32 v91, v91
    v_mfma_f32_16x16x32_bf16 v[72:75], a[216:219], a[72:75], v[72:75]
    v_cvt_pk_bf16_f32 v172, v88, v89
    v_cvt_pk_bf16_f32 v173, v90, v91
    v_mfma_f32_16x16x32_bf16 v[72:75], a[220:223], a[76:79], v[72:75]
    v_fma_f32 v84, v84, s24, -v13
    v_fma_f32 v85, v85, s24, -v13
    v_mfma_f32_16x16x32_bf16 v[72:75], a[224:227], a[80:83], v[72:75]
    v_exp_f32 v84, v84
    v_mfma_f32_16x16x32_bf16 v[72:75], a[228:231], a[84:87], v[72:75]
    v_exp_f32 v85, v85
    v_mfma_f32_16x16x32_bf16 v[72:75], a[232:235], a[88:91], v[72:75]
    v_fma_f32 v86, v86, s24, -v13
    v_fma_f32 v87, v87, s24, -v13
    v_mfma_f32_16x16x32_bf16 v[72:75], a[236:239], a[92:95], v[72:75]
    s_waitcnt lgkmcnt(5)
    v_exp_f32 v86, v86
    v_mfma_f32_16x16x32_bf16 v[80:83], a[128:131], a[0:3], 0
    s_waitcnt vmcnt(4)
    ds_read_b128 a[252:255], v4 offset:16640
    v_cvt_pk_bf16_f32 v170, v84, v85
    v_mfma_f32_16x16x32_bf16 v[80:83], a[132:135], a[4:7], v[80:83]
    s_barrier
    v_exp_f32 v87, v87
    v_mfma_f32_16x16x32_bf16 v[88:91], a[128:131], a[32:35], 0
    s_add_u32 m0, s30, 0
    ds_read_b128 a[128:131], v1 offset:18432
    v_fma_f32 v72, v72, s24, -v15
    v_mfma_f32_16x16x32_bf16 v[88:91], a[132:135], a[36:39], v[88:91]
    s_waitcnt lgkmcnt(5)
    ds_read_b128 a[132:135], v2 offset:18432
    v_fma_f32 v73, v73, s24, -v15
    v_mfma_f32_16x16x32_bf16 v[80:83], a[136:139], a[8:11], v[80:83]
    s_xor_b32 s48, s29, 196608
    v_exp_f32 v72, v72
    v_mfma_f32_16x16x32_bf16 v[80:83], a[140:143], a[12:15], v[80:83]
    buffer_load_dwordx4 v7, s[12:15], s48 offen offset:0 lds
    v_mfma_f32_16x16x32_bf16 v[88:91], a[136:139], a[40:43], v[88:91]
    ds_read_b128 a[136:139], v3 offset:18432
    v_fma_f32 v74, v74, s24, -v15
    v_mfma_f32_16x16x32_bf16 v[88:91], a[140:143], a[44:47], v[88:91]
    s_waitcnt lgkmcnt(5)
    ds_read_b128 a[140:143], v4 offset:18432
    v_fma_f32 v75, v75, s24, -v15
    v_mfma_f32_16x16x32_bf16 v[80:83], a[240:243], a[16:19], v[80:83]
    buffer_load_dwordx4 v7, s[12:15], s48 offen offset:1024 lds
    v_mfma_f32_16x16x32_bf16 v[80:83], a[244:247], a[20:23], v[80:83]
    v_exp_f32 v73, v73
    v_mfma_f32_16x16x32_bf16 v[88:91], a[240:243], a[48:51], v[88:91]
    ds_read_b128 a[240:243], v1 offset:18688
    v_cvt_pk_bf16_f32 v72, v72, v73
    v_mfma_f32_16x16x32_bf16 v[88:91], a[244:247], a[52:55], v[88:91]
    s_waitcnt lgkmcnt(5)
    ds_read_b128 a[244:247], v2 offset:18688
    v_cvt_pk_bf16_f32 v171, v86, v87
    v_mfma_f32_16x16x32_bf16 v[80:83], a[248:251], a[24:27], v[80:83]
    buffer_load_dwordx4 v7, s[12:15], s48 offen offset:2048 lds
    v_mfma_f32_16x16x32_bf16 v[80:83], a[252:255], a[28:31], v[80:83]
    v_exp_f32 v74, v74
    v_mfma_f32_16x16x32_bf16 v[88:91], a[248:251], a[56:59], v[88:91]
    ds_read_b128 a[248:251], v3 offset:18688
    v_fma_f32 v92, v92, s24, -v14
    v_mfma_f32_16x16x32_bf16 v[88:91], a[252:255], a[60:63], v[88:91]
    s_waitcnt lgkmcnt(5)
    ds_read_b128 a[252:255], v4 offset:18688
    v_fma_f32 v93, v93, s24, -v14
    v_mfma_f32_16x16x32_bf16 v[84:87], a[128:131], a[0:3], 0
    buffer_load_dwordx4 v7, s[12:15], s48 offen offset:3072 lds
    v_mfma_f32_16x16x32_bf16 v[84:87], a[132:135], a[4:7], v[84:87]
    v_exp_f32 v75, v75
    v_fma_f32 v94, v94, s24, -v14
    v_fma_f32 v95, v95, s24, -v14
    v_exp_f32 v92, v92
    v_exp_f32 v93, v93
    v_exp_f32 v94, v94
    v_exp_f32 v95, v95
    v_cvt_pk_bf16_f32 v174, v92, v93
    v_cvt_pk_bf16_f32 v175, v94, v95
    v_mfma_f32_16x16x32_bf16 v[92:95], a[128:131], a[32:35], 0
    ds_read_b128 a[128:131], v1 offset:32768
    v_cvt_pk_bf16_f32 v73, v74, v75
    v_mfma_f32_16x16x32_bf16 v[92:95], a[132:135], a[36:39], v[92:95]
    s_waitcnt lgkmcnt(5)
    ds_read_b128 a[132:135], v2 offset:32768
    v_fma_f32 v48, v48, s24, -v13
    v_mfma_f32_16x16x32_bf16 v[84:87], a[136:139], a[8:11], v[84:87]
    ds_write_b64 v252, v[72:73] offset:0
    v_mfma_f32_16x16x32_bf16 v[84:87], a[140:143], a[12:15], v[84:87]
    v_exp_f32 v48, v48
    v_mfma_f32_16x16x32_bf16 v[92:95], a[136:139], a[40:43], v[92:95]
    ds_read_b128 a[136:139], v3 offset:32768
    v_fma_f32 v49, v49, s24, -v13
    v_mfma_f32_16x16x32_bf16 v[92:95], a[140:143], a[44:47], v[92:95]
    ds_read_b128 a[140:143], v4 offset:32768
    v_fma_f32 v50, v50, s24, -v13
    v_mfma_f32_16x16x32_bf16 v[26:29], v[22:25], v[160:163], v[26:29]
    v_exp_f32 v49, v49
    v_mfma_f32_16x16x32_bf16 v[26:29], v[22:25], v[168:171], v[26:29]
    v_exp_f32 v50, v50
    v_mfma_f32_16x16x32_bf16 v[30:33], v[22:25], v[164:167], v[30:33]
    v_fma_f32 v51, v51, s24, -v13
    v_cvt_pk_bf16_f32 v176, v48, v49
    v_mfma_f32_16x16x32_bf16 v[30:33], v[22:25], v[172:175], v[30:33]
    v_exp_f32 v51, v51
    v_mfma_f32_16x16x32_bf16 v[34:37], v[22:25], a[168:171], v[34:37]
    v_cvt_pk_bf16_f32 v177, v50, v51
    v_fma_f32 v56, v56, s24, -v14
    v_mfma_f32_16x16x32_bf16 v[34:37], v[22:25], a[172:175], v[34:37]
    s_waitcnt lgkmcnt(7)
    v_exp_f32 v56, v56
    v_mfma_f32_16x16x32_bf16 v[84:87], a[240:243], a[16:19], v[84:87]
    v_fma_f32 v57, v57, s24, -v14
    v_fma_f32 v58, v58, s24, -v14
    v_mfma_f32_16x16x32_bf16 v[84:87], a[244:247], a[20:23], v[84:87]
    v_exp_f32 v57, v57
    v_mfma_f32_16x16x32_bf16 v[92:95], a[240:243], a[48:51], v[92:95]
    ds_read_b128 a[240:243], v1 offset:33024
    v_fma_f32 v59, v59, s24, -v14
    v_mfma_f32_16x16x32_bf16 v[92:95], a[244:247], a[52:55], v[92:95]
    s_waitcnt lgkmcnt(6)
    ds_read_b128 a[244:247], v2 offset:33024
    v_cvt_pk_bf16_f32 v180, v56, v57
    v_mfma_f32_16x16x32_bf16 v[84:87], a[248:251], a[24:27], v[84:87]
    v_exp_f32 v58, v58
    v_mfma_f32_16x16x32_bf16 v[84:87], a[252:255], a[28:31], v[84:87]
    v_exp_f32 v59, v59
    v_mfma_f32_16x16x32_bf16 v[92:95], a[248:251], a[56:59], v[92:95]
    ds_read_b128 a[248:251], v3 offset:33024
    v_cvt_pk_bf16_f32 v181, v58, v59
    v_mfma_f32_16x16x32_bf16 v[92:95], a[252:255], a[60:63], v[92:95]
    s_waitcnt lgkmcnt(6)
    v_fma_f32 v52, v52, s24, -v13
    v_fma_f32 v53, v53, s24, -v13
    v_mfma_f32_16x16x32_bf16 v[48:51], a[128:131], a[0:3], 0
    s_waitcnt vmcnt(4)
    ds_read_b128 a[252:255], v4 offset:33024
    v_fma_f32 v54, v54, s24, -v13
    v_mfma_f32_16x16x32_bf16 v[48:51], a[132:135], a[4:7], v[48:51]
    s_add_u32 m0, s30, 16384
    v_exp_f32 v52, v52
    v_mfma_f32_16x16x32_bf16 v[56:59], a[128:131], a[32:35], 0
    s_xor_b32 s48, s29, 212992
    ds_read_b128 a[128:131], v1 offset:34816
    v_fma_f32 v55, v55, s24, -v13
    v_mfma_f32_16x16x32_bf16 v[56:59], a[132:135], a[36:39], v[56:59]
    s_waitcnt lgkmcnt(5)
    ds_read_b128 a[132:135], v2 offset:34816
    v_fma_f32 v60, v60, s24, -v14
    v_mfma_f32_16x16x32_bf16 v[48:51], a[136:139], a[8:11], v[48:51]
    s_barrier
    ds_read_b128 a[208:211], v248 offset:32768
    v_fma_f32 v61, v61, s24, -v14
    v_mfma_f32_16x16x32_bf16 v[48:51], a[140:143], a[12:15], v[48:51]
    buffer_load_dwordx4 v7, s[12:15], s48 offen offset:0 lds
    v_mfma_f32_16x16x32_bf16 v[56:59], a[136:139], a[40:43], v[56:59]
    ds_read_b128 a[136:139], v3 offset:34816
    ds_read_b128 a[212:215], v249 offset:32768
    v_mfma_f32_16x16x32_bf16 v[56:59], a[140:143], a[44:47], v[56:59]
    s_waitcnt lgkmcnt(7)
    ds_read_b128 a[140:143], v4 offset:34816
    ds_read_b128 a[216:219], v250 offset:32768
    v_mfma_f32_16x16x32_bf16 v[48:51], a[240:243], a[16:19], v[48:51]
    buffer_load_dwordx4 v7, s[12:15], s48 offen offset:1024 lds
    v_mfma_f32_16x16x32_bf16 v[48:51], a[244:247], a[20:23], v[48:51]
    ds_read_b128 a[220:223], v251 offset:32768
    v_fma_f32 v62, v62, s24, -v14
    v_mfma_f32_16x16x32_bf16 v[56:59], a[240:243], a[48:51], v[56:59]
    ds_read_b128 a[240:243], v1 offset:35072
    ds_read_b128 a[224:227], v248 offset:33024
    v_mfma_f32_16x16x32_bf16 v[56:59], a[244:247], a[52:55], v[56:59]
    s_waitcnt lgkmcnt(10)
    ds_read_b128 a[244:247], v2 offset:35072
    ds_read_b128 a[228:231], v249 offset:33024
    v_mfma_f32_16x16x32_bf16 v[48:51], a[248:251], a[24:27], v[48:51]
    buffer_load_dwordx4 v7, s[12:15], s48 offen offset:2048 lds
    v_mfma_f32_16x16x32_bf16 v[48:51], a[252:255], a[28:31], v[48:51]
    ds_read_b128 a[232:235], v250 offset:33024
    v_fma_f32 v63, v63, s24, -v14
    v_mfma_f32_16x16x32_bf16 v[56:59], a[248:251], a[56:59], v[56:59]
    ds_read_b128 a[248:251], v3 offset:35072
    ds_read_b128 a[236:239], v251 offset:33024
    v_mfma_f32_16x16x32_bf16 v[56:59], a[252:255], a[60:63], v[56:59]
    s_waitcnt lgkmcnt(13)
    ds_read_b128 a[252:255], v4 offset:35072
    ds_read_b128 a[176:179], v253 offset:0
    v_exp_f32 v53, v53
    v_exp_f32 v54, v54
    v_exp_f32 v55, v55
    v_cvt_pk_bf16_f32 v178, v52, v53
    v_cvt_pk_bf16_f32 v179, v54, v55
    v_mfma_f32_16x16x32_bf16 v[52:55], a[128:131], a[0:3], 0
    buffer_load_dwordx4 v7, s[12:15], s48 offen offset:3072 lds
    v_mfma_f32_16x16x32_bf16 v[52:55], a[132:135], a[4:7], v[52:55]
    ds_read_b128 a[180:183], v253 offset:1024
    v_fma_f32 v80, v80, s24, -v13
    v_exp_f32 v60, v60
    v_exp_f32 v61, v61
    v_exp_f32 v62, v62
    v_exp_f32 v63, v63
    v_cvt_pk_bf16_f32 v182, v60, v61
    v_cvt_pk_bf16_f32 v183, v62, v63
    v_mfma_f32_16x16x32_bf16 v[60:63], a[128:131], a[32:35], 0
    ds_read_b128 a[128:131], v1 offset:49152
    v_fma_f32 v81, v81, s24, -v13
    v_mfma_f32_16x16x32_bf16 v[60:63], a[132:135], a[36:39], v[60:63]
    s_waitcnt lgkmcnt(13)
    ds_read_b128 a[132:135], v2 offset:49152
    v_fma_f32 v82, v82, s24, -v13
    v_mfma_f32_16x16x32_bf16 v[52:55], a[136:139], a[8:11], v[52:55]
    v_exp_f32 v80, v80
    v_mfma_f32_16x16x32_bf16 v[52:55], a[140:143], a[12:15], v[52:55]
    v_exp_f32 v81, v81
    v_mfma_f32_16x16x32_bf16 v[60:63], a[136:139], a[40:43], v[60:63]
    ds_read_b128 a[136:139], v3 offset:49152
    v_fma_f32 v83, v83, s24, -v13
    v_mfma_f32_16x16x32_bf16 v[60:63], a[140:143], a[44:47], v[60:63]
    s_waitcnt lgkmcnt(10)
    ds_read_b128 a[140:143], v4 offset:49152
    v_cvt_pk_bf16_f32 v184, v80, v81
    v_mfma_f32_16x16x32_bf16 v[52:55], a[240:243], a[16:19], v[52:55]
    v_exp_f32 v82, v82
    v_mfma_f32_16x16x32_bf16 v[52:55], a[244:247], a[20:23], v[52:55]
    v_exp_f32 v83, v83
    v_mfma_f32_16x16x32_bf16 v[60:63], a[240:243], a[48:51], v[60:63]
    ds_read_b128 a[240:243], v1 offset:49408
    v_cvt_pk_bf16_f32 v185, v82, v83
    v_mfma_f32_16x16x32_bf16 v[60:63], a[244:247], a[52:55], v[60:63]
    s_waitcnt lgkmcnt(7)
    ds_read_b128 a[244:247], v2 offset:49408
    v_fma_f32 v88, v88, s24, -v14
    v_mfma_f32_16x16x32_bf16 v[52:55], a[248:251], a[24:27], v[52:55]
    v_exp_f32 v88, v88
    v_mfma_f32_16x16x32_bf16 v[52:55], a[252:255], a[28:31], v[52:55]
    v_fma_f32 v89, v89, s24, -v14
    v_fma_f32 v90, v90, s24, -v14
    v_mfma_f32_16x16x32_bf16 v[60:63], a[248:251], a[56:59], v[60:63]
    ds_read_b128 a[248:251], v3 offset:49408
    v_fma_f32 v91, v91, s24, -v14
    v_mfma_f32_16x16x32_bf16 v[60:63], a[252:255], a[60:63], v[60:63]
    v_exp_f32 v89, v89
    v_mfma_f32_16x16x32_bf16 v[76:79], a[208:211], a[64:67], 0
    v_exp_f32 v90, v90
    v_mfma_f32_16x16x32_bf16 v[76:79], a[212:215], a[68:71], v[76:79]
    v_exp_f32 v91, v91
    v_mfma_f32_16x16x32_bf16 v[76:79], a[216:219], a[72:75], v[76:79]
    v_cvt_pk_bf16_f32 v188, v88, v89
    v_cvt_pk_bf16_f32 v189, v90, v91
    v_mfma_f32_16x16x32_bf16 v[76:79], a[220:223], a[76:79], v[76:79]
    v_fma_f32 v84, v84, s24, -v13
    v_fma_f32 v85, v85, s24, -v13
    v_mfma_f32_16x16x32_bf16 v[76:79], a[224:227], a[80:83], v[76:79]
    v_exp_f32 v84, v84
    v_mfma_f32_16x16x32_bf16 v[76:79], a[228:231], a[84:87], v[76:79]
    v_exp_f32 v85, v85
    v_mfma_f32_16x16x32_bf16 v[76:79], a[232:235], a[88:91], v[76:79]
    v_fma_f32 v86, v86, s24, -v13
    v_fma_f32 v87, v87, s24, -v13
    v_mfma_f32_16x16x32_bf16 v[76:79], a[236:239], a[92:95], v[76:79]
    s_waitcnt lgkmcnt(5)
    v_exp_f32 v86, v86
    v_mfma_f32_16x16x32_bf16 v[80:83], a[128:131], a[0:3], 0
    s_waitcnt vmcnt(4)
    ds_read_b128 a[252:255], v4 offset:49408
    v_cvt_pk_bf16_f32 v186, v84, v85
    v_mfma_f32_16x16x32_bf16 v[80:83], a[132:135], a[4:7], v[80:83]
    s_barrier
    v_exp_f32 v87, v87
    v_mfma_f32_16x16x32_bf16 v[88:91], a[128:131], a[32:35], 0
    s_add_u32 m0, s30, 32768
    ds_read_b128 a[128:131], v1 offset:51200
    v_fma_f32 v76, v76, s24, -v15
    v_mfma_f32_16x16x32_bf16 v[88:91], a[132:135], a[36:39], v[88:91]
    s_waitcnt lgkmcnt(5)
    ds_read_b128 a[132:135], v2 offset:51200
    v_fma_f32 v77, v77, s24, -v15
    v_mfma_f32_16x16x32_bf16 v[80:83], a[136:139], a[8:11], v[80:83]
    s_xor_b32 s48, s29, 229376
    v_exp_f32 v76, v76
    v_mfma_f32_16x16x32_bf16 v[80:83], a[140:143], a[12:15], v[80:83]
    buffer_load_dwordx4 v7, s[12:15], s48 offen offset:0 lds
    v_mfma_f32_16x16x32_bf16 v[88:91], a[136:139], a[40:43], v[88:91]
    ds_read_b128 a[136:139], v3 offset:51200
    v_fma_f32 v78, v78, s24, -v15
    v_mfma_f32_16x16x32_bf16 v[88:91], a[140:143], a[44:47], v[88:91]
    s_waitcnt lgkmcnt(5)
    ds_read_b128 a[140:143], v4 offset:51200
    v_fma_f32 v79, v79, s24, -v15
    v_mfma_f32_16x16x32_bf16 v[80:83], a[240:243], a[16:19], v[80:83]
    buffer_load_dwordx4 v7, s[12:15], s48 offen offset:1024 lds
    v_mfma_f32_16x16x32_bf16 v[80:83], a[244:247], a[20:23], v[80:83]
    v_exp_f32 v77, v77
    v_mfma_f32_16x16x32_bf16 v[88:91], a[240:243], a[48:51], v[88:91]
    ds_read_b128 a[240:243], v1 offset:51456
    v_cvt_pk_bf16_f32 v76, v76, v77
    v_mfma_f32_16x16x32_bf16 v[88:91], a[244:247], a[52:55], v[88:91]
    s_waitcnt lgkmcnt(5)
    ds_read_b128 a[244:247], v2 offset:51456
    v_cvt_pk_bf16_f32 v187, v86, v87
    v_mfma_f32_16x16x32_bf16 v[80:83], a[248:251], a[24:27], v[80:83]
    buffer_load_dwordx4 v7, s[12:15], s48 offen offset:2048 lds
    v_mfma_f32_16x16x32_bf16 v[80:83], a[252:255], a[28:31], v[80:83]
    v_exp_f32 v78, v78
    v_mfma_f32_16x16x32_bf16 v[88:91], a[248:251], a[56:59], v[88:91]
    ds_read_b128 a[248:251], v3 offset:51456
    v_fma_f32 v92, v92, s24, -v14
    v_mfma_f32_16x16x32_bf16 v[88:91], a[252:255], a[60:63], v[88:91]
    s_waitcnt lgkmcnt(5)
    ds_read_b128 a[252:255], v4 offset:51456
    v_fma_f32 v93, v93, s24, -v14
    v_mfma_f32_16x16x32_bf16 v[84:87], a[128:131], a[0:3], 0
    buffer_load_dwordx4 v7, s[12:15], s48 offen offset:3072 lds
    v_mfma_f32_16x16x32_bf16 v[84:87], a[132:135], a[4:7], v[84:87]
    v_exp_f32 v79, v79
    v_fma_f32 v94, v94, s24, -v14
    v_fma_f32 v95, v95, s24, -v14
    v_exp_f32 v92, v92
    v_exp_f32 v93, v93
    v_exp_f32 v94, v94
    v_exp_f32 v95, v95
    v_cvt_pk_bf16_f32 v190, v92, v93
    v_cvt_pk_bf16_f32 v191, v94, v95
    v_mfma_f32_16x16x32_bf16 v[92:95], a[128:131], a[32:35], 0
    ds_read_b128 a[128:131], v1 offset:0
    v_cvt_pk_bf16_f32 v77, v78, v79
    v_mfma_f32_16x16x32_bf16 v[92:95], a[132:135], a[36:39], v[92:95]
    s_waitcnt lgkmcnt(5)
    ds_read_b128 a[132:135], v2 offset:0
    v_fma_f32 v48, v48, s24, -v13
    v_mfma_f32_16x16x32_bf16 v[84:87], a[136:139], a[8:11], v[84:87]
    ds_write_b64 v252, v[76:77] offset:2048
    v_mfma_f32_16x16x32_bf16 v[84:87], a[140:143], a[12:15], v[84:87]
    v_exp_f32 v48, v48
    v_mfma_f32_16x16x32_bf16 v[92:95], a[136:139], a[40:43], v[92:95]
    ds_read_b128 a[136:139], v3 offset:0
    v_fma_f32 v49, v49, s24, -v13
    v_mfma_f32_16x16x32_bf16 v[92:95], a[140:143], a[44:47], v[92:95]
    ds_read_b128 a[140:143], v4 offset:0
    v_fma_f32 v50, v50, s24, -v13
    v_mfma_f32_16x16x32_bf16 v[26:29], v[22:25], v[176:179], v[26:29]
    v_exp_f32 v49, v49
    v_mfma_f32_16x16x32_bf16 v[26:29], v[22:25], v[184:187], v[26:29]
    v_exp_f32 v50, v50
    v_mfma_f32_16x16x32_bf16 v[30:33], v[22:25], v[180:183], v[30:33]
    v_fma_f32 v51, v51, s24, -v13
    v_cvt_pk_bf16_f32 v192, v48, v49
    v_mfma_f32_16x16x32_bf16 v[30:33], v[22:25], v[188:191], v[30:33]
    v_exp_f32 v51, v51
    v_mfma_f32_16x16x32_bf16 v[34:37], v[22:25], a[176:179], v[34:37]
    v_cvt_pk_bf16_f32 v193, v50, v51
    v_fma_f32 v56, v56, s24, -v14
    v_mfma_f32_16x16x32_bf16 v[34:37], v[22:25], a[180:183], v[34:37]
    s_waitcnt lgkmcnt(7)
    v_exp_f32 v56, v56
    v_mfma_f32_16x16x32_bf16 v[84:87], a[240:243], a[16:19], v[84:87]
    v_fma_f32 v57, v57, s24, -v14
    v_fma_f32 v58, v58, s24, -v14
    v_mfma_f32_16x16x32_bf16 v[84:87], a[244:247], a[20:23], v[84:87]
    v_exp_f32 v57, v57
    v_mfma_f32_16x16x32_bf16 v[92:95], a[240:243], a[48:51], v[92:95]
    ds_read_b128 a[240:243], v1 offset:256
    v_fma_f32 v59, v59, s24, -v14
    v_mfma_f32_16x16x32_bf16 v[92:95], a[244:247], a[52:55], v[92:95]
    s_waitcnt lgkmcnt(6)
    ds_read_b128 a[244:247], v2 offset:256
    v_cvt_pk_bf16_f32 v196, v56, v57
    v_mfma_f32_16x16x32_bf16 v[84:87], a[248:251], a[24:27], v[84:87]
    v_exp_f32 v58, v58
    v_mfma_f32_16x16x32_bf16 v[84:87], a[252:255], a[28:31], v[84:87]
    v_exp_f32 v59, v59
    v_mfma_f32_16x16x32_bf16 v[92:95], a[248:251], a[56:59], v[92:95]
    ds_read_b128 a[248:251], v3 offset:256
    v_cvt_pk_bf16_f32 v197, v58, v59
    v_mfma_f32_16x16x32_bf16 v[92:95], a[252:255], a[60:63], v[92:95]
    s_waitcnt lgkmcnt(6)
    v_fma_f32 v52, v52, s24, -v13
    v_fma_f32 v53, v53, s24, -v13
    v_mfma_f32_16x16x32_bf16 v[48:51], a[128:131], a[0:3], 0
    s_waitcnt vmcnt(4)
    ds_read_b128 a[252:255], v4 offset:256
    v_fma_f32 v54, v54, s24, -v13
    v_mfma_f32_16x16x32_bf16 v[48:51], a[132:135], a[4:7], v[48:51]
    s_add_u32 m0, s30, 49152
    v_exp_f32 v52, v52
    v_mfma_f32_16x16x32_bf16 v[56:59], a[128:131], a[32:35], 0
    s_xor_b32 s48, s29, 245760
    ds_read_b128 a[128:131], v1 offset:2048
    v_fma_f32 v55, v55, s24, -v13
    v_mfma_f32_16x16x32_bf16 v[56:59], a[132:135], a[36:39], v[56:59]
    s_waitcnt lgkmcnt(5)
    ds_read_b128 a[132:135], v2 offset:2048
    v_fma_f32 v60, v60, s24, -v14
    v_mfma_f32_16x16x32_bf16 v[48:51], a[136:139], a[8:11], v[48:51]
    s_barrier
    ds_read_b128 a[208:211], v248 offset:0
    v_fma_f32 v61, v61, s24, -v14
    v_mfma_f32_16x16x32_bf16 v[48:51], a[140:143], a[12:15], v[48:51]
    buffer_load_dwordx4 v7, s[12:15], s48 offen offset:0 lds
    v_mfma_f32_16x16x32_bf16 v[56:59], a[136:139], a[40:43], v[56:59]
    ds_read_b128 a[136:139], v3 offset:2048
    ds_read_b128 a[212:215], v249 offset:0
    v_mfma_f32_16x16x32_bf16 v[56:59], a[140:143], a[44:47], v[56:59]
    s_waitcnt lgkmcnt(7)
    ds_read_b128 a[140:143], v4 offset:2048
    ds_read_b128 a[216:219], v250 offset:0
    v_mfma_f32_16x16x32_bf16 v[48:51], a[240:243], a[16:19], v[48:51]
    buffer_load_dwordx4 v7, s[12:15], s48 offen offset:1024 lds
    v_mfma_f32_16x16x32_bf16 v[48:51], a[244:247], a[20:23], v[48:51]
    ds_read_b128 a[220:223], v251 offset:0
    v_fma_f32 v62, v62, s24, -v14
    v_mfma_f32_16x16x32_bf16 v[56:59], a[240:243], a[48:51], v[56:59]
    ds_read_b128 a[240:243], v1 offset:2304
    ds_read_b128 a[224:227], v248 offset:256
    v_mfma_f32_16x16x32_bf16 v[56:59], a[244:247], a[52:55], v[56:59]
    s_waitcnt lgkmcnt(10)
    ds_read_b128 a[244:247], v2 offset:2304
    ds_read_b128 a[228:231], v249 offset:256
    v_mfma_f32_16x16x32_bf16 v[48:51], a[248:251], a[24:27], v[48:51]
    buffer_load_dwordx4 v7, s[12:15], s48 offen offset:2048 lds
    v_mfma_f32_16x16x32_bf16 v[48:51], a[252:255], a[28:31], v[48:51]
    ds_read_b128 a[232:235], v250 offset:256
    v_fma_f32 v63, v63, s24, -v14
    v_mfma_f32_16x16x32_bf16 v[56:59], a[248:251], a[56:59], v[56:59]
    ds_read_b128 a[248:251], v3 offset:2304
    ds_read_b128 a[236:239], v251 offset:256
    v_mfma_f32_16x16x32_bf16 v[56:59], a[252:255], a[60:63], v[56:59]
    s_waitcnt lgkmcnt(13)
    ds_read_b128 a[252:255], v4 offset:2304
    ds_read_b128 a[184:187], v253 offset:2048
    v_exp_f32 v53, v53
    v_exp_f32 v54, v54
    v_exp_f32 v55, v55
    v_cvt_pk_bf16_f32 v194, v52, v53
    v_cvt_pk_bf16_f32 v195, v54, v55
    v_mfma_f32_16x16x32_bf16 v[52:55], a[128:131], a[0:3], 0
    buffer_load_dwordx4 v7, s[12:15], s48 offen offset:3072 lds
    v_mfma_f32_16x16x32_bf16 v[52:55], a[132:135], a[4:7], v[52:55]
    ds_read_b128 a[188:191], v253 offset:3072
    v_fma_f32 v80, v80, s24, -v13
    v_exp_f32 v60, v60
    v_exp_f32 v61, v61
    v_exp_f32 v62, v62
    v_exp_f32 v63, v63
    v_cvt_pk_bf16_f32 v198, v60, v61
    v_cvt_pk_bf16_f32 v199, v62, v63
    v_mfma_f32_16x16x32_bf16 v[60:63], a[128:131], a[32:35], 0
    ds_read_b128 a[128:131], v1 offset:16384
    v_fma_f32 v81, v81, s24, -v13
    v_mfma_f32_16x16x32_bf16 v[60:63], a[132:135], a[36:39], v[60:63]
    s_waitcnt lgkmcnt(13)
    ds_read_b128 a[132:135], v2 offset:16384
    v_fma_f32 v82, v82, s24, -v13
    v_mfma_f32_16x16x32_bf16 v[52:55], a[136:139], a[8:11], v[52:55]
    v_exp_f32 v80, v80
    v_mfma_f32_16x16x32_bf16 v[52:55], a[140:143], a[12:15], v[52:55]
    v_exp_f32 v81, v81
    v_mfma_f32_16x16x32_bf16 v[60:63], a[136:139], a[40:43], v[60:63]
    ds_read_b128 a[136:139], v3 offset:16384
    v_fma_f32 v83, v83, s24, -v13
    v_mfma_f32_16x16x32_bf16 v[60:63], a[140:143], a[44:47], v[60:63]
    s_waitcnt lgkmcnt(10)
    ds_read_b128 a[140:143], v4 offset:16384
    v_cvt_pk_bf16_f32 v200, v80, v81
    v_mfma_f32_16x16x32_bf16 v[52:55], a[240:243], a[16:19], v[52:55]
    v_exp_f32 v82, v82
    v_mfma_f32_16x16x32_bf16 v[52:55], a[244:247], a[20:23], v[52:55]
    v_exp_f32 v83, v83
    v_mfma_f32_16x16x32_bf16 v[60:63], a[240:243], a[48:51], v[60:63]
    ds_read_b128 a[240:243], v1 offset:16640
    v_cvt_pk_bf16_f32 v201, v82, v83
    v_mfma_f32_16x16x32_bf16 v[60:63], a[244:247], a[52:55], v[60:63]
    s_waitcnt lgkmcnt(7)
    ds_read_b128 a[244:247], v2 offset:16640
    v_fma_f32 v88, v88, s24, -v14
    v_mfma_f32_16x16x32_bf16 v[52:55], a[248:251], a[24:27], v[52:55]
    v_exp_f32 v88, v88
    v_mfma_f32_16x16x32_bf16 v[52:55], a[252:255], a[28:31], v[52:55]
    v_fma_f32 v89, v89, s24, -v14
    v_fma_f32 v90, v90, s24, -v14
    v_mfma_f32_16x16x32_bf16 v[60:63], a[248:251], a[56:59], v[60:63]
    ds_read_b128 a[248:251], v3 offset:16640
    v_fma_f32 v91, v91, s24, -v14
    v_mfma_f32_16x16x32_bf16 v[60:63], a[252:255], a[60:63], v[60:63]
    v_exp_f32 v89, v89
    v_mfma_f32_16x16x32_bf16 v[72:75], a[208:211], a[64:67], 0
    v_exp_f32 v90, v90
    v_mfma_f32_16x16x32_bf16 v[72:75], a[212:215], a[68:71], v[72:75]
    v_exp_f32 v91, v91
    v_mfma_f32_16x16x32_bf16 v[72:75], a[216:219], a[72:75], v[72:75]
    v_cvt_pk_bf16_f32 v204, v88, v89
    v_cvt_pk_bf16_f32 v205, v90, v91
    v_mfma_f32_16x16x32_bf16 v[72:75], a[220:223], a[76:79], v[72:75]
    v_fma_f32 v84, v84, s24, -v13
    v_fma_f32 v85, v85, s24, -v13
    v_mfma_f32_16x16x32_bf16 v[72:75], a[224:227], a[80:83], v[72:75]
    v_exp_f32 v84, v84
    v_mfma_f32_16x16x32_bf16 v[72:75], a[228:231], a[84:87], v[72:75]
    v_exp_f32 v85, v85
    v_mfma_f32_16x16x32_bf16 v[72:75], a[232:235], a[88:91], v[72:75]
    v_fma_f32 v86, v86, s24, -v13
    v_fma_f32 v87, v87, s24, -v13
    v_mfma_f32_16x16x32_bf16 v[72:75], a[236:239], a[92:95], v[72:75]
    s_waitcnt lgkmcnt(5)
    v_exp_f32 v86, v86
    v_mfma_f32_16x16x32_bf16 v[80:83], a[128:131], a[0:3], 0
    s_waitcnt vmcnt(4)
    ds_read_b128 a[252:255], v4 offset:16640
    v_cvt_pk_bf16_f32 v202, v84, v85
    v_mfma_f32_16x16x32_bf16 v[80:83], a[132:135], a[4:7], v[80:83]
    s_barrier
    v_exp_f32 v87, v87
    v_mfma_f32_16x16x32_bf16 v[88:91], a[128:131], a[32:35], 0
    s_add_u32 m0, s30, 0
    ds_read_b128 a[128:131], v1 offset:18432
    v_fma_f32 v72, v72, s24, -v15
    v_mfma_f32_16x16x32_bf16 v[88:91], a[132:135], a[36:39], v[88:91]
    s_waitcnt lgkmcnt(5)
    ds_read_b128 a[132:135], v2 offset:18432
    v_fma_f32 v73, v73, s24, -v15
    v_mfma_f32_16x16x32_bf16 v[80:83], a[136:139], a[8:11], v[80:83]
    s_xor_b32 s48, s4, 0
    v_exp_f32 v72, v72
    v_mfma_f32_16x16x32_bf16 v[80:83], a[140:143], a[12:15], v[80:83]
    buffer_load_dwordx4 v8, s[16:19], s48 offen offset:0 lds
    v_mfma_f32_16x16x32_bf16 v[88:91], a[136:139], a[40:43], v[88:91]
    ds_read_b128 a[136:139], v3 offset:18432
    v_fma_f32 v74, v74, s24, -v15
    v_mfma_f32_16x16x32_bf16 v[88:91], a[140:143], a[44:47], v[88:91]
    s_waitcnt lgkmcnt(5)
    ds_read_b128 a[140:143], v4 offset:18432
    v_fma_f32 v75, v75, s24, -v15
    v_mfma_f32_16x16x32_bf16 v[80:83], a[240:243], a[16:19], v[80:83]
    buffer_load_dwordx4 v8, s[16:19], s48 offen offset:1024 lds
    v_mfma_f32_16x16x32_bf16 v[80:83], a[244:247], a[20:23], v[80:83]
    v_exp_f32 v73, v73
    v_mfma_f32_16x16x32_bf16 v[88:91], a[240:243], a[48:51], v[88:91]
    ds_read_b128 a[240:243], v1 offset:18688
    v_cvt_pk_bf16_f32 v72, v72, v73
    v_mfma_f32_16x16x32_bf16 v[88:91], a[244:247], a[52:55], v[88:91]
    s_waitcnt lgkmcnt(5)
    ds_read_b128 a[244:247], v2 offset:18688
    v_cvt_pk_bf16_f32 v203, v86, v87
    v_mfma_f32_16x16x32_bf16 v[80:83], a[248:251], a[24:27], v[80:83]
    buffer_load_dwordx4 v8, s[16:19], s48 offen offset:2048 lds
    v_mfma_f32_16x16x32_bf16 v[80:83], a[252:255], a[28:31], v[80:83]
    v_exp_f32 v74, v74
    v_mfma_f32_16x16x32_bf16 v[88:91], a[248:251], a[56:59], v[88:91]
    ds_read_b128 a[248:251], v3 offset:18688
    v_fma_f32 v92, v92, s24, -v14
    v_mfma_f32_16x16x32_bf16 v[88:91], a[252:255], a[60:63], v[88:91]
    s_waitcnt lgkmcnt(5)
    ds_read_b128 a[252:255], v4 offset:18688
    v_fma_f32 v93, v93, s24, -v14
    v_mfma_f32_16x16x32_bf16 v[84:87], a[128:131], a[0:3], 0
    buffer_load_dwordx4 v8, s[16:19], s48 offen offset:3072 lds
    v_mfma_f32_16x16x32_bf16 v[84:87], a[132:135], a[4:7], v[84:87]
    v_exp_f32 v75, v75
    v_fma_f32 v94, v94, s24, -v14
    v_fma_f32 v95, v95, s24, -v14
    v_exp_f32 v92, v92
    v_exp_f32 v93, v93
    v_exp_f32 v94, v94
    v_exp_f32 v95, v95
    v_cvt_pk_bf16_f32 v206, v92, v93
    v_cvt_pk_bf16_f32 v207, v94, v95
    v_mfma_f32_16x16x32_bf16 v[92:95], a[128:131], a[32:35], 0
    ds_read_b128 a[128:131], v1 offset:32768
    v_cvt_pk_bf16_f32 v73, v74, v75
    v_mfma_f32_16x16x32_bf16 v[92:95], a[132:135], a[36:39], v[92:95]
    s_waitcnt lgkmcnt(5)
    ds_read_b128 a[132:135], v2 offset:32768
    v_fma_f32 v48, v48, s24, -v13
    v_mfma_f32_16x16x32_bf16 v[84:87], a[136:139], a[8:11], v[84:87]
    ds_write_b64 v252, v[72:73] offset:0
    v_mfma_f32_16x16x32_bf16 v[84:87], a[140:143], a[12:15], v[84:87]
    v_exp_f32 v48, v48
    v_mfma_f32_16x16x32_bf16 v[92:95], a[136:139], a[40:43], v[92:95]
    ds_read_b128 a[136:139], v3 offset:32768
    v_fma_f32 v49, v49, s24, -v13
    v_mfma_f32_16x16x32_bf16 v[92:95], a[140:143], a[44:47], v[92:95]
L_t3_3:
    s_cbranch_execz L_tback3
    ds_read_b128 a[140:143], v4 offset:32768
    v_fma_f32 v50, v50, s24, -v13
    v_mfma_f32_16x16x32_bf16 v[26:29], v[22:25], v[192:195], v[26:29]
    v_exp_f32 v49, v49
    v_mfma_f32_16x16x32_bf16 v[26:29], v[22:25], v[200:203], v[26:29]
    v_exp_f32 v50, v50
    v_mfma_f32_16x16x32_bf16 v[30:33], v[22:25], v[196:199], v[30:33]
    v_fma_f32 v51, v51, s24, -v13
    v_cvt_pk_bf16_f32 v208, v48, v49
    v_mfma_f32_16x16x32_bf16 v[30:33], v[22:25], v[204:207], v[30:33]
    v_exp_f32 v51, v51
    v_mfma_f32_16x16x32_bf16 v[34:37], v[22:25], a[184:187], v[34:37]
    v_cvt_pk_bf16_f32 v209, v50, v51
    v_fma_f32 v56, v56, s24, -v14
    v_mfma_f32_16x16x32_bf16 v[34:37], v[22:25], a[188:191], v[34:37]
    s_waitcnt lgkmcnt(7)
    v_exp_f32 v56, v56
    v_mfma_f32_16x16x32_bf16 v[84:87], a[240:243], a[16:19], v[84:87]
    v_fma_f32 v57, v57, s24, -v14
    v_fma_f32 v58, v58, s24, -v14
    v_mfma_f32_16x16x32_bf16 v[84:87], a[244:247], a[20:23], v[84:87]
    v_exp_f32 v57, v57
    v_mfma_f32_16x16x32_bf16 v[92:95], a[240:243], a[48:51], v[92:95]
    ds_read_b128 a[240:243], v1 offset:33024
    v_fma_f32 v59, v59, s24, -v14
    v_mfma_f32_16x16x32_bf16 v[92:95], a[244:247], a[52:55], v[92:95]
    s_waitcnt lgkmcnt(6)
    ds_read_b128 a[244:247], v2 offset:33024
    v_cvt_pk_bf16_f32 v212, v56, v57
    v_mfma_f32_16x16x32_bf16 v[84:87], a[248:251], a[24:27], v[84:87]
    v_exp_f32 v58, v58
    v_mfma_f32_16x16x32_bf16 v[84:87], a[252:255], a[28:31], v[84:87]
    v_exp_f32 v59, v59
    v_mfma_f32_16x16x32_bf16 v[92:95], a[248:251], a[56:59], v[92:95]
    ds_read_b128 a[248:251], v3 offset:33024
    v_cvt_pk_bf16_f32 v213, v58, v59
    v_mfma_f32_16x16x32_bf16 v[92:95], a[252:255], a[60:63], v[92:95]
    s_waitcnt lgkmcnt(6)
    v_fma_f32 v52, v52, s24, -v13
    v_fma_f32 v53, v53, s24, -v13
    v_mfma_f32_16x16x32_bf16 v[48:51], a[128:131], a[0:3], 0
    s_waitcnt vmcnt(4)
    ds_read_b128 a[252:255], v4 offset:33024
    v_fma_f32 v54, v54, s24, -v13
    v_mfma_f32_16x16x32_bf16 v[48:51], a[132:135], a[4:7], v[48:51]
    s_add_u32 m0, s30, 16384
    v_exp_f32 v52, v52
    v_mfma_f32_16x16x32_bf16 v[56:59], a[128:131], a[32:35], 0
    s_xor_b32 s48, s4, 65536
    ds_read_b128 a[128:131], v1 offset:34816
    v_fma_f32 v55, v55, s24, -v13
    v_mfma_f32_16x16x32_bf16 v[56:59], a[132:135], a[36:39], v[56:59]
    s_waitcnt lgkmcnt(5)
    ds_read_b128 a[132:135], v2 offset:34816
    v_fma_f32 v60, v60, s24, -v14
    v_mfma_f32_16x16x32_bf16 v[48:51], a[136:139], a[8:11], v[48:51]
    s_barrier
    ds_read_b128 a[208:211], v248 offset:32768
    v_fma_f32 v61, v61, s24, -v14
    v_mfma_f32_16x16x32_bf16 v[48:51], a[140:143], a[12:15], v[48:51]
    buffer_load_dwordx4 v8, s[16:19], s48 offen offset:0 lds
    v_mfma_f32_16x16x32_bf16 v[56:59], a[136:139], a[40:43], v[56:59]
    ds_read_b128 a[136:139], v3 offset:34816
    ds_read_b128 a[212:215], v249 offset:32768
    v_mfma_f32_16x16x32_bf16 v[56:59], a[140:143], a[44:47], v[56:59]
    s_waitcnt lgkmcnt(7)
    ds_read_b128 a[140:143], v4 offset:34816
    ds_read_b128 a[216:219], v250 offset:32768
    v_mfma_f32_16x16x32_bf16 v[48:51], a[240:243], a[16:19], v[48:51]
    buffer_load_dwordx4 v8, s[16:19], s48 offen offset:1024 lds
    v_mfma_f32_16x16x32_bf16 v[48:51], a[244:247], a[20:23], v[48:51]
    ds_read_b128 a[220:223], v251 offset:32768
    v_fma_f32 v62, v62, s24, -v14
    v_mfma_f32_16x16x32_bf16 v[56:59], a[240:243], a[48:51], v[56:59]
    ds_read_b128 a[240:243], v1 offset:35072
    ds_read_b128 a[224:227], v248 offset:33024
    v_mfma_f32_16x16x32_bf16 v[56:59], a[244:247], a[52:55], v[56:59]
    s_waitcnt lgkmcnt(10)
    ds_read_b128 a[244:247], v2 offset:35072
    ds_read_b128 a[228:231], v249 offset:33024
    v_mfma_f32_16x16x32_bf16 v[48:51], a[248:251], a[24:27], v[48:51]
    buffer_load_dwordx4 v8, s[16:19], s48 offen offset:2048 lds
    v_mfma_f32_16x16x32_bf16 v[48:51], a[252:255], a[28:31], v[48:51]
    ds_read_b128 a[232:235], v250 offset:33024
    v_fma_f32 v63, v63, s24, -v14
    v_mfma_f32_16x16x32_bf16 v[56:59], a[248:251], a[56:59], v[56:59]
    ds_read_b128 a[248:251], v3 offset:35072
    ds_read_b128 a[236:239], v251 offset:33024
    v_mfma_f32_16x16x32_bf16 v[56:59], a[252:255], a[60:63], v[56:59]
    s_waitcnt lgkmcnt(13)
    ds_read_b128 a[252:255], v4 offset:35072
    ds_read_b128 a[192:195], v253 offset:0
    v_exp_f32 v53, v53
    v_exp_f32 v54, v54
    v_exp_f32 v55, v55
    v_cvt_pk_bf16_f32 v210, v52, v53
    v_cvt_pk_bf16_f32 v211, v54, v55
    v_mfma_f32_16x16x32_bf16 v[52:55], a[128:131], a[0:3], 0
    buffer_load_dwordx4 v8, s[16:19], s48 offen offset:3072 lds
    v_mfma_f32_16x16x32_bf16 v[52:55], a[132:135], a[4:7], v[52:55]
    ds_read_b128 a[196:199], v253 offset:1024
    v_fma_f32 v80, v80, s24, -v13
    v_exp_f32 v60, v60
    v_exp_f32 v61, v61
    v_exp_f32 v62, v62
    v_exp_f32 v63, v63
    v_cvt_pk_bf16_f32 v214, v60, v61
    v_cvt_pk_bf16_f32 v215, v62, v63
    v_mfma_f32_16x16x32_bf16 v[60:63], a[128:131], a[32:35], 0
    ds_read_b128 a[128:131], v1 offset:49152
    v_fma_f32 v81, v81, s24, -v13
    v_mfma_f32_16x16x32_bf16 v[60:63], a[132:135], a[36:39], v[60:63]
    s_waitcnt lgkmcnt(13)
    ds_read_b128 a[132:135], v2 offset:49152
    v_fma_f32 v82, v82, s24, -v13
    v_mfma_f32_16x16x32_bf16 v[52:55], a[136:139], a[8:11], v[52:55]
    v_exp_f32 v80, v80
    v_mfma_f32_16x16x32_bf16 v[52:55], a[140:143], a[12:15], v[52:55]
    v_exp_f32 v81, v81
    v_mfma_f32_16x16x32_bf16 v[60:63], a[136:139], a[40:43], v[60:63]
    ds_read_b128 a[136:139], v3 offset:49152
    v_fma_f32 v83, v83, s24, -v13
    v_mfma_f32_16x16x32_bf16 v[60:63], a[140:143], a[44:47], v[60:63]
    s_waitcnt lgkmcnt(10)
    ds_read_b128 a[140:143], v4 offset:49152
    v_cvt_pk_bf16_f32 v216, v80, v81
    v_mfma_f32_16x16x32_bf16 v[52:55], a[240:243], a[16:19], v[52:55]
    v_exp_f32 v82, v82
    v_mfma_f32_16x16x32_bf16 v[52:55], a[244:247], a[20:23], v[52:55]
    v_exp_f32 v83, v83
    v_mfma_f32_16x16x32_bf16 v[60:63], a[240:243], a[48:51], v[60:63]
    ds_read_b128 a[240:243], v1 offset:49408
    v_cvt_pk_bf16_f32 v217, v82, v83
    v_mfma_f32_16x16x32_bf16 v[60:63], a[244:247], a[52:55], v[60:63]
    s_waitcnt lgkmcnt(7)
    ds_read_b128 a[244:247], v2 offset:49408
    v_fma_f32 v88, v88, s24, -v14
    v_mfma_f32_16x16x32_bf16 v[52:55], a[248:251], a[24:27], v[52:55]
    v_exp_f32 v88, v88
    v_mfma_f32_16x16x32_bf16 v[52:55], a[252:255], a[28:31], v[52:55]
    v_fma_f32 v89, v89, s24, -v14
    v_fma_f32 v90, v90, s24, -v14
    v_mfma_f32_16x16x32_bf16 v[60:63], a[248:251], a[56:59], v[60:63]
    ds_read_b128 a[248:251], v3 offset:49408
    v_fma_f32 v91, v91, s24, -v14
    v_mfma_f32_16x16x32_bf16 v[60:63], a[252:255], a[60:63], v[60:63]
    v_exp_f32 v89, v89
    v_mfma_f32_16x16x32_bf16 v[76:79], a[208:211], a[64:67], 0
    v_exp_f32 v90, v90
    v_mfma_f32_16x16x32_bf16 v[76:79], a[212:215], a[68:71], v[76:79]
    v_exp_f32 v91, v91
    v_mfma_f32_16x16x32_bf16 v[76:79], a[216:219], a[72:75], v[76:79]
    v_cvt_pk_bf16_f32 v220, v88, v89
    v_cvt_pk_bf16_f32 v221, v90, v91
    v_mfma_f32_16x16x32_bf16 v[76:79], a[220:223], a[76:79], v[76:79]
    v_fma_f32 v84, v84, s24, -v13
    v_fma_f32 v85, v85, s24, -v13
    v_mfma_f32_16x16x32_bf16 v[76:79], a[224:227], a[80:83], v[76:79]
    v_exp_f32 v84, v84
    v_mfma_f32_16x16x32_bf16 v[76:79], a[228:231], a[84:87], v[76:79]
    v_exp_f32 v85, v85
    v_mfma_f32_16x16x32_bf16 v[76:79], a[232:235], a[88:91], v[76:79]
    v_fma_f32 v86, v86, s24, -v13
    v_fma_f32 v87, v87, s24, -v13
    v_mfma_f32_16x16x32_bf16 v[76:79], a[236:239], a[92:95], v[76:79]
    s_waitcnt lgkmcnt(5)
    v_exp_f32 v86, v86
    v_mfma_f32_16x16x32_bf16 v[80:83], a[128:131], a[0:3], 0
    s_waitcnt vmcnt(4)
    ds_read_b128 a[252:255], v4 offset:49408
    v_cvt_pk_bf16_f32 v218, v84, v85
    v_mfma_f32_16x16x32_bf16 v[80:83], a[132:135], a[4:7], v[80:83]
    s_barrier
    v_exp_f32 v87, v87
    v_mfma_f32_16x16x32_bf16 v[88:91], a[128:131], a[32:35], 0
    s_add_u32 m0, s30, 32768
    ds_read_b128 a[128:131], v1 offset:51200
    v_fma_f32 v76, v76, s24, -v15
    v_mfma_f32_16x16x32_bf16 v[88:91], a[132:135], a[36:39], v[88:91]
    s_waitcnt lgkmcnt(5)
    ds_read_b128 a[132:135], v2 offset:51200
    v_fma_f32 v77, v77, s24, -v15
    v_mfma_f32_16x16x32_bf16 v[80:83], a[136:139], a[8:11], v[80:83]
    s_xor_b32 s48, s4, 131072
    v_exp_f32 v76, v76
    v_mfma_f32_16x16x32_bf16 v[80:83], a[140:143], a[12:15], v[80:83]
    buffer_load_dwordx4 v8, s[16:19], s48 offen offset:0 lds
    v_mfma_f32_16x16x32_bf16 v[88:91], a[136:139], a[40:43], v[88:91]
    ds_read_b128 a[136:139], v3 offset:51200
    v_fma_f32 v78, v78, s24, -v15
    v_mfma_f32_16x16x32_bf16 v[88:91], a[140:143], a[44:47], v[88:91]
    s_waitcnt lgkmcnt(5)
    ds_read_b128 a[140:143], v4 offset:51200
    v_fma_f32 v79, v79, s24, -v15
    v_mfma_f32_16x16x32_bf16 v[80:83], a[240:243], a[16:19], v[80:83]
    buffer_load_dwordx4 v8, s[16:19], s48 offen offset:1024 lds
    v_mfma_f32_16x16x32_bf16 v[80:83], a[244:247], a[20:23], v[80:83]
    v_exp_f32 v77, v77
    v_mfma_f32_16x16x32_bf16 v[88:91], a[240:243], a[48:51], v[88:91]
    ds_read_b128 a[240:243], v1 offset:51456
    v_cvt_pk_bf16_f32 v76, v76, v77
    v_mfma_f32_16x16x32_bf16 v[88:91], a[244:247], a[52:55], v[88:91]
    s_waitcnt lgkmcnt(5)
    ds_read_b128 a[244:247], v2 offset:51456
    v_cvt_pk_bf16_f32 v219, v86, v87
    v_mfma_f32_16x16x32_bf16 v[80:83], a[248:251], a[24:27], v[80:83]
    buffer_load_dwordx4 v8, s[16:19], s48 offen offset:2048 lds
    v_mfma_f32_16x16x32_bf16 v[80:83], a[252:255], a[28:31], v[80:83]
    v_exp_f32 v78, v78
    v_mfma_f32_16x16x32_bf16 v[88:91], a[248:251], a[56:59], v[88:91]
    ds_read_b128 a[248:251], v3 offset:51456
    v_fma_f32 v92, v92, s24, -v14
    v_mfma_f32_16x16x32_bf16 v[88:91], a[252:255], a[60:63], v[88:91]
    s_waitcnt lgkmcnt(5)
    ds_read_b128 a[252:255], v4 offset:51456
    v_fma_f32 v93, v93, s24, -v14
    v_mfma_f32_16x16x32_bf16 v[84:87], a[128:131], a[0:3], 0
    buffer_load_dwordx4 v8, s[16:19], s48 offen offset:3072 lds
    v_mfma_f32_16x16x32_bf16 v[84:87], a[132:135], a[4:7], v[84:87]
    v_exp_f32_e64 v79, v79
    v_fma_f32 v94, v94, s24, -v14
    v_fma_f32 v95, v95, s24, -v14
    v_exp_f32 v92, v92
    v_exp_f32 v93, v93
    v_exp_f32 v94, v94
    v_exp_f32 v95, v95
    v_cvt_pk_bf16_f32 v222, v92, v93
    v_cvt_pk_bf16_f32 v223, v94, v95
    v_mfma_f32_16x16x32_bf16 v[92:95], a[128:131], a[32:35], 0
    ds_read_b64_tr_b16 a[128:129], v5 offset:0
    ds_read_b64_tr_b16 a[130:131], v5 offset:2048
    v_mfma_f32_16x16x32_bf16 v[92:95], a[132:135], a[36:39], v[92:95]
    s_waitcnt lgkmcnt(6)
    ds_read_b64_tr_b16 a[132:133], v5 offset:4096
    ds_read_b64_tr_b16 a[134:135], v5 offset:6144
    v_mfma_f32_16x16x32_bf16 v[84:87], a[136:139], a[8:11], v[84:87]
    v_cvt_pk_bf16_f32 v77, v78, v79
    v_fma_f32 v48, v48, s24, -v13
    v_mfma_f32_16x16x32_bf16 v[84:87], a[140:143], a[12:15], v[84:87]
    ds_write_b64 v252, v[76:77] offset:2048
    v_mfma_f32_16x16x32_bf16 v[92:95], a[136:139], a[40:43], v[92:95]
    ds_read_b64_tr_b16 a[136:137], v5 offset:8192
    ds_read_b64_tr_b16 a[138:139], v5 offset:10240
    v_mfma_f32_16x16x32_bf16 v[92:95], a[140:143], a[44:47], v[92:95]
    ds_read_b64_tr_b16 a[140:141], v5 offset:12288
    ds_read_b64_tr_b16 a[142:143], v5 offset:14336
    v_mfma_f32_16x16x32_bf16 v[26:29], v[22:25], v[208:211], v[26:29]
    v_exp_f32 v48, v48
    v_mfma_f32_16x16x32_bf16 v[26:29], v[22:25], v[216:219], v[26:29]
    v_fma_f32 v49, v49, s24, -v13
    v_fma_f32 v50, v50, s24, -v13
    v_mfma_f32_16x16x32_bf16 v[30:33], v[22:25], v[212:215], v[30:33]
    v_exp_f32 v49, v49
    v_mfma_f32_16x16x32_bf16 v[30:33], v[22:25], v[220:223], v[30:33]
    v_exp_f32 v50, v50
    v_mfma_f32_16x16x32_bf16 v[34:37], v[22:25], a[192:195], v[34:37]
    v_fma_f32 v51, v51, s24, -v13
    v_cvt_pk_bf16_f32 v224, v48, v49
    v_mfma_f32_16x16x32_bf16 v[34:37], v[22:25], a[196:199], v[34:37]
    s_waitcnt lgkmcnt(11)
    v_exp_f32 v51, v51
    v_mfma_f32_16x16x32_bf16 v[84:87], a[240:243], a[16:19], v[84:87]
    v_cvt_pk_bf16_f32 v225, v50, v51
    v_fma_f32 v56, v56, s24, -v14
    v_mfma_f32_16x16x32_bf16 v[84:87], a[244:247], a[20:23], v[84:87]
    v_exp_f32 v56, v56
    v_mfma_f32_16x16x32_bf16 v[92:95], a[240:243], a[48:51], v[92:95]
    ds_read_b64_tr_b16 a[240:241], v6 offset:0
    ds_read_b64_tr_b16 a[242:243], v6 offset:2048
    v_mfma_f32_16x16x32_bf16 v[92:95], a[244:247], a[52:55], v[92:95]
    s_waitcnt lgkmcnt(11)
    ds_read_b64_tr_b16 a[244:245], v6 offset:4096
    ds_read_b64_tr_b16 a[246:247], v6 offset:6144
    v_mfma_f32_16x16x32_bf16 v[84:87], a[248:251], a[24:27], v[84:87]
    v_fma_f32 v57, v57, s24, -v14
    v_fma_f32 v58, v58, s24, -v14
    v_mfma_f32_16x16x32_bf16 v[84:87], a[252:255], a[28:31], v[84:87]
    v_exp_f32 v57, v57
    v_mfma_f32_16x16x32_bf16 v[92:95], a[248:251], a[56:59], v[92:95]
    ds_read_b64_tr_b16 a[248:249], v6 offset:8192
    ds_read_b64_tr_b16 a[250:251], v6 offset:10240
    v_mfma_f32_16x16x32_bf16 v[92:95], a[252:255], a[60:63], v[92:95]
    s_waitcnt lgkmcnt(11)
    v_exp_f32 v58, v58
    v_mfma_f32_16x16x32_bf16 v[64:67], a[128:131], v[112:115], 0
    s_waitcnt vmcnt(4)
    ds_read_b64_tr_b16 a[252:253], v6 offset:12288
    ds_read_b64_tr_b16 a[254:255], v6 offset:14336
    v_mfma_f32_16x16x32_bf16 v[64:67], a[132:135], v[120:123], v[64:67]
    s_add_u32 m0, s30, 49152
    v_fma_f32 v59, v59, s24, -v14
    v_cvt_pk_bf16_f32 v228, v56, v57
    v_mfma_f32_16x16x32_bf16 v[72:75], a[128:131], v[116:119], 0
    s_xor_b32 s48, s4, 196608
    v_exp_f32 v59, v59
    v_mfma_f32_16x16x32_bf16 v[72:75], a[132:135], v[124:127], v[72:75]
    v_cvt_pk_bf16_f32 v229, v58, v59
    v_fma_f32 v52, v52, s24, -v13
    v_mfma_f32_16x16x32_bf16 v[38:41], a[128:131], a[144:147], 0
    ds_read_b64_tr_b16 a[128:129], v21 offset:0
    ds_read_b64_tr_b16 a[130:131], v21 offset:2048
    v_mfma_f32_16x16x32_bf16 v[38:41], a[132:135], a[148:151], v[38:41]
    s_waitcnt lgkmcnt(10)
    ds_read_b64_tr_b16 a[132:133], v21 offset:4096
    ds_read_b64_tr_b16 a[134:135], v21 offset:6144
    v_mfma_f32_16x16x32_bf16 v[64:67], a[136:139], v[128:131], v[64:67]
    s_barrier
    ds_read_b128 a[200:203], v253 offset:2048
    v_fma_f32 v53, v53, s24, -v13
    v_mfma_f32_16x16x32_bf16 v[64:67], a[140:143], v[136:139], v[64:67]
    buffer_load_dwordx4 v8, s[16:19], s48 offen offset:0 lds
    v_mfma_f32_16x16x32_bf16 v[72:75], a[136:139], v[132:135], v[72:75]
    ds_read_b128 a[204:207], v253 offset:3072
    v_fma_f32 v54, v54, s24, -v13
    v_mfma_f32_16x16x32_bf16 v[72:75], a[140:143], v[140:143], v[72:75]
    v_exp_f32 v52, v52
    v_mfma_f32_16x16x32_bf16 v[38:41], a[136:139], a[152:155], v[38:41]
    ds_read_b64_tr_b16 a[136:137], v21 offset:8192
    ds_read_b64_tr_b16 a[138:139], v21 offset:10240
    v_mfma_f32_16x16x32_bf16 v[38:41], a[140:143], a[156:159], v[38:41]
    s_waitcnt lgkmcnt(12)
    ds_read_b64_tr_b16 a[140:141], v21 offset:12288
    ds_read_b64_tr_b16 a[142:143], v21 offset:14336
    v_mfma_f32_16x16x32_bf16 v[68:71], a[240:243], v[112:115], 0
    buffer_load_dwordx4 v8, s[16:19], s48 offen offset:1024 lds
    v_mfma_f32_16x16x32_bf16 v[68:71], a[244:247], v[120:123], v[68:71]
    v_exp_f32 v53, v53
    v_mfma_f32_16x16x32_bf16 v[76:79], a[240:243], v[116:119], 0
    ds_read_b64_tr_b16 a[240:241], v45 offset:0
    ds_read_b64_tr_b16 a[242:243], v45 offset:2048
    v_mfma_f32_16x16x32_bf16 v[76:79], a[244:247], v[124:127], v[76:79]
    s_waitcnt lgkmcnt(12)
    ds_read_b64_tr_b16 a[244:245], v45 offset:4096
    ds_read_b64_tr_b16 a[246:247], v45 offset:6144
    v_mfma_f32_16x16x32_bf16 v[68:71], a[248:251], v[128:131], v[68:71]
    buffer_load_dwordx4 v8, s[16:19], s48 offen offset:2048 lds
    v_mfma_f32_16x16x32_bf16 v[68:71], a[252:255], v[136:139], v[68:71]
    v_exp_f32 v54, v54
    v_mfma_f32_16x16x32_bf16 v[76:79], a[248:251], v[132:135], v[76:79]
    ds_read_b64_tr_b16 a[248:249], v45 offset:8192
    ds_read_b64_tr_b16 a[250:251], v45 offset:10240
    v_mfma_f32_16x16x32_bf16 v[76:79], a[252:255], v[140:143], v[76:79]
    s_waitcnt lgkmcnt(12)
    ds_read_b64_tr_b16 a[252:253], v45 offset:12288
    ds_read_b64_tr_b16 a[254:255], v45 offset:14336
    v_mfma_f32_16x16x32_bf16 v[96:99], a[128:131], v[112:115], 0
    buffer_load_dwordx4 v8, s[16:19], s48 offen offset:3072 lds
    v_mfma_f32_16x16x32_bf16 v[96:99], a[132:135], v[120:123], v[96:99]
    v_fma_f32 v55, v55, s24, -v13
    v_cvt_pk_bf16_f32 v226, v52, v53
    v_mfma_f32_16x16x32_bf16 v[104:107], a[128:131], v[116:119], 0
    ds_read_b64_tr_b16 a[128:129], v5 offset:16384
    ds_read_b64_tr_b16 a[130:131], v5 offset:18432
    v_mfma_f32_16x16x32_bf16 v[104:107], a[132:135], v[124:127], v[104:107]
    s_waitcnt lgkmcnt(10)
    ds_read_b64_tr_b16 a[132:133], v5 offset:20480
    ds_read_b64_tr_b16 a[134:135], v5 offset:22528
    v_mfma_f32_16x16x32_bf16 v[96:99], a[136:139], v[128:131], v[96:99]
    v_exp_f32 v55, v55
    v_mfma_f32_16x16x32_bf16 v[96:99], a[140:143], v[136:139], v[96:99]
    v_cvt_pk_bf16_f32 v227, v54, v55
    v_fma_f32 v60, v60, s24, -v14
    v_mfma_f32_16x16x32_bf16 v[104:107], a[136:139], v[132:135], v[104:107]
    ds_read_b64_tr_b16 a[136:137], v5 offset:24576
    ds_read_b64_tr_b16 a[138:139], v5 offset:26624
    v_mfma_f32_16x16x32_bf16 v[104:107], a[140:143], v[140:143], v[104:107]
    s_waitcnt lgkmcnt(10)
    v_exp_f32 v60, v60
    v_mfma_f32_16x16x32_bf16 v[100:103], a[240:243], v[112:115], 0
    v_fma_f32 v61, v61, s24, -v14
    v_fma_f32 v62, v62, s24, -v14
    v_mfma_f32_16x16x32_bf16 v[100:103], a[244:247], v[120:123], v[100:103]
    v_exp_f32 v61, v61
    v_mfma_f32_16x16x32_bf16 v[108:111], a[240:243], v[116:119], 0
    v_exp_f32 v62, v62
    v_mfma_f32_16x16x32_bf16 v[108:111], a[244:247], v[124:127], v[108:111]
    s_waitcnt lgkmcnt(6)
    v_fma_f32 v63, v63, s24, -v14
    v_cvt_pk_bf16_f32 v230, v60, v61
    v_mfma_f32_16x16x32_bf16 v[100:103], a[248:251], v[128:131], v[100:103]
    v_exp_f32 v63, v63
    v_mfma_f32_16x16x32_bf16 v[100:103], a[252:255], v[136:139], v[100:103]
    v_cvt_pk_bf16_f32 v231, v62, v63
    v_fma_f32 v80, v80, s24, -v13
    v_mfma_f32_16x16x32_bf16 v[108:111], a[248:251], v[132:135], v[108:111]
    v_exp_f32 v80, v80
    v_mfma_f32_16x16x32_bf16 v[108:111], a[252:255], v[140:143], v[108:111]
    v_fma_f32 v81, v81, s24, -v13
    v_fma_f32 v82, v82, s24, -v13
    v_mfma_f32_16x16x32_bf16 v[26:29], v[22:25], v[224:227], v[26:29]
    v_exp_f32_e64 v81, v81
    v_fma_f32 v83, v83, s24, -v13
    v_exp_f32 v82, v82
    v_exp_f32 v83, v83
    v_cvt_pk_bf16_f32 v232, v80, v81
    v_cvt_pk_bf16_f32 v233, v82, v83
    v_fma_f32 v84, v84, s24, -v13
    v_fma_f32 v85, v85, s24, -v13
    v_fma_f32 v86, v86, s24, -v13
    v_fma_f32 v87, v87, s24, -v13
    v_exp_f32 v84, v84
    v_exp_f32 v85, v85
    v_exp_f32 v86, v86
    v_exp_f32 v87, v87
    v_cvt_pk_bf16_f32 v234, v84, v85
    v_cvt_pk_bf16_f32 v235, v86, v87
    s_nop 0
    s_nop 0
    v_mfma_f32_16x16x32_bf16 v[26:29], v[22:25], v[232:235], v[26:29]
    v_fma_f32 v88, v88, s24, -v14
    v_fma_f32 v89, v89, s24, -v14
    v_mfma_f32_16x16x32_bf16 v[30:33], v[22:25], v[228:231], v[30:33]
    v_exp_f32_e64 v88, v88
    v_fma_f32 v90, v90, s24, -v14
    v_fma_f32 v91, v91, s24, -v14
    v_exp_f32 v89, v89
    v_exp_f32 v90, v90
    v_exp_f32_e64 v91, v91
    v_cvt_pk_bf16_f32 v236, v88, v89
    v_cvt_pk_bf16_f32 v237, v90, v91
    v_fma_f32 v92, v92, s24, -v14
    v_fma_f32 v93, v93, s24, -v14
    v_fma_f32 v94, v94, s24, -v14
    v_fma_f32 v95, v95, s24, -v14
    v_exp_f32 v92, v92
    v_exp_f32 v93, v93
    v_exp_f32 v94, v94
    v_exp_f32 v95, v95
    v_cvt_pk_bf16_f32 v238, v92, v93
    v_cvt_pk_bf16_f32 v239, v94, v95
    s_nop 0
    s_nop 0
    v_mfma_f32_16x16x32_bf16 v[30:33], v[22:25], v[236:239], v[30:33]
    v_mfma_f32_16x16x32_bf16 v[34:37], v[22:25], a[200:203], v[34:37]
    v_mfma_f32_16x16x32_bf16 v[34:37], v[22:25], a[204:207], v[34:37]
    s_waitcnt lgkmcnt(2)
    s_nop 0
    s_nop 0
    s_nop 0
    s_nop 0
    s_nop 0
    v_add_f32 v46, v26, v30
    s_nop 0
    v_add_f32 v46, v46, v34
    s_nop 0
    v_cmp_nge_f32 vcc, s25, v46
    s_nop 0
    s_cbranch_vccnz L_slow_3
L_ret_3:
    v_mfma_f32_16x16x32_bf16 v[64:67], a[128:131], v[144:147], v[64:67]
    s_waitcnt vmcnt(4)
    ds_read_b64_tr_b16 a[140:141], v5 offset:28672
    ds_read_b64_tr_b16 a[142:143], v5 offset:30720
    v_mfma_f32_16x16x32_bf16 v[64:67], a[132:135], v[152:155], v[64:67]
    s_barrier
    ds_read_b64_tr_b16 a[240:241], v6 offset:16384
    ds_read_b64_tr_b16 a[242:243], v6 offset:18432
    v_mfma_f32_16x16x32_bf16 v[72:75], a[128:131], v[148:151], v[72:75]
    s_add_u32 m0, s30, 0
    ds_read_b64_tr_b16 a[244:245], v6 offset:20480
    ds_read_b64_tr_b16 a[246:247], v6 offset:22528
    v_mfma_f32_16x16x32_bf16 v[72:75], a[132:135], v[156:159], v[72:75]
    s_xor_b32 s48, s5, 0
    ds_read_b64_tr_b16 a[248:249], v6 offset:24576
    ds_read_b64_tr_b16 a[250:251], v6 offset:26624
    v_mfma_f32_16x16x32_bf16 v[38:41], a[128:131], a[160:163], v[38:41]
    ds_read_b64_tr_b16 a[252:253], v6 offset:28672
    ds_read_b64_tr_b16 a[254:255], v6 offset:30720
    v_mfma_f32_16x16x32_bf16 v[38:41], a[132:135], a[164:167], v[38:41]
    s_waitcnt lgkmcnt(8)
    ds_read_b64_tr_b16 a[128:129], v21 offset:16384
    ds_read_b64_tr_b16 a[130:131], v21 offset:18432
    v_mfma_f32_16x16x32_bf16 v[64:67], a[136:139], v[160:163], v[64:67]
    ds_read_b64_tr_b16 a[132:133], v21 offset:20480
    ds_read_b64_tr_b16 a[134:135], v21 offset:22528
    v_mfma_f32_16x16x32_bf16 v[64:67], a[140:143], v[168:171], v[64:67]
    buffer_load_dwordx4 v8, s[16:19], s48 offen offset:0 lds
    v_mfma_f32_16x16x32_bf16 v[72:75], a[136:139], v[164:167], v[72:75]
    v_rcp_f32 v17, v26
    v_mfma_f32_16x16x32_bf16 v[72:75], a[140:143], v[172:175], v[72:75]
    v_rcp_f32 v18, v30
    v_mfma_f32_16x16x32_bf16 v[38:41], a[136:139], a[168:171], v[38:41]
    ds_read_b64_tr_b16 a[136:137], v21 offset:24576
    ds_read_b64_tr_b16 a[138:139], v21 offset:26624
    v_mfma_f32_16x16x32_bf16 v[38:41], a[140:143], a[172:175], v[38:41]
    s_waitcnt lgkmcnt(10)
    ds_read_b64_tr_b16 a[140:141], v21 offset:28672
    ds_read_b64_tr_b16 a[142:143], v21 offset:30720
    v_mfma_f32_16x16x32_bf16 v[68:71], a[240:243], v[144:147], v[68:71]
    buffer_load_dwordx4 v8, s[16:19], s48 offen offset:1024 lds
    v_mfma_f32_16x16x32_bf16 v[68:71], a[244:247], v[152:155], v[68:71]
    v_rcp_f32 v19, v34
    v_mfma_f32_16x16x32_bf16 v[76:79], a[240:243], v[148:151], v[76:79]
    ds_read_b64_tr_b16 a[240:241], v45 offset:16384
    ds_read_b64_tr_b16 a[242:243], v45 offset:18432
    v_mfma_f32_16x16x32_bf16 v[76:79], a[244:247], v[156:159], v[76:79]
    s_waitcnt lgkmcnt(10)
    ds_read_b64_tr_b16 a[244:245], v45 offset:20480
    ds_read_b64_tr_b16 a[246:247], v45 offset:22528
    v_mfma_f32_16x16x32_bf16 v[68:71], a[248:251], v[160:163], v[68:71]
    buffer_load_dwordx4 v8, s[16:19], s48 offen offset:2048 lds
    v_mfma_f32_16x16x32_bf16 v[68:71], a[252:255], v[168:171], v[68:71]
    v_mbcnt_lo_u32_b32 v20, -1, 0
    v_mfma_f32_16x16x32_bf16 v[76:79], a[248:251], v[164:167], v[76:79]
    ds_read_b64_tr_b16 a[248:249], v45 offset:24576
    ds_read_b64_tr_b16 a[250:251], v45 offset:26624
    v_mfma_f32_16x16x32_bf16 v[76:79], a[252:255], v[172:175], v[76:79]
    s_waitcnt lgkmcnt(10)
    ds_read_b64_tr_b16 a[252:253], v45 offset:28672
    ds_read_b64_tr_b16 a[254:255], v45 offset:30720
    v_mfma_f32_16x16x32_bf16 v[96:99], a[128:131], v[144:147], v[96:99]
    buffer_load_dwordx4 v8, s[16:19], s48 offen offset:3072 lds
    v_mfma_f32_16x16x32_bf16 v[96:99], a[132:135], v[152:155], v[96:99]
    v_mbcnt_hi_u32_b32 v20, -1, v20
    v_mfma_f32_16x16x32_bf16 v[104:107], a[128:131], v[148:151], v[104:107]
    ds_read_b64_tr_b16 a[128:129], v5 offset:32768
    ds_read_b64_tr_b16 a[130:131], v5 offset:34816
    v_mfma_f32_16x16x32_bf16 v[104:107], a[132:135], v[156:159], v[104:107]
    s_waitcnt lgkmcnt(10)
    ds_read_b64_tr_b16 a[132:133], v5 offset:36864
    ds_read_b64_tr_b16 a[134:135], v5 offset:38912
    v_mfma_f32_16x16x32_bf16 v[96:99], a[136:139], v[160:163], v[96:99]
    v_and_b32 v16, 15, v20
    v_lshrrev_b32 v20, 1, v20
    v_mfma_f32_16x16x32_bf16 v[96:99], a[140:143], v[168:171], v[96:99]
    v_lshlrev_b32 v16, 9, v16
    v_mfma_f32_16x16x32_bf16 v[104:107], a[136:139], v[164:167], v[104:107]
    ds_read_b64_tr_b16 a[136:137], v5 offset:40960
    ds_read_b64_tr_b16 a[138:139], v5 offset:43008
    v_mfma_f32_16x16x32_bf16 v[104:107], a[140:143], v[172:175], v[104:107]
    s_waitcnt lgkmcnt(10)
    ds_read_b64_tr_b16 a[140:141], v5 offset:45056
    ds_read_b64_tr_b16 a[142:143], v5 offset:47104
    v_mfma_f32_16x16x32_bf16 v[100:103], a[240:243], v[144:147], v[100:103]
    v_and_or_b32 v16, v20, 24, v16
    v_mfma_f32_16x16x32_bf16 v[100:103], a[244:247], v[152:155], v[100:103]
    v_lshl_or_b32 v16, s38, 5, v16
    v_mfma_f32_16x16x32_bf16 v[108:111], a[240:243], v[148:151], v[108:111]
    ds_read_b64_tr_b16 a[240:241], v6 offset:32768
    ds_read_b64_tr_b16 a[242:243], v6 offset:34816
    v_mfma_f32_16x16x32_bf16 v[108:111], a[244:247], v[156:159], v[108:111]
    s_waitcnt lgkmcnt(10)
    ds_read_b64_tr_b16 a[244:245], v6 offset:36864
    ds_read_b64_tr_b16 a[246:247], v6 offset:38912
    v_mfma_f32_16x16x32_bf16 v[100:103], a[248:251], v[160:163], v[100:103]
    v_mfma_f32_16x16x32_bf16 v[100:103], a[252:255], v[168:171], v[100:103]
    v_mfma_f32_16x16x32_bf16 v[108:111], a[248:251], v[164:167], v[108:111]
    ds_read_b64_tr_b16 a[248:249], v6 offset:40960
    ds_read_b64_tr_b16 a[250:251], v6 offset:43008
    v_mfma_f32_16x16x32_bf16 v[108:111], a[252:255], v[172:175], v[108:111]
    s_waitcnt lgkmcnt(10)
    v_mfma_f32_16x16x32_bf16 v[64:67], a[128:131], v[176:179], v[64:67]
    s_waitcnt vmcnt(4)
    ds_read_b64_tr_b16 a[252:253], v6 offset:45056
    ds_read_b64_tr_b16 a[254:255], v6 offset:47104
    v_mfma_f32_16x16x32_bf16 v[64:67], a[132:135], v[184:187], v[64:67]
    s_barrier
    v_mfma_f32_16x16x32_bf16 v[72:75], a[128:131], v[180:183], v[72:75]
    s_add_u32 m0, s30, 16384
    v_mfma_f32_16x16x32_bf16 v[72:75], a[132:135], v[188:191], v[72:75]
    s_xor_b32 s48, s5, 65536
    v_mfma_f32_16x16x32_bf16 v[38:41], a[128:131], a[176:179], v[38:41]
    ds_read_b64_tr_b16 a[128:129], v21 offset:32768
    ds_read_b64_tr_b16 a[130:131], v21 offset:34816
    v_mfma_f32_16x16x32_bf16 v[38:41], a[132:135], a[180:183], v[38:41]
    s_waitcnt lgkmcnt(10)
    ds_read_b64_tr_b16 a[132:133], v21 offset:36864
    ds_read_b64_tr_b16 a[134:135], v21 offset:38912
    v_mfma_f32_16x16x32_bf16 v[64:67], a[136:139], v[192:195], v[64:67]
    buffer_load_dwordx4 v8, s[16:19], s48 offen offset:0 lds
    v_mfma_f32_16x16x32_bf16 v[64:67], a[140:143], v[200:203], v[64:67]
    v_mfma_f32_16x16x32_bf16 v[72:75], a[136:139], v[196:199], v[72:75]
    v_mfma_f32_16x16x32_bf16 v[72:75], a[140:143], v[204:207], v[72:75]
    buffer_load_dwordx4 v8, s[16:19], s48 offen offset:1024 lds
    v_mfma_f32_16x16x32_bf16 v[38:41], a[136:139], a[184:187], v[38:41]
    ds_read_b64_tr_b16 a[136:137], v21 offset:40960
    ds_read_b64_tr_b16 a[138:139], v21 offset:43008
    v_mfma_f32_16x16x32_bf16 v[38:41], a[140:143], a[188:191], v[38:41]
    s_waitcnt lgkmcnt(10)
    ds_read_b64_tr_b16 a[140:141], v21 offset:45056
    ds_read_b64_tr_b16 a[142:143], v21 offset:47104
    v_mfma_f32_16x16x32_bf16 v[68:71], a[240:243], v[176:179], v[68:71]
    buffer_load_dwordx4 v8, s[16:19], s48 offen offset:2048 lds
L_t3_4:
    s_cbranch_execz L_tback3
    v_mfma_f32_16x16x32_bf16 v[68:71], a[244:247], v[184:187], v[68:71]
    v_mfma_f32_16x16x32_bf16 v[76:79], a[240:243], v[180:183], v[76:79]
    ds_read_b64_tr_b16 a[240:241], v45 offset:32768
    ds_read_b64_tr_b16 a[242:243], v45 offset:34816
    v_mfma_f32_16x16x32_bf16 v[76:79], a[244:247], v[188:191], v[76:79]
    s_waitcnt lgkmcnt(10)
    ds_read_b64_tr_b16 a[244:245], v45 offset:36864
    ds_read_b64_tr_b16 a[246:247], v45 offset:38912
    v_mfma_f32_16x16x32_bf16 v[68:71], a[248:251], v[192:195], v[68:71]
    buffer_load_dwordx4 v8, s[16:19], s48 offen offset:3072 lds
    v_mfma_f32_16x16x32_bf16 v[68:71], a[252:255], v[200:203], v[68:71]
    v_mfma_f32_16x16x32_bf16 v[76:79], a[248:251], v[196:199], v[76:79]
    ds_read_b64_tr_b16 a[248:249], v45 offset:40960
    ds_read_b64_tr_b16 a[250:251], v45 offset:43008
    v_mfma_f32_16x16x32_bf16 v[76:79], a[252:255], v[204:207], v[76:79]
    s_waitcnt lgkmcnt(10)
    ds_read_b64_tr_b16 a[252:253], v45 offset:45056
    ds_read_b64_tr_b16 a[254:255], v45 offset:47104
    v_mfma_f32_16x16x32_bf16 v[96:99], a[128:131], v[176:179], v[96:99]
    v_mfma_f32_16x16x32_bf16 v[96:99], a[132:135], v[184:187], v[96:99]
    v_mfma_f32_16x16x32_bf16 v[104:107], a[128:131], v[180:183], v[104:107]
    ds_read_b64_tr_b16 a[128:129], v5 offset:49152
    ds_read_b64_tr_b16 a[130:131], v5 offset:51200
    v_mfma_f32_16x16x32_bf16 v[104:107], a[132:135], v[188:191], v[104:107]
    s_waitcnt lgkmcnt(10)
    ds_read_b64_tr_b16 a[132:133], v5 offset:53248
    ds_read_b64_tr_b16 a[134:135], v5 offset:55296
    v_mfma_f32_16x16x32_bf16 v[96:99], a[136:139], v[192:195], v[96:99]
    v_mfma_f32_16x16x32_bf16 v[96:99], a[140:143], v[200:203], v[96:99]
    v_mfma_f32_16x16x32_bf16 v[104:107], a[136:139], v[196:199], v[104:107]
    ds_read_b64_tr_b16 a[136:137], v5 offset:57344
    ds_read_b64_tr_b16 a[138:139], v5 offset:59392
    v_mfma_f32_16x16x32_bf16 v[104:107], a[140:143], v[204:207], v[104:107]
    s_waitcnt lgkmcnt(10)
    ds_read_b64_tr_b16 a[140:141], v5 offset:61440
    ds_read_b64_tr_b16 a[142:143], v5 offset:63488
    v_mfma_f32_16x16x32_bf16 v[100:103], a[240:243], v[176:179], v[100:103]
    v_mfma_f32_16x16x32_bf16 v[100:103], a[244:247], v[184:187], v[100:103]
    v_mfma_f32_16x16x32_bf16 v[108:111], a[240:243], v[180:183], v[108:111]
    ds_read_b64_tr_b16 a[240:241], v6 offset:49152
    ds_read_b64_tr_b16 a[242:243], v6 offset:51200
    v_mfma_f32_16x16x32_bf16 v[108:111], a[244:247], v[188:191], v[108:111]
    s_waitcnt lgkmcnt(10)
    ds_read_b64_tr_b16 a[244:245], v6 offset:53248
    ds_read_b64_tr_b16 a[246:247], v6 offset:55296
    v_mfma_f32_16x16x32_bf16 v[100:103], a[248:251], v[192:195], v[100:103]
    v_mfma_f32_16x16x32_bf16 v[100:103], a[252:255], v[200:203], v[100:103]
    v_mfma_f32_16x16x32_bf16 v[108:111], a[248:251], v[196:199], v[108:111]
    ds_read_b64_tr_b16 a[248:249], v6 offset:57344
    ds_read_b64_tr_b16 a[250:251], v6 offset:59392
    v_mfma_f32_16x16x32_bf16 v[108:111], a[252:255], v[204:207], v[108:111]
    s_waitcnt lgkmcnt(10)
    v_mfma_f32_16x16x32_bf16 v[64:67], a[128:131], v[208:211], v[64:67]
    s_waitcnt vmcnt(4)
    ds_read_b64_tr_b16 a[252:253], v6 offset:61440
    ds_read_b64_tr_b16 a[254:255], v6 offset:63488
    v_mfma_f32_16x16x32_bf16 v[64:67], a[132:135], v[216:219], v[64:67]
    s_barrier
    v_xor_b32 v43, 32, v11
    v_xor_b32 v42, 64, v11
    v_mfma_f32_16x16x32_bf16 v[72:75], a[128:131], v[212:215], v[72:75]
    s_add_u32 m0, s30, 32768
    v_mfma_f32_16x16x32_bf16 v[72:75], a[132:135], v[220:223], v[72:75]
    s_xor_b32 s48, s5, 131072
    v_mfma_f32_16x16x32_bf16 v[38:41], a[128:131], a[192:195], v[38:41]
    s_add_u32 s51, s8, 65536
    ds_read_b64_tr_b16 a[128:129], v21 offset:49152
    ds_read_b64_tr_b16 a[130:131], v21 offset:51200
    v_mfma_f32_16x16x32_bf16 v[38:41], a[132:135], a[196:199], v[38:41]
    s_waitcnt lgkmcnt(10)
    ds_read_b64_tr_b16 a[132:133], v21 offset:53248
    ds_read_b64_tr_b16 a[134:135], v21 offset:55296
    v_mfma_f32_16x16x32_bf16 v[64:67], a[136:139], v[224:227], v[64:67]
    buffer_load_dwordx4 v8, s[16:19], s48 offen offset:0 lds
    v_mfma_f32_16x16x32_bf16 v[64:67], a[140:143], v[232:235], v[64:67]
    s_add_u32 s50, s8, 0
    v_mfma_f32_16x16x32_bf16 v[72:75], a[136:139], v[228:231], v[72:75]
    v_mfma_f32_16x16x32_bf16 v[72:75], a[140:143], v[236:239], v[72:75]
    buffer_load_dwordx4 v8, s[16:19], s48 offen offset:1024 lds
    v_mfma_f32_16x16x32_bf16 v[38:41], a[136:139], a[200:203], v[38:41]
    ds_read_b64_tr_b16 a[136:137], v21 offset:57344
    ds_read_b64_tr_b16 a[138:139], v21 offset:59392
    v_mfma_f32_16x16x32_bf16 v[38:41], a[140:143], a[204:207], v[38:41]
    s_waitcnt lgkmcnt(10)
    ds_read_b64_tr_b16 a[140:141], v21 offset:61440
    ds_read_b64_tr_b16 a[142:143], v21 offset:63488
    v_mfma_f32_16x16x32_bf16 v[68:71], a[240:243], v[208:211], v[68:71]
    buffer_load_dwordx4 v8, s[16:19], s48 offen offset:2048 lds
    v_mfma_f32_16x16x32_bf16 v[68:71], a[244:247], v[216:219], v[68:71]
    v_mul_f32 v64, v64, v17
    v_mul_f32 v65, v65, v17
    v_mfma_f32_16x16x32_bf16 v[76:79], a[240:243], v[212:215], v[76:79]
    ds_read_b64_tr_b16 a[240:241], v45 offset:49152
    ds_read_b64_tr_b16 a[242:243], v45 offset:51200
    v_mfma_f32_16x16x32_bf16 v[76:79], a[244:247], v[220:223], v[76:79]
    s_waitcnt lgkmcnt(10)
    ds_read_b64_tr_b16 a[244:245], v45 offset:53248
    ds_read_b64_tr_b16 a[246:247], v45 offset:55296
    v_mfma_f32_16x16x32_bf16 v[68:71], a[248:251], v[224:227], v[68:71]
    buffer_load_dwordx4 v8, s[16:19], s48 offen offset:3072 lds
    v_mfma_f32_16x16x32_bf16 v[68:71], a[252:255], v[232:235], v[68:71]
    v_mul_f32 v66, v66, v17
    v_mul_f32 v67, v67, v17
    v_mfma_f32_16x16x32_bf16 v[76:79], a[248:251], v[228:231], v[76:79]
    ds_read_b64_tr_b16 a[248:249], v45 offset:57344
    ds_read_b64_tr_b16 a[250:251], v45 offset:59392
    v_mfma_f32_16x16x32_bf16 v[76:79], a[252:255], v[236:239], v[76:79]
    s_waitcnt lgkmcnt(10)
    ds_read_b64_tr_b16 a[252:253], v45 offset:61440
    ds_read_b64_tr_b16 a[254:255], v45 offset:63488
    v_mfma_f32_16x16x32_bf16 v[96:99], a[128:131], v[208:211], v[96:99]
    v_cvt_pk_bf16_f32 v64, v64, v65
    v_cvt_pk_bf16_f32 v65, v66, v67
    v_mfma_f32_16x16x32_bf16 v[96:99], a[132:135], v[216:219], v[96:99]
    ds_write_b64 v11, v[64:65] offset:0
    v_mfma_f32_16x16x32_bf16 v[104:107], a[128:131], v[212:215], v[104:107]
    ds_read_b64_tr_b16 a[128:129], v5 offset:0
    ds_read_b64_tr_b16 a[130:131], v5 offset:2048
    v_mfma_f32_16x16x32_bf16 v[104:107], a[132:135], v[220:223], v[104:107]
    s_waitcnt lgkmcnt(11)
    ds_read_b64_tr_b16 a[132:133], v5 offset:4096
    ds_read_b64_tr_b16 a[134:135], v5 offset:6144
    v_mfma_f32_16x16x32_bf16 v[96:99], a[136:139], v[224:227], v[96:99]
    v_mul_f32 v72, v72, v18
    v_mul_f32 v73, v73, v18
    v_mfma_f32_16x16x32_bf16 v[96:99], a[140:143], v[232:235], v[96:99]
    v_mul_f32 v74, v74, v18
    v_mul_f32 v75, v75, v18
    v_mfma_f32_16x16x32_bf16 v[104:107], a[136:139], v[228:231], v[104:107]
    ds_read_b64_tr_b16 a[136:137], v5 offset:8192
    ds_read_b64_tr_b16 a[138:139], v5 offset:10240
    v_mfma_f32_16x16x32_bf16 v[104:107], a[140:143], v[236:239], v[104:107]
    s_waitcnt lgkmcnt(11)
    ds_read_b64_tr_b16 a[140:141], v5 offset:12288
    ds_read_b64_tr_b16 a[142:143], v5 offset:14336
    v_mfma_f32_16x16x32_bf16 v[100:103], a[240:243], v[208:211], v[100:103]
    v_cvt_pk_bf16_f32 v72, v72, v73
    v_cvt_pk_bf16_f32 v73, v74, v75
    v_mfma_f32_16x16x32_bf16 v[100:103], a[244:247], v[216:219], v[100:103]
    ds_write_b64 v11, v[72:73] offset:2048
    v_mfma_f32_16x16x32_bf16 v[108:111], a[240:243], v[212:215], v[108:111]
    ds_read_b64_tr_b16 a[240:241], v6 offset:0
    ds_read_b64_tr_b16 a[242:243], v6 offset:2048
    v_mfma_f32_16x16x32_bf16 v[108:111], a[244:247], v[220:223], v[108:111]
    s_waitcnt lgkmcnt(12)
    ds_read_b64_tr_b16 a[244:245], v6 offset:4096
    ds_read_b64_tr_b16 a[246:247], v6 offset:6144
    v_mfma_f32_16x16x32_bf16 v[100:103], a[248:251], v[224:227], v[100:103]
    v_mul_f32 v68, v68, v17
    v_mul_f32 v69, v69, v17
    v_mfma_f32_16x16x32_bf16 v[100:103], a[252:255], v[232:235], v[100:103]
    v_mul_f32 v70, v70, v17
    v_mul_f32 v71, v71, v17
    v_mfma_f32_16x16x32_bf16 v[108:111], a[248:251], v[228:231], v[108:111]
    ds_read_b64_tr_b16 a[248:249], v6 offset:8192
    ds_read_b64_tr_b16 a[250:251], v6 offset:10240
    v_mfma_f32_16x16x32_bf16 v[108:111], a[252:255], v[236:239], v[108:111]
    s_waitcnt lgkmcnt(11)
    v_cvt_pk_bf16_f32 v68, v68, v69
    v_cvt_pk_bf16_f32 v69, v70, v71
    v_mfma_f32_16x16x32_bf16 v[48:51], a[128:131], v[112:115], 0
    s_waitcnt vmcnt(4)
    ds_read_b64_tr_b16 a[252:253], v6 offset:12288
    ds_read_b64_tr_b16 a[254:255], v6 offset:14336
    v_mfma_f32_16x16x32_bf16 v[48:51], a[132:135], v[120:123], v[48:51]
    s_barrier
    ds_write_b64 v43, v[68:69] offset:0
    v_mfma_f32_16x16x32_bf16 v[56:59], a[128:131], v[116:119], 0
    s_add_u32 m0, s30, 49152
    v_mul_f32 v76, v76, v18
    v_mul_f32 v77, v77, v18
    v_mfma_f32_16x16x32_bf16 v[56:59], a[132:135], v[124:127], v[56:59]
    s_xor_b32 s48, s5, 196608
    v_mul_f32 v78, v78, v18
    v_mul_f32 v79, v79, v18
    v_mfma_f32_16x16x32_bf16 v[34:37], a[128:131], a[144:147], 0
    ds_read_b64_tr_b16 a[128:129], v21 offset:0
    ds_read_b64_tr_b16 a[130:131], v21 offset:2048
    v_mfma_f32_16x16x32_bf16 v[34:37], a[132:135], a[148:151], v[34:37]
    s_waitcnt lgkmcnt(12)
    ds_read_b64_tr_b16 a[132:133], v21 offset:4096
    ds_read_b64_tr_b16 a[134:135], v21 offset:6144
    v_mfma_f32_16x16x32_bf16 v[48:51], a[136:139], v[128:131], v[48:51]
    buffer_load_dwordx4 v8, s[16:19], s48 offen offset:0 lds
    v_mfma_f32_16x16x32_bf16 v[48:51], a[140:143], v[136:139], v[48:51]
    v_cvt_pk_bf16_f32 v76, v76, v77
    v_cvt_pk_bf16_f32 v77, v78, v79
    v_mfma_f32_16x16x32_bf16 v[56:59], a[136:139], v[132:135], v[56:59]
    ds_write_b64 v43, v[76:77] offset:2048
    v_mfma_f32_16x16x32_bf16 v[56:59], a[140:143], v[140:143], v[56:59]
    buffer_load_dwordx4 v8, s[16:19], s48 offen offset:1024 lds
    v_mfma_f32_16x16x32_bf16 v[34:37], a[136:139], a[152:155], v[34:37]
    ds_read_b64_tr_b16 a[136:137], v21 offset:8192
    ds_read_b64_tr_b16 a[138:139], v21 offset:10240
    v_mfma_f32_16x16x32_bf16 v[34:37], a[140:143], a[156:159], v[34:37]
    s_waitcnt lgkmcnt(12)
    ds_read_b64_tr_b16 a[140:141], v21 offset:12288
    ds_read_b64_tr_b16 a[142:143], v21 offset:14336
    v_mfma_f32_16x16x32_bf16 v[52:55], a[240:243], v[112:115], 0
    buffer_load_dwordx4 v8, s[16:19], s48 offen offset:2048 lds
    v_mfma_f32_16x16x32_bf16 v[52:55], a[244:247], v[120:123], v[52:55]
    v_xor_b32 v43, 96, v11
    v_mul_f32 v96, v96, v17
    v_mfma_f32_16x16x32_bf16 v[60:63], a[240:243], v[116:119], 0
    ds_read_b64_tr_b16 a[240:241], v45 offset:0
    ds_read_b64_tr_b16 a[242:243], v45 offset:2048
    v_mfma_f32_16x16x32_bf16 v[60:63], a[244:247], v[124:127], v[60:63]
    s_waitcnt lgkmcnt(12)
    ds_read_b64_tr_b16 a[244:245], v45 offset:4096
    ds_read_b64_tr_b16 a[246:247], v45 offset:6144
    v_mfma_f32_16x16x32_bf16 v[52:55], a[248:251], v[128:131], v[52:55]
    buffer_load_dwordx4 v8, s[16:19], s48 offen offset:3072 lds
    v_mfma_f32_16x16x32_bf16 v[52:55], a[252:255], v[136:139], v[52:55]
    v_mul_f32 v97, v97, v17
    v_mul_f32 v98, v98, v17
    v_mfma_f32_16x16x32_bf16 v[60:63], a[248:251], v[132:135], v[60:63]
    ds_read_b64_tr_b16 a[248:249], v45 offset:8192
    ds_read_b64_tr_b16 a[250:251], v45 offset:10240
    v_mfma_f32_16x16x32_bf16 v[60:63], a[252:255], v[140:143], v[60:63]
    s_waitcnt lgkmcnt(11)
    ds_read_b64_tr_b16 a[252:253], v45 offset:12288
    ds_read_b64_tr_b16 a[254:255], v45 offset:14336
    v_mfma_f32_16x16x32_bf16 v[80:83], a[128:131], v[112:115], 0
    v_mul_f32 v99, v99, v17
    v_cvt_pk_bf16_f32 v96, v96, v97
    v_mfma_f32_16x16x32_bf16 v[80:83], a[132:135], v[120:123], v[80:83]
    v_cvt_pk_bf16_f32 v97, v98, v99
    v_mul_f32 v104, v104, v18
    v_mfma_f32_16x16x32_bf16 v[88:91], a[128:131], v[116:119], 0
    ds_read_b64_tr_b16 a[128:129], v5 offset:16384
    ds_read_b64_tr_b16 a[130:131], v5 offset:18432
    v_mfma_f32_16x16x32_bf16 v[88:91], a[132:135], v[124:127], v[88:91]
    s_waitcnt lgkmcnt(10)
    ds_read_b64_tr_b16 a[132:133], v5 offset:20480
    ds_read_b64_tr_b16 a[134:135], v5 offset:22528
    v_mfma_f32_16x16x32_bf16 v[80:83], a[136:139], v[128:131], v[80:83]
    ds_write_b64 v42, v[96:97] offset:0
    v_mfma_f32_16x16x32_bf16 v[80:83], a[140:143], v[136:139], v[80:83]
    v_mul_f32 v105, v105, v18
    v_mul_f32 v106, v106, v18
    v_mfma_f32_16x16x32_bf16 v[88:91], a[136:139], v[132:135], v[88:91]
    ds_read_b64_tr_b16 a[136:137], v5 offset:24576
    ds_read_b64_tr_b16 a[138:139], v5 offset:26624
    v_mfma_f32_16x16x32_bf16 v[88:91], a[140:143], v[140:143], v[88:91]
    s_waitcnt lgkmcnt(11)
    ds_read_b64_tr_b16 a[140:141], v5 offset:28672
    ds_read_b64_tr_b16 a[142:143], v5 offset:30720
    v_mfma_f32_16x16x32_bf16 v[84:87], a[240:243], v[112:115], 0
    v_mul_f32 v107, v107, v18
    v_cvt_pk_bf16_f32 v104, v104, v105
    v_mfma_f32_16x16x32_bf16 v[84:87], a[244:247], v[120:123], v[84:87]
    v_cvt_pk_bf16_f32 v105, v106, v107
    v_mul_f32 v100, v100, v17
    v_mfma_f32_16x16x32_bf16 v[92:95], a[240:243], v[116:119], 0
    ds_read_b64_tr_b16 a[240:241], v6 offset:16384
    ds_read_b64_tr_b16 a[242:243], v6 offset:18432
    v_mfma_f32_16x16x32_bf16 v[92:95], a[244:247], v[124:127], v[92:95]
    s_waitcnt lgkmcnt(11)
    ds_read_b64_tr_b16 a[244:245], v6 offset:20480
    ds_read_b64_tr_b16 a[246:247], v6 offset:22528
    v_mfma_f32_16x16x32_bf16 v[84:87], a[248:251], v[128:131], v[84:87]
    ds_write_b64 v42, v[104:105] offset:2048
    v_mfma_f32_16x16x32_bf16 v[84:87], a[252:255], v[136:139], v[84:87]
    v_mul_f32 v101, v101, v17
    v_mul_f32 v102, v102, v17
    v_mfma_f32_16x16x32_bf16 v[92:95], a[248:251], v[132:135], v[92:95]
    ds_read_b64_tr_b16 a[248:249], v6 offset:24576
    ds_read_b64_tr_b16 a[250:251], v6 offset:26624
    v_mfma_f32_16x16x32_bf16 v[92:95], a[252:255], v[140:143], v[92:95]
    s_waitcnt lgkmcnt(12)
    v_mul_f32 v103, v103, v17
    v_cvt_pk_bf16_f32 v100, v100, v101
    v_mfma_f32_16x16x32_bf16 v[48:51], a[128:131], v[144:147], v[48:51]
    s_waitcnt vmcnt(4)
    ds_read_b64_tr_b16 a[252:253], v6 offset:28672
    ds_read_b64_tr_b16 a[254:255], v6 offset:30720
    v_mfma_f32_16x16x32_bf16 v[48:51], a[132:135], v[152:155], v[48:51]
    s_barrier
    v_cvt_pk_bf16_f32 v101, v102, v103
    v_mul_f32 v108, v108, v18
    v_mfma_f32_16x16x32_bf16 v[56:59], a[128:131], v[148:151], v[56:59]
    s_add_u32 m0, s30, 0
    ds_write_b64 v43, v[100:101] offset:0
    v_mfma_f32_16x16x32_bf16 v[56:59], a[132:135], v[156:159], v[56:59]
    s_xor_b32 s48, s6, 0
    v_mul_f32 v109, v109, v18
    v_mul_f32 v110, v110, v18
    v_mfma_f32_16x16x32_bf16 v[34:37], a[128:131], a[160:163], v[34:37]
    ds_read_b64_tr_b16 a[128:129], v21 offset:16384
    ds_read_b64_tr_b16 a[130:131], v21 offset:18432
    v_mfma_f32_16x16x32_bf16 v[34:37], a[132:135], a[164:167], v[34:37]
    s_waitcnt lgkmcnt(12)
    ds_read_b64_tr_b16 a[132:133], v21 offset:20480
    ds_read_b64_tr_b16 a[134:135], v21 offset:22528
    v_mfma_f32_16x16x32_bf16 v[48:51], a[136:139], v[160:163], v[48:51]
    buffer_load_dwordx4 v8, s[16:19], s48 offen offset:0 lds
    v_mfma_f32_16x16x32_bf16 v[48:51], a[140:143], v[168:171], v[48:51]
    v_mul_f32 v111, v111, v18
    v_cvt_pk_bf16_f32 v108, v108, v109
    v_mfma_f32_16x16x32_bf16 v[56:59], a[136:139], v[164:167], v[56:59]
    v_cvt_pk_bf16_f32 v109, v110, v111
    v_mul_f32 v38, v38, v19
    v_mfma_f32_16x16x32_bf16 v[56:59], a[140:143], v[172:175], v[56:59]
    ds_write_b64 v43, v[108:109] offset:2048
    v_mfma_f32_16x16x32_bf16 v[34:37], a[136:139], a[168:171], v[34:37]
    ds_read_b64_tr_b16 a[136:137], v21 offset:24576
    ds_read_b64_tr_b16 a[138:139], v21 offset:26624
    v_mfma_f32_16x16x32_bf16 v[34:37], a[140:143], a[172:175], v[34:37]
    s_waitcnt lgkmcnt(13)
    ds_read_b64_tr_b16 a[140:141], v21 offset:28672
    ds_read_b64_tr_b16 a[142:143], v21 offset:30720
    v_mfma_f32_16x16x32_bf16 v[52:55], a[240:243], v[144:147], v[52:55]
    buffer_load_dwordx4 v8, s[16:19], s48 offen offset:1024 lds
    v_mfma_f32_16x16x32_bf16 v[52:55], a[244:247], v[152:155], v[52:55]
    ds_read_b128 v[26:29], v0 offset:0
    v_mul_f32 v39, v39, v19
    v_mfma_f32_16x16x32_bf16 v[60:63], a[240:243], v[148:151], v[60:63]
    ds_read_b64_tr_b16 a[240:241], v45 offset:16384
    ds_read_b64_tr_b16 a[242:243], v45 offset:18432
    v_mfma_f32_16x16x32_bf16 v[60:63], a[244:247], v[156:159], v[60:63]
    s_waitcnt lgkmcnt(13)
    ds_read_b64_tr_b16 a[244:245], v45 offset:20480
    ds_read_b64_tr_b16 a[246:247], v45 offset:22528
    v_mfma_f32_16x16x32_bf16 v[52:55], a[248:251], v[160:163], v[52:55]
    buffer_load_dwordx4 v8, s[16:19], s48 offen offset:2048 lds
    v_mfma_f32_16x16x32_bf16 v[52:55], a[252:255], v[168:171], v[52:55]
    ds_read_b64 v[30:31], v0 offset:1032
    v_mul_f32 v40, v40, v19
    v_mfma_f32_16x16x32_bf16 v[60:63], a[248:251], v[164:167], v[60:63]
    ds_read_b64_tr_b16 a[248:249], v45 offset:24576
    ds_read_b64_tr_b16 a[250:251], v45 offset:26624
    v_mfma_f32_16x16x32_bf16 v[60:63], a[252:255], v[172:175], v[60:63]
    s_waitcnt lgkmcnt(13)
    ds_read_b64_tr_b16 a[252:253], v45 offset:28672
    ds_read_b64_tr_b16 a[254:255], v45 offset:30720
    v_mfma_f32_16x16x32_bf16 v[80:83], a[128:131], v[144:147], v[80:83]
    buffer_load_dwordx4 v8, s[16:19], s48 offen offset:3072 lds
    v_mfma_f32_16x16x32_bf16 v[80:83], a[132:135], v[152:155], v[80:83]
    ds_read_b64 v[32:33], v0 offset:1024
    v_mul_f32 v41, v41, v19
    v_mfma_f32_16x16x32_bf16 v[88:91], a[128:131], v[148:151], v[88:91]
    ds_read_b64_tr_b16 a[128:129], v5 offset:32768
    ds_read_b64_tr_b16 a[130:131], v5 offset:34816
    v_mfma_f32_16x16x32_bf16 v[88:91], a[132:135], v[156:159], v[88:91]
    s_waitcnt lgkmcnt(13)
    ds_read_b64_tr_b16 a[132:133], v5 offset:36864
    ds_read_b64_tr_b16 a[134:135], v5 offset:38912
    v_mfma_f32_16x16x32_bf16 v[80:83], a[136:139], v[160:163], v[80:83]
    v_cvt_pk_bf16_f32 v38, v38, v39
    v_cvt_pk_bf16_f32 v39, v40, v41
    v_mfma_f32_16x16x32_bf16 v[80:83], a[140:143], v[168:171], v[80:83]
    buffer_store_dwordx2 v[38:39], v16, s[20:23], s51 offen nt
    v_mfma_f32_16x16x32_bf16 v[88:91], a[136:139], v[164:167], v[88:91]
    ds_read_b64_tr_b16 a[136:137], v5 offset:40960
    ds_read_b64_tr_b16 a[138:139], v5 offset:43008
    v_mfma_f32_16x16x32_bf16 v[88:91], a[140:143], v[172:175], v[88:91]
    s_waitcnt lgkmcnt(12)
    ds_read_b64_tr_b16 a[140:141], v5 offset:45056
    ds_read_b64_tr_b16 a[142:143], v5 offset:47104
    v_mfma_f32_16x16x32_bf16 v[84:87], a[240:243], v[144:147], v[84:87]
    buffer_store_dwordx4 v[26:29], v12, s[20:23], s50 offen nt
    v_mfma_f32_16x16x32_bf16 v[84:87], a[244:247], v[152:155], v[84:87]
    s_add_u32 s50, s8, 4096
    ds_read_b128 v[26:29], v0 offset:2048
    v_mfma_f32_16x16x32_bf16 v[92:95], a[240:243], v[148:151], v[92:95]
    ds_read_b64_tr_b16 a[240:241], v6 offset:32768
    ds_read_b64_tr_b16 a[242:243], v6 offset:34816
    v_mfma_f32_16x16x32_bf16 v[92:95], a[244:247], v[156:159], v[92:95]
    s_waitcnt lgkmcnt(12)
    ds_read_b64_tr_b16 a[244:245], v6 offset:36864
    ds_read_b64_tr_b16 a[246:247], v6 offset:38912
    v_mfma_f32_16x16x32_bf16 v[84:87], a[248:251], v[160:163], v[84:87]
    v_mfma_f32_16x16x32_bf16 v[84:87], a[252:255], v[168:171], v[84:87]
    v_mfma_f32_16x16x32_bf16 v[92:95], a[248:251], v[164:167], v[92:95]
    ds_read_b64_tr_b16 a[248:249], v6 offset:40960
    ds_read_b64_tr_b16 a[250:251], v6 offset:43008
    v_mfma_f32_16x16x32_bf16 v[92:95], a[252:255], v[172:175], v[92:95]
    s_waitcnt lgkmcnt(11)
    v_mfma_f32_16x16x32_bf16 v[48:51], a[128:131], v[176:179], v[48:51]
    s_waitcnt vmcnt(6)
    ds_read_b64_tr_b16 a[252:253], v6 offset:45056
    ds_read_b64_tr_b16 a[254:255], v6 offset:47104
    v_mfma_f32_16x16x32_bf16 v[48:51], a[132:135], v[184:187], v[48:51]
    s_barrier
    v_mfma_f32_16x16x32_bf16 v[56:59], a[128:131], v[180:183], v[56:59]
    s_add_u32 m0, s30, 16384
    v_mfma_f32_16x16x32_bf16 v[56:59], a[132:135], v[188:191], v[56:59]
    s_xor_b32 s48, s6, 65536
    v_mfma_f32_16x16x32_bf16 v[34:37], a[128:131], a[176:179], v[34:37]
    ds_read_b64_tr_b16 a[128:129], v21 offset:32768
    ds_read_b64_tr_b16 a[130:131], v21 offset:34816
    v_mfma_f32_16x16x32_bf16 v[34:37], a[132:135], a[180:183], v[34:37]
    s_waitcnt lgkmcnt(11)
    ds_read_b64_tr_b16 a[132:133], v21 offset:36864
    ds_read_b64_tr_b16 a[134:135], v21 offset:38912
    v_mfma_f32_16x16x32_bf16 v[48:51], a[136:139], v[192:195], v[48:51]
    buffer_load_dwordx4 v8, s[16:19], s48 offen offset:0 lds
    v_mfma_f32_16x16x32_bf16 v[48:51], a[140:143], v[200:203], v[48:51]
    v_mfma_f32_16x16x32_bf16 v[56:59], a[136:139], v[196:199], v[56:59]
    v_mfma_f32_16x16x32_bf16 v[56:59], a[140:143], v[204:207], v[56:59]
    buffer_load_dwordx4 v8, s[16:19], s48 offen offset:1024 lds
    v_mfma_f32_16x16x32_bf16 v[34:37], a[136:139], a[184:187], v[34:37]
    ds_read_b64_tr_b16 a[136:137], v21 offset:40960
    ds_read_b64_tr_b16 a[138:139], v21 offset:43008
    v_mfma_f32_16x16x32_bf16 v[34:37], a[140:143], a[188:191], v[34:37]
    s_waitcnt lgkmcnt(10)
    ds_read_b64_tr_b16 a[140:141], v21 offset:45056
    ds_read_b64_tr_b16 a[142:143], v21 offset:47104
    v_mfma_f32_16x16x32_bf16 v[52:55], a[240:243], v[176:179], v[52:55]
    buffer_load_dwordx4 v8, s[16:19], s48 offen offset:2048 lds
    v_mfma_f32_16x16x32_bf16 v[52:55], a[244:247], v[184:187], v[52:55]
    v_mfma_f32_16x16x32_bf16 v[60:63], a[240:243], v[180:183], v[60:63]
    ds_read_b64_tr_b16 a[240:241], v45 offset:32768
    ds_read_b64_tr_b16 a[242:243], v45 offset:34816
    v_mfma_f32_16x16x32_bf16 v[60:63], a[244:247], v[188:191], v[60:63]
    s_waitcnt lgkmcnt(10)
    ds_read_b64_tr_b16 a[244:245], v45 offset:36864
    ds_read_b64_tr_b16 a[246:247], v45 offset:38912
    v_mfma_f32_16x16x32_bf16 v[52:55], a[248:251], v[192:195], v[52:55]
    buffer_load_dwordx4 v8, s[16:19], s48 offen offset:3072 lds
    v_mfma_f32_16x16x32_bf16 v[52:55], a[252:255], v[200:203], v[52:55]
    v_mfma_f32_16x16x32_bf16 v[60:63], a[248:251], v[196:199], v[60:63]
    ds_read_b64_tr_b16 a[248:249], v45 offset:40960
    ds_read_b64_tr_b16 a[250:251], v45 offset:43008
    v_mfma_f32_16x16x32_bf16 v[60:63], a[252:255], v[204:207], v[60:63]
    s_waitcnt lgkmcnt(10)
    ds_read_b64_tr_b16 a[252:253], v45 offset:45056
    ds_read_b64_tr_b16 a[254:255], v45 offset:47104
    v_mfma_f32_16x16x32_bf16 v[80:83], a[128:131], v[176:179], v[80:83]
    buffer_store_dwordx4 v[30:33], v12, s[20:23], s50 offen nt
    v_mfma_f32_16x16x32_bf16 v[80:83], a[132:135], v[184:187], v[80:83]
    s_add_u32 s50, s8, 32768
    ds_read_b64 v[30:31], v0 offset:3080
    v_mfma_f32_16x16x32_bf16 v[88:91], a[128:131], v[180:183], v[88:91]
    ds_read_b64_tr_b16 a[128:129], v5 offset:49152
    ds_read_b64_tr_b16 a[130:131], v5 offset:51200
    v_mfma_f32_16x16x32_bf16 v[88:91], a[132:135], v[188:191], v[88:91]
    s_waitcnt lgkmcnt(11)
    ds_read_b64_tr_b16 a[132:133], v5 offset:53248
    ds_read_b64_tr_b16 a[134:135], v5 offset:55296
    v_mfma_f32_16x16x32_bf16 v[80:83], a[136:139], v[192:195], v[80:83]
    ds_read_b64 v[32:33], v0 offset:3072
    v_mfma_f32_16x16x32_bf16 v[80:83], a[140:143], v[200:203], v[80:83]
    v_mfma_f32_16x16x32_bf16 v[88:91], a[136:139], v[196:199], v[88:91]
    ds_read_b64_tr_b16 a[136:137], v5 offset:57344
    ds_read_b64_tr_b16 a[138:139], v5 offset:59392
    v_mfma_f32_16x16x32_bf16 v[88:91], a[140:143], v[204:207], v[88:91]
    s_waitcnt lgkmcnt(12)
    ds_read_b64_tr_b16 a[140:141], v5 offset:61440
    ds_read_b64_tr_b16 a[142:143], v5 offset:63488
    v_mfma_f32_16x16x32_bf16 v[84:87], a[240:243], v[176:179], v[84:87]
    v_mfma_f32_16x16x32_bf16 v[84:87], a[244:247], v[184:187], v[84:87]
    v_mfma_f32_16x16x32_bf16 v[92:95], a[240:243], v[180:183], v[92:95]
    ds_read_b64_tr_b16 a[240:241], v6 offset:49152
    ds_read_b64_tr_b16 a[242:243], v6 offset:51200
    v_mfma_f32_16x16x32_bf16 v[92:95], a[244:247], v[188:191], v[92:95]
    s_waitcnt lgkmcnt(12)
    ds_read_b64_tr_b16 a[244:245], v6 offset:53248
    ds_read_b64_tr_b16 a[246:247], v6 offset:55296
    v_mfma_f32_16x16x32_bf16 v[84:87], a[248:251], v[192:195], v[84:87]
    v_mfma_f32_16x16x32_bf16 v[84:87], a[252:255], v[200:203], v[84:87]
    v_mfma_f32_16x16x32_bf16 v[92:95], a[248:251], v[196:199], v[92:95]
    ds_read_b64_tr_b16 a[248:249], v6 offset:57344
    ds_read_b64_tr_b16 a[250:251], v6 offset:59392
    v_mfma_f32_16x16x32_bf16 v[92:95], a[252:255], v[204:207], v[92:95]
    s_waitcnt lgkmcnt(11)
    v_mfma_f32_16x16x32_bf16 v[48:51], a[128:131], v[208:211], v[48:51]
    s_waitcnt vmcnt(7)
    ds_read_b64_tr_b16 a[252:253], v6 offset:61440
    ds_read_b64_tr_b16 a[254:255], v6 offset:63488
    v_mfma_f32_16x16x32_bf16 v[48:51], a[132:135], v[216:219], v[48:51]
    s_barrier
    v_xor_b32 v43, 32, v11
    v_xor_b32 v42, 64, v11
    v_mfma_f32_16x16x32_bf16 v[56:59], a[128:131], v[212:215], v[56:59]
    s_add_u32 m0, s30, 32768
    v_mfma_f32_16x16x32_bf16 v[56:59], a[132:135], v[220:223], v[56:59]
    s_xor_b32 s48, s6, 131072
    v_mfma_f32_16x16x32_bf16 v[34:37], a[128:131], a[192:195], v[34:37]
    s_add_u32 s51, s9, 65536
    ds_read_b64_tr_b16 a[128:129], v21 offset:49152
    ds_read_b64_tr_b16 a[130:131], v21 offset:51200
    v_mfma_f32_16x16x32_bf16 v[34:37], a[132:135], a[196:199], v[34:37]
    s_waitcnt lgkmcnt(10)
    ds_read_b64_tr_b16 a[132:133], v21 offset:53248
    ds_read_b64_tr_b16 a[134:135], v21 offset:55296
    v_mfma_f32_16x16x32_bf16 v[48:51], a[136:139], v[224:227], v[48:51]
    buffer_load_dwordx4 v8, s[16:19], s48 offen offset:0 lds
    v_mfma_f32_16x16x32_bf16 v[48:51], a[140:143], v[232:235], v[48:51]
    v_mfma_f32_16x16x32_bf16 v[56:59], a[136:139], v[228:231], v[56:59]
    v_mfma_f32_16x16x32_bf16 v[56:59], a[140:143], v[236:239], v[56:59]
    buffer_load_dwordx4 v8, s[16:19], s48 offen offset:1024 lds
    v_mfma_f32_16x16x32_bf16 v[34:37], a[136:139], a[200:203], v[34:37]
    ds_read_b64_tr_b16 a[136:137], v21 offset:57344
    ds_read_b64_tr_b16 a[138:139], v21 offset:59392
    v_mfma_f32_16x16x32_bf16 v[34:37], a[140:143], a[204:207], v[34:37]
    s_waitcnt lgkmcnt(10)
    ds_read_b64_tr_b16 a[140:141], v21 offset:61440
    ds_read_b64_tr_b16 a[142:143], v21 offset:63488
    v_mfma_f32_16x16x32_bf16 v[52:55], a[240:243], v[208:211], v[52:55]
    buffer_store_dwordx4 v[26:29], v12, s[20:23], s50 offen nt
    v_mfma_f32_16x16x32_bf16 v[52:55], a[244:247], v[216:219], v[52:55]
    s_add_u32 s50, s8, 36864
    v_mul_f32 v48, v48, v17
    v_mul_f32 v49, v49, v17
    v_mfma_f32_16x16x32_bf16 v[60:63], a[240:243], v[212:215], v[60:63]
    ds_read_b64_tr_b16 a[240:241], v45 offset:49152
    ds_read_b64_tr_b16 a[242:243], v45 offset:51200
    v_mfma_f32_16x16x32_bf16 v[60:63], a[244:247], v[220:223], v[60:63]
    s_waitcnt lgkmcnt(10)
    ds_read_b64_tr_b16 a[244:245], v45 offset:53248
    ds_read_b64_tr_b16 a[246:247], v45 offset:55296
    v_mfma_f32_16x16x32_bf16 v[52:55], a[248:251], v[224:227], v[52:55]
    buffer_load_dwordx4 v8, s[16:19], s48 offen offset:2048 lds
    v_mfma_f32_16x16x32_bf16 v[52:55], a[252:255], v[232:235], v[52:55]
    v_mul_f32 v50, v50, v17
    v_mul_f32 v51, v51, v17
    v_mfma_f32_16x16x32_bf16 v[60:63], a[248:251], v[228:231], v[60:63]
    ds_read_b64_tr_b16 a[248:249], v45 offset:57344
    ds_read_b64_tr_b16 a[250:251], v45 offset:59392
    v_mfma_f32_16x16x32_bf16 v[60:63], a[252:255], v[236:239], v[60:63]
    s_waitcnt lgkmcnt(10)
    ds_read_b64_tr_b16 a[252:253], v45 offset:61440
    ds_read_b64_tr_b16 a[254:255], v45 offset:63488
    v_mfma_f32_16x16x32_bf16 v[80:83], a[128:131], v[208:211], v[80:83]
    buffer_load_dwordx4 v8, s[16:19], s48 offen offset:3072 lds
    v_mfma_f32_16x16x32_bf16 v[80:83], a[132:135], v[216:219], v[80:83]
    v_cvt_pk_bf16_f32 v48, v48, v49
    v_cvt_pk_bf16_f32 v49, v50, v51
    v_mfma_f32_16x16x32_bf16 v[88:91], a[128:131], v[212:215], v[88:91]
    ds_read_b64_tr_b16 a[128:129], v5 offset:0
    ds_read_b64_tr_b16 a[130:131], v5 offset:2048
    v_mfma_f32_16x16x32_bf16 v[88:91], a[132:135], v[220:223], v[88:91]
    s_waitcnt lgkmcnt(10)
    ds_read_b64_tr_b16 a[132:133], v5 offset:4096
    ds_read_b64_tr_b16 a[134:135], v5 offset:6144
    v_mfma_f32_16x16x32_bf16 v[80:83], a[136:139], v[224:227], v[80:83]
    ds_write_b64 v11, v[48:49] offset:8192
    v_mfma_f32_16x16x32_bf16 v[80:83], a[140:143], v[232:235], v[80:83]
    v_mul_f32 v56, v56, v18
    v_mul_f32 v57, v57, v18
    v_mfma_f32_16x16x32_bf16 v[88:91], a[136:139], v[228:231], v[88:91]
    ds_read_b64_tr_b16 a[136:137], v5 offset:8192
    ds_read_b64_tr_b16 a[138:139], v5 offset:10240
    v_mfma_f32_16x16x32_bf16 v[88:91], a[140:143], v[236:239], v[88:91]
    s_waitcnt lgkmcnt(11)
    ds_read_b64_tr_b16 a[140:141], v5 offset:12288
    ds_read_b64_tr_b16 a[142:143], v5 offset:14336
    v_mfma_f32_16x16x32_bf16 v[84:87], a[240:243], v[208:211], v[84:87]
    v_mul_f32 v58, v58, v18
    v_mul_f32 v59, v59, v18
    v_mfma_f32_16x16x32_bf16 v[84:87], a[244:247], v[216:219], v[84:87]
    v_cvt_pk_bf16_f32 v56, v56, v57
    v_cvt_pk_bf16_f32 v57, v58, v59
    v_mfma_f32_16x16x32_bf16 v[92:95], a[240:243], v[212:215], v[92:95]
    ds_read_b64_tr_b16 a[240:241], v6 offset:0
    ds_read_b64_tr_b16 a[242:243], v6 offset:2048
    v_mfma_f32_16x16x32_bf16 v[92:95], a[244:247], v[220:223], v[92:95]
    s_waitcnt lgkmcnt(11)
    ds_read_b64_tr_b16 a[244:245], v6 offset:4096
    ds_read_b64_tr_b16 a[246:247], v6 offset:6144
    v_mfma_f32_16x16x32_bf16 v[84:87], a[248:251], v[224:227], v[84:87]
L_t3_5:
    s_cbranch_execz L_tback3
    ds_write_b64 v11, v[56:57] offset:10240
    v_mfma_f32_16x16x32_bf16 v[84:87], a[252:255], v[232:235], v[84:87]
    v_mul_f32 v52, v52, v17
    v_mul_f32 v53, v53, v17
    v_mfma_f32_16x16x32_bf16 v[92:95], a[248:251], v[228:231], v[92:95]
    ds_read_b64_tr_b16 a[248:249], v6 offset:8192
    ds_read_b64_tr_b16 a[250:251], v6 offset:10240
    v_mfma_f32_16x16x32_bf16 v[92:95], a[252:255], v[236:239], v[92:95]
    s_waitcnt lgkmcnt(12)
    v_mul_f32 v54, v54, v17
    v_mul_f32 v55, v55, v17
    v_mfma_f32_16x16x32_bf16 v[64:67], a[128:131], v[112:115], 0
    s_waitcnt vmcnt(6)
    ds_read_b64_tr_b16 a[252:253], v6 offset:12288
    ds_read_b64_tr_b16 a[254:255], v6 offset:14336
    v_mfma_f32_16x16x32_bf16 v[64:67], a[132:135], v[120:123], v[64:67]
    s_barrier
    v_cvt_pk_bf16_f32 v52, v52, v53
    v_cvt_pk_bf16_f32 v53, v54, v55
    v_mfma_f32_16x16x32_bf16 v[72:75], a[128:131], v[116:119], 0
    s_add_u32 m0, s30, 49152
    ds_write_b64 v43, v[52:53] offset:8192
    v_mfma_f32_16x16x32_bf16 v[72:75], a[132:135], v[124:127], v[72:75]
    s_xor_b32 s48, s6, 196608
    v_mul_f32 v60, v60, v18
    v_mul_f32 v61, v61, v18
    v_mfma_f32_16x16x32_bf16 v[38:41], a[128:131], a[144:147], 0
    ds_read_b64_tr_b16 a[128:129], v21 offset:0
    ds_read_b64_tr_b16 a[130:131], v21 offset:2048
    v_mfma_f32_16x16x32_bf16 v[38:41], a[132:135], a[148:151], v[38:41]
    s_waitcnt lgkmcnt(12)
    ds_read_b64_tr_b16 a[132:133], v21 offset:4096
    ds_read_b64_tr_b16 a[134:135], v21 offset:6144
    v_mfma_f32_16x16x32_bf16 v[64:67], a[136:139], v[128:131], v[64:67]
    buffer_store_dwordx4 v[30:33], v12, s[20:23], s50 offen nt
    v_mfma_f32_16x16x32_bf16 v[64:67], a[140:143], v[136:139], v[64:67]
    s_add_u32 s50, s9, 0
    v_mul_f32 v62, v62, v18
    v_mul_f32 v63, v63, v18
    v_mfma_f32_16x16x32_bf16 v[72:75], a[136:139], v[132:135], v[72:75]
    v_cvt_pk_bf16_f32 v60, v60, v61
    v_cvt_pk_bf16_f32 v61, v62, v63
    v_mfma_f32_16x16x32_bf16 v[72:75], a[140:143], v[140:143], v[72:75]
    ds_write_b64 v43, v[60:61] offset:10240
    v_mfma_f32_16x16x32_bf16 v[38:41], a[136:139], a[152:155], v[38:41]
    ds_read_b64_tr_b16 a[136:137], v21 offset:8192
    ds_read_b64_tr_b16 a[138:139], v21 offset:10240
    v_mfma_f32_16x16x32_bf16 v[38:41], a[140:143], a[156:159], v[38:41]
    s_waitcnt lgkmcnt(13)
    ds_read_b64_tr_b16 a[140:141], v21 offset:12288
    ds_read_b64_tr_b16 a[142:143], v21 offset:14336
    v_mfma_f32_16x16x32_bf16 v[68:71], a[240:243], v[112:115], 0
    buffer_load_dwordx4 v8, s[16:19], s48 offen offset:0 lds
    v_mfma_f32_16x16x32_bf16 v[68:71], a[244:247], v[120:123], v[68:71]
    v_xor_b32 v43, 96, v11
    v_mul_f32 v80, v80, v17
    v_mfma_f32_16x16x32_bf16 v[76:79], a[240:243], v[116:119], 0
    ds_read_b64_tr_b16 a[240:241], v45 offset:0
    ds_read_b64_tr_b16 a[242:243], v45 offset:2048
    v_mfma_f32_16x16x32_bf16 v[76:79], a[244:247], v[124:127], v[76:79]
    s_waitcnt lgkmcnt(12)
    ds_read_b64_tr_b16 a[244:245], v45 offset:4096
    ds_read_b64_tr_b16 a[246:247], v45 offset:6144
    v_mfma_f32_16x16x32_bf16 v[68:71], a[248:251], v[128:131], v[68:71]
    buffer_load_dwordx4 v8, s[16:19], s48 offen offset:1024 lds
    v_mfma_f32_16x16x32_bf16 v[68:71], a[252:255], v[136:139], v[68:71]
    v_mul_f32 v81, v81, v17
    v_mul_f32 v82, v82, v17
    v_mfma_f32_16x16x32_bf16 v[76:79], a[248:251], v[132:135], v[76:79]
    ds_read_b64_tr_b16 a[248:249], v45 offset:8192
    ds_read_b64_tr_b16 a[250:251], v45 offset:10240
    v_mfma_f32_16x16x32_bf16 v[76:79], a[252:255], v[140:143], v[76:79]
    s_waitcnt lgkmcnt(11)
    ds_read_b64_tr_b16 a[252:253], v45 offset:12288
    ds_read_b64_tr_b16 a[254:255], v45 offset:14336
    v_mfma_f32_16x16x32_bf16 v[96:99], a[128:131], v[112:115], 0
    buffer_load_dwordx4 v8, s[16:19], s48 offen offset:2048 lds
    v_mfma_f32_16x16x32_bf16 v[96:99], a[132:135], v[120:123], v[96:99]
    v_mul_f32 v83, v83, v17
    v_cvt_pk_bf16_f32 v80, v80, v81
    v_mfma_f32_16x16x32_bf16 v[104:107], a[128:131], v[116:119], 0
    ds_read_b64_tr_b16 a[128:129], v5 offset:16384
    ds_read_b64_tr_b16 a[130:131], v5 offset:18432
    v_mfma_f32_16x16x32_bf16 v[104:107], a[132:135], v[124:127], v[104:107]
    s_waitcnt lgkmcnt(10)
    ds_read_b64_tr_b16 a[132:133], v5 offset:20480
    ds_read_b64_tr_b16 a[134:135], v5 offset:22528
    v_mfma_f32_16x16x32_bf16 v[96:99], a[136:139], v[128:131], v[96:99]
    buffer_load_dwordx4 v8, s[16:19], s48 offen offset:3072 lds
    v_mfma_f32_16x16x32_bf16 v[96:99], a[140:143], v[136:139], v[96:99]
    v_cvt_pk_bf16_f32 v81, v82, v83
    v_mul_f32 v88, v88, v18
    v_mfma_f32_16x16x32_bf16 v[104:107], a[136:139], v[132:135], v[104:107]
    ds_read_b64_tr_b16 a[136:137], v5 offset:24576
    ds_read_b64_tr_b16 a[138:139], v5 offset:26624
    v_mfma_f32_16x16x32_bf16 v[104:107], a[140:143], v[140:143], v[104:107]
    s_waitcnt lgkmcnt(10)
    ds_read_b64_tr_b16 a[140:141], v5 offset:28672
    ds_read_b64_tr_b16 a[142:143], v5 offset:30720
    v_mfma_f32_16x16x32_bf16 v[100:103], a[240:243], v[112:115], 0
    ds_write_b64 v42, v[80:81] offset:8192
    v_mfma_f32_16x16x32_bf16 v[100:103], a[244:247], v[120:123], v[100:103]
    v_mul_f32 v89, v89, v18
    v_mul_f32 v90, v90, v18
    v_mfma_f32_16x16x32_bf16 v[108:111], a[240:243], v[116:119], 0
    ds_read_b64_tr_b16 a[240:241], v6 offset:16384
    ds_read_b64_tr_b16 a[242:243], v6 offset:18432
    v_mfma_f32_16x16x32_bf16 v[108:111], a[244:247], v[124:127], v[108:111]
    s_waitcnt lgkmcnt(11)
    ds_read_b64_tr_b16 a[244:245], v6 offset:20480
    ds_read_b64_tr_b16 a[246:247], v6 offset:22528
    v_mfma_f32_16x16x32_bf16 v[100:103], a[248:251], v[128:131], v[100:103]
    v_mul_f32 v91, v91, v18
    v_cvt_pk_bf16_f32 v88, v88, v89
    v_mfma_f32_16x16x32_bf16 v[100:103], a[252:255], v[136:139], v[100:103]
    v_cvt_pk_bf16_f32 v89, v90, v91
    v_mul_f32 v84, v84, v17
    v_mfma_f32_16x16x32_bf16 v[108:111], a[248:251], v[132:135], v[108:111]
    ds_read_b64_tr_b16 a[248:249], v6 offset:24576
    ds_read_b64_tr_b16 a[250:251], v6 offset:26624
    v_mfma_f32_16x16x32_bf16 v[108:111], a[252:255], v[140:143], v[108:111]
    s_waitcnt lgkmcnt(11)
    ds_write_b64 v42, v[88:89] offset:10240
    v_mfma_f32_16x16x32_bf16 v[64:67], a[128:131], v[144:147], v[64:67]
    s_waitcnt vmcnt(5)
    ds_read_b64_tr_b16 a[252:253], v6 offset:28672
    ds_read_b64_tr_b16 a[254:255], v6 offset:30720
    v_mfma_f32_16x16x32_bf16 v[64:67], a[132:135], v[152:155], v[64:67]
    s_barrier
    v_mul_f32 v85, v85, v17
    v_mul_f32 v86, v86, v17
    v_mfma_f32_16x16x32_bf16 v[72:75], a[128:131], v[148:151], v[72:75]
    s_add_u32 m0, s30, 0
    v_mul_f32 v87, v87, v17
    v_cvt_pk_bf16_f32 v84, v84, v85
    v_mfma_f32_16x16x32_bf16 v[72:75], a[132:135], v[156:159], v[72:75]
    s_xor_b32 s48, s7, 0
    v_cvt_pk_bf16_f32 v85, v86, v87
    v_mul_f32 v92, v92, v18
    v_mfma_f32_16x16x32_bf16 v[38:41], a[128:131], a[160:163], v[38:41]
    ds_read_b64_tr_b16 a[128:129], v21 offset:16384
    ds_read_b64_tr_b16 a[130:131], v21 offset:18432
    v_mfma_f32_16x16x32_bf16 v[38:41], a[132:135], a[164:167], v[38:41]
    s_waitcnt lgkmcnt(12)
    ds_read_b64_tr_b16 a[132:133], v21 offset:20480
    ds_read_b64_tr_b16 a[134:135], v21 offset:22528
    v_mfma_f32_16x16x32_bf16 v[64:67], a[136:139], v[160:163], v[64:67]
    ds_write_b64 v43, v[84:85] offset:8192
    v_mfma_f32_16x16x32_bf16 v[64:67], a[140:143], v[168:171], v[64:67]
    buffer_load_dwordx4 v8, s[16:19], s48 offen offset:0 lds
    v_mfma_f32_16x16x32_bf16 v[72:75], a[136:139], v[164:167], v[72:75]
    v_mul_f32 v93, v93, v18
    v_mul_f32 v94, v94, v18
    v_mfma_f32_16x16x32_bf16 v[72:75], a[140:143], v[172:175], v[72:75]
    v_mul_f32 v95, v95, v18
    v_cvt_pk_bf16_f32 v92, v92, v93
    v_mfma_f32_16x16x32_bf16 v[38:41], a[136:139], a[168:171], v[38:41]
    ds_read_b64_tr_b16 a[136:137], v21 offset:24576
    ds_read_b64_tr_b16 a[138:139], v21 offset:26624
    v_mfma_f32_16x16x32_bf16 v[38:41], a[140:143], a[172:175], v[38:41]
    s_waitcnt lgkmcnt(12)
    ds_read_b64_tr_b16 a[140:141], v21 offset:28672
    ds_read_b64_tr_b16 a[142:143], v21 offset:30720
    v_mfma_f32_16x16x32_bf16 v[68:71], a[240:243], v[144:147], v[68:71]
    buffer_load_dwordx4 v8, s[16:19], s48 offen offset:1024 lds
    v_mfma_f32_16x16x32_bf16 v[68:71], a[244:247], v[152:155], v[68:71]
    v_cvt_pk_bf16_f32 v93, v94, v95
    v_mul_f32 v34, v34, v19
    v_mfma_f32_16x16x32_bf16 v[76:79], a[240:243], v[148:151], v[76:79]
    ds_read_b64_tr_b16 a[240:241], v45 offset:16384
    ds_read_b64_tr_b16 a[242:243], v45 offset:18432
    v_mfma_f32_16x16x32_bf16 v[76:79], a[244:247], v[156:159], v[76:79]
    s_waitcnt lgkmcnt(11)
    ds_read_b64_tr_b16 a[244:245], v45 offset:20480
    ds_read_b64_tr_b16 a[246:247], v45 offset:22528
    v_mfma_f32_16x16x32_bf16 v[68:71], a[248:251], v[160:163], v[68:71]
    ds_write_b64 v43, v[92:93] offset:10240
    v_mfma_f32_16x16x32_bf16 v[68:71], a[252:255], v[168:171], v[68:71]
    buffer_load_dwordx4 v8, s[16:19], s48 offen offset:2048 lds
    v_mfma_f32_16x16x32_bf16 v[76:79], a[248:251], v[164:167], v[76:79]
    ds_read_b64_tr_b16 a[248:249], v45 offset:24576
    ds_read_b64_tr_b16 a[250:251], v45 offset:26624
    v_mfma_f32_16x16x32_bf16 v[76:79], a[252:255], v[172:175], v[76:79]
    s_waitcnt lgkmcnt(12)
    ds_read_b64_tr_b16 a[252:253], v45 offset:28672
    ds_read_b64_tr_b16 a[254:255], v45 offset:30720
    v_mfma_f32_16x16x32_bf16 v[96:99], a[128:131], v[144:147], v[96:99]
    buffer_load_dwordx4 v8, s[16:19], s48 offen offset:3072 lds
    v_mfma_f32_16x16x32_bf16 v[96:99], a[132:135], v[152:155], v[96:99]
    ds_read_b128 v[26:29], v0 offset:8192
    v_mul_f32 v35, v35, v19
    v_mfma_f32_16x16x32_bf16 v[104:107], a[128:131], v[148:151], v[104:107]
    ds_read_b64_tr_b16 a[128:129], v5 offset:32768
    ds_read_b64_tr_b16 a[130:131], v5 offset:34816
    v_mfma_f32_16x16x32_bf16 v[104:107], a[132:135], v[156:159], v[104:107]
    s_waitcnt lgkmcnt(12)
    ds_read_b64_tr_b16 a[132:133], v5 offset:36864
    ds_read_b64_tr_b16 a[134:135], v5 offset:38912
    v_mfma_f32_16x16x32_bf16 v[96:99], a[136:139], v[160:163], v[96:99]
    ds_read_b64 v[30:31], v0 offset:9224
    v_mul_f32 v36, v36, v19
    v_mfma_f32_16x16x32_bf16 v[96:99], a[140:143], v[168:171], v[96:99]
    ds_read_b64 v[32:33], v0 offset:9216
    v_mul_f32 v37, v37, v19
    v_mfma_f32_16x16x32_bf16 v[104:107], a[136:139], v[164:167], v[104:107]
    ds_read_b64_tr_b16 a[136:137], v5 offset:40960
    ds_read_b64_tr_b16 a[138:139], v5 offset:43008
    v_mfma_f32_16x16x32_bf16 v[104:107], a[140:143], v[172:175], v[104:107]
    s_waitcnt lgkmcnt(14)
    ds_read_b64_tr_b16 a[140:141], v5 offset:45056
    ds_read_b64_tr_b16 a[142:143], v5 offset:47104
    v_mfma_f32_16x16x32_bf16 v[100:103], a[240:243], v[144:147], v[100:103]
    v_cvt_pk_bf16_f32 v34, v34, v35
    v_cvt_pk_bf16_f32 v35, v36, v37
    v_mfma_f32_16x16x32_bf16 v[100:103], a[244:247], v[152:155], v[100:103]
    buffer_store_dwordx2 v[34:35], v16, s[20:23], s51 offen nt
    v_mfma_f32_16x16x32_bf16 v[108:111], a[240:243], v[148:151], v[108:111]
    ds_read_b64_tr_b16 a[240:241], v6 offset:32768
    ds_read_b64_tr_b16 a[242:243], v6 offset:34816
    v_mfma_f32_16x16x32_bf16 v[108:111], a[244:247], v[156:159], v[108:111]
    s_waitcnt lgkmcnt(13)
    ds_read_b64_tr_b16 a[244:245], v6 offset:36864
    ds_read_b64_tr_b16 a[246:247], v6 offset:38912
    v_mfma_f32_16x16x32_bf16 v[100:103], a[248:251], v[160:163], v[100:103]
    v_mfma_f32_16x16x32_bf16 v[100:103], a[252:255], v[168:171], v[100:103]
    v_mfma_f32_16x16x32_bf16 v[108:111], a[248:251], v[164:167], v[108:111]
    ds_read_b64_tr_b16 a[248:249], v6 offset:40960
    ds_read_b64_tr_b16 a[250:251], v6 offset:43008
    v_mfma_f32_16x16x32_bf16 v[108:111], a[252:255], v[172:175], v[108:111]
    s_waitcnt lgkmcnt(12)
    v_mfma_f32_16x16x32_bf16 v[64:67], a[128:131], v[176:179], v[64:67]
    s_waitcnt vmcnt(5)
    ds_read_b64_tr_b16 a[252:253], v6 offset:45056
    ds_read_b64_tr_b16 a[254:255], v6 offset:47104
    v_mfma_f32_16x16x32_bf16 v[64:67], a[132:135], v[184:187], v[64:67]
    buffer_store_dwordx4 v[26:29], v12, s[20:23], s50 offen nt
    v_mfma_f32_16x16x32_bf16 v[72:75], a[128:131], v[180:183], v[72:75]
    s_add_u32 s50, s9, 4096
    ds_read_b128 v[26:29], v0 offset:10240
    v_mfma_f32_16x16x32_bf16 v[72:75], a[132:135], v[188:191], v[72:75]
    s_barrier
    v_mfma_f32_16x16x32_bf16 v[38:41], a[128:131], a[176:179], v[38:41]
    s_add_u32 m0, s30, 16384
    ds_read_b64_tr_b16 a[128:129], v21 offset:32768
    ds_read_b64_tr_b16 a[130:131], v21 offset:34816
    v_mfma_f32_16x16x32_bf16 v[38:41], a[132:135], a[180:183], v[38:41]
    s_waitcnt lgkmcnt(11)
    ds_read_b64_tr_b16 a[132:133], v21 offset:36864
    ds_read_b64_tr_b16 a[134:135], v21 offset:38912
    v_mfma_f32_16x16x32_bf16 v[64:67], a[136:139], v[192:195], v[64:67]
    s_xor_b32 s48, s7, 65536
    v_mfma_f32_16x16x32_bf16 v[64:67], a[140:143], v[200:203], v[64:67]
    buffer_load_dwordx4 v8, s[16:19], s48 offen offset:0 lds
    v_mfma_f32_16x16x32_bf16 v[72:75], a[136:139], v[196:199], v[72:75]
    v_mfma_f32_16x16x32_bf16 v[72:75], a[140:143], v[204:207], v[72:75]
    v_mfma_f32_16x16x32_bf16 v[38:41], a[136:139], a[184:187], v[38:41]
    ds_read_b64_tr_b16 a[136:137], v21 offset:40960
    ds_read_b64_tr_b16 a[138:139], v21 offset:43008
    v_mfma_f32_16x16x32_bf16 v[38:41], a[140:143], a[188:191], v[38:41]
    s_waitcnt lgkmcnt(11)
    ds_read_b64_tr_b16 a[140:141], v21 offset:45056
    ds_read_b64_tr_b16 a[142:143], v21 offset:47104
    v_mfma_f32_16x16x32_bf16 v[68:71], a[240:243], v[176:179], v[68:71]
    buffer_load_dwordx4 v8, s[16:19], s48 offen offset:1024 lds
    v_mfma_f32_16x16x32_bf16 v[68:71], a[244:247], v[184:187], v[68:71]
    v_mfma_f32_16x16x32_bf16 v[76:79], a[240:243], v[180:183], v[76:79]
    ds_read_b64_tr_b16 a[240:241], v45 offset:32768
    ds_read_b64_tr_b16 a[242:243], v45 offset:34816
    v_mfma_f32_16x16x32_bf16 v[76:79], a[244:247], v[188:191], v[76:79]
    s_waitcnt lgkmcnt(11)
    ds_read_b64_tr_b16 a[244:245], v45 offset:36864
    ds_read_b64_tr_b16 a[246:247], v45 offset:38912
    v_mfma_f32_16x16x32_bf16 v[68:71], a[248:251], v[192:195], v[68:71]
    buffer_load_dwordx4 v8, s[16:19], s48 offen offset:2048 lds
    v_mfma_f32_16x16x32_bf16 v[68:71], a[252:255], v[200:203], v[68:71]
    v_mfma_f32_16x16x32_bf16 v[76:79], a[248:251], v[196:199], v[76:79]
    ds_read_b64_tr_b16 a[248:249], v45 offset:40960
    ds_read_b64_tr_b16 a[250:251], v45 offset:43008
    v_mfma_f32_16x16x32_bf16 v[76:79], a[252:255], v[204:207], v[76:79]
    s_waitcnt lgkmcnt(10)
    ds_read_b64_tr_b16 a[252:253], v45 offset:45056
    ds_read_b64_tr_b16 a[254:255], v45 offset:47104
    v_mfma_f32_16x16x32_bf16 v[96:99], a[128:131], v[176:179], v[96:99]
    buffer_load_dwordx4 v8, s[16:19], s48 offen offset:3072 lds
    v_mfma_f32_16x16x32_bf16 v[96:99], a[132:135], v[184:187], v[96:99]
    v_mfma_f32_16x16x32_bf16 v[104:107], a[128:131], v[180:183], v[104:107]
    ds_read_b64_tr_b16 a[128:129], v5 offset:49152
    ds_read_b64_tr_b16 a[130:131], v5 offset:51200
    v_mfma_f32_16x16x32_bf16 v[104:107], a[132:135], v[188:191], v[104:107]
    s_waitcnt lgkmcnt(10)
    ds_read_b64_tr_b16 a[132:133], v5 offset:53248
    ds_read_b64_tr_b16 a[134:135], v5 offset:55296
    v_mfma_f32_16x16x32_bf16 v[96:99], a[136:139], v[192:195], v[96:99]
    v_mfma_f32_16x16x32_bf16 v[96:99], a[140:143], v[200:203], v[96:99]
    v_mfma_f32_16x16x32_bf16 v[104:107], a[136:139], v[196:199], v[104:107]
    ds_read_b64_tr_b16 a[136:137], v5 offset:57344
    ds_read_b64_tr_b16 a[138:139], v5 offset:59392
    v_mfma_f32_16x16x32_bf16 v[104:107], a[140:143], v[204:207], v[104:107]
    s_waitcnt lgkmcnt(10)
    ds_read_b64_tr_b16 a[140:141], v5 offset:61440
    ds_read_b64_tr_b16 a[142:143], v5 offset:63488
    v_mfma_f32_16x16x32_bf16 v[100:103], a[240:243], v[176:179], v[100:103]
    v_mfma_f32_16x16x32_bf16 v[100:103], a[244:247], v[184:187], v[100:103]
    buffer_store_dwordx4 v[30:33], v12, s[20:23], s50 offen nt
    v_mfma_f32_16x16x32_bf16 v[108:111], a[240:243], v[180:183], v[108:111]
    s_add_u32 s50, s9, 32768
    ds_read_b64_tr_b16 a[240:241], v6 offset:49152
    ds_read_b64_tr_b16 a[242:243], v6 offset:51200
    v_mfma_f32_16x16x32_bf16 v[108:111], a[244:247], v[188:191], v[108:111]
    s_waitcnt lgkmcnt(10)
    ds_read_b64_tr_b16 a[244:245], v6 offset:53248
    ds_read_b64_tr_b16 a[246:247], v6 offset:55296
    v_mfma_f32_16x16x32_bf16 v[100:103], a[248:251], v[192:195], v[100:103]
    ds_read_b64 v[30:31], v0 offset:11272
    v_mfma_f32_16x16x32_bf16 v[100:103], a[252:255], v[200:203], v[100:103]
    ds_read_b64 v[32:33], v0 offset:11264
    v_mfma_f32_16x16x32_bf16 v[108:111], a[248:251], v[196:199], v[108:111]
    ds_read_b64_tr_b16 a[248:249], v6 offset:57344
    ds_read_b64_tr_b16 a[250:251], v6 offset:59392
    v_mfma_f32_16x16x32_bf16 v[108:111], a[252:255], v[204:207], v[108:111]
    s_waitcnt lgkmcnt(12)
    v_mfma_f32_16x16x32_bf16 v[64:67], a[128:131], v[208:211], v[64:67]
    s_waitcnt vmcnt(7)
    ds_read_b64_tr_b16 a[252:253], v6 offset:61440
    ds_read_b64_tr_b16 a[254:255], v6 offset:63488
    v_mfma_f32_16x16x32_bf16 v[64:67], a[132:135], v[216:219], v[64:67]
    s_barrier
    v_xor_b32 v43, 32, v11
    v_xor_b32 v42, 64, v11
    v_mfma_f32_16x16x32_bf16 v[72:75], a[128:131], v[212:215], v[72:75]
    s_add_u32 m0, s30, 32768
    v_mfma_f32_16x16x32_bf16 v[72:75], a[132:135], v[220:223], v[72:75]
    s_xor_b32 s48, s7, 131072
    v_mfma_f32_16x16x32_bf16 v[38:41], a[128:131], a[192:195], v[38:41]
    s_add_u32 s51, s10, 65536
    ds_read_b64_tr_b16 a[128:129], v21 offset:49152
    ds_read_b64_tr_b16 a[130:131], v21 offset:51200
    v_mfma_f32_16x16x32_bf16 v[38:41], a[132:135], a[196:199], v[38:41]
    s_waitcnt lgkmcnt(12)
    ds_read_b64_tr_b16 a[132:133], v21 offset:53248
    ds_read_b64_tr_b16 a[134:135], v21 offset:55296
    v_mfma_f32_16x16x32_bf16 v[64:67], a[136:139], v[224:227], v[64:67]
    buffer_load_dwordx4 v8, s[16:19], s48 offen offset:0 lds
    v_mfma_f32_16x16x32_bf16 v[64:67], a[140:143], v[232:235], v[64:67]
    v_mfma_f32_16x16x32_bf16 v[72:75], a[136:139], v[228:231], v[72:75]
    v_mfma_f32_16x16x32_bf16 v[72:75], a[140:143], v[236:239], v[72:75]
    buffer_load_dwordx4 v8, s[16:19], s48 offen offset:1024 lds
    v_mfma_f32_16x16x32_bf16 v[38:41], a[136:139], a[200:203], v[38:41]
    ds_read_b64_tr_b16 a[136:137], v21 offset:57344
    ds_read_b64_tr_b16 a[138:139], v21 offset:59392
    v_mfma_f32_16x16x32_bf16 v[38:41], a[140:143], a[204:207], v[38:41]
    s_waitcnt lgkmcnt(12)
    ds_read_b64_tr_b16 a[140:141], v21 offset:61440
    ds_read_b64_tr_b16 a[142:143], v21 offset:63488
    v_mfma_f32_16x16x32_bf16 v[68:71], a[240:243], v[208:211], v[68:71]
    buffer_load_dwordx4 v8, s[16:19], s48 offen offset:2048 lds
    v_mfma_f32_16x16x32_bf16 v[68:71], a[244:247], v[216:219], v[68:71]
    v_mul_f32 v64, v64, v17
    v_mul_f32 v65, v65, v17
    v_mfma_f32_16x16x32_bf16 v[76:79], a[240:243], v[212:215], v[76:79]
    ds_read_b64_tr_b16 a[240:241], v45 offset:49152
    ds_read_b64_tr_b16 a[242:243], v45 offset:51200
    v_mfma_f32_16x16x32_bf16 v[76:79], a[244:247], v[220:223], v[76:79]
    s_waitcnt lgkmcnt(10)
    ds_read_b64_tr_b16 a[244:245], v45 offset:53248
    ds_read_b64_tr_b16 a[246:247], v45 offset:55296
    v_mfma_f32_16x16x32_bf16 v[68:71], a[248:251], v[224:227], v[68:71]
    buffer_load_dwordx4 v8, s[16:19], s48 offen offset:3072 lds
    v_mfma_f32_16x16x32_bf16 v[68:71], a[252:255], v[232:235], v[68:71]
    v_mul_f32 v66, v66, v17
    v_mul_f32 v67, v67, v17
    v_mfma_f32_16x16x32_bf16 v[76:79], a[248:251], v[228:231], v[76:79]
    ds_read_b64_tr_b16 a[248:249], v45 offset:57344
    ds_read_b64_tr_b16 a[250:251], v45 offset:59392
    v_mfma_f32_16x16x32_bf16 v[76:79], a[252:255], v[236:239], v[76:79]
    s_waitcnt lgkmcnt(10)
    ds_read_b64_tr_b16 a[252:253], v45 offset:61440
    ds_read_b64_tr_b16 a[254:255], v45 offset:63488
    v_mfma_f32_16x16x32_bf16 v[96:99], a[128:131], v[208:211], v[96:99]
    v_cvt_pk_bf16_f32 v64, v64, v65
    v_cvt_pk_bf16_f32 v65, v66, v67
    v_mfma_f32_16x16x32_bf16 v[96:99], a[132:135], v[216:219], v[96:99]
    buffer_store_dwordx4 v[26:29], v12, s[20:23], s50 offen nt
    v_mfma_f32_16x16x32_bf16 v[104:107], a[128:131], v[212:215], v[104:107]
    s_add_u32 s50, s9, 36864
    ds_read_b64_tr_b16 a[128:129], v5 offset:0
    ds_read_b64_tr_b16 a[130:131], v5 offset:2048
    v_mfma_f32_16x16x32_bf16 v[104:107], a[132:135], v[220:223], v[104:107]
    s_waitcnt lgkmcnt(10)
    ds_read_b64_tr_b16 a[132:133], v5 offset:4096
    ds_read_b64_tr_b16 a[134:135], v5 offset:6144
    v_mfma_f32_16x16x32_bf16 v[96:99], a[136:139], v[224:227], v[96:99]
    ds_write_b64 v11, v[64:65] offset:0
    v_mfma_f32_16x16x32_bf16 v[96:99], a[140:143], v[232:235], v[96:99]
    v_mul_f32 v72, v72, v18
    v_mul_f32 v73, v73, v18
    v_mfma_f32_16x16x32_bf16 v[104:107], a[136:139], v[228:231], v[104:107]
    ds_read_b64_tr_b16 a[136:137], v5 offset:8192
    ds_read_b64_tr_b16 a[138:139], v5 offset:10240
    v_mfma_f32_16x16x32_bf16 v[104:107], a[140:143], v[236:239], v[104:107]
    s_waitcnt lgkmcnt(11)
    ds_read_b64_tr_b16 a[140:141], v5 offset:12288
    ds_read_b64_tr_b16 a[142:143], v5 offset:14336
    v_mfma_f32_16x16x32_bf16 v[100:103], a[240:243], v[208:211], v[100:103]
    v_mul_f32 v74, v74, v18
    v_mul_f32 v75, v75, v18
    v_mfma_f32_16x16x32_bf16 v[100:103], a[244:247], v[216:219], v[100:103]
    v_cvt_pk_bf16_f32 v72, v72, v73
    v_cvt_pk_bf16_f32 v73, v74, v75
    v_mfma_f32_16x16x32_bf16 v[108:111], a[240:243], v[212:215], v[108:111]
    ds_read_b64_tr_b16 a[240:241], v6 offset:0
    ds_read_b64_tr_b16 a[242:243], v6 offset:2048
    v_mfma_f32_16x16x32_bf16 v[108:111], a[244:247], v[220:223], v[108:111]
    s_waitcnt lgkmcnt(11)
    ds_read_b64_tr_b16 a[244:245], v6 offset:4096
    ds_read_b64_tr_b16 a[246:247], v6 offset:6144
    v_mfma_f32_16x16x32_bf16 v[100:103], a[248:251], v[224:227], v[100:103]
    ds_write_b64 v11, v[72:73] offset:2048
    v_mfma_f32_16x16x32_bf16 v[100:103], a[252:255], v[232:235], v[100:103]
    v_mul_f32 v68, v68, v17
    v_mul_f32 v69, v69, v17
    v_mfma_f32_16x16x32_bf16 v[108:111], a[248:251], v[228:231], v[108:111]
    ds_read_b64_tr_b16 a[248:249], v6 offset:8192
    ds_read_b64_tr_b16 a[250:251], v6 offset:10240
    v_mfma_f32_16x16x32_bf16 v[108:111], a[252:255], v[236:239], v[108:111]
    s_waitcnt lgkmcnt(12)
    v_mul_f32 v70, v70, v17
    v_mul_f32 v71, v71, v17
    v_mfma_f32_16x16x32_bf16 v[48:51], a[128:131], v[112:115], 0
    s_waitcnt vmcnt(6)
    ds_read_b64_tr_b16 a[252:253], v6 offset:12288
    ds_read_b64_tr_b16 a[254:255], v6 offset:14336
    v_mfma_f32_16x16x32_bf16 v[48:51], a[132:135], v[120:123], v[48:51]
    s_barrier
    v_cvt_pk_bf16_f32 v68, v68, v69
    v_cvt_pk_bf16_f32 v69, v70, v71
    v_mfma_f32_16x16x32_bf16 v[56:59], a[128:131], v[116:119], 0
    s_add_u32 m0, s30, 49152
    ds_write_b64 v43, v[68:69] offset:0
    v_mfma_f32_16x16x32_bf16 v[56:59], a[132:135], v[124:127], v[56:59]
    s_xor_b32 s48, s7, 196608
    v_mul_f32 v76, v76, v18
    v_mul_f32 v77, v77, v18
    v_mfma_f32_16x16x32_bf16 v[34:37], a[128:131], a[144:147], 0
    ds_read_b64_tr_b16 a[128:129], v21 offset:0
    ds_read_b64_tr_b16 a[130:131], v21 offset:2048
    v_mfma_f32_16x16x32_bf16 v[34:37], a[132:135], a[148:151], v[34:37]
    s_waitcnt lgkmcnt(12)
    ds_read_b64_tr_b16 a[132:133], v21 offset:4096
    ds_read_b64_tr_b16 a[134:135], v21 offset:6144
    v_mfma_f32_16x16x32_bf16 v[48:51], a[136:139], v[128:131], v[48:51]
    buffer_load_dwordx4 v8, s[16:19], s48 offen offset:0 lds
    v_mfma_f32_16x16x32_bf16 v[48:51], a[140:143], v[136:139], v[48:51]
    v_mul_f32 v78, v78, v18
    v_mul_f32 v79, v79, v18
    v_mfma_f32_16x16x32_bf16 v[56:59], a[136:139], v[132:135], v[56:59]
    v_cvt_pk_bf16_f32 v76, v76, v77
    v_cvt_pk_bf16_f32 v77, v78, v79
    v_mfma_f32_16x16x32_bf16 v[56:59], a[140:143], v[140:143], v[56:59]
    ds_write_b64 v43, v[76:77] offset:2048
    v_mfma_f32_16x16x32_bf16 v[34:37], a[136:139], a[152:155], v[34:37]
    ds_read_b64_tr_b16 a[136:137], v21 offset:8192
    ds_read_b64_tr_b16 a[138:139], v21 offset:10240
    v_mfma_f32_16x16x32_bf16 v[34:37], a[140:143], a[156:159], v[34:37]
    s_waitcnt lgkmcnt(13)
    ds_read_b64_tr_b16 a[140:141], v21 offset:12288
    ds_read_b64_tr_b16 a[142:143], v21 offset:14336
    v_mfma_f32_16x16x32_bf16 v[52:55], a[240:243], v[112:115], 0
    buffer_load_dwordx4 v8, s[16:19], s48 offen offset:1024 lds
    v_mfma_f32_16x16x32_bf16 v[52:55], a[244:247], v[120:123], v[52:55]
    v_xor_b32 v43, 96, v11
    v_mul_f32 v96, v96, v17
    v_mfma_f32_16x16x32_bf16 v[60:63], a[240:243], v[116:119], 0
    ds_read_b64_tr_b16 a[240:241], v45 offset:0
    ds_read_b64_tr_b16 a[242:243], v45 offset:2048
    v_mfma_f32_16x16x32_bf16 v[60:63], a[244:247], v[124:127], v[60:63]
    s_waitcnt lgkmcnt(12)
    ds_read_b64_tr_b16 a[244:245], v45 offset:4096
    ds_read_b64_tr_b16 a[246:247], v45 offset:6144
    v_mfma_f32_16x16x32_bf16 v[52:55], a[248:251], v[128:131], v[52:55]
    buffer_store_dwordx4 v[30:33], v12, s[20:23], s50 offen nt
    v_mfma_f32_16x16x32_bf16 v[52:55], a[252:255], v[136:139], v[52:55]
    s_add_u32 s50, s10, 0
    v_mul_f32 v97, v97, v17
    v_mul_f32 v98, v98, v17
    v_mfma_f32_16x16x32_bf16 v[60:63], a[248:251], v[132:135], v[60:63]
    ds_read_b64_tr_b16 a[248:249], v45 offset:8192
    ds_read_b64_tr_b16 a[250:251], v45 offset:10240
    v_mfma_f32_16x16x32_bf16 v[60:63], a[252:255], v[140:143], v[60:63]
    s_waitcnt lgkmcnt(11)
    ds_read_b64_tr_b16 a[252:253], v45 offset:12288
    ds_read_b64_tr_b16 a[254:255], v45 offset:14336
    v_mfma_f32_16x16x32_bf16 v[80:83], a[128:131], v[112:115], 0
    buffer_load_dwordx4 v8, s[16:19], s48 offen offset:2048 lds
    v_mfma_f32_16x16x32_bf16 v[80:83], a[132:135], v[120:123], v[80:83]
    v_mul_f32 v99, v99, v17
    v_cvt_pk_bf16_f32 v96, v96, v97
    v_mfma_f32_16x16x32_bf16 v[88:91], a[128:131], v[116:119], 0
    ds_read_b64_tr_b16 a[128:129], v5 offset:16384
    ds_read_b64_tr_b16 a[130:131], v5 offset:18432
    v_mfma_f32_16x16x32_bf16 v[88:91], a[132:135], v[124:127], v[88:91]
    s_waitcnt lgkmcnt(10)
    ds_read_b64_tr_b16 a[132:133], v5 offset:20480
    ds_read_b64_tr_b16 a[134:135], v5 offset:22528
    v_mfma_f32_16x16x32_bf16 v[80:83], a[136:139], v[128:131], v[80:83]
    buffer_load_dwordx4 v8, s[16:19], s48 offen offset:3072 lds
    v_mfma_f32_16x16x32_bf16 v[80:83], a[140:143], v[136:139], v[80:83]
    v_cvt_pk_bf16_f32 v97, v98, v99
    v_mul_f32 v104, v104, v18
    v_mfma_f32_16x16x32_bf16 v[88:91], a[136:139], v[132:135], v[88:91]
    ds_read_b64_tr_b16 a[136:137], v5 offset:24576
    ds_read_b64_tr_b16 a[138:139], v5 offset:26624
    v_mfma_f32_16x16x32_bf16 v[88:91], a[140:143], v[140:143], v[88:91]
    s_waitcnt lgkmcnt(10)
    ds_read_b64_tr_b16 a[140:141], v5 offset:28672
    ds_read_b64_tr_b16 a[142:143], v5 offset:30720
    v_mfma_f32_16x16x32_bf16 v[84:87], a[240:243], v[112:115], 0
    ds_write_b64 v42, v[96:97] offset:0
    v_mfma_f32_16x16x32_bf16 v[84:87], a[244:247], v[120:123], v[84:87]
    v_mul_f32 v105, v105, v18
    v_mul_f32 v106, v106, v18
    v_mfma_f32_16x16x32_bf16 v[92:95], a[240:243], v[116:119], 0
    ds_read_b64_tr_b16 a[240:241], v6 offset:16384
    ds_read_b64_tr_b16 a[242:243], v6 offset:18432
    v_mfma_f32_16x16x32_bf16 v[92:95], a[244:247], v[124:127], v[92:95]
    s_waitcnt lgkmcnt(11)
    ds_read_b64_tr_b16 a[244:245], v6 offset:20480
    ds_read_b64_tr_b16 a[246:247], v6 offset:22528
    v_mfma_f32_16x16x32_bf16 v[84:87], a[248:251], v[128:131], v[84:87]
    v_mul_f32 v107, v107, v18
    v_cvt_pk_bf16_f32 v104, v104, v105
    v_mfma_f32_16x16x32_bf16 v[84:87], a[252:255], v[136:139], v[84:87]
    v_cvt_pk_bf16_f32 v105, v106, v107
    v_mul_f32 v100, v100, v17
    v_mfma_f32_16x16x32_bf16 v[92:95], a[248:251], v[132:135], v[92:95]
    ds_read_b64_tr_b16 a[248:249], v6 offset:24576
    ds_read_b64_tr_b16 a[250:251], v6 offset:26624
    v_mfma_f32_16x16x32_bf16 v[92:95], a[252:255], v[140:143], v[92:95]
    s_waitcnt lgkmcnt(11)
    ds_write_b64 v42, v[104:105] offset:2048
    v_mfma_f32_16x16x32_bf16 v[48:51], a[128:131], v[144:147], v[48:51]
    s_waitcnt vmcnt(6)
    ds_read_b64_tr_b16 a[252:253], v6 offset:28672
    ds_read_b64_tr_b16 a[254:255], v6 offset:30720
    v_mfma_f32_16x16x32_bf16 v[48:51], a[132:135], v[152:155], v[48:51]
    s_barrier
    v_mul_f32 v101, v101, v17
    v_mul_f32 v102, v102, v17
    v_mfma_f32_16x16x32_bf16 v[56:59], a[128:131], v[148:151], v[56:59]
    v_mul_f32 v103, v103, v17
    v_cvt_pk_bf16_f32 v100, v100, v101
    v_mfma_f32_16x16x32_bf16 v[56:59], a[132:135], v[156:159], v[56:59]
    v_cvt_pk_bf16_f32 v101, v102, v103
    v_mul_f32 v108, v108, v18
    v_mfma_f32_16x16x32_bf16 v[34:37], a[128:131], a[160:163], v[34:37]
    ds_read_b64_tr_b16 a[128:129], v21 offset:16384
    ds_read_b64_tr_b16 a[130:131], v21 offset:18432
    v_mfma_f32_16x16x32_bf16 v[34:37], a[132:135], a[164:167], v[34:37]
    s_waitcnt lgkmcnt(12)
    ds_read_b64_tr_b16 a[132:133], v21 offset:20480
    ds_read_b64_tr_b16 a[134:135], v21 offset:22528
    v_mfma_f32_16x16x32_bf16 v[48:51], a[136:139], v[160:163], v[48:51]
    ds_write_b64 v43, v[100:101] offset:0
    v_mfma_f32_16x16x32_bf16 v[48:51], a[140:143], v[168:171], v[48:51]
    v_mul_f32 v109, v109, v18
    v_mul_f32 v110, v110, v18
    v_mfma_f32_16x16x32_bf16 v[56:59], a[136:139], v[164:167], v[56:59]
    v_mul_f32 v111, v111, v18
    v_cvt_pk_bf16_f32 v108, v108, v109
    v_mfma_f32_16x16x32_bf16 v[56:59], a[140:143], v[172:175], v[56:59]
L_t3_6:
    s_cbranch_execz L_tback3
    v_cvt_pk_bf16_f32 v109, v110, v111
    v_mul_f32 v38, v38, v19
    v_mfma_f32_16x16x32_bf16 v[34:37], a[136:139], a[168:171], v[34:37]
    ds_read_b64_tr_b16 a[136:137], v21 offset:24576
    ds_read_b64_tr_b16 a[138:139], v21 offset:26624
    v_mfma_f32_16x16x32_bf16 v[34:37], a[140:143], a[172:175], v[34:37]
    s_waitcnt lgkmcnt(12)
    ds_read_b64_tr_b16 a[140:141], v21 offset:28672
    ds_read_b64_tr_b16 a[142:143], v21 offset:30720
    v_mfma_f32_16x16x32_bf16 v[52:55], a[240:243], v[144:147], v[52:55]
    ds_write_b64 v43, v[108:109] offset:2048
    v_mfma_f32_16x16x32_bf16 v[52:55], a[244:247], v[152:155], v[52:55]
    ds_read_b128 v[26:29], v0 offset:0
    v_mul_f32 v39, v39, v19
    v_mfma_f32_16x16x32_bf16 v[60:63], a[240:243], v[148:151], v[60:63]
    ds_read_b64_tr_b16 a[240:241], v45 offset:16384
    ds_read_b64_tr_b16 a[242:243], v45 offset:18432
    v_mfma_f32_16x16x32_bf16 v[60:63], a[244:247], v[156:159], v[60:63]
    s_waitcnt lgkmcnt(13)
    ds_read_b64_tr_b16 a[244:245], v45 offset:20480
    ds_read_b64_tr_b16 a[246:247], v45 offset:22528
    v_mfma_f32_16x16x32_bf16 v[52:55], a[248:251], v[160:163], v[52:55]
    ds_read_b64 v[30:31], v0 offset:1032
    v_mul_f32 v40, v40, v19
    v_mfma_f32_16x16x32_bf16 v[52:55], a[252:255], v[168:171], v[52:55]
    ds_read_b64 v[32:33], v0 offset:1024
    v_mul_f32 v41, v41, v19
    v_mfma_f32_16x16x32_bf16 v[60:63], a[248:251], v[164:167], v[60:63]
    ds_read_b64_tr_b16 a[248:249], v45 offset:24576
    ds_read_b64_tr_b16 a[250:251], v45 offset:26624
    v_mfma_f32_16x16x32_bf16 v[60:63], a[252:255], v[172:175], v[60:63]
    s_waitcnt lgkmcnt(15)
    ds_read_b64_tr_b16 a[252:253], v45 offset:28672
    ds_read_b64_tr_b16 a[254:255], v45 offset:30720
    v_mfma_f32_16x16x32_bf16 v[80:83], a[128:131], v[144:147], v[80:83]
    v_cvt_pk_bf16_f32 v38, v38, v39
    v_cvt_pk_bf16_f32 v39, v40, v41
    v_mfma_f32_16x16x32_bf16 v[80:83], a[132:135], v[152:155], v[80:83]
    buffer_store_dwordx2 v[38:39], v16, s[20:23], s51 offen nt
    v_mfma_f32_16x16x32_bf16 v[88:91], a[128:131], v[148:151], v[88:91]
    ds_read_b64_tr_b16 a[128:129], v5 offset:32768
    ds_read_b64_tr_b16 a[130:131], v5 offset:34816
    v_mfma_f32_16x16x32_bf16 v[88:91], a[132:135], v[156:159], v[88:91]
    s_waitcnt lgkmcnt(14)
    ds_read_b64_tr_b16 a[132:133], v5 offset:36864
    ds_read_b64_tr_b16 a[134:135], v5 offset:38912
    v_mfma_f32_16x16x32_bf16 v[80:83], a[136:139], v[160:163], v[80:83]
    v_mfma_f32_16x16x32_bf16 v[80:83], a[140:143], v[168:171], v[80:83]
    v_mfma_f32_16x16x32_bf16 v[88:91], a[136:139], v[164:167], v[88:91]
    ds_read_b64_tr_b16 a[136:137], v5 offset:40960
    ds_read_b64_tr_b16 a[138:139], v5 offset:43008
    v_mfma_f32_16x16x32_bf16 v[88:91], a[140:143], v[172:175], v[88:91]
    s_waitcnt lgkmcnt(12)
    ds_read_b64_tr_b16 a[140:141], v5 offset:45056
    ds_read_b64_tr_b16 a[142:143], v5 offset:47104
    v_mfma_f32_16x16x32_bf16 v[84:87], a[240:243], v[144:147], v[84:87]
    buffer_store_dwordx4 v[26:29], v12, s[20:23], s50 offen nt
    v_mfma_f32_16x16x32_bf16 v[84:87], a[244:247], v[152:155], v[84:87]
    s_add_u32 s50, s10, 4096
    ds_read_b128 v[26:29], v0 offset:2048
    v_mfma_f32_16x16x32_bf16 v[92:95], a[240:243], v[148:151], v[92:95]
    ds_read_b64_tr_b16 a[240:241], v6 offset:32768
    ds_read_b64_tr_b16 a[242:243], v6 offset:34816
    v_mfma_f32_16x16x32_bf16 v[92:95], a[244:247], v[156:159], v[92:95]
    s_waitcnt lgkmcnt(11)
    ds_read_b64_tr_b16 a[244:245], v6 offset:36864
    ds_read_b64_tr_b16 a[246:247], v6 offset:38912
    v_mfma_f32_16x16x32_bf16 v[84:87], a[248:251], v[160:163], v[84:87]
    v_mfma_f32_16x16x32_bf16 v[84:87], a[252:255], v[168:171], v[84:87]
    v_mfma_f32_16x16x32_bf16 v[92:95], a[248:251], v[164:167], v[92:95]
    ds_read_b64_tr_b16 a[248:249], v6 offset:40960
    ds_read_b64_tr_b16 a[250:251], v6 offset:43008
    v_mfma_f32_16x16x32_bf16 v[92:95], a[252:255], v[172:175], v[92:95]
    s_waitcnt lgkmcnt(11)
    v_mfma_f32_16x16x32_bf16 v[48:51], a[128:131], v[176:179], v[48:51]
    s_waitcnt vmcnt(2)
    ds_read_b64_tr_b16 a[252:253], v6 offset:45056
    ds_read_b64_tr_b16 a[254:255], v6 offset:47104
    v_mfma_f32_16x16x32_bf16 v[48:51], a[132:135], v[184:187], v[48:51]
    s_barrier
    v_mfma_f32_16x16x32_bf16 v[56:59], a[128:131], v[180:183], v[56:59]
    v_mfma_f32_16x16x32_bf16 v[56:59], a[132:135], v[188:191], v[56:59]
    v_mfma_f32_16x16x32_bf16 v[34:37], a[128:131], a[176:179], v[34:37]
    ds_read_b64_tr_b16 a[128:129], v21 offset:32768
    ds_read_b64_tr_b16 a[130:131], v21 offset:34816
    v_mfma_f32_16x16x32_bf16 v[34:37], a[132:135], a[180:183], v[34:37]
    s_waitcnt lgkmcnt(11)
    ds_read_b64_tr_b16 a[132:133], v21 offset:36864
    ds_read_b64_tr_b16 a[134:135], v21 offset:38912
    v_mfma_f32_16x16x32_bf16 v[48:51], a[136:139], v[192:195], v[48:51]
    v_mfma_f32_16x16x32_bf16 v[48:51], a[140:143], v[200:203], v[48:51]
    v_mfma_f32_16x16x32_bf16 v[56:59], a[136:139], v[196:199], v[56:59]
    v_mfma_f32_16x16x32_bf16 v[56:59], a[140:143], v[204:207], v[56:59]
    v_mfma_f32_16x16x32_bf16 v[34:37], a[136:139], a[184:187], v[34:37]
    ds_read_b64_tr_b16 a[136:137], v21 offset:40960
    ds_read_b64_tr_b16 a[138:139], v21 offset:43008
    v_mfma_f32_16x16x32_bf16 v[34:37], a[140:143], a[188:191], v[34:37]
    s_waitcnt lgkmcnt(10)
    ds_read_b64_tr_b16 a[140:141], v21 offset:45056
    ds_read_b64_tr_b16 a[142:143], v21 offset:47104
    v_mfma_f32_16x16x32_bf16 v[52:55], a[240:243], v[176:179], v[52:55]
    v_mfma_f32_16x16x32_bf16 v[52:55], a[244:247], v[184:187], v[52:55]
    buffer_store_dwordx4 v[30:33], v12, s[20:23], s50 offen nt
    v_mfma_f32_16x16x32_bf16 v[60:63], a[240:243], v[180:183], v[60:63]
    s_add_u32 s50, s10, 32768
    ds_read_b64_tr_b16 a[240:241], v45 offset:32768
    ds_read_b64_tr_b16 a[242:243], v45 offset:34816
    v_mfma_f32_16x16x32_bf16 v[60:63], a[244:247], v[188:191], v[60:63]
    s_waitcnt lgkmcnt(10)
    ds_read_b64_tr_b16 a[244:245], v45 offset:36864
    ds_read_b64_tr_b16 a[246:247], v45 offset:38912
    v_mfma_f32_16x16x32_bf16 v[52:55], a[248:251], v[192:195], v[52:55]
    ds_read_b64 v[30:31], v0 offset:3080
    v_mfma_f32_16x16x32_bf16 v[52:55], a[252:255], v[200:203], v[52:55]
    ds_read_b64 v[32:33], v0 offset:3072
    v_mfma_f32_16x16x32_bf16 v[60:63], a[248:251], v[196:199], v[60:63]
    ds_read_b64_tr_b16 a[248:249], v45 offset:40960
    ds_read_b64_tr_b16 a[250:251], v45 offset:43008
    v_mfma_f32_16x16x32_bf16 v[60:63], a[252:255], v[204:207], v[60:63]
    s_waitcnt lgkmcnt(12)
    ds_read_b64_tr_b16 a[252:253], v45 offset:45056
    ds_read_b64_tr_b16 a[254:255], v45 offset:47104
    v_mfma_f32_16x16x32_bf16 v[80:83], a[128:131], v[176:179], v[80:83]
    v_mfma_f32_16x16x32_bf16 v[80:83], a[132:135], v[184:187], v[80:83]
    v_mfma_f32_16x16x32_bf16 v[88:91], a[128:131], v[180:183], v[88:91]
    ds_read_b64_tr_b16 a[128:129], v5 offset:49152
    ds_read_b64_tr_b16 a[130:131], v5 offset:51200
    v_mfma_f32_16x16x32_bf16 v[88:91], a[132:135], v[188:191], v[88:91]
    s_waitcnt lgkmcnt(12)
    ds_read_b64_tr_b16 a[132:133], v5 offset:53248
    ds_read_b64_tr_b16 a[134:135], v5 offset:55296
    v_mfma_f32_16x16x32_bf16 v[80:83], a[136:139], v[192:195], v[80:83]
    v_mfma_f32_16x16x32_bf16 v[80:83], a[140:143], v[200:203], v[80:83]
    v_mfma_f32_16x16x32_bf16 v[88:91], a[136:139], v[196:199], v[88:91]
    ds_read_b64_tr_b16 a[136:137], v5 offset:57344
    ds_read_b64_tr_b16 a[138:139], v5 offset:59392
    v_mfma_f32_16x16x32_bf16 v[88:91], a[140:143], v[204:207], v[88:91]
    s_waitcnt lgkmcnt(12)
    ds_read_b64_tr_b16 a[140:141], v5 offset:61440
    ds_read_b64_tr_b16 a[142:143], v5 offset:63488
    v_mfma_f32_16x16x32_bf16 v[84:87], a[240:243], v[176:179], v[84:87]
    v_mfma_f32_16x16x32_bf16 v[84:87], a[244:247], v[184:187], v[84:87]
    v_mfma_f32_16x16x32_bf16 v[92:95], a[240:243], v[180:183], v[92:95]
    ds_read_b64_tr_b16 a[240:241], v6 offset:49152
    ds_read_b64_tr_b16 a[242:243], v6 offset:51200
    v_mfma_f32_16x16x32_bf16 v[92:95], a[244:247], v[188:191], v[92:95]
    s_waitcnt lgkmcnt(10)
    ds_read_b64_tr_b16 a[244:245], v6 offset:53248
    ds_read_b64_tr_b16 a[246:247], v6 offset:55296
    v_mfma_f32_16x16x32_bf16 v[84:87], a[248:251], v[192:195], v[84:87]
    v_mfma_f32_16x16x32_bf16 v[84:87], a[252:255], v[200:203], v[84:87]
    v_mfma_f32_16x16x32_bf16 v[92:95], a[248:251], v[196:199], v[92:95]
    ds_read_b64_tr_b16 a[248:249], v6 offset:57344
    ds_read_b64_tr_b16 a[250:251], v6 offset:59392
    v_mfma_f32_16x16x32_bf16 v[92:95], a[252:255], v[204:207], v[92:95]
    s_waitcnt lgkmcnt(10)
    buffer_store_dwordx4 v[26:29], v12, s[20:23], s50 offen nt
    v_mfma_f32_16x16x32_bf16 v[48:51], a[128:131], v[208:211], v[48:51]
    s_add_u32 s50, s10, 36864
    ds_read_b64_tr_b16 a[252:253], v6 offset:61440
    ds_read_b64_tr_b16 a[254:255], v6 offset:63488
    v_mfma_f32_16x16x32_bf16 v[48:51], a[132:135], v[216:219], v[48:51]
    s_barrier
    v_xor_b32 v43, 32, v11
    v_mfma_f32_16x16x32_bf16 v[56:59], a[128:131], v[212:215], v[56:59]
    s_add_u32 s51, s11, 65536
    v_mfma_f32_16x16x32_bf16 v[56:59], a[132:135], v[220:223], v[56:59]
    v_mfma_f32_16x16x32_bf16 v[34:37], a[128:131], a[192:195], v[34:37]
    ds_read_b64_tr_b16 a[128:129], v21 offset:49152
    ds_read_b64_tr_b16 a[130:131], v21 offset:51200
    v_mfma_f32_16x16x32_bf16 v[34:37], a[132:135], a[196:199], v[34:37]
    s_waitcnt lgkmcnt(10)
    ds_read_b64_tr_b16 a[132:133], v21 offset:53248
    ds_read_b64_tr_b16 a[134:135], v21 offset:55296
    v_mfma_f32_16x16x32_bf16 v[48:51], a[136:139], v[224:227], v[48:51]
    v_mfma_f32_16x16x32_bf16 v[48:51], a[140:143], v[232:235], v[48:51]
    v_mfma_f32_16x16x32_bf16 v[56:59], a[136:139], v[228:231], v[56:59]
    v_mfma_f32_16x16x32_bf16 v[56:59], a[140:143], v[236:239], v[56:59]
    v_mfma_f32_16x16x32_bf16 v[34:37], a[136:139], a[200:203], v[34:37]
    ds_read_b64_tr_b16 a[136:137], v21 offset:57344
    ds_read_b64_tr_b16 a[138:139], v21 offset:59392
    v_mfma_f32_16x16x32_bf16 v[34:37], a[140:143], a[204:207], v[34:37]
    s_waitcnt lgkmcnt(10)
    ds_read_b64_tr_b16 a[140:141], v21 offset:61440
    ds_read_b64_tr_b16 a[142:143], v21 offset:63488
    v_mfma_f32_16x16x32_bf16 v[52:55], a[240:243], v[208:211], v[52:55]
    v_mul_f32 v48, v48, v17
    v_mul_f32 v49, v49, v17
    v_mfma_f32_16x16x32_bf16 v[52:55], a[244:247], v[216:219], v[52:55]
    v_mul_f32 v50, v50, v17
    v_mul_f32 v51, v51, v17
    v_mfma_f32_16x16x32_bf16 v[60:63], a[240:243], v[212:215], v[60:63]
    ds_read_b64_tr_b16 a[240:241], v45 offset:49152
    ds_read_b64_tr_b16 a[242:243], v45 offset:51200
    v_mfma_f32_16x16x32_bf16 v[60:63], a[244:247], v[220:223], v[60:63]
    s_waitcnt lgkmcnt(10)
    ds_read_b64_tr_b16 a[244:245], v45 offset:53248
    ds_read_b64_tr_b16 a[246:247], v45 offset:55296
    v_mfma_f32_16x16x32_bf16 v[52:55], a[248:251], v[224:227], v[52:55]
    v_cvt_pk_bf16_f32 v48, v48, v49
    v_cvt_pk_bf16_f32 v49, v50, v51
    v_mfma_f32_16x16x32_bf16 v[52:55], a[252:255], v[232:235], v[52:55]
    ds_write_b64 v11, v[48:49] offset:8192
    v_mfma_f32_16x16x32_bf16 v[60:63], a[248:251], v[228:231], v[60:63]
    ds_read_b64_tr_b16 a[248:249], v45 offset:57344
    ds_read_b64_tr_b16 a[250:251], v45 offset:59392
    v_mfma_f32_16x16x32_bf16 v[60:63], a[252:255], v[236:239], v[60:63]
    s_waitcnt lgkmcnt(11)
    ds_read_b64_tr_b16 a[252:253], v45 offset:61440
    ds_read_b64_tr_b16 a[254:255], v45 offset:63488
    v_mfma_f32_16x16x32_bf16 v[80:83], a[128:131], v[208:211], v[80:83]
    buffer_store_dwordx4 v[30:33], v12, s[20:23], s50 offen nt
    v_mfma_f32_16x16x32_bf16 v[80:83], a[132:135], v[216:219], v[80:83]
    v_mul_f32 v56, v56, v18
    v_mul_f32 v57, v57, v18
    v_mfma_f32_16x16x32_bf16 v[88:91], a[128:131], v[212:215], v[88:91]
    v_mul_f32 v58, v58, v18
    v_mul_f32 v59, v59, v18
    v_mfma_f32_16x16x32_bf16 v[88:91], a[132:135], v[220:223], v[88:91]
    s_waitcnt lgkmcnt(9)
    v_cvt_pk_bf16_f32 v56, v56, v57
    v_cvt_pk_bf16_f32 v57, v58, v59
    v_mfma_f32_16x16x32_bf16 v[80:83], a[136:139], v[224:227], v[80:83]
    ds_write_b64 v11, v[56:57] offset:10240
    v_mfma_f32_16x16x32_bf16 v[80:83], a[140:143], v[232:235], v[80:83]
    v_mul_f32 v52, v52, v17
    v_mul_f32 v53, v53, v17
    v_mfma_f32_16x16x32_bf16 v[88:91], a[136:139], v[228:231], v[88:91]
    v_mul_f32 v54, v54, v17
    v_mul_f32 v55, v55, v17
    v_mfma_f32_16x16x32_bf16 v[88:91], a[140:143], v[236:239], v[88:91]
    s_waitcnt lgkmcnt(6)
    v_cvt_pk_bf16_f32 v52, v52, v53
    v_cvt_pk_bf16_f32 v53, v54, v55
    v_mfma_f32_16x16x32_bf16 v[84:87], a[240:243], v[208:211], v[84:87]
    ds_write_b64 v43, v[52:53] offset:8192
    v_mfma_f32_16x16x32_bf16 v[84:87], a[244:247], v[216:219], v[84:87]
    v_mul_f32 v60, v60, v18
    v_mul_f32 v61, v61, v18
    v_mfma_f32_16x16x32_bf16 v[92:95], a[240:243], v[212:215], v[92:95]
    v_mul_f32 v62, v62, v18
    v_mul_f32 v63, v63, v18
    v_mfma_f32_16x16x32_bf16 v[92:95], a[244:247], v[220:223], v[92:95]
    s_waitcnt lgkmcnt(2)
    v_cvt_pk_bf16_f32 v60, v60, v61
    v_cvt_pk_bf16_f32 v61, v62, v63
    v_mfma_f32_16x16x32_bf16 v[84:87], a[248:251], v[224:227], v[84:87]
    ds_write_b64 v43, v[60:61] offset:10240
    v_mfma_f32_16x16x32_bf16 v[84:87], a[252:255], v[232:235], v[84:87]
    v_mul_f32 v34, v34, v19
    v_mul_f32 v35, v35, v19
    v_mfma_f32_16x16x32_bf16 v[92:95], a[248:251], v[228:231], v[92:95]
    v_mul_f32 v36, v36, v19
    v_mul_f32 v37, v37, v19
    v_mfma_f32_16x16x32_bf16 v[92:95], a[252:255], v[236:239], v[92:95]
    v_cvt_pk_bf16_f32 v34, v34, v35
    v_cvt_pk_bf16_f32 v35, v36, v37
    buffer_store_dwordx2 v[34:35], v16, s[20:23], s51 offen nt
    s_nop 1
    s_nop 5
    v_xor_b32_e64 v42, 64, v11
    v_pk_mul_f32 v[80:81], v[80:81], v[16:17] op_sel:[0,1] op_sel_hi:[1,1]
    v_pk_mul_f32 v[82:83], v[82:83], v[16:17] op_sel:[0,1] op_sel_hi:[1,1]
    v_cvt_pk_bf16_f32 v80, v80, v81
    v_cvt_pk_bf16_f32 v81, v82, v83
    ds_write_b64 v42, v[80:81] offset:8192
    v_pk_mul_f32 v[88:89], v[88:89], v[18:19] op_sel_hi:[1,0]
    v_pk_mul_f32 v[90:91], v[90:91], v[18:19] op_sel_hi:[1,0]
    v_cvt_pk_bf16_f32 v88, v88, v89
    v_cvt_pk_bf16_f32 v89, v90, v91
    ds_write_b64 v42, v[88:89] offset:10240
    v_xor_b32 v43, 96, v11
    v_pk_mul_f32 v[84:85], v[84:85], v[16:17] op_sel:[0,1] op_sel_hi:[1,1]
    v_pk_mul_f32 v[86:87], v[86:87], v[16:17] op_sel:[0,1] op_sel_hi:[1,1]
    v_cvt_pk_bf16_f32 v84, v84, v85
    v_cvt_pk_bf16_f32 v85, v86, v87
    ds_write_b64 v43, v[84:85] offset:8192
    v_pk_mul_f32 v[92:93], v[92:93], v[18:19] op_sel_hi:[1,0]
    v_pk_mul_f32 v[94:95], v[94:95], v[18:19] op_sel_hi:[1,0]
    v_cvt_pk_bf16_f32 v92, v92, v93
    v_cvt_pk_bf16_f32 v93, v94, v95
    ds_write_b64 v43, v[92:93] offset:10240
    ds_read_b128 v[112:115], v0 offset:8192
    ds_read_b64 v[116:117], v0 offset:9224
    ds_read_b64 v[118:119], v0 offset:9216
    ds_read_b128 v[120:123], v0 offset:10240
    ds_read_b64 v[124:125], v0 offset:11272
    ds_read_b64 v[126:127], v0 offset:11264
    s_add_u32 s50, s11, 0
    s_waitcnt lgkmcnt(5)
    buffer_store_dwordx4 v[112:115], v12, s[20:23], s50 offen nt
    s_add_u32 s50, s11, 4096
    s_waitcnt lgkmcnt(3)
    buffer_store_dwordx4 v[116:119], v12, s[20:23], s50 offen nt
    s_add_u32 s50, s11, 32768
    s_waitcnt lgkmcnt(2)
    buffer_store_dwordx4 v[120:123], v12, s[20:23], s50 offen nt
    s_add_u32 s50, s11, 36864
    s_waitcnt lgkmcnt(0)
    buffer_store_dwordx4 v[124:127], v12, s[20:23], s50 offen nt
    s_endpgm
L_end:
L_slow_4:
    s_waitcnt vmcnt(0) lgkmcnt(0)
    s_nop 7
    v_mbcnt_lo_u32_b32 v43, -1, 0
    v_mbcnt_hi_u32_b32 v43, -1, v43
    v_and_b32 v42, 48, v43
    v_and_b32 v44, 6, v43
    v_lshl_add_u32 v42, v44, 11, v42
    v_and_b32_e64 v44, 8, v43
    v_lshl_add_u32 v42, v44, 7, v42
    v_and_b32_e64 v44, 1, v43
    v_lshl_add_u32 v42, v44, 9, v42
    v_mov_b32 v13, 0xff800000
    v_mov_b32 v14, 0xff800000
    v_mov_b32 v15, 0xff800000
    v_mov_b32 v16, 0xff800000
    s_mov_b32 s42, 0
    s_mov_b32 s43, 0
L_slow1_4:
    s_call_b64 s[68:69], L_slowqk_4
    s_nop 0
    v_max3_f32 v13, v13, v80, v81
    v_max3_f32 v13, v13, v82, v83
    v_max3_f32 v13, v13, v84, v85
    v_max3_f32 v13, v13, v86, v87
    v_max3_f32 v14, v14, v88, v89
    v_max3_f32 v14, v14, v90, v91
    v_max3_f32 v14, v14, v92, v93
    v_max3_f32 v14, v14, v94, v95
    v_max3_f32 v15, v15, v96, v97
    v_max3_f32 v15, v15, v98, v99
    v_max3_f32 v15, v15, v100, v101
    v_max3_f32 v15, v15, v102, v103
    v_max3_f32 v16, v16, v104, v105
    v_max3_f32 v16, v16, v106, v107
    v_max3_f32 v16, v16, v108, v109
    v_max3_f32 v16, v16, v110, v111
    s_add_u32 s43, s43, 1
    s_cmp_lt_u32 s43, 16
    s_cbranch_scc1 L_slow1_4
    v_mov_b32 v26, v13
    v_mov_b32 v30, v14
    v_mov_b32 v34, v15
    v_mov_b32 v38, v16
    v_permlane32_swap_b32 v13, v26
    v_permlane32_swap_b32 v14, v30
    v_permlane32_swap_b32 v15, v34
    v_permlane32_swap_b32 v16, v38
    v_max_f32 v13, v13, v26
    v_max_f32 v14, v14, v30
    v_max_f32 v15, v15, v34
    v_max_f32 v16, v16, v38
    v_mov_b32 v26, v13
    v_mov_b32 v30, v14
    v_mov_b32 v34, v15
    v_mov_b32 v38, v16
    v_permlane16_swap_b32 v13, v26
    v_permlane16_swap_b32 v14, v30
    v_permlane16_swap_b32 v15, v34
    v_permlane16_swap_b32 v16, v38
    v_max_f32 v13, v13, v26
    v_max_f32 v14, v14, v30
    v_max_f32 v15, v15, v34
    v_max_f32 v16, v16, v38
    v_mul_f32 v13, s24, v13
    v_mul_f32 v14, s24, v14
    v_mul_f32 v15, s24, v15
    v_mul_f32 v16, s24, v16
    s_mov_b32 s42, 0
    s_call_b64 s[68:69], L_slowqk_4
    s_call_b64 s[68:69], L_slowsm_4
    v_mov_b32 v112, v80
    v_mov_b32 v113, v81
    v_mov_b32 v114, v82
    v_mov_b32 v115, v83
    v_mov_b32 v116, v88
    v_mov_b32 v117, v89
    v_mov_b32 v118, v90
    v_mov_b32 v119, v91
    v_mov_b32 v120, v96
    v_mov_b32 v121, v97
    v_mov_b32 v122, v98
    v_mov_b32 v123, v99
    v_mov_b32 v124, v104
    v_mov_b32 v125, v105
    v_mov_b32 v126, v106
    v_mov_b32 v127, v107
    s_nop 1
    v_mfma_f32_16x16x32_bf16 v[26:29], v[22:25], v[112:115], 0
    v_mfma_f32_16x16x32_bf16 v[30:33], v[22:25], v[116:119], 0
    v_mfma_f32_16x16x32_bf16 v[34:37], v[22:25], v[120:123], 0
    v_mfma_f32_16x16x32_bf16 v[38:41], v[22:25], v[124:127], 0
    s_call_b64 s[68:69], L_slowqk_4
    s_call_b64 s[68:69], L_slowsm_4
    v_mov_b32 v128, v80
    v_mov_b32 v129, v81
    v_mov_b32 v130, v82
    v_mov_b32 v131, v83
    v_mov_b32 v132, v88
    v_mov_b32 v133, v89
    v_mov_b32 v134, v90
    v_mov_b32 v135, v91
    v_mov_b32 v136, v96
    v_mov_b32 v137, v97
    v_mov_b32 v138, v98
    v_mov_b32 v139, v99
    v_mov_b32 v140, v104
    v_mov_b32 v141, v105
    v_mov_b32 v142, v106
    v_mov_b32 v143, v107
    s_nop 1
    v_mfma_f32_16x16x32_bf16 v[26:29], v[22:25], v[128:131], v[26:29]
    v_mfma_f32_16x16x32_bf16 v[30:33], v[22:25], v[132:135], v[30:33]
    v_mfma_f32_16x16x32_bf16 v[34:37], v[22:25], v[136:139], v[34:37]
    v_mfma_f32_16x16x32_bf16 v[38:41], v[22:25], v[140:143], v[38:41]
    s_call_b64 s[68:69], L_slowqk_4
    s_call_b64 s[68:69], L_slowsm_4
    v_mov_b32 v144, v80
    v_mov_b32 v145, v81
    v_mov_b32 v146, v82
    v_mov_b32 v147, v83
    v_mov_b32 v148, v88
    v_mov_b32 v149, v89
    v_mov_b32 v150, v90
    v_mov_b32 v151, v91
    v_mov_b32 v152, v96
    v_mov_b32 v153, v97
    v_mov_b32 v154, v98
    v_mov_b32 v155, v99
    v_mov_b32 v156, v104
    v_mov_b32 v157, v105
    v_mov_b32 v158, v106
    v_mov_b32 v159, v107
    s_nop 1
    v_mfma_f32_16x16x32_bf16 v[26:29], v[22:25], v[144:147], v[26:29]
    v_mfma_f32_16x16x32_bf16 v[30:33], v[22:25], v[148:151], v[30:33]
    v_mfma_f32_16x16x32_bf16 v[34:37], v[22:25], v[152:155], v[34:37]
    v_mfma_f32_16x16x32_bf16 v[38:41], v[22:25], v[156:159], v[38:41]
    s_call_b64 s[68:69], L_slowqk_4
    s_call_b64 s[68:69], L_slowsm_4
    s_nop 0
    v_accvgpr_write_b32 a144, v80
    v_accvgpr_write_b32 a145, v81
    v_accvgpr_write_b32 a146, v82
    v_accvgpr_write_b32 a147, v83
    v_accvgpr_write_b32 a148, v88
    v_accvgpr_write_b32 a149, v89
    v_accvgpr_write_b32 a150, v90
    v_accvgpr_write_b32 a151, v91
    v_accvgpr_write_b32 a152, v96
    v_accvgpr_write_b32 a153, v97
    v_accvgpr_write_b32 a154, v98
    v_accvgpr_write_b32 a155, v99
    v_accvgpr_write_b32 a156, v104
    v_accvgpr_write_b32 a157, v105
    v_accvgpr_write_b32 a158, v106
    v_accvgpr_write_b32 a159, v107
    s_nop 1
    v_mfma_f32_16x16x32_bf16 v[26:29], v[22:25], a[144:147], v[26:29]
    v_mfma_f32_16x16x32_bf16 v[30:33], v[22:25], a[148:151], v[30:33]
    v_mfma_f32_16x16x32_bf16 v[34:37], v[22:25], a[152:155], v[34:37]
    v_mfma_f32_16x16x32_bf16 v[38:41], v[22:25], a[156:159], v[38:41]
    s_call_b64 s[68:69], L_slowqk_4
    s_call_b64 s[68:69], L_slowsm_4
    v_mov_b32 v160, v80
    v_mov_b32 v161, v81
    v_mov_b32 v162, v82
    v_mov_b32 v163, v83
    v_mov_b32 v164, v88
    v_mov_b32 v165, v89
    v_mov_b32 v166, v90
    v_mov_b32 v167, v91
    v_mov_b32 v168, v96
    v_mov_b32 v169, v97
    v_mov_b32 v170, v98
    v_mov_b32 v171, v99
    v_mov_b32 v172, v104
    v_mov_b32 v173, v105
    v_mov_b32 v174, v106
    v_mov_b32 v175, v107
    s_nop 1
    v_mfma_f32_16x16x32_bf16 v[26:29], v[22:25], v[160:163], v[26:29]
    v_mfma_f32_16x16x32_bf16 v[30:33], v[22:25], v[164:167], v[30:33]
    v_mfma_f32_16x16x32_bf16 v[34:37], v[22:25], v[168:171], v[34:37]
    v_mfma_f32_16x16x32_bf16 v[38:41], v[22:25], v[172:175], v[38:41]
    s_call_b64 s[68:69], L_slowqk_4
    s_call_b64 s[68:69], L_slowsm_4
    v_accvgpr_write_b32 a160, v80
    v_accvgpr_write_b32 a161, v81
    v_accvgpr_write_b32 a162, v82
    v_accvgpr_write_b32 a163, v83
    v_accvgpr_write_b32 a164, v88
    v_accvgpr_write_b32 a165, v89
    v_accvgpr_write_b32 a166, v90
    v_accvgpr_write_b32 a167, v91
    v_accvgpr_write_b32 a168, v96
    v_accvgpr_write_b32 a169, v97
    v_accvgpr_write_b32 a170, v98
    v_accvgpr_write_b32 a171, v99
    v_accvgpr_write_b32 a172, v104
    v_accvgpr_write_b32 a173, v105
    v_accvgpr_write_b32 a174, v106
    v_accvgpr_write_b32 a175, v107
    s_nop 1
    v_mfma_f32_16x16x32_bf16 v[26:29], v[22:25], a[160:163], v[26:29]
    v_mfma_f32_16x16x32_bf16 v[30:33], v[22:25], a[164:167], v[30:33]
    v_mfma_f32_16x16x32_bf16 v[34:37], v[22:25], a[168:171], v[34:37]
    v_mfma_f32_16x16x32_bf16 v[38:41], v[22:25], a[172:175], v[38:41]
    s_call_b64 s[68:69], L_slowqk_4
    s_call_b64 s[68:69], L_slowsm_4
    v_mov_b32 v176, v80
    v_mov_b32 v177, v81
    v_mov_b32 v178, v82
    v_mov_b32 v179, v83
    v_mov_b32 v180, v88
    v_mov_b32 v181, v89
    v_mov_b32 v182, v90
    v_mov_b32 v183, v91
    v_mov_b32 v184, v96
    v_mov_b32 v185, v97
    v_mov_b32 v186, v98
    v_mov_b32 v187, v99
    v_mov_b32 v188, v104
    v_mov_b32 v189, v105
    v_mov_b32 v190, v106
    v_mov_b32 v191, v107
    s_nop 1
    v_mfma_f32_16x16x32_bf16 v[26:29], v[22:25], v[176:179], v[26:29]
    v_mfma_f32_16x16x32_bf16 v[30:33], v[22:25], v[180:183], v[30:33]
    v_mfma_f32_16x16x32_bf16 v[34:37], v[22:25], v[184:187], v[34:37]
    v_mfma_f32_16x16x32_bf16 v[38:41], v[22:25], v[188:191], v[38:41]
    s_call_b64 s[68:69], L_slowqk_4
    s_call_b64 s[68:69], L_slowsm_4
    v_accvgpr_write_b32 a176, v80
    v_accvgpr_write_b32 a177, v81
    v_accvgpr_write_b32 a178, v82
    v_accvgpr_write_b32 a179, v83
    v_accvgpr_write_b32 a180, v88
    v_accvgpr_write_b32 a181, v89
    v_accvgpr_write_b32 a182, v90
    v_accvgpr_write_b32 a183, v91
    v_accvgpr_write_b32 a184, v96
    v_accvgpr_write_b32 a185, v97
    v_accvgpr_write_b32 a186, v98
    v_accvgpr_write_b32 a187, v99
    v_accvgpr_write_b32 a188, v104
    v_accvgpr_write_b32 a189, v105
    v_accvgpr_write_b32 a190, v106
    v_accvgpr_write_b32 a191, v107
    s_nop 1
    v_mfma_f32_16x16x32_bf16 v[26:29], v[22:25], a[176:179], v[26:29]
    v_mfma_f32_16x16x32_bf16 v[30:33], v[22:25], a[180:183], v[30:33]
    v_mfma_f32_16x16x32_bf16 v[34:37], v[22:25], a[184:187], v[34:37]
    v_mfma_f32_16x16x32_bf16 v[38:41], v[22:25], a[188:191], v[38:41]
    s_call_b64 s[68:69], L_slowqk_4
    s_call_b64 s[68:69], L_slowsm_4
    v_mov_b32 v192, v80
    v_mov_b32 v193, v81
    v_mov_b32 v194, v82
    v_mov_b32 v195, v83
    v_mov_b32 v196, v88
    v_mov_b32 v197, v89
    v_mov_b32 v198, v90
    v_mov_b32 v199, v91
    v_mov_b32 v200, v96
    v_mov_b32 v201, v97
    v_mov_b32 v202, v98
    v_mov_b32 v203, v99
    v_mov_b32 v204, v104
    v_mov_b32 v205, v105
    v_mov_b32 v206, v106
    v_mov_b32 v207, v107
    s_nop 1
    v_mfma_f32_16x16x32_bf16 v[26:29], v[22:25], v[192:195], v[26:29]
    v_mfma_f32_16x16x32_bf16 v[30:33], v[22:25], v[196:199], v[30:33]
    v_mfma_f32_16x16x32_bf16 v[34:37], v[22:25], v[200:203], v[34:37]
    v_mfma_f32_16x16x32_bf16 v[38:41], v[22:25], v[204:207], v[38:41]
    s_call_b64 s[68:69], L_slowqk_4
    s_call_b64 s[68:69], L_slowsm_4
    v_accvgpr_write_b32 a192, v80
    v_accvgpr_write_b32 a193, v81
    v_accvgpr_write_b32 a194, v82
    v_accvgpr_write_b32 a195, v83
    v_accvgpr_write_b32 a196, v88
    v_accvgpr_write_b32 a197, v89
    v_accvgpr_write_b32 a198, v90
    v_accvgpr_write_b32 a199, v91
    v_accvgpr_write_b32 a200, v96
    v_accvgpr_write_b32 a201, v97
    v_accvgpr_write_b32 a202, v98
    v_accvgpr_write_b32 a203, v99
    v_accvgpr_write_b32 a204, v104
    v_accvgpr_write_b32 a205, v105
    v_accvgpr_write_b32 a206, v106
    v_accvgpr_write_b32 a207, v107
    s_nop 1
    v_mfma_f32_16x16x32_bf16 v[26:29], v[22:25], a[192:195], v[26:29]
    v_mfma_f32_16x16x32_bf16 v[30:33], v[22:25], a[196:199], v[30:33]
    v_mfma_f32_16x16x32_bf16 v[34:37], v[22:25], a[200:203], v[34:37]
    v_mfma_f32_16x16x32_bf16 v[38:41], v[22:25], a[204:207], v[38:41]
    s_call_b64 s[68:69], L_slowqk_4
    s_call_b64 s[68:69], L_slowsm_4
    v_mov_b32 v208, v80
    v_mov_b32 v209, v81
    v_mov_b32 v210, v82
    v_mov_b32 v211, v83
    v_mov_b32 v212, v88
    v_mov_b32 v213, v89
    v_mov_b32 v214, v90
    v_mov_b32 v215, v91
    v_mov_b32 v216, v96
    v_mov_b32 v217, v97
    v_mov_b32 v218, v98
    v_mov_b32 v219, v99
    v_mov_b32 v220, v104
    v_mov_b32 v221, v105
    v_mov_b32 v222, v106
    v_mov_b32 v223, v107
    s_nop 1
    v_mfma_f32_16x16x32_bf16 v[26:29], v[22:25], v[208:211], v[26:29]
    v_mfma_f32_16x16x32_bf16 v[30:33], v[22:25], v[212:215], v[30:33]
    v_mfma_f32_16x16x32_bf16 v[34:37], v[22:25], v[216:219], v[34:37]
    v_mfma_f32_16x16x32_bf16 v[38:41], v[22:25], v[220:223], v[38:41]
    s_call_b64 s[68:69], L_slowqk_4
    s_call_b64 s[68:69], L_slowsm_4
    v_accvgpr_write_b32 a208, v80
    v_accvgpr_write_b32 a209, v81
    v_accvgpr_write_b32 a210, v82
    v_accvgpr_write_b32 a211, v83
    v_accvgpr_write_b32 a212, v88
    v_accvgpr_write_b32 a213, v89
    v_accvgpr_write_b32 a214, v90
    v_accvgpr_write_b32 a215, v91
    v_accvgpr_write_b32 a216, v96
    v_accvgpr_write_b32 a217, v97
    v_accvgpr_write_b32 a218, v98
    v_accvgpr_write_b32 a219, v99
    v_accvgpr_write_b32 a220, v104
    v_accvgpr_write_b32 a221, v105
    v_accvgpr_write_b32 a222, v106
    v_accvgpr_write_b32 a223, v107
    s_nop 1
    v_mfma_f32_16x16x32_bf16 v[26:29], v[22:25], a[208:211], v[26:29]
    v_mfma_f32_16x16x32_bf16 v[30:33], v[22:25], a[212:215], v[30:33]
    v_mfma_f32_16x16x32_bf16 v[34:37], v[22:25], a[216:219], v[34:37]
    v_mfma_f32_16x16x32_bf16 v[38:41], v[22:25], a[220:223], v[38:41]
    s_call_b64 s[68:69], L_slowqk_4
    s_call_b64 s[68:69], L_slowsm_4
    s_nop 0
    v_accvgpr_write_b32 a224, v80
    v_accvgpr_write_b32 a225, v81
    v_accvgpr_write_b32 a226, v82
    v_accvgpr_write_b32 a227, v83
    v_accvgpr_write_b32 a228, v88
    v_accvgpr_write_b32 a229, v89
    v_accvgpr_write_b32 a230, v90
    v_accvgpr_write_b32 a231, v91
    v_accvgpr_write_b32 a232, v96
    v_accvgpr_write_b32 a233, v97
    v_accvgpr_write_b32 a234, v98
    v_accvgpr_write_b32 a235, v99
    v_accvgpr_write_b32 a236, v104
    v_accvgpr_write_b32 a237, v105
    v_accvgpr_write_b32 a238, v106
    v_accvgpr_write_b32 a239, v107
    s_nop 1
    v_mfma_f32_16x16x32_bf16 v[26:29], v[22:25], a[224:227], v[26:29]
    v_mfma_f32_16x16x32_bf16 v[30:33], v[22:25], a[228:231], v[30:33]
    v_mfma_f32_16x16x32_bf16 v[34:37], v[22:25], a[232:235], v[34:37]
    v_mfma_f32_16x16x32_bf16 v[38:41], v[22:25], a[236:239], v[38:41]
    s_call_b64 s[68:69], L_slowqk_4
    s_call_b64 s[68:69], L_slowsm_4
    s_nop 0
    v_accvgpr_write_b32 a240, v80
    v_accvgpr_write_b32 a241, v81
    v_accvgpr_write_b32 a242, v82
    v_accvgpr_write_b32 a243, v83
    v_accvgpr_write_b32 a244, v88
    v_accvgpr_write_b32 a245, v89
    v_accvgpr_write_b32 a246, v90
    v_accvgpr_write_b32 a247, v91
    v_accvgpr_write_b32 a248, v96
    v_accvgpr_write_b32 a249, v97
    v_accvgpr_write_b32 a250, v98
    v_accvgpr_write_b32 a251, v99
    v_accvgpr_write_b32 a252, v104
    v_accvgpr_write_b32 a253, v105
    v_accvgpr_write_b32 a254, v106
    v_accvgpr_write_b32 a255, v107
    s_nop 1
    v_mfma_f32_16x16x32_bf16 v[26:29], v[22:25], a[240:243], v[26:29]
    v_mfma_f32_16x16x32_bf16 v[30:33], v[22:25], a[244:247], v[30:33]
    v_mfma_f32_16x16x32_bf16 v[34:37], v[22:25], a[248:251], v[34:37]
    v_mfma_f32_16x16x32_bf16 v[38:41], v[22:25], a[252:255], v[38:41]
    s_call_b64 s[68:69], L_slowqk_4
    s_call_b64 s[68:69], L_slowsm_4
    v_mov_b32 v224, v80
    v_mov_b32 v225, v81
    v_mov_b32 v226, v82
    v_mov_b32 v227, v83
    v_mov_b32 v228, v88
    v_mov_b32 v229, v89
    v_mov_b32 v230, v90
    v_mov_b32 v231, v91
    v_mov_b32 v232, v96
    v_mov_b32 v233, v97
    v_mov_b32 v234, v98
    v_mov_b32 v235, v99
    v_mov_b32 v236, v104
    v_mov_b32 v237, v105
    v_mov_b32 v238, v106
    v_mov_b32 v239, v107
    s_nop 1
    v_mfma_f32_16x16x32_bf16 v[26:29], v[22:25], v[224:227], v[26:29]
    v_mfma_f32_16x16x32_bf16 v[30:33], v[22:25], v[228:231], v[30:33]
    v_mfma_f32_16x16x32_bf16 v[34:37], v[22:25], v[232:235], v[34:37]
    v_mfma_f32_16x16x32_bf16 v[38:41], v[22:25], v[236:239], v[38:41]
    s_call_b64 s[68:69], L_slowqk_4
    s_call_b64 s[68:69], L_slowsm_4
    v_mov_b32 v240, v80
    v_mov_b32 v241, v81
    v_mov_b32 v242, v82
    v_mov_b32 v243, v83
    v_mov_b32 v244, v88
    v_mov_b32 v245, v89
    v_mov_b32 v246, v90
    v_mov_b32 v247, v91
    v_mov_b32 v248, v96
    v_mov_b32 v249, v97
    v_mov_b32 v250, v98
    v_mov_b32 v251, v99
    v_mov_b32 v252, v104
    v_mov_b32 v253, v105
    v_mov_b32 v254, v106
    v_mov_b32 v255, v107
    s_nop 1
    v_mfma_f32_16x16x32_bf16 v[26:29], v[22:25], v[240:243], v[26:29]
    v_mfma_f32_16x16x32_bf16 v[30:33], v[22:25], v[244:247], v[30:33]
    v_mfma_f32_16x16x32_bf16 v[34:37], v[22:25], v[248:251], v[34:37]
    v_mfma_f32_16x16x32_bf16 v[38:41], v[22:25], v[252:255], v[38:41]
    ds_read_b64_tr_b16 a[128:129], v5 offset:0
    ds_read_b64_tr_b16 a[130:131], v5 offset:2048
    ds_read_b64_tr_b16 a[132:133], v5 offset:4096
    ds_read_b64_tr_b16 a[134:135], v5 offset:6144
    s_waitcnt lgkmcnt(0)
    v_mfma_f32_16x16x32_bf16 v[48:51], a[128:131], v[112:115], 0
    v_mfma_f32_16x16x32_bf16 v[48:51], a[132:135], v[128:131], v[48:51]
    v_mfma_f32_16x16x32_bf16 v[56:59], a[128:131], v[116:119], 0
    v_mfma_f32_16x16x32_bf16 v[56:59], a[132:135], v[132:135], v[56:59]
    v_mfma_f32_16x16x32_bf16 v[64:67], a[128:131], v[120:123], 0
    v_mfma_f32_16x16x32_bf16 v[64:67], a[132:135], v[136:139], v[64:67]
    v_mfma_f32_16x16x32_bf16 v[72:75], a[128:131], v[124:127], 0
    v_mfma_f32_16x16x32_bf16 v[72:75], a[132:135], v[140:143], v[72:75]
    ds_read_b64_tr_b16 a[136:137], v5 offset:8192
    ds_read_b64_tr_b16 a[138:139], v5 offset:10240
    ds_read_b64_tr_b16 a[140:141], v5 offset:12288
    ds_read_b64_tr_b16 a[142:143], v5 offset:14336
    s_waitcnt lgkmcnt(0)
    v_mfma_f32_16x16x32_bf16 v[48:51], a[136:139], v[144:147], v[48:51]
    v_mfma_f32_16x16x32_bf16 v[48:51], a[140:143], a[144:147], v[48:51]
    v_mfma_f32_16x16x32_bf16 v[56:59], a[136:139], v[148:151], v[56:59]
    v_mfma_f32_16x16x32_bf16 v[56:59], a[140:143], a[148:151], v[56:59]
    v_mfma_f32_16x16x32_bf16 v[64:67], a[136:139], v[152:155], v[64:67]
    v_mfma_f32_16x16x32_bf16 v[64:67], a[140:143], a[152:155], v[64:67]
    v_mfma_f32_16x16x32_bf16 v[72:75], a[136:139], v[156:159], v[72:75]
    v_mfma_f32_16x16x32_bf16 v[72:75], a[140:143], a[156:159], v[72:75]
    ds_read_b64_tr_b16 a[128:129], v6 offset:0
    ds_read_b64_tr_b16 a[130:131], v6 offset:2048
    ds_read_b64_tr_b16 a[132:133], v6 offset:4096
    ds_read_b64_tr_b16 a[134:135], v6 offset:6144
    s_waitcnt lgkmcnt(0)
    v_mfma_f32_16x16x32_bf16 v[52:55], a[128:131], v[112:115], 0
    v_mfma_f32_16x16x32_bf16 v[52:55], a[132:135], v[128:131], v[52:55]
    v_mfma_f32_16x16x32_bf16 v[60:63], a[128:131], v[116:119], 0
    v_mfma_f32_16x16x32_bf16 v[60:63], a[132:135], v[132:135], v[60:63]
    v_mfma_f32_16x16x32_bf16 v[68:71], a[128:131], v[120:123], 0
    v_mfma_f32_16x16x32_bf16 v[68:71], a[132:135], v[136:139], v[68:71]
    v_mfma_f32_16x16x32_bf16 v[76:79], a[128:131], v[124:127], 0
    v_mfma_f32_16x16x32_bf16 v[76:79], a[132:135], v[140:143], v[76:79]
    ds_read_b64_tr_b16 a[136:137], v6 offset:8192
    ds_read_b64_tr_b16 a[138:139], v6 offset:10240
    ds_read_b64_tr_b16 a[140:141], v6 offset:12288
    ds_read_b64_tr_b16 a[142:143], v6 offset:14336
    s_waitcnt lgkmcnt(0)
    v_mfma_f32_16x16x32_bf16 v[52:55], a[136:139], v[144:147], v[52:55]
    v_mfma_f32_16x16x32_bf16 v[52:55], a[140:143], a[144:147], v[52:55]
    v_mfma_f32_16x16x32_bf16 v[60:63], a[136:139], v[148:151], v[60:63]
    v_mfma_f32_16x16x32_bf16 v[60:63], a[140:143], a[148:151], v[60:63]
    v_mfma_f32_16x16x32_bf16 v[68:71], a[136:139], v[152:155], v[68:71]
    v_mfma_f32_16x16x32_bf16 v[68:71], a[140:143], a[152:155], v[68:71]
    v_mfma_f32_16x16x32_bf16 v[76:79], a[136:139], v[156:159], v[76:79]
    v_mfma_f32_16x16x32_bf16 v[76:79], a[140:143], a[156:159], v[76:79]
    ds_read_b64_tr_b16 a[128:129], v21 offset:0
    ds_read_b64_tr_b16 a[130:131], v21 offset:2048
    ds_read_b64_tr_b16 a[132:133], v21 offset:4096
    ds_read_b64_tr_b16 a[134:135], v21 offset:6144
    s_waitcnt lgkmcnt(0)
    v_mfma_f32_16x16x32_bf16 v[80:83], a[128:131], v[112:115], 0
    v_mfma_f32_16x16x32_bf16 v[80:83], a[132:135], v[128:131], v[80:83]
    v_mfma_f32_16x16x32_bf16 v[88:91], a[128:131], v[116:119], 0
    v_mfma_f32_16x16x32_bf16 v[88:91], a[132:135], v[132:135], v[88:91]
    v_mfma_f32_16x16x32_bf16 v[96:99], a[128:131], v[120:123], 0
    v_mfma_f32_16x16x32_bf16 v[96:99], a[132:135], v[136:139], v[96:99]
    v_mfma_f32_16x16x32_bf16 v[104:107], a[128:131], v[124:127], 0
    v_mfma_f32_16x16x32_bf16 v[104:107], a[132:135], v[140:143], v[104:107]
    ds_read_b64_tr_b16 a[136:137], v21 offset:8192
    ds_read_b64_tr_b16 a[138:139], v21 offset:10240
    ds_read_b64_tr_b16 a[140:141], v21 offset:12288
    ds_read_b64_tr_b16 a[142:143], v21 offset:14336
    s_waitcnt lgkmcnt(0)
    v_mfma_f32_16x16x32_bf16 v[80:83], a[136:139], v[144:147], v[80:83]
    v_mfma_f32_16x16x32_bf16 v[80:83], a[140:143], a[144:147], v[80:83]
    v_mfma_f32_16x16x32_bf16 v[88:91], a[136:139], v[148:151], v[88:91]
    v_mfma_f32_16x16x32_bf16 v[88:91], a[140:143], a[148:151], v[88:91]
    v_mfma_f32_16x16x32_bf16 v[96:99], a[136:139], v[152:155], v[96:99]
    v_mfma_f32_16x16x32_bf16 v[96:99], a[140:143], a[152:155], v[96:99]
    v_mfma_f32_16x16x32_bf16 v[104:107], a[136:139], v[156:159], v[104:107]
    v_mfma_f32_16x16x32_bf16 v[104:107], a[140:143], a[156:159], v[104:107]
    ds_read_b64_tr_b16 a[128:129], v45 offset:0
    ds_read_b64_tr_b16 a[130:131], v45 offset:2048
    ds_read_b64_tr_b16 a[132:133], v45 offset:4096
    ds_read_b64_tr_b16 a[134:135], v45 offset:6144
    s_waitcnt lgkmcnt(0)
    v_mfma_f32_16x16x32_bf16 v[84:87], a[128:131], v[112:115], 0
    v_mfma_f32_16x16x32_bf16 v[84:87], a[132:135], v[128:131], v[84:87]
    v_mfma_f32_16x16x32_bf16 v[92:95], a[128:131], v[116:119], 0
    v_mfma_f32_16x16x32_bf16 v[92:95], a[132:135], v[132:135], v[92:95]
    v_mfma_f32_16x16x32_bf16 v[100:103], a[128:131], v[120:123], 0
    v_mfma_f32_16x16x32_bf16 v[100:103], a[132:135], v[136:139], v[100:103]
    v_mfma_f32_16x16x32_bf16 v[108:111], a[128:131], v[124:127], 0
    v_mfma_f32_16x16x32_bf16 v[108:111], a[132:135], v[140:143], v[108:111]
    ds_read_b64_tr_b16 a[136:137], v45 offset:8192
    ds_read_b64_tr_b16 a[138:139], v45 offset:10240
    ds_read_b64_tr_b16 a[140:141], v45 offset:12288
    ds_read_b64_tr_b16 a[142:143], v45 offset:14336
    s_waitcnt lgkmcnt(0)
    v_mfma_f32_16x16x32_bf16 v[84:87], a[136:139], v[144:147], v[84:87]
    v_mfma_f32_16x16x32_bf16 v[84:87], a[140:143], a[144:147], v[84:87]
    v_mfma_f32_16x16x32_bf16 v[92:95], a[136:139], v[148:151], v[92:95]
    v_mfma_f32_16x16x32_bf16 v[92:95], a[140:143], a[148:151], v[92:95]
    v_mfma_f32_16x16x32_bf16 v[100:103], a[136:139], v[152:155], v[100:103]
    v_mfma_f32_16x16x32_bf16 v[100:103], a[140:143], a[152:155], v[100:103]
    v_mfma_f32_16x16x32_bf16 v[108:111], a[136:139], v[156:159], v[108:111]
    v_mfma_f32_16x16x32_bf16 v[108:111], a[140:143], a[156:159], v[108:111]
    s_nop 0
    ds_read_b64_tr_b16 a[128:129], v5 offset:16384
    ds_read_b64_tr_b16 a[130:131], v5 offset:18432
    ds_read_b64_tr_b16 a[132:133], v5 offset:20480
    ds_read_b64_tr_b16 a[134:135], v5 offset:22528
    ds_read_b64_tr_b16 a[136:137], v5 offset:24576
    ds_read_b64_tr_b16 a[138:139], v5 offset:26624
    s_waitcnt lgkmcnt(0)
    s_nop 7
    s_branch L_ret_4
L_slowqk_4:
    s_xor_b32 s48, s29, s42
    buffer_load_dwordx4 v[48:51], v42, s[12:15], s48 offen offset:0
    buffer_load_dwordx4 v[52:55], v42, s[12:15], s48 offen offset:64
    buffer_load_dwordx4 v[56:59], v42, s[12:15], s48 offen offset:128
    buffer_load_dwordx4 v[60:63], v42, s[12:15], s48 offen offset:192
    buffer_load_dwordx4 v[64:67], v42, s[12:15], s48 offen offset:256
    buffer_load_dwordx4 v[68:71], v42, s[12:15], s48 offen offset:320
    buffer_load_dwordx4 v[72:75], v42, s[12:15], s48 offen offset:384
    buffer_load_dwordx4 v[76:79], v42, s[12:15], s48 offen offset:448
    s_waitcnt vmcnt(0)
    v_mfma_f32_16x16x32_bf16 v[80:83], v[48:51], a[0:3], 0
    v_mfma_f32_16x16x32_bf16 v[88:91], v[48:51], a[32:35], 0
    v_mfma_f32_16x16x32_bf16 v[96:99], v[48:51], a[64:67], 0
    v_mfma_f32_16x16x32_bf16 v[104:107], v[48:51], a[96:99], 0
    v_mfma_f32_16x16x32_bf16 v[80:83], v[52:55], a[4:7], v[80:83]
    v_mfma_f32_16x16x32_bf16 v[88:91], v[52:55], a[36:39], v[88:91]
    v_mfma_f32_16x16x32_bf16 v[96:99], v[52:55], a[68:71], v[96:99]
    v_mfma_f32_16x16x32_bf16 v[104:107], v[52:55], a[100:103], v[104:107]
    v_mfma_f32_16x16x32_bf16 v[80:83], v[56:59], a[8:11], v[80:83]
    v_mfma_f32_16x16x32_bf16 v[88:91], v[56:59], a[40:43], v[88:91]
    v_mfma_f32_16x16x32_bf16 v[96:99], v[56:59], a[72:75], v[96:99]
    v_mfma_f32_16x16x32_bf16 v[104:107], v[56:59], a[104:107], v[104:107]
    v_mfma_f32_16x16x32_bf16 v[80:83], v[60:63], a[12:15], v[80:83]
    v_mfma_f32_16x16x32_bf16 v[88:91], v[60:63], a[44:47], v[88:91]
    v_mfma_f32_16x16x32_bf16 v[96:99], v[60:63], a[76:79], v[96:99]
    v_mfma_f32_16x16x32_bf16 v[104:107], v[60:63], a[108:111], v[104:107]
    v_mfma_f32_16x16x32_bf16 v[80:83], v[64:67], a[16:19], v[80:83]
    v_mfma_f32_16x16x32_bf16 v[88:91], v[64:67], a[48:51], v[88:91]
    v_mfma_f32_16x16x32_bf16 v[96:99], v[64:67], a[80:83], v[96:99]
    v_mfma_f32_16x16x32_bf16 v[104:107], v[64:67], a[112:115], v[104:107]
    v_mfma_f32_16x16x32_bf16 v[80:83], v[68:71], a[20:23], v[80:83]
    v_mfma_f32_16x16x32_bf16 v[88:91], v[68:71], a[52:55], v[88:91]
    v_mfma_f32_16x16x32_bf16 v[96:99], v[68:71], a[84:87], v[96:99]
    v_mfma_f32_16x16x32_bf16 v[104:107], v[68:71], a[116:119], v[104:107]
    v_mfma_f32_16x16x32_bf16 v[80:83], v[72:75], a[24:27], v[80:83]
    v_mfma_f32_16x16x32_bf16 v[88:91], v[72:75], a[56:59], v[88:91]
    v_mfma_f32_16x16x32_bf16 v[96:99], v[72:75], a[88:91], v[96:99]
    v_mfma_f32_16x16x32_bf16 v[104:107], v[72:75], a[120:123], v[104:107]
    v_mfma_f32_16x16x32_bf16 v[80:83], v[76:79], a[28:31], v[80:83]
    v_mfma_f32_16x16x32_bf16 v[88:91], v[76:79], a[60:63], v[88:91]
    v_mfma_f32_16x16x32_bf16 v[96:99], v[76:79], a[92:95], v[96:99]
    v_mfma_f32_16x16x32_bf16 v[104:107], v[76:79], a[124:127], v[104:107]
    s_nop 7
    buffer_load_dwordx4 v[48:51], v42, s[12:15], s48 offen offset:2048
    buffer_load_dwordx4 v[52:55], v42, s[12:15], s48 offen offset:2112
    buffer_load_dwordx4 v[56:59], v42, s[12:15], s48 offen offset:2176
    buffer_load_dwordx4 v[60:63], v42, s[12:15], s48 offen offset:2240
    buffer_load_dwordx4 v[64:67], v42, s[12:15], s48 offen offset:2304
    buffer_load_dwordx4 v[68:71], v42, s[12:15], s48 offen offset:2368
    buffer_load_dwordx4 v[72:75], v42, s[12:15], s48 offen offset:2432
    buffer_load_dwordx4 v[76:79], v42, s[12:15], s48 offen offset:2496
    s_waitcnt vmcnt(0)
    v_mfma_f32_16x16x32_bf16 v[84:87], v[48:51], a[0:3], 0
    v_mfma_f32_16x16x32_bf16 v[92:95], v[48:51], a[32:35], 0
    v_mfma_f32_16x16x32_bf16 v[100:103], v[48:51], a[64:67], 0
    v_mfma_f32_16x16x32_bf16 v[108:111], v[48:51], a[96:99], 0
    v_mfma_f32_16x16x32_bf16 v[84:87], v[52:55], a[4:7], v[84:87]
    v_mfma_f32_16x16x32_bf16 v[92:95], v[52:55], a[36:39], v[92:95]
    v_mfma_f32_16x16x32_bf16 v[100:103], v[52:55], a[68:71], v[100:103]
    v_mfma_f32_16x16x32_bf16 v[108:111], v[52:55], a[100:103], v[108:111]
    v_mfma_f32_16x16x32_bf16 v[84:87], v[56:59], a[8:11], v[84:87]
    v_mfma_f32_16x16x32_bf16 v[92:95], v[56:59], a[40:43], v[92:95]
    v_mfma_f32_16x16x32_bf16 v[100:103], v[56:59], a[72:75], v[100:103]
    v_mfma_f32_16x16x32_bf16 v[108:111], v[56:59], a[104:107], v[108:111]
    v_mfma_f32_16x16x32_bf16 v[84:87], v[60:63], a[12:15], v[84:87]
    v_mfma_f32_16x16x32_bf16 v[92:95], v[60:63], a[44:47], v[92:95]
    v_mfma_f32_16x16x32_bf16 v[100:103], v[60:63], a[76:79], v[100:103]
    v_mfma_f32_16x16x32_bf16 v[108:111], v[60:63], a[108:111], v[108:111]
    v_mfma_f32_16x16x32_bf16 v[84:87], v[64:67], a[16:19], v[84:87]
    v_mfma_f32_16x16x32_bf16 v[92:95], v[64:67], a[48:51], v[92:95]
    v_mfma_f32_16x16x32_bf16 v[100:103], v[64:67], a[80:83], v[100:103]
    v_mfma_f32_16x16x32_bf16 v[108:111], v[64:67], a[112:115], v[108:111]
    v_mfma_f32_16x16x32_bf16 v[84:87], v[68:71], a[20:23], v[84:87]
    v_mfma_f32_16x16x32_bf16 v[92:95], v[68:71], a[52:55], v[92:95]
    v_mfma_f32_16x16x32_bf16 v[100:103], v[68:71], a[84:87], v[100:103]
    v_mfma_f32_16x16x32_bf16 v[108:111], v[68:71], a[116:119], v[108:111]
    v_mfma_f32_16x16x32_bf16 v[84:87], v[72:75], a[24:27], v[84:87]
    v_mfma_f32_16x16x32_bf16 v[92:95], v[72:75], a[56:59], v[92:95]
    v_mfma_f32_16x16x32_bf16 v[100:103], v[72:75], a[88:91], v[100:103]
    v_mfma_f32_16x16x32_bf16 v[108:111], v[72:75], a[120:123], v[108:111]
    v_mfma_f32_16x16x32_bf16 v[84:87], v[76:79], a[28:31], v[84:87]
    v_mfma_f32_16x16x32_bf16 v[92:95], v[76:79], a[60:63], v[92:95]
    v_mfma_f32_16x16x32_bf16 v[100:103], v[76:79], a[92:95], v[100:103]
    v_mfma_f32_16x16x32_bf16 v[108:111], v[76:79], a[124:127], v[108:111]
    s_nop 7
    s_add_u32 s42, s42, 16384
    s_nop 7
    s_setpc_b64 s[68:69]
L_slowsm_4:
    v_fma_f32 v80, v80, s24, -v13
    v_fma_f32 v81, v81, s24, -v13
    v_fma_f32 v82, v82, s24, -v13
    v_fma_f32 v83, v83, s24, -v13
    v_exp_f32 v80, v80
    v_exp_f32 v81, v81
    v_exp_f32 v82, v82
    v_exp_f32 v83, v83
    v_cvt_pk_bf16_f32 v80, v80, v81
    v_cvt_pk_bf16_f32 v81, v82, v83
    v_fma_f32 v84, v84, s24, -v13
    v_fma_f32 v85, v85, s24, -v13
    v_fma_f32 v86, v86, s24, -v13
    v_fma_f32 v87, v87, s24, -v13
    v_exp_f32 v84, v84
    v_exp_f32 v85, v85
    v_exp_f32 v86, v86
    v_exp_f32 v87, v87
    v_cvt_pk_bf16_f32 v82, v84, v85
    v_cvt_pk_bf16_f32 v83, v86, v87
    v_fma_f32 v88, v88, s24, -v14
    v_fma_f32 v89, v89, s24, -v14
    v_fma_f32 v90, v90, s24, -v14
    v_fma_f32 v91, v91, s24, -v14
    v_exp_f32 v88, v88
    v_exp_f32 v89, v89
    v_exp_f32 v90, v90
    v_exp_f32 v91, v91
    v_cvt_pk_bf16_f32 v88, v88, v89
    v_cvt_pk_bf16_f32 v89, v90, v91
    v_fma_f32 v92, v92, s24, -v14
    v_fma_f32 v93, v93, s24, -v14
    v_fma_f32 v94, v94, s24, -v14
    v_fma_f32 v95, v95, s24, -v14
    v_exp_f32 v92, v92
    v_exp_f32 v93, v93
    v_exp_f32 v94, v94
    v_exp_f32 v95, v95
    v_cvt_pk_bf16_f32 v90, v92, v93
    v_cvt_pk_bf16_f32 v91, v94, v95
    v_fma_f32 v96, v96, s24, -v15
    v_fma_f32 v97, v97, s24, -v15
    v_fma_f32 v98, v98, s24, -v15
    v_fma_f32 v99, v99, s24, -v15
    v_exp_f32 v96, v96
    v_exp_f32 v97, v97
    v_exp_f32 v98, v98
    v_exp_f32 v99, v99
    v_cvt_pk_bf16_f32 v96, v96, v97
    v_cvt_pk_bf16_f32 v97, v98, v99
    v_fma_f32 v100, v100, s24, -v15
    v_fma_f32 v101, v101, s24, -v15
    v_fma_f32 v102, v102, s24, -v15
    v_fma_f32 v103, v103, s24, -v15
    v_exp_f32 v100, v100
    v_exp_f32 v101, v101
    v_exp_f32 v102, v102
    v_exp_f32 v103, v103
    v_cvt_pk_bf16_f32 v98, v100, v101
    v_cvt_pk_bf16_f32 v99, v102, v103
    v_fma_f32 v104, v104, s24, -v16
    v_fma_f32 v105, v105, s24, -v16
    v_fma_f32 v106, v106, s24, -v16
    v_fma_f32 v107, v107, s24, -v16
    v_exp_f32 v104, v104
    v_exp_f32 v105, v105
    v_exp_f32 v106, v106
    v_exp_f32 v107, v107
    v_cvt_pk_bf16_f32 v104, v104, v105
    v_cvt_pk_bf16_f32 v105, v106, v107
    v_fma_f32 v108, v108, s24, -v16
    v_fma_f32 v109, v109, s24, -v16
    v_fma_f32 v110, v110, s24, -v16
    v_fma_f32 v111, v111, s24, -v16
    v_exp_f32 v108, v108
    v_exp_f32 v109, v109
    v_exp_f32 v110, v110
    v_exp_f32 v111, v111
    v_cvt_pk_bf16_f32 v106, v108, v109
    v_cvt_pk_bf16_f32 v107, v110, v111
    s_setpc_b64 s[68:69]
L_slow_3:
    s_waitcnt vmcnt(0) lgkmcnt(0)
    s_nop 7
    v_mbcnt_lo_u32_b32 v43, -1, 0
    v_mbcnt_hi_u32_b32 v43, -1, v43
    v_and_b32 v42, 48, v43
    v_and_b32_e64 v44, 6, v43
    v_lshl_add_u32 v42, v44, 11, v42
    v_and_b32_e64 v44, 8, v43
    v_lshl_add_u32 v42, v44, 7, v42
    v_and_b32_e64 v44, 1, v43
    v_lshl_add_u32 v42, v44, 9, v42
    v_mov_b32 v13, 0xff800000
    v_mov_b32 v14, 0xff800000
    v_mov_b32 v15, 0xff800000
    s_mov_b32 s42, 0
    s_mov_b32 s43, 0
L_slow1_3:
    s_call_b64 s[68:69], L_slowqk_3
    s_nop 0
    v_max3_f32 v13, v13, v80, v81
    v_max3_f32 v13, v13, v82, v83
    v_max3_f32 v13, v13, v84, v85
    v_max3_f32 v13, v13, v86, v87
    v_max3_f32 v14, v14, v88, v89
    v_max3_f32 v14, v14, v90, v91
    v_max3_f32 v14, v14, v92, v93
    v_max3_f32 v14, v14, v94, v95
    v_max3_f32 v15, v15, v96, v97
    v_max3_f32 v15, v15, v98, v99
    v_max3_f32 v15, v15, v100, v101
    v_max3_f32 v15, v15, v102, v103
    s_add_u32 s43, s43, 1
    s_cmp_lt_u32 s43, 16
    s_cbranch_scc1 L_slow1_3
    v_mov_b32 v26, v13
    v_mov_b32 v30, v14
    v_mov_b32 v34, v15
    v_permlane32_swap_b32 v13, v26
    v_permlane32_swap_b32 v14, v30
    v_permlane32_swap_b32 v15, v34
    v_max_f32 v13, v13, v26
    v_max_f32 v14, v14, v30
    v_max_f32 v15, v15, v34
    v_mov_b32 v26, v13
    v_mov_b32 v30, v14
    v_mov_b32 v34, v15
    v_permlane16_swap_b32 v13, v26
    v_permlane16_swap_b32 v14, v30
    v_permlane16_swap_b32 v15, v34
    v_max_f32 v13, v13, v26
    v_max_f32 v14, v14, v30
    v_max_f32 v15, v15, v34
    v_mul_f32 v13, s24, v13
    v_mul_f32 v14, s24, v14
    v_mul_f32 v15, s24, v15
    s_mov_b32 s42, 0
    s_call_b64 s[68:69], L_slowqk_3
    s_call_b64 s[68:69], L_slowsm_3
    v_mov_b32 v112, v80
    v_mov_b32 v113, v81
    v_mov_b32 v114, v82
    v_mov_b32 v115, v83
    v_mov_b32 v116, v88
    v_mov_b32 v117, v89
    v_mov_b32 v118, v90
    v_mov_b32_e64 v119, v91
    v_accvgpr_write_b32 a144, v96
    v_accvgpr_write_b32 a145, v97
    v_accvgpr_write_b32 a146, v98
    v_accvgpr_write_b32 a147, v99
    s_nop 1
    v_mfma_f32_16x16x32_bf16 v[26:29], v[22:25], v[112:115], 0
    v_mfma_f32_16x16x32_bf16 v[30:33], v[22:25], v[116:119], 0
    v_mfma_f32_16x16x32_bf16 v[34:37], v[22:25], a[144:147], 0
    s_call_b64 s[68:69], L_slowqk_3
    s_call_b64 s[68:69], L_slowsm_3
    v_mov_b32 v120, v80
    v_mov_b32 v121, v81
    v_mov_b32 v122, v82
    v_mov_b32 v123, v83
    v_mov_b32 v124, v88
    v_mov_b32 v125, v89
    v_mov_b32 v126, v90
    v_mov_b32_e64 v127, v91
    v_accvgpr_write_b32 a148, v96
    v_accvgpr_write_b32 a149, v97
    v_accvgpr_write_b32 a150, v98
    v_accvgpr_write_b32 a151, v99
    s_nop 1
    v_mfma_f32_16x16x32_bf16 v[26:29], v[22:25], v[120:123], v[26:29]
    v_mfma_f32_16x16x32_bf16 v[30:33], v[22:25], v[124:127], v[30:33]
    v_mfma_f32_16x16x32_bf16 v[34:37], v[22:25], a[148:151], v[34:37]
    s_call_b64 s[68:69], L_slowqk_3
    s_call_b64 s[68:69], L_slowsm_3
    v_mov_b32 v128, v80
    v_mov_b32 v129, v81
    v_mov_b32 v130, v82
    v_mov_b32 v131, v83
    v_mov_b32 v132, v88
    v_mov_b32 v133, v89
    v_mov_b32 v134, v90
    v_mov_b32_e64 v135, v91
    v_accvgpr_write_b32 a152, v96
    v_accvgpr_write_b32 a153, v97
    v_accvgpr_write_b32 a154, v98
    v_accvgpr_write_b32 a155, v99
    s_nop 1
    v_mfma_f32_16x16x32_bf16 v[26:29], v[22:25], v[128:131], v[26:29]
    v_mfma_f32_16x16x32_bf16 v[30:33], v[22:25], v[132:135], v[30:33]
    v_mfma_f32_16x16x32_bf16 v[34:37], v[22:25], a[152:155], v[34:37]
    s_call_b64 s[68:69], L_slowqk_3
    s_call_b64 s[68:69], L_slowsm_3
    v_mov_b32 v136, v80
    v_mov_b32 v137, v81
    v_mov_b32 v138, v82
    v_mov_b32 v139, v83
    v_mov_b32 v140, v88
    v_mov_b32 v141, v89
    v_mov_b32 v142, v90
    v_mov_b32_e64 v143, v91
    v_accvgpr_write_b32 a156, v96
    v_accvgpr_write_b32 a157, v97
    v_accvgpr_write_b32 a158, v98
    v_accvgpr_write_b32 a159, v99
    s_nop 1
    v_mfma_f32_16x16x32_bf16 v[26:29], v[22:25], v[136:139], v[26:29]
    v_mfma_f32_16x16x32_bf16 v[30:33], v[22:25], v[140:143], v[30:33]
    v_mfma_f32_16x16x32_bf16 v[34:37], v[22:25], a[156:159], v[34:37]
    s_call_b64 s[68:69], L_slowqk_3
    s_call_b64 s[68:69], L_slowsm_3
    v_mov_b32 v144, v80
    v_mov_b32 v145, v81
    v_mov_b32 v146, v82
    v_mov_b32 v147, v83
    v_mov_b32 v148, v88
    v_mov_b32 v149, v89
    v_mov_b32 v150, v90
    v_mov_b32_e64 v151, v91
    v_accvgpr_write_b32 a160, v96
    v_accvgpr_write_b32 a161, v97
    v_accvgpr_write_b32 a162, v98
    v_accvgpr_write_b32 a163, v99
    s_nop 1
    v_mfma_f32_16x16x32_bf16 v[26:29], v[22:25], v[144:147], v[26:29]
    v_mfma_f32_16x16x32_bf16 v[30:33], v[22:25], v[148:151], v[30:33]
    v_mfma_f32_16x16x32_bf16 v[34:37], v[22:25], a[160:163], v[34:37]
    s_call_b64 s[68:69], L_slowqk_3
    s_call_b64 s[68:69], L_slowsm_3
    v_mov_b32 v152, v80
    v_mov_b32 v153, v81
    v_mov_b32 v154, v82
    v_mov_b32 v155, v83
    v_mov_b32 v156, v88
    v_mov_b32 v157, v89
    v_mov_b32 v158, v90
    v_mov_b32_e64 v159, v91
    v_accvgpr_write_b32 a164, v96
    v_accvgpr_write_b32 a165, v97
    v_accvgpr_write_b32 a166, v98
    v_accvgpr_write_b32 a167, v99
    s_nop 1
    v_mfma_f32_16x16x32_bf16 v[26:29], v[22:25], v[152:155], v[26:29]
    v_mfma_f32_16x16x32_bf16 v[30:33], v[22:25], v[156:159], v[30:33]
    v_mfma_f32_16x16x32_bf16 v[34:37], v[22:25], a[164:167], v[34:37]
    s_call_b64 s[68:69], L_slowqk_3
    s_call_b64 s[68:69], L_slowsm_3
    v_mov_b32 v160, v80
    v_mov_b32 v161, v81
    v_mov_b32 v162, v82
    v_mov_b32 v163, v83
    v_mov_b32 v164, v88
    v_mov_b32 v165, v89
    v_mov_b32 v166, v90
    v_mov_b32_e64 v167, v91
    v_accvgpr_write_b32 a168, v96
    v_accvgpr_write_b32 a169, v97
    v_accvgpr_write_b32 a170, v98
    v_accvgpr_write_b32 a171, v99
    s_nop 1
    v_mfma_f32_16x16x32_bf16 v[26:29], v[22:25], v[160:163], v[26:29]
    v_mfma_f32_16x16x32_bf16 v[30:33], v[22:25], v[164:167], v[30:33]
    v_mfma_f32_16x16x32_bf16 v[34:37], v[22:25], a[168:171], v[34:37]
    s_call_b64 s[68:69], L_slowqk_3
    s_call_b64 s[68:69], L_slowsm_3
    v_mov_b32 v168, v80
    v_mov_b32 v169, v81
    v_mov_b32 v170, v82
    v_mov_b32 v171, v83
    v_mov_b32 v172, v88
    v_mov_b32 v173, v89
    v_mov_b32 v174, v90
    v_mov_b32_e64 v175, v91
    v_accvgpr_write_b32 a172, v96
    v_accvgpr_write_b32 a173, v97
    v_accvgpr_write_b32 a174, v98
    v_accvgpr_write_b32 a175, v99
    s_nop 1
    v_mfma_f32_16x16x32_bf16 v[26:29], v[22:25], v[168:171], v[26:29]
    v_mfma_f32_16x16x32_bf16 v[30:33], v[22:25], v[172:175], v[30:33]
    v_mfma_f32_16x16x32_bf16 v[34:37], v[22:25], a[172:175], v[34:37]
    s_call_b64 s[68:69], L_slowqk_3
    s_call_b64 s[68:69], L_slowsm_3
    v_mov_b32 v176, v80
    v_mov_b32 v177, v81
    v_mov_b32 v178, v82
    v_mov_b32 v179, v83
    v_mov_b32 v180, v88
    v_mov_b32 v181, v89
    v_mov_b32 v182, v90
    v_mov_b32_e64 v183, v91
    v_accvgpr_write_b32 a176, v96
    v_accvgpr_write_b32 a177, v97
    v_accvgpr_write_b32 a178, v98
    v_accvgpr_write_b32 a179, v99
    s_nop 1
    v_mfma_f32_16x16x32_bf16 v[26:29], v[22:25], v[176:179], v[26:29]
    v_mfma_f32_16x16x32_bf16 v[30:33], v[22:25], v[180:183], v[30:33]
    v_mfma_f32_16x16x32_bf16 v[34:37], v[22:25], a[176:179], v[34:37]
    s_call_b64 s[68:69], L_slowqk_3
    s_call_b64 s[68:69], L_slowsm_3
    v_mov_b32 v184, v80
    v_mov_b32 v185, v81
    v_mov_b32 v186, v82
    v_mov_b32 v187, v83
    v_mov_b32 v188, v88
    v_mov_b32 v189, v89
    v_mov_b32 v190, v90
    v_mov_b32_e64 v191, v91
    v_accvgpr_write_b32 a180, v96
    v_accvgpr_write_b32 a181, v97
    v_accvgpr_write_b32 a182, v98
    v_accvgpr_write_b32 a183, v99
    s_nop 1
    v_mfma_f32_16x16x32_bf16 v[26:29], v[22:25], v[184:187], v[26:29]
    v_mfma_f32_16x16x32_bf16 v[30:33], v[22:25], v[188:191], v[30:33]
    v_mfma_f32_16x16x32_bf16 v[34:37], v[22:25], a[180:183], v[34:37]
    s_call_b64 s[68:69], L_slowqk_3
    s_call_b64 s[68:69], L_slowsm_3
    v_mov_b32 v192, v80
    v_mov_b32 v193, v81
    v_mov_b32 v194, v82
    v_mov_b32 v195, v83
    v_mov_b32 v196, v88
    v_mov_b32 v197, v89
    v_mov_b32 v198, v90
    v_mov_b32_e64 v199, v91
    v_accvgpr_write_b32 a184, v96
    v_accvgpr_write_b32 a185, v97
    v_accvgpr_write_b32 a186, v98
    v_accvgpr_write_b32 a187, v99
    s_nop 1
    v_mfma_f32_16x16x32_bf16 v[26:29], v[22:25], v[192:195], v[26:29]
    v_mfma_f32_16x16x32_bf16 v[30:33], v[22:25], v[196:199], v[30:33]
    v_mfma_f32_16x16x32_bf16 v[34:37], v[22:25], a[184:187], v[34:37]
    s_call_b64 s[68:69], L_slowqk_3
    s_call_b64 s[68:69], L_slowsm_3
    v_mov_b32 v200, v80
    v_mov_b32 v201, v81
    v_mov_b32 v202, v82
    v_mov_b32 v203, v83
    v_mov_b32 v204, v88
    v_mov_b32 v205, v89
    v_mov_b32 v206, v90
    v_mov_b32_e64 v207, v91
    v_accvgpr_write_b32 a188, v96
    v_accvgpr_write_b32 a189, v97
    v_accvgpr_write_b32 a190, v98
    v_accvgpr_write_b32 a191, v99
    s_nop 1
    v_mfma_f32_16x16x32_bf16 v[26:29], v[22:25], v[200:203], v[26:29]
    v_mfma_f32_16x16x32_bf16 v[30:33], v[22:25], v[204:207], v[30:33]
    v_mfma_f32_16x16x32_bf16 v[34:37], v[22:25], a[188:191], v[34:37]
    s_call_b64 s[68:69], L_slowqk_3
    s_call_b64 s[68:69], L_slowsm_3
    v_mov_b32 v208, v80
    v_mov_b32 v209, v81
    v_mov_b32 v210, v82
    v_mov_b32 v211, v83
    v_mov_b32 v212, v88
    v_mov_b32 v213, v89
    v_mov_b32 v214, v90
    v_mov_b32_e64 v215, v91
    v_accvgpr_write_b32 a192, v96
    v_accvgpr_write_b32 a193, v97
    v_accvgpr_write_b32 a194, v98
    v_accvgpr_write_b32 a195, v99
    s_nop 1
    v_mfma_f32_16x16x32_bf16 v[26:29], v[22:25], v[208:211], v[26:29]
    v_mfma_f32_16x16x32_bf16 v[30:33], v[22:25], v[212:215], v[30:33]
    v_mfma_f32_16x16x32_bf16 v[34:37], v[22:25], a[192:195], v[34:37]
    s_call_b64 s[68:69], L_slowqk_3
    s_call_b64 s[68:69], L_slowsm_3
    v_mov_b32 v216, v80
    v_mov_b32 v217, v81
    v_mov_b32 v218, v82
    v_mov_b32 v219, v83
    v_mov_b32 v220, v88
    v_mov_b32 v221, v89
    v_mov_b32 v222, v90
    v_mov_b32_e64 v223, v91
    v_accvgpr_write_b32 a196, v96
    v_accvgpr_write_b32 a197, v97
    v_accvgpr_write_b32 a198, v98
    v_accvgpr_write_b32 a199, v99
    s_nop 1
    v_mfma_f32_16x16x32_bf16 v[26:29], v[22:25], v[216:219], v[26:29]
    v_mfma_f32_16x16x32_bf16 v[30:33], v[22:25], v[220:223], v[30:33]
    v_mfma_f32_16x16x32_bf16 v[34:37], v[22:25], a[196:199], v[34:37]
    s_call_b64 s[68:69], L_slowqk_3
    s_call_b64 s[68:69], L_slowsm_3
    v_mov_b32 v224, v80
    v_mov_b32 v225, v81
    v_mov_b32 v226, v82
    v_mov_b32 v227, v83
    v_mov_b32 v228, v88
    v_mov_b32 v229, v89
    v_mov_b32 v230, v90
    v_mov_b32_e64 v231, v91
    v_accvgpr_write_b32 a200, v96
    v_accvgpr_write_b32 a201, v97
    v_accvgpr_write_b32 a202, v98
    v_accvgpr_write_b32 a203, v99
    s_nop 1
    v_mfma_f32_16x16x32_bf16 v[26:29], v[22:25], v[224:227], v[26:29]
    v_mfma_f32_16x16x32_bf16 v[30:33], v[22:25], v[228:231], v[30:33]
    v_mfma_f32_16x16x32_bf16 v[34:37], v[22:25], a[200:203], v[34:37]
    s_call_b64 s[68:69], L_slowqk_3
    s_call_b64 s[68:69], L_slowsm_3
    v_mov_b32 v232, v80
    v_mov_b32 v233, v81
    v_mov_b32 v234, v82
    v_mov_b32 v235, v83
    v_mov_b32 v236, v88
    v_mov_b32 v237, v89
    v_mov_b32 v238, v90
    v_mov_b32_e64 v239, v91
    v_accvgpr_write_b32 a204, v96
    v_accvgpr_write_b32 a205, v97
    v_accvgpr_write_b32 a206, v98
    v_accvgpr_write_b32 a207, v99
    s_nop 1
    v_mfma_f32_16x16x32_bf16 v[26:29], v[22:25], v[232:235], v[26:29]
    v_mfma_f32_16x16x32_bf16 v[30:33], v[22:25], v[236:239], v[30:33]
    v_mfma_f32_16x16x32_bf16 v[34:37], v[22:25], a[204:207], v[34:37]
    ds_read_b64_tr_b16 a[128:129], v5 offset:0
    ds_read_b64_tr_b16 a[130:131], v5 offset:2048
    ds_read_b64_tr_b16 a[132:133], v5 offset:4096
    ds_read_b64_tr_b16 a[134:135], v5 offset:6144
    s_waitcnt lgkmcnt(0)
    v_mfma_f32_16x16x32_bf16 v[64:67], a[128:131], v[112:115], 0
    v_mfma_f32_16x16x32_bf16 v[64:67], a[132:135], v[120:123], v[64:67]
    v_mfma_f32_16x16x32_bf16 v[72:75], a[128:131], v[116:119], 0
    v_mfma_f32_16x16x32_bf16 v[72:75], a[132:135], v[124:127], v[72:75]
    v_mfma_f32_16x16x32_bf16 v[38:41], a[128:131], a[144:147], 0
    v_mfma_f32_16x16x32_bf16 v[38:41], a[132:135], a[148:151], v[38:41]
    ds_read_b64_tr_b16 a[136:137], v5 offset:8192
    ds_read_b64_tr_b16 a[138:139], v5 offset:10240
    ds_read_b64_tr_b16 a[140:141], v5 offset:12288
    ds_read_b64_tr_b16 a[142:143], v5 offset:14336
    s_waitcnt lgkmcnt(0)
    v_mfma_f32_16x16x32_bf16 v[64:67], a[136:139], v[128:131], v[64:67]
    v_mfma_f32_16x16x32_bf16 v[64:67], a[140:143], v[136:139], v[64:67]
    v_mfma_f32_16x16x32_bf16 v[72:75], a[136:139], v[132:135], v[72:75]
    v_mfma_f32_16x16x32_bf16 v[72:75], a[140:143], v[140:143], v[72:75]
    v_mfma_f32_16x16x32_bf16 v[38:41], a[136:139], a[152:155], v[38:41]
    v_mfma_f32_16x16x32_bf16 v[38:41], a[140:143], a[156:159], v[38:41]
    ds_read_b64_tr_b16 a[240:241], v6 offset:0
    ds_read_b64_tr_b16 a[242:243], v6 offset:2048
    ds_read_b64_tr_b16 a[244:245], v6 offset:4096
    ds_read_b64_tr_b16 a[246:247], v6 offset:6144
    s_waitcnt lgkmcnt(0)
    v_mfma_f32_16x16x32_bf16 v[68:71], a[240:243], v[112:115], 0
    v_mfma_f32_16x16x32_bf16 v[68:71], a[244:247], v[120:123], v[68:71]
    v_mfma_f32_16x16x32_bf16 v[76:79], a[240:243], v[116:119], 0
    v_mfma_f32_16x16x32_bf16 v[76:79], a[244:247], v[124:127], v[76:79]
    ds_read_b64_tr_b16 a[248:249], v6 offset:8192
    ds_read_b64_tr_b16 a[250:251], v6 offset:10240
    ds_read_b64_tr_b16 a[252:253], v6 offset:12288
    ds_read_b64_tr_b16 a[254:255], v6 offset:14336
    s_waitcnt lgkmcnt(0)
    v_mfma_f32_16x16x32_bf16 v[68:71], a[248:251], v[128:131], v[68:71]
    v_mfma_f32_16x16x32_bf16 v[68:71], a[252:255], v[136:139], v[68:71]
    v_mfma_f32_16x16x32_bf16 v[76:79], a[248:251], v[132:135], v[76:79]
    v_mfma_f32_16x16x32_bf16 v[76:79], a[252:255], v[140:143], v[76:79]
    ds_read_b64_tr_b16 a[128:129], v21 offset:0
    ds_read_b64_tr_b16 a[130:131], v21 offset:2048
    ds_read_b64_tr_b16 a[132:133], v21 offset:4096
    ds_read_b64_tr_b16 a[134:135], v21 offset:6144
    s_waitcnt lgkmcnt(0)
    v_mfma_f32_16x16x32_bf16 v[96:99], a[128:131], v[112:115], 0
    v_mfma_f32_16x16x32_bf16 v[96:99], a[132:135], v[120:123], v[96:99]
    v_mfma_f32_16x16x32_bf16 v[104:107], a[128:131], v[116:119], 0
    v_mfma_f32_16x16x32_bf16 v[104:107], a[132:135], v[124:127], v[104:107]
    ds_read_b64_tr_b16 a[136:137], v21 offset:8192
    ds_read_b64_tr_b16 a[138:139], v21 offset:10240
    ds_read_b64_tr_b16 a[140:141], v21 offset:12288
    ds_read_b64_tr_b16 a[142:143], v21 offset:14336
    s_waitcnt lgkmcnt(0)
    v_mfma_f32_16x16x32_bf16 v[96:99], a[136:139], v[128:131], v[96:99]
    v_mfma_f32_16x16x32_bf16 v[96:99], a[140:143], v[136:139], v[96:99]
    v_mfma_f32_16x16x32_bf16 v[104:107], a[136:139], v[132:135], v[104:107]
    v_mfma_f32_16x16x32_bf16 v[104:107], a[140:143], v[140:143], v[104:107]
    ds_read_b64_tr_b16 a[240:241], v45 offset:0
    ds_read_b64_tr_b16 a[242:243], v45 offset:2048
    ds_read_b64_tr_b16 a[244:245], v45 offset:4096
    ds_read_b64_tr_b16 a[246:247], v45 offset:6144
    s_waitcnt lgkmcnt(0)
    v_mfma_f32_16x16x32_bf16 v[100:103], a[240:243], v[112:115], 0
    v_mfma_f32_16x16x32_bf16 v[100:103], a[244:247], v[120:123], v[100:103]
    v_mfma_f32_16x16x32_bf16 v[108:111], a[240:243], v[116:119], 0
    v_mfma_f32_16x16x32_bf16 v[108:111], a[244:247], v[124:127], v[108:111]
    ds_read_b64_tr_b16 a[248:249], v45 offset:8192
    ds_read_b64_tr_b16 a[250:251], v45 offset:10240
    ds_read_b64_tr_b16 a[252:253], v45 offset:12288
    ds_read_b64_tr_b16 a[254:255], v45 offset:14336
    s_waitcnt lgkmcnt(0)
    v_mfma_f32_16x16x32_bf16 v[100:103], a[248:251], v[128:131], v[100:103]
    v_mfma_f32_16x16x32_bf16 v[100:103], a[252:255], v[136:139], v[100:103]
    v_mfma_f32_16x16x32_bf16 v[108:111], a[248:251], v[132:135], v[108:111]
    v_mfma_f32_16x16x32_bf16 v[108:111], a[252:255], v[140:143], v[108:111]
    s_nop 0
    ds_read_b64_tr_b16 a[128:129], v5 offset:16384
    ds_read_b64_tr_b16 a[130:131], v5 offset:18432
    ds_read_b64_tr_b16 a[132:133], v5 offset:20480
    ds_read_b64_tr_b16 a[134:135], v5 offset:22528
    ds_read_b64_tr_b16 a[136:137], v5 offset:24576
    ds_read_b64_tr_b16 a[138:139], v5 offset:26624
    s_waitcnt lgkmcnt(0)
    s_nop 7
    s_branch L_ret_3
L_slowqk_3:
    s_xor_b32 s48, s29, s42
    buffer_load_dwordx4 v[48:51], v42, s[12:15], s48 offen offset:0
    buffer_load_dwordx4 v[52:55], v42, s[12:15], s48 offen offset:64
    buffer_load_dwordx4 v[56:59], v42, s[12:15], s48 offen offset:128
    buffer_load_dwordx4 v[60:63], v42, s[12:15], s48 offen offset:192
    buffer_load_dwordx4 v[64:67], v42, s[12:15], s48 offen offset:256
    buffer_load_dwordx4 v[68:71], v42, s[12:15], s48 offen offset:320
    buffer_load_dwordx4 v[72:75], v42, s[12:15], s48 offen offset:384
    buffer_load_dwordx4 v[76:79], v42, s[12:15], s48 offen offset:448
    s_waitcnt vmcnt(0)
    v_mfma_f32_16x16x32_bf16 v[80:83], v[48:51], a[0:3], 0
    v_mfma_f32_16x16x32_bf16 v[88:91], v[48:51], a[32:35], 0
    v_mfma_f32_16x16x32_bf16 v[96:99], v[48:51], a[64:67], 0
    v_mfma_f32_16x16x32_bf16 v[80:83], v[52:55], a[4:7], v[80:83]
    v_mfma_f32_16x16x32_bf16 v[88:91], v[52:55], a[36:39], v[88:91]
    v_mfma_f32_16x16x32_bf16 v[96:99], v[52:55], a[68:71], v[96:99]
    v_mfma_f32_16x16x32_bf16 v[80:83], v[56:59], a[8:11], v[80:83]
    v_mfma_f32_16x16x32_bf16 v[88:91], v[56:59], a[40:43], v[88:91]
    v_mfma_f32_16x16x32_bf16 v[96:99], v[56:59], a[72:75], v[96:99]
    v_mfma_f32_16x16x32_bf16 v[80:83], v[60:63], a[12:15], v[80:83]
    v_mfma_f32_16x16x32_bf16 v[88:91], v[60:63], a[44:47], v[88:91]
    v_mfma_f32_16x16x32_bf16 v[96:99], v[60:63], a[76:79], v[96:99]
    v_mfma_f32_16x16x32_bf16 v[80:83], v[64:67], a[16:19], v[80:83]
    v_mfma_f32_16x16x32_bf16 v[88:91], v[64:67], a[48:51], v[88:91]
    v_mfma_f32_16x16x32_bf16 v[96:99], v[64:67], a[80:83], v[96:99]
    v_mfma_f32_16x16x32_bf16 v[80:83], v[68:71], a[20:23], v[80:83]
    v_mfma_f32_16x16x32_bf16 v[88:91], v[68:71], a[52:55], v[88:91]
    v_mfma_f32_16x16x32_bf16 v[96:99], v[68:71], a[84:87], v[96:99]
    v_mfma_f32_16x16x32_bf16 v[80:83], v[72:75], a[24:27], v[80:83]
    v_mfma_f32_16x16x32_bf16 v[88:91], v[72:75], a[56:59], v[88:91]
    v_mfma_f32_16x16x32_bf16 v[96:99], v[72:75], a[88:91], v[96:99]
    v_mfma_f32_16x16x32_bf16 v[80:83], v[76:79], a[28:31], v[80:83]
    v_mfma_f32_16x16x32_bf16 v[88:91], v[76:79], a[60:63], v[88:91]
    v_mfma_f32_16x16x32_bf16 v[96:99], v[76:79], a[92:95], v[96:99]
    s_nop 7
    buffer_load_dwordx4 v[48:51], v42, s[12:15], s48 offen offset:2048
    buffer_load_dwordx4 v[52:55], v42, s[12:15], s48 offen offset:2112
    buffer_load_dwordx4 v[56:59], v42, s[12:15], s48 offen offset:2176
    buffer_load_dwordx4 v[60:63], v42, s[12:15], s48 offen offset:2240
    buffer_load_dwordx4 v[64:67], v42, s[12:15], s48 offen offset:2304
    buffer_load_dwordx4 v[68:71], v42, s[12:15], s48 offen offset:2368
    buffer_load_dwordx4 v[72:75], v42, s[12:15], s48 offen offset:2432
    buffer_load_dwordx4 v[76:79], v42, s[12:15], s48 offen offset:2496
    s_waitcnt vmcnt(0)
    v_mfma_f32_16x16x32_bf16 v[84:87], v[48:51], a[0:3], 0
    v_mfma_f32_16x16x32_bf16 v[92:95], v[48:51], a[32:35], 0
    v_mfma_f32_16x16x32_bf16 v[100:103], v[48:51], a[64:67], 0
    v_mfma_f32_16x16x32_bf16 v[84:87], v[52:55], a[4:7], v[84:87]
    v_mfma_f32_16x16x32_bf16 v[92:95], v[52:55], a[36:39], v[92:95]
    v_mfma_f32_16x16x32_bf16 v[100:103], v[52:55], a[68:71], v[100:103]
    v_mfma_f32_16x16x32_bf16 v[84:87], v[56:59], a[8:11], v[84:87]
    v_mfma_f32_16x16x32_bf16 v[92:95], v[56:59], a[40:43], v[92:95]
    v_mfma_f32_16x16x32_bf16 v[100:103], v[56:59], a[72:75], v[100:103]
    v_mfma_f32_16x16x32_bf16 v[84:87], v[60:63], a[12:15], v[84:87]
    v_mfma_f32_16x16x32_bf16 v[92:95], v[60:63], a[44:47], v[92:95]
    v_mfma_f32_16x16x32_bf16 v[100:103], v[60:63], a[76:79], v[100:103]
    v_mfma_f32_16x16x32_bf16 v[84:87], v[64:67], a[16:19], v[84:87]
    v_mfma_f32_16x16x32_bf16 v[92:95], v[64:67], a[48:51], v[92:95]
    v_mfma_f32_16x16x32_bf16 v[100:103], v[64:67], a[80:83], v[100:103]
    v_mfma_f32_16x16x32_bf16 v[84:87], v[68:71], a[20:23], v[84:87]
    v_mfma_f32_16x16x32_bf16 v[92:95], v[68:71], a[52:55], v[92:95]
    v_mfma_f32_16x16x32_bf16 v[100:103], v[68:71], a[84:87], v[100:103]
    v_mfma_f32_16x16x32_bf16 v[84:87], v[72:75], a[24:27], v[84:87]
    v_mfma_f32_16x16x32_bf16 v[92:95], v[72:75], a[56:59], v[92:95]
    v_mfma_f32_16x16x32_bf16 v[100:103], v[72:75], a[88:91], v[100:103]
    v_mfma_f32_16x16x32_bf16 v[84:87], v[76:79], a[28:31], v[84:87]
    v_mfma_f32_16x16x32_bf16 v[92:95], v[76:79], a[60:63], v[92:95]
    v_mfma_f32_16x16x32_bf16 v[100:103], v[76:79], a[92:95], v[100:103]
    s_nop 7
    s_add_u32 s42, s42, 16384
    s_nop 7
    s_setpc_b64 s[68:69]
L_slowsm_3:
    v_fma_f32 v80, v80, s24, -v13
    v_fma_f32 v81, v81, s24, -v13
    v_fma_f32 v82, v82, s24, -v13
    v_fma_f32 v83, v83, s24, -v13
    v_exp_f32 v80, v80
    v_exp_f32 v81, v81
    v_exp_f32 v82, v82
    v_exp_f32 v83, v83
    v_cvt_pk_bf16_f32 v80, v80, v81
    v_cvt_pk_bf16_f32 v81, v82, v83
    v_fma_f32 v84, v84, s24, -v13
    v_fma_f32 v85, v85, s24, -v13
    v_fma_f32 v86, v86, s24, -v13
    v_fma_f32 v87, v87, s24, -v13
    v_exp_f32 v84, v84
    v_exp_f32 v85, v85
    v_exp_f32 v86, v86
    v_exp_f32 v87, v87
    v_cvt_pk_bf16_f32 v82, v84, v85
    v_cvt_pk_bf16_f32 v83, v86, v87
    v_fma_f32 v88, v88, s24, -v14
    v_fma_f32 v89, v89, s24, -v14
    v_fma_f32 v90, v90, s24, -v14
    v_fma_f32 v91, v91, s24, -v14
    v_exp_f32 v88, v88
    v_exp_f32 v89, v89
    v_exp_f32 v90, v90
    v_exp_f32 v91, v91
    v_cvt_pk_bf16_f32 v88, v88, v89
    v_cvt_pk_bf16_f32 v89, v90, v91
    v_fma_f32 v92, v92, s24, -v14
    v_fma_f32 v93, v93, s24, -v14
    v_fma_f32 v94, v94, s24, -v14
    v_fma_f32 v95, v95, s24, -v14
    v_exp_f32 v92, v92
    v_exp_f32 v93, v93
    v_exp_f32 v94, v94
    v_exp_f32 v95, v95
    v_cvt_pk_bf16_f32 v90, v92, v93
    v_cvt_pk_bf16_f32 v91, v94, v95
    v_fma_f32 v96, v96, s24, -v15
    v_fma_f32 v97, v97, s24, -v15
    v_fma_f32 v98, v98, s24, -v15
    v_fma_f32 v99, v99, s24, -v15
    v_exp_f32 v96, v96
    v_exp_f32 v97, v97
    v_exp_f32 v98, v98
    v_exp_f32 v99, v99
    v_cvt_pk_bf16_f32 v96, v96, v97
    v_cvt_pk_bf16_f32 v97, v98, v99
    v_fma_f32 v100, v100, s24, -v15
    v_fma_f32 v101, v101, s24, -v15
    v_fma_f32 v102, v102, s24, -v15
    v_fma_f32 v103, v103, s24, -v15
    v_exp_f32 v100, v100
    v_exp_f32 v101, v101
    v_exp_f32 v102, v102
    v_exp_f32 v103, v103
    v_cvt_pk_bf16_f32 v98, v100, v101
    v_cvt_pk_bf16_f32 v99, v102, v103
    s_setpc_b64 s[68:69]
.section .rodata,"a"
.p2align 6
.amdhsa_kernel standalone__mha_softmax__near_ridge_kernel
  .amdhsa_next_free_vgpr 512
  .amdhsa_next_free_sgpr 102
  .amdhsa_accum_offset 256
  .amdhsa_group_segment_fixed_size 0
  .amdhsa_kernarg_size 48
  .amdhsa_user_sgpr_count 2
  .amdhsa_user_sgpr_kernarg_segment_ptr 1
  .amdhsa_system_sgpr_workgroup_id_x 1
.end_amdhsa_kernel
```
